```python
import torch

def _softmax(x, axis=-1):
    return torch.softmax(x, dim=axis)
def _gelu(x):
    return torch.nn.functional.gelu(x, approximate="tanh")
def _silu(x):
    return torch.nn.functional.silu(x)
def _sigmoid(x):
    return torch.sigmoid(x)
def _layernorm(x, axis=-1, eps=1e-5):
    m = x.mean(dim=axis, keepdim=True)
    v = x.var(dim=axis, keepdim=True, unbiased=False)
    return (x - m) / torch.sqrt(v + eps)
def _scatter_add(tgt, idx, src, axis=0):
    return tgt.clone().index_add_(axis, idx, src)
def _segment_sum(src, seg, n):
    out = torch.zeros((n,) + src.shape[1:], dtype=src.dtype)
    return out.index_add_(0, seg, src)
def _pad(x, pw):
    flat = tuple(v for pair in reversed(pw) for v in pair)
    return torch.nn.functional.pad(x, flat)

kernel_name = 'concat_heads__mha_block_cached__gqa_block_cached__near_ridge'

def setup_inputs():

    _w = (lambda a: (lambda t: t.to(torch.bfloat16) if t.is_floating_point() else t)(torch.as_tensor(a)))
    def _A_setup():
        B, Sq, D = 8, 144, 448
        H, Sk, Dh = 16, 512, 256
        return {
            "x": _w((lambda *s: torch.randn(*s, dtype=torch.bfloat16) * 0.8)(B, Sq, D)),
            "k_cache": _w((lambda *s: torch.randn(*s, dtype=torch.bfloat16) * 0.8)(B, H, Sk, Dh)),
            "v_cache": _w((lambda *s: torch.randn(*s, dtype=torch.bfloat16) * 0.05)(B, H, Sk, Dh)),
            "wq": _w((lambda *s: torch.randn(*s, dtype=torch.bfloat16) * 0.8)(D, H * Dh) * (D ** -0.5)),
            "wo": _w((lambda *s: torch.randn(*s, dtype=torch.bfloat16) * 0.05)(H * Dh, D) * ((H * Dh) ** -0.5)),
        }
    _A_in = _A_setup()

    def _B_setup():
        B, Sq, D = 8, 144, 448
        Hq, Hkv, Sk, Dh = 16, 16, 512, 256
        assert Hq % Hkv == 0, (Hq, Hkv)
        return {
            "x": _w((lambda *s: torch.randn(*s, dtype=torch.bfloat16) * 0.8)(B, Sq, D)),
            "k_cache": _w((lambda *s: torch.randn(*s, dtype=torch.bfloat16) * 0.8)(B, Hkv, Sk, Dh)),
            "v_cache": _w((lambda *s: torch.randn(*s, dtype=torch.bfloat16) * 0.05)(B, Hkv, Sk, Dh)),
            "wq": _w((lambda *s: torch.randn(*s, dtype=torch.bfloat16) * 0.8)(D, Hq * Dh) * (D ** -0.5)),
            "wo": _w((lambda *s: torch.randn(*s, dtype=torch.bfloat16) * 0.05)(Hq * Dh, D) * ((Hq * Dh) ** -0.5)),
        }
    _B_in = _B_setup()

    return {
        "A_x": _A_in["x"],
        "A_k_cache": _A_in["k_cache"],
        "A_v_cache": _A_in["v_cache"],
        "A_wq": _A_in["wq"],
        "A_wo": _A_in["wo"],
        "B_x": _B_in["x"],
        "B_k_cache": _B_in["k_cache"],
        "B_v_cache": _B_in["v_cache"],
        "B_wq": _B_in["wq"],
        "B_wo": _B_in["wo"],
    }

def reference(A_x, A_k_cache, A_v_cache, A_wq, A_wo, B_x, B_k_cache, B_v_cache, B_wq, B_wo):
    def _A_ref(x, k_cache, v_cache, wq, wo):
        B, Sq, D = x.shape
        H, Dh = 16, 256
        q = (lambda x, *d: x.permute(*d))((x @ wq).reshape(B, Sq, H, Dh), 0, 2, 1, 3)
        scores = torch.einsum("bhqd,bhkd->bhqk", q, k_cache) * (Dh ** -0.5)
        p = _softmax(scores, axis=-1)
        o = torch.einsum("bhqk,bhkd->bhqd", p, v_cache)
        return (lambda x, *d: x.permute(*d))(o, 0, 2, 1, 3).reshape(B, Sq, H * Dh) @ wo

    def _B_ref(x, k_cache, v_cache, wq, wo):
        B, Sq, D = x.shape
        Hq, Dh = 16, 256
        Hkv = k_cache.shape[1]
        rep = Hq // Hkv
        q = (lambda x, *d: x.permute(*d))((x @ wq).reshape(B, Sq, Hq, Dh), 0, 2, 1, 3)
        k = (lambda x, n, axis: torch.repeat_interleave(x, n, dim=axis))(k_cache, rep, axis=1)
        v = (lambda x, n, axis: torch.repeat_interleave(x, n, dim=axis))(v_cache, rep, axis=1)
        scores = torch.einsum("bhqd,bhkd->bhqk", q, k) * (Dh ** -0.5)
        p = _softmax(scores, axis=-1)
        o = torch.einsum("bhqk,bhkd->bhqd", p, v)
        return (lambda x, *d: x.permute(*d))(o, 0, 2, 1, 3).reshape(B, Sq, Hq * Dh) @ wo

    a = _A_ref(A_x, A_k_cache, A_v_cache, A_wq, A_wo)
    b = _B_ref(B_x, B_k_cache, B_v_cache, B_wq, B_wo)
    return torch.concatenate([a, b], axis=-1)
```

```asm
; @launch kernel=attn_kernel grid=(256,1,1) block=(256,1,1) lds=163840
; @launch kernel=oproj_kernel grid=(252,1,1) block=(512,1,1) lds=163840
.amdgcn_target "amdgcn-amd-amdhsa--gfx950"
.text
.globl attn_kernel
.p2align 8
.type attn_kernel,@function
attn_kernel:
  s_cmp_ge_u32 s2, 256
  s_cbranch_scc1 L_k1_end
  s_load_dwordx8 s[32:39], s[0:1], 0
  s_load_dwordx8 s[40:47], s[0:1], 40
  s_load_dwordx2 s[48:49], s[0:1], 96
  s_load_dwordx2 s[56:57], s[0:1], 32
  s_load_dwordx2 s[58:59], s[0:1], 72
  s_lshr_b32 s28, s2, 7
  s_lshr_b32 s29, s2, 4
  s_and_b32 s29, s29, 7
  s_and_b32 s30, s2, 15
  v_lshrrev_b32 v1, 6, v0
  s_nop 0
  v_readfirstlane_b32 s3, v1
  v_and_b32 v1, 63, v0
  s_waitcnt lgkmcnt(0)
  s_cmp_eq_u32 s28, 0
  s_cselect_b32 s32, s32, s40
  s_cselect_b32 s33, s33, s41
  s_cselect_b32 s34, s34, s42
  s_cselect_b32 s35, s35, s43
  s_cselect_b32 s36, s36, s44
  s_cselect_b32 s37, s37, s45
  s_cselect_b32 s38, s38, s46
  s_cselect_b32 s39, s39, s47
  s_mul_i32 s4, s29, 129024
  s_add_u32 s8, s32, s4
  s_addc_u32 s9, s33, 0
  s_and_b32 s9, s9, 0xffff
  s_mov_b32 s10, 129024
  s_mov_b32 s11, 0x00020000
  s_lshl_b32 s4, s30, 9
  s_add_u32 s12, s38, s4
  s_addc_u32 s13, s39, 0
  s_and_b32 s13, s13, 0xffff
  s_sub_u32 s14, 3670016, s4
  s_mov_b32 s15, 0x00020000
  s_lshl_b32 s4, s29, 4
  s_add_u32 s4, s4, s30
  s_lshr_b32 s5, s4, 14
  s_lshl_b32 s4, s4, 18
  s_add_u32 s16, s34, s4
  s_addc_u32 s17, s35, s5
  s_and_b32 s17, s17, 0xffff
  s_mov_b32 s18, 262144
  s_mov_b32 s19, 0x00020000
  s_add_u32 s20, s36, s4
  s_addc_u32 s21, s37, s5
  s_and_b32 s21, s21, 0xffff
  s_mov_b32 s22, 262144
  s_mov_b32 s23, 0x00020000
  s_mov_b32 s24, s48
  s_and_b32 s25, s49, 0xffff
  s_mov_b32 s26, 18874368
  s_mov_b32 s27, 0x00020000
  s_mov_b32 s51, 0x3db8aa3b
  s_mov_b32 s52, 0x41000000
  s_cmp_eq_u32 s3, 3
  s_cbranch_scc1 L_loader
  v_and_b32 v6, 15, v1
  v_lshrrev_b32 v7, 4, v1
  v_and_b32 v9, 7, v6
  v_lshlrev_b32 v9, 1, v9
  v_xor_b32 v9, v9, v7
  v_lshlrev_b32 v9, 4, v9
  v_lshl_add_u32 v2, v6, 9, v9
  v_lshrrev_b32 v8, 2, v1
  v_and_b32 v9, 7, v8
  v_lshlrev_b32 v9, 1, v9
  v_bfe_u32 v6, v1, 1, 1
  v_xor_b32 v6, v6, v9
  v_lshlrev_b32 v6, 4, v6
  v_lshl_add_u32 v3, v8, 9, v6
  v_and_b32 v6, 1, v1
  v_lshl_add_u32 v3, v6, 3, v3
  v_and_b32 v6, 3, v1
  v_xor_b32 v6, v6, v9
  v_lshlrev_b32 v6, 4, v6
  v_lshl_add_u32 v4, v8, 9, v6
  s_mul_i32 s6, s3, 3
  s_lshl_b32 s50, s6, 10
  s_lshl_b32 s6, s6, 1
  v_lshrrev_b32 v8, 5, v1
  v_add_u32 v8, s6, v8
  v_and_b32 v9, 31, v1
  v_add_u32 v6, 0, v8
  v_and_b32 v7, 7, v6
  v_lshlrev_b32 v7, 1, v7
  v_xor_b32 v7, v7, v9
  v_lshlrev_b32 v7, 4, v7
  v_lshl_add_u32 v248, v6, 9, v7
  v_lshl_add_u32 v251, v6, 13, v7
  v_add_u32 v6, 2, v8
  v_and_b32 v7, 7, v6
  v_lshlrev_b32 v7, 1, v7
  v_xor_b32 v7, v7, v9
  v_lshlrev_b32 v7, 4, v7
  v_lshl_add_u32 v249, v6, 9, v7
  v_lshl_add_u32 v252, v6, 13, v7
  v_add_u32 v6, 4, v8
  v_and_b32 v7, 7, v6
  v_lshlrev_b32 v7, 1, v7
  v_xor_b32 v7, v7, v9
  v_lshlrev_b32 v7, 4, v7
  v_lshl_add_u32 v250, v6, 9, v7
  v_lshl_add_u32 v253, v6, 13, v7
  v_lshlrev_b32 v28, 4, v1
  s_mul_i32 s5, s3, 904
  s_mul_i32 s6, s3, 896
  s_mov_b32 exec_lo, -1
  s_mov_b32 exec_hi, 0x00ffffff
  s_add_u32 m0, s5, 32768
  s_add_u32 s53, s6, 0
  buffer_load_dwordx4 v28, s[8:11], s53 offen lds
  s_add_u32 m0, s5, 36384
  s_add_u32 s53, s6, 3584
  buffer_load_dwordx4 v28, s[8:11], s53 offen lds
  s_add_u32 m0, s5, 40000
  s_add_u32 s53, s6, 7168
  buffer_load_dwordx4 v28, s[8:11], s53 offen lds
  s_add_u32 m0, s5, 43616
  s_add_u32 s53, s6, 10752
  buffer_load_dwordx4 v28, s[8:11], s53 offen lds
  s_add_u32 m0, s5, 47232
  s_add_u32 s53, s6, 14336
  buffer_load_dwordx4 v28, s[8:11], s53 offen lds
  s_add_u32 m0, s5, 50848
  s_add_u32 s53, s6, 17920
  buffer_load_dwordx4 v28, s[8:11], s53 offen lds
  s_add_u32 m0, s5, 54464
  s_add_u32 s53, s6, 21504
  buffer_load_dwordx4 v28, s[8:11], s53 offen lds
  s_add_u32 m0, s5, 58080
  s_add_u32 s53, s6, 25088
  buffer_load_dwordx4 v28, s[8:11], s53 offen lds
  s_add_u32 m0, s5, 61696
  s_add_u32 s53, s6, 28672
  buffer_load_dwordx4 v28, s[8:11], s53 offen lds
  s_add_u32 m0, s5, 65312
  s_add_u32 s53, s6, 32256
  buffer_load_dwordx4 v28, s[8:11], s53 offen lds
  s_add_u32 m0, s5, 68928
  s_add_u32 s53, s6, 35840
  buffer_load_dwordx4 v28, s[8:11], s53 offen lds
  s_add_u32 m0, s5, 72544
  s_add_u32 s53, s6, 39424
  buffer_load_dwordx4 v28, s[8:11], s53 offen lds
  s_add_u32 m0, s5, 76160
  s_add_u32 s53, s6, 43008
  buffer_load_dwordx4 v28, s[8:11], s53 offen lds
  s_add_u32 m0, s5, 79776
  s_add_u32 s53, s6, 46592
  buffer_load_dwordx4 v28, s[8:11], s53 offen lds
  s_add_u32 m0, s5, 83392
  s_add_u32 s53, s6, 50176
  buffer_load_dwordx4 v28, s[8:11], s53 offen lds
  s_add_u32 m0, s5, 87008
  s_add_u32 s53, s6, 53760
  buffer_load_dwordx4 v28, s[8:11], s53 offen lds
  s_add_u32 m0, s5, 90624
  s_add_u32 s53, s6, 57344
  buffer_load_dwordx4 v28, s[8:11], s53 offen lds
  s_add_u32 m0, s5, 94240
  s_add_u32 s53, s6, 60928
  buffer_load_dwordx4 v28, s[8:11], s53 offen lds
  s_add_u32 m0, s5, 97856
  s_add_u32 s53, s6, 64512
  buffer_load_dwordx4 v28, s[8:11], s53 offen lds
  s_add_u32 m0, s5, 101472
  s_add_u32 s53, s6, 68096
  buffer_load_dwordx4 v28, s[8:11], s53 offen lds
  s_add_u32 m0, s5, 105088
  s_add_u32 s53, s6, 71680
  buffer_load_dwordx4 v28, s[8:11], s53 offen lds
  s_add_u32 m0, s5, 108704
  s_add_u32 s53, s6, 75264
  buffer_load_dwordx4 v28, s[8:11], s53 offen lds
  s_add_u32 m0, s5, 112320
  s_add_u32 s53, s6, 78848
  buffer_load_dwordx4 v28, s[8:11], s53 offen lds
  s_add_u32 m0, s5, 115936
  s_add_u32 s53, s6, 82432
  buffer_load_dwordx4 v28, s[8:11], s53 offen lds
  s_add_u32 m0, s5, 119552
  s_add_u32 s53, s6, 86016
  buffer_load_dwordx4 v28, s[8:11], s53 offen lds
  s_add_u32 m0, s5, 123168
  s_add_u32 s53, s6, 89600
  buffer_load_dwordx4 v28, s[8:11], s53 offen lds
  s_add_u32 m0, s5, 126784
  s_add_u32 s53, s6, 93184
  buffer_load_dwordx4 v28, s[8:11], s53 offen lds
  s_add_u32 m0, s5, 130400
  s_add_u32 s53, s6, 96768
  buffer_load_dwordx4 v28, s[8:11], s53 offen lds
  s_add_u32 m0, s5, 134016
  s_add_u32 s53, s6, 100352
  buffer_load_dwordx4 v28, s[8:11], s53 offen lds
  s_add_u32 m0, s5, 137632
  s_add_u32 s53, s6, 103936
  buffer_load_dwordx4 v28, s[8:11], s53 offen lds
  s_add_u32 m0, s5, 141248
  s_add_u32 s53, s6, 107520
  buffer_load_dwordx4 v28, s[8:11], s53 offen lds
  s_add_u32 m0, s5, 144864
  s_add_u32 s53, s6, 111104
  buffer_load_dwordx4 v28, s[8:11], s53 offen lds
  s_add_u32 m0, s5, 148480
  s_add_u32 s53, s6, 114688
  buffer_load_dwordx4 v28, s[8:11], s53 offen lds
  s_add_u32 m0, s5, 152096
  s_add_u32 s53, s6, 118272
  buffer_load_dwordx4 v28, s[8:11], s53 offen lds
  s_add_u32 m0, s5, 155712
  s_add_u32 s53, s6, 121856
  buffer_load_dwordx4 v28, s[8:11], s53 offen lds
  s_add_u32 m0, s5, 159328
  s_add_u32 s53, s6, 125440
  buffer_load_dwordx4 v28, s[8:11], s53 offen lds
  s_mov_b64 exec, -1
  s_add_u32 m0, s50, 0
  s_mov_b32 s53, 0
  buffer_load_dwordx4 v251, s[12:15], s53 offen nt lds
  s_add_u32 m0, s50, 1024
  s_mov_b32 s53, 0
  buffer_load_dwordx4 v252, s[12:15], s53 offen nt lds
  s_add_u32 m0, s50, 2048
  s_mov_b32 s53, 0
  buffer_load_dwordx4 v253, s[12:15], s53 offen nt lds
  s_add_u32 m0, s50, 16384
  s_mov_b32 s53, 262144
  buffer_load_dwordx4 v251, s[12:15], s53 offen nt lds
  s_add_u32 m0, s50, 17408
  s_mov_b32 s53, 262144
  buffer_load_dwordx4 v252, s[12:15], s53 offen nt lds
  s_add_u32 m0, s50, 18432
  s_mov_b32 s53, 262144
  buffer_load_dwordx4 v253, s[12:15], s53 offen nt lds
  s_waitcnt vmcnt(6)
  s_barrier
  v_and_b32 v6, 15, v1
  v_lshrrev_b32 v7, 4, v1
  s_mul_i32 s5, s3, 48
  v_add_u32 v8, s5, v6
  v_mul_u32_u24 v8, 904, v8
  v_lshl_add_u32 v8, v7, 3, v8
  v_add_u32 v8, 32768, v8
  ds_read_b64 v[32:33], v8 offset:0
  ds_read_b64 v[34:35], v8 offset:32
  ds_read_b64 v[36:37], v8 offset:64
  ds_read_b64 v[38:39], v8 offset:96
  ds_read_b64 v[40:41], v8 offset:128
  ds_read_b64 v[42:43], v8 offset:160
  ds_read_b64 v[44:45], v8 offset:192
  ds_read_b64 v[46:47], v8 offset:224
  ds_read_b64 v[48:49], v8 offset:256
  ds_read_b64 v[50:51], v8 offset:288
  ds_read_b64 v[52:53], v8 offset:320
  ds_read_b64 v[54:55], v8 offset:352
  ds_read_b64 v[56:57], v8 offset:384
  ds_read_b64 v[58:59], v8 offset:416
  s_waitcnt lgkmcnt(6)
  ds_read_b64 v[60:61], v8 offset:448
  ds_read_b64 v[62:63], v8 offset:480
  ds_read_b64 v[64:65], v8 offset:512
  ds_read_b64 v[66:67], v8 offset:544
  ds_read_b64 v[68:69], v8 offset:576
  ds_read_b64 v[70:71], v8 offset:608
  ds_read_b64 v[72:73], v8 offset:640
  ds_read_b64 v[74:75], v8 offset:672
  ds_read_b64 v[76:77], v8 offset:704
  ds_read_b64 v[78:79], v8 offset:736
  ds_read_b64 v[80:81], v8 offset:768
  ds_read_b64 v[82:83], v8 offset:800
  ds_read_b64 v[84:85], v8 offset:832
  ds_read_b64 v[86:87], v8 offset:864
  s_waitcnt lgkmcnt(6)
  ds_read_b64 v[88:89], v8 offset:14464
  ds_read_b64 v[90:91], v8 offset:14496
  ds_read_b64 v[92:93], v8 offset:14528
  ds_read_b64 v[94:95], v8 offset:14560
  ds_read_b64 v[96:97], v8 offset:14592
  ds_read_b64 v[98:99], v8 offset:14624
  ds_read_b64 v[100:101], v8 offset:14656
  ds_read_b64 v[102:103], v8 offset:14688
  ds_read_b64 v[104:105], v8 offset:14720
  ds_read_b64 v[106:107], v8 offset:14752
  ds_read_b64 v[108:109], v8 offset:14784
  ds_read_b64 v[110:111], v8 offset:14816
  ds_read_b64 v[112:113], v8 offset:14848
  ds_read_b64 v[114:115], v8 offset:14880
  s_waitcnt lgkmcnt(6)
  ds_read_b64 v[116:117], v8 offset:14912
  ds_read_b64 v[118:119], v8 offset:14944
  ds_read_b64 v[120:121], v8 offset:14976
  ds_read_b64 v[122:123], v8 offset:15008
  ds_read_b64 v[124:125], v8 offset:15040
  ds_read_b64 v[126:127], v8 offset:15072
  ds_read_b64 v[128:129], v8 offset:15104
  ds_read_b64 v[130:131], v8 offset:15136
  ds_read_b64 v[132:133], v8 offset:15168
  ds_read_b64 v[134:135], v8 offset:15200
  ds_read_b64 v[136:137], v8 offset:15232
  ds_read_b64 v[138:139], v8 offset:15264
  ds_read_b64 v[140:141], v8 offset:15296
  ds_read_b64 v[142:143], v8 offset:15328
  s_waitcnt lgkmcnt(6)
  ds_read_b64 v[144:145], v8 offset:28928
  ds_read_b64 v[146:147], v8 offset:28960
  ds_read_b64 v[148:149], v8 offset:28992
  ds_read_b64 v[150:151], v8 offset:29024
  ds_read_b64 v[152:153], v8 offset:29056
  ds_read_b64 v[154:155], v8 offset:29088
  ds_read_b64 v[156:157], v8 offset:29120
  ds_read_b64 v[158:159], v8 offset:29152
  ds_read_b64 v[160:161], v8 offset:29184
  ds_read_b64 v[162:163], v8 offset:29216
  ds_read_b64 v[164:165], v8 offset:29248
  ds_read_b64 v[166:167], v8 offset:29280
  ds_read_b64 v[168:169], v8 offset:29312
  ds_read_b64 v[170:171], v8 offset:29344
  s_waitcnt lgkmcnt(6)
  ds_read_b64 v[172:173], v8 offset:29376
  ds_read_b64 v[174:175], v8 offset:29408
  ds_read_b64 v[176:177], v8 offset:29440
  ds_read_b64 v[178:179], v8 offset:29472
  ds_read_b64 v[180:181], v8 offset:29504
  ds_read_b64 v[182:183], v8 offset:29536
  ds_read_b64 v[184:185], v8 offset:29568
  ds_read_b64 v[186:187], v8 offset:29600
  ds_read_b64 v[188:189], v8 offset:29632
  ds_read_b64 v[190:191], v8 offset:29664
  ds_read_b64 v[192:193], v8 offset:29696
  ds_read_b64 v[194:195], v8 offset:29728
  ds_read_b64 v[196:197], v8 offset:29760
  ds_read_b64 v[198:199], v8 offset:29792
  s_waitcnt lgkmcnt(6)
  s_waitcnt lgkmcnt(0)
  s_barrier
  s_add_u32 m0, s50, 32768
  s_mov_b32 s53, 524288
  buffer_load_dwordx4 v251, s[12:15], s53 offen nt lds
  s_add_u32 m0, s50, 33792
  s_mov_b32 s53, 524288
  buffer_load_dwordx4 v252, s[12:15], s53 offen nt lds
  s_add_u32 m0, s50, 34816
  s_mov_b32 s53, 524288
  buffer_load_dwordx4 v253, s[12:15], s53 offen nt lds
  s_add_u32 m0, s50, 49152
  s_mov_b32 s53, 786432
  buffer_load_dwordx4 v251, s[12:15], s53 offen nt lds
  s_add_u32 m0, s50, 50176
  s_mov_b32 s53, 786432
  buffer_load_dwordx4 v252, s[12:15], s53 offen nt lds
  s_add_u32 m0, s50, 51200
  s_mov_b32 s53, 786432
  buffer_load_dwordx4 v253, s[12:15], s53 offen nt lds
  s_add_u32 m0, s50, 65536
  s_mov_b32 s53, 1048576
  buffer_load_dwordx4 v251, s[12:15], s53 offen nt lds
  s_add_u32 m0, s50, 66560
  s_mov_b32 s53, 1048576
  buffer_load_dwordx4 v252, s[12:15], s53 offen nt lds
  s_add_u32 m0, s50, 67584
  s_mov_b32 s53, 1048576
  buffer_load_dwordx4 v253, s[12:15], s53 offen nt lds
  s_add_u32 m0, s50, 81920
  s_mov_b32 s53, 1310720
  buffer_load_dwordx4 v251, s[12:15], s53 offen nt lds
  s_add_u32 m0, s50, 82944
  s_mov_b32 s53, 1310720
  buffer_load_dwordx4 v252, s[12:15], s53 offen nt lds
  s_add_u32 m0, s50, 83968
  s_mov_b32 s53, 1310720
  buffer_load_dwordx4 v253, s[12:15], s53 offen nt lds
  s_add_u32 m0, s50, 98304
  s_mov_b32 s53, 1572864
  buffer_load_dwordx4 v251, s[12:15], s53 offen nt lds
  s_add_u32 m0, s50, 99328
  s_mov_b32 s53, 1572864
  buffer_load_dwordx4 v252, s[12:15], s53 offen nt lds
  s_add_u32 m0, s50, 100352
  s_mov_b32 s53, 1572864
  buffer_load_dwordx4 v253, s[12:15], s53 offen nt lds
  s_add_u32 m0, s50, 114688
  s_mov_b32 s53, 1835008
  buffer_load_dwordx4 v251, s[12:15], s53 offen nt lds
  s_add_u32 m0, s50, 115712
  s_mov_b32 s53, 1835008
  buffer_load_dwordx4 v252, s[12:15], s53 offen nt lds
  s_add_u32 m0, s50, 116736
  s_mov_b32 s53, 1835008
  buffer_load_dwordx4 v253, s[12:15], s53 offen nt lds
  s_waitcnt vmcnt(21)
  s_barrier
  s_add_u32 m0, s50, 131072
  s_mov_b32 s53, 2097152
  buffer_load_dwordx4 v251, s[12:15], s53 offen nt lds
  s_add_u32 m0, s50, 132096
  s_mov_b32 s53, 2097152
  buffer_load_dwordx4 v252, s[12:15], s53 offen nt lds
  s_add_u32 m0, s50, 133120
  s_mov_b32 s53, 2097152
  buffer_load_dwordx4 v253, s[12:15], s53 offen nt lds
  v_add_u32 v5, 0, v4
  v_xor_b32 v7, 0, v5
  ds_read_b64_tr_b16 a[192:193], v7 offset:0
  ds_read_b64_tr_b16 a[194:195], v7 offset:8192
  ds_read_b64_tr_b16 a[196:197], v7 offset:8
  ds_read_b64_tr_b16 a[198:199], v7 offset:8200
  v_xor_b32 v8, 64, v5
  ds_read_b64_tr_b16 a[200:201], v8 offset:0
  ds_read_b64_tr_b16 a[202:203], v8 offset:8192
  ds_read_b64_tr_b16 a[204:205], v8 offset:8
  ds_read_b64_tr_b16 a[206:207], v8 offset:8200
  v_xor_b32 v9, 128, v5
  ds_read_b64_tr_b16 a[208:209], v9 offset:0
  ds_read_b64_tr_b16 a[210:211], v9 offset:8192
  ds_read_b64_tr_b16 a[212:213], v9 offset:8
  ds_read_b64_tr_b16 a[214:215], v9 offset:8200
  v_xor_b32 v6, 192, v5
  ds_read_b64_tr_b16 a[216:217], v6 offset:0
  ds_read_b64_tr_b16 a[218:219], v6 offset:8192
  s_waitcnt lgkmcnt(12)
  v_mfma_f32_16x16x32_bf16 a[0:3], a[192:195], v[32:35], 0
  v_mfma_f32_16x16x32_bf16 a[64:67], a[192:195], v[88:91], 0
  ds_read_b64_tr_b16 a[220:221], v6 offset:8
  v_mfma_f32_16x16x32_bf16 a[128:131], a[192:195], v[144:147], 0
  ds_read_b64_tr_b16 a[222:223], v6 offset:8200
  s_waitcnt lgkmcnt(12)
  v_mfma_f32_16x16x32_bf16 a[4:7], a[196:199], v[32:35], 0
  v_xor_b32 v7, 0, v5
  v_mfma_f32_16x16x32_bf16 a[68:71], a[196:199], v[88:91], 0
  ds_read_b64_tr_b16 a[192:193], v7 offset:256
  v_mfma_f32_16x16x32_bf16 a[132:135], a[196:199], v[144:147], 0
  ds_read_b64_tr_b16 a[194:195], v7 offset:8448
  s_waitcnt lgkmcnt(12)
  v_mfma_f32_16x16x32_bf16 a[8:11], a[200:203], v[32:35], 0
  v_mfma_f32_16x16x32_bf16 a[72:75], a[200:203], v[88:91], 0
  ds_read_b64_tr_b16 a[196:197], v7 offset:264
  v_mfma_f32_16x16x32_bf16 a[136:139], a[200:203], v[144:147], 0
  ds_read_b64_tr_b16 a[198:199], v7 offset:8456
  s_waitcnt lgkmcnt(12)
  v_mfma_f32_16x16x32_bf16 a[12:15], a[204:207], v[32:35], 0
  v_xor_b32 v8, 64, v5
  v_mfma_f32_16x16x32_bf16 a[76:79], a[204:207], v[88:91], 0
  ds_read_b64_tr_b16 a[200:201], v8 offset:256
  v_mfma_f32_16x16x32_bf16 a[140:143], a[204:207], v[144:147], 0
  ds_read_b64_tr_b16 a[202:203], v8 offset:8448
  s_waitcnt lgkmcnt(12)
  v_mfma_f32_16x16x32_bf16 a[16:19], a[208:211], v[32:35], 0
  v_mfma_f32_16x16x32_bf16 a[80:83], a[208:211], v[88:91], 0
  ds_read_b64_tr_b16 a[204:205], v8 offset:264
  v_mfma_f32_16x16x32_bf16 a[144:147], a[208:211], v[144:147], 0
  ds_read_b64_tr_b16 a[206:207], v8 offset:8456
  s_waitcnt lgkmcnt(12)
  v_mfma_f32_16x16x32_bf16 a[20:23], a[212:215], v[32:35], 0
  v_xor_b32 v9, 128, v5
  v_mfma_f32_16x16x32_bf16 a[84:87], a[212:215], v[88:91], 0
  ds_read_b64_tr_b16 a[208:209], v9 offset:256
  v_mfma_f32_16x16x32_bf16 a[148:151], a[212:215], v[144:147], 0
  ds_read_b64_tr_b16 a[210:211], v9 offset:8448
  s_waitcnt lgkmcnt(12)
  v_mfma_f32_16x16x32_bf16 a[24:27], a[216:219], v[32:35], 0
  v_mfma_f32_16x16x32_bf16 a[88:91], a[216:219], v[88:91], 0
  ds_read_b64_tr_b16 a[212:213], v9 offset:264
  v_mfma_f32_16x16x32_bf16 a[152:155], a[216:219], v[144:147], 0
  ds_read_b64_tr_b16 a[214:215], v9 offset:8456
  s_waitcnt lgkmcnt(12)
  v_mfma_f32_16x16x32_bf16 a[28:31], a[220:223], v[32:35], 0
  v_xor_b32 v6, 192, v5
  v_mfma_f32_16x16x32_bf16 a[92:95], a[220:223], v[88:91], 0
  ds_read_b64_tr_b16 a[216:217], v6 offset:256
  v_mfma_f32_16x16x32_bf16 a[156:159], a[220:223], v[144:147], 0
  ds_read_b64_tr_b16 a[218:219], v6 offset:8448
  s_waitcnt lgkmcnt(12)
  v_mfma_f32_16x16x32_bf16 a[32:35], a[192:195], v[32:35], 0
  v_mfma_f32_16x16x32_bf16 a[96:99], a[192:195], v[88:91], 0
  ds_read_b64_tr_b16 a[220:221], v6 offset:264
  v_mfma_f32_16x16x32_bf16 a[160:163], a[192:195], v[144:147], 0
  ds_read_b64_tr_b16 a[222:223], v6 offset:8456
  s_waitcnt lgkmcnt(12)
  v_mfma_f32_16x16x32_bf16 a[36:39], a[196:199], v[32:35], 0
  s_waitcnt vmcnt(21)
  s_barrier
  s_add_u32 m0, s50, 147456
  s_mov_b32 s53, 2359296
  buffer_load_dwordx4 v251, s[12:15], s53 offen nt lds
  v_mfma_f32_16x16x32_bf16 a[100:103], a[196:199], v[88:91], 0
  s_add_u32 m0, s50, 148480
  s_mov_b32 s53, 2359296
  buffer_load_dwordx4 v252, s[12:15], s53 offen nt lds
  s_add_u32 m0, s50, 149504
  s_mov_b32 s53, 2359296
  v_mfma_f32_16x16x32_bf16 a[164:167], a[196:199], v[144:147], 0
  buffer_load_dwordx4 v253, s[12:15], s53 offen nt lds
  v_add_u32 v5, 16384, v4
  v_xor_b32 v7, 0, v5
  ds_read_b64_tr_b16 a[192:193], v7 offset:0
  ds_read_b64_tr_b16 a[194:195], v7 offset:8192
  s_waitcnt lgkmcnt(12)
  v_mfma_f32_16x16x32_bf16 a[40:43], a[200:203], v[32:35], 0
  v_mfma_f32_16x16x32_bf16 a[104:107], a[200:203], v[88:91], 0
  ds_read_b64_tr_b16 a[196:197], v7 offset:8
  v_mfma_f32_16x16x32_bf16 a[168:171], a[200:203], v[144:147], 0
  ds_read_b64_tr_b16 a[198:199], v7 offset:8200
  s_waitcnt lgkmcnt(12)
  v_mfma_f32_16x16x32_bf16 a[44:47], a[204:207], v[32:35], 0
  v_xor_b32 v8, 64, v5
  v_mfma_f32_16x16x32_bf16 a[108:111], a[204:207], v[88:91], 0
  ds_read_b64_tr_b16 a[200:201], v8 offset:0
  v_mfma_f32_16x16x32_bf16 a[172:175], a[204:207], v[144:147], 0
  ds_read_b64_tr_b16 a[202:203], v8 offset:8192
  s_waitcnt lgkmcnt(12)
  v_mfma_f32_16x16x32_bf16 a[48:51], a[208:211], v[32:35], 0
  v_mfma_f32_16x16x32_bf16 a[112:115], a[208:211], v[88:91], 0
  ds_read_b64_tr_b16 a[204:205], v8 offset:8
  v_mfma_f32_16x16x32_bf16 a[176:179], a[208:211], v[144:147], 0
  ds_read_b64_tr_b16 a[206:207], v8 offset:8200
  s_waitcnt lgkmcnt(12)
  v_mfma_f32_16x16x32_bf16 a[52:55], a[212:215], v[32:35], 0
  v_xor_b32 v9, 128, v5
  v_mfma_f32_16x16x32_bf16 a[116:119], a[212:215], v[88:91], 0
  ds_read_b64_tr_b16 a[208:209], v9 offset:0
  v_mfma_f32_16x16x32_bf16 a[180:183], a[212:215], v[144:147], 0
  ds_read_b64_tr_b16 a[210:211], v9 offset:8192
  s_waitcnt lgkmcnt(12)
  v_mfma_f32_16x16x32_bf16 a[56:59], a[216:219], v[32:35], 0
  v_mfma_f32_16x16x32_bf16 a[120:123], a[216:219], v[88:91], 0
  ds_read_b64_tr_b16 a[212:213], v9 offset:8
  v_mfma_f32_16x16x32_bf16 a[184:187], a[216:219], v[144:147], 0
  ds_read_b64_tr_b16 a[214:215], v9 offset:8200
  s_waitcnt lgkmcnt(12)
  v_mfma_f32_16x16x32_bf16 a[60:63], a[220:223], v[32:35], 0
  v_xor_b32 v6, 192, v5
  v_mfma_f32_16x16x32_bf16 a[124:127], a[220:223], v[88:91], 0
  ds_read_b64_tr_b16 a[216:217], v6 offset:0
  v_mfma_f32_16x16x32_bf16 a[188:191], a[220:223], v[144:147], 0
  ds_read_b64_tr_b16 a[218:219], v6 offset:8192
  s_waitcnt lgkmcnt(12)
  v_mfma_f32_16x16x32_bf16 a[0:3], a[192:195], v[36:39], a[0:3]
  v_mfma_f32_16x16x32_bf16 a[64:67], a[192:195], v[92:95], a[64:67]
  ds_read_b64_tr_b16 a[220:221], v6 offset:8
  v_mfma_f32_16x16x32_bf16 a[128:131], a[192:195], v[148:151], a[128:131]
  ds_read_b64_tr_b16 a[222:223], v6 offset:8200
  s_waitcnt lgkmcnt(12)
  v_mfma_f32_16x16x32_bf16 a[4:7], a[196:199], v[36:39], a[4:7]
  v_xor_b32 v7, 0, v5
  v_mfma_f32_16x16x32_bf16 a[68:71], a[196:199], v[92:95], a[68:71]
  ds_read_b64_tr_b16 a[192:193], v7 offset:256
  v_mfma_f32_16x16x32_bf16 a[132:135], a[196:199], v[148:151], a[132:135]
  ds_read_b64_tr_b16 a[194:195], v7 offset:8448
  s_waitcnt lgkmcnt(12)
  v_mfma_f32_16x16x32_bf16 a[8:11], a[200:203], v[36:39], a[8:11]
  v_mfma_f32_16x16x32_bf16 a[72:75], a[200:203], v[92:95], a[72:75]
  ds_read_b64_tr_b16 a[196:197], v7 offset:264
  v_mfma_f32_16x16x32_bf16 a[136:139], a[200:203], v[148:151], a[136:139]
  ds_read_b64_tr_b16 a[198:199], v7 offset:8456
  s_waitcnt lgkmcnt(12)
  v_mfma_f32_16x16x32_bf16 a[12:15], a[204:207], v[36:39], a[12:15]
  v_xor_b32 v8, 64, v5
  v_mfma_f32_16x16x32_bf16 a[76:79], a[204:207], v[92:95], a[76:79]
  ds_read_b64_tr_b16 a[200:201], v8 offset:256
  v_mfma_f32_16x16x32_bf16 a[140:143], a[204:207], v[148:151], a[140:143]
  ds_read_b64_tr_b16 a[202:203], v8 offset:8448
  s_waitcnt lgkmcnt(12)
  v_mfma_f32_16x16x32_bf16 a[16:19], a[208:211], v[36:39], a[16:19]
  v_mfma_f32_16x16x32_bf16 a[80:83], a[208:211], v[92:95], a[80:83]
  ds_read_b64_tr_b16 a[204:205], v8 offset:264
  v_mfma_f32_16x16x32_bf16 a[144:147], a[208:211], v[148:151], a[144:147]
  ds_read_b64_tr_b16 a[206:207], v8 offset:8456
  s_waitcnt lgkmcnt(12)
  v_mfma_f32_16x16x32_bf16 a[20:23], a[212:215], v[36:39], a[20:23]
  v_xor_b32 v9, 128, v5
  v_mfma_f32_16x16x32_bf16 a[84:87], a[212:215], v[92:95], a[84:87]
  ds_read_b64_tr_b16 a[208:209], v9 offset:256
  v_mfma_f32_16x16x32_bf16 a[148:151], a[212:215], v[148:151], a[148:151]
  ds_read_b64_tr_b16 a[210:211], v9 offset:8448
  s_waitcnt lgkmcnt(12)
  v_mfma_f32_16x16x32_bf16 a[24:27], a[216:219], v[36:39], a[24:27]
  v_mfma_f32_16x16x32_bf16 a[88:91], a[216:219], v[92:95], a[88:91]
  ds_read_b64_tr_b16 a[212:213], v9 offset:264
  v_mfma_f32_16x16x32_bf16 a[152:155], a[216:219], v[148:151], a[152:155]
  ds_read_b64_tr_b16 a[214:215], v9 offset:8456
  s_waitcnt lgkmcnt(12)
  v_mfma_f32_16x16x32_bf16 a[28:31], a[220:223], v[36:39], a[28:31]
  v_xor_b32 v6, 192, v5
  v_mfma_f32_16x16x32_bf16 a[92:95], a[220:223], v[92:95], a[92:95]
  ds_read_b64_tr_b16 a[216:217], v6 offset:256
  v_mfma_f32_16x16x32_bf16 a[156:159], a[220:223], v[148:151], a[156:159]
  ds_read_b64_tr_b16 a[218:219], v6 offset:8448
  s_waitcnt lgkmcnt(12)
  v_mfma_f32_16x16x32_bf16 a[32:35], a[192:195], v[36:39], a[32:35]
  v_mfma_f32_16x16x32_bf16 a[96:99], a[192:195], v[92:95], a[96:99]
  ds_read_b64_tr_b16 a[220:221], v6 offset:264
  v_mfma_f32_16x16x32_bf16 a[160:163], a[192:195], v[148:151], a[160:163]
  ds_read_b64_tr_b16 a[222:223], v6 offset:8456
  s_waitcnt lgkmcnt(12)
  v_mfma_f32_16x16x32_bf16 a[36:39], a[196:199], v[36:39], a[36:39]
  s_waitcnt vmcnt(21)
  s_barrier
  s_add_u32 m0, s50, 0
  s_mov_b32 s53, 2621440
  buffer_load_dwordx4 v251, s[12:15], s53 offen nt lds
  v_mfma_f32_16x16x32_bf16 a[100:103], a[196:199], v[92:95], a[100:103]
  s_add_u32 m0, s50, 1024
  s_mov_b32 s53, 2621440
  buffer_load_dwordx4 v252, s[12:15], s53 offen nt lds
  s_add_u32 m0, s50, 2048
  s_mov_b32 s53, 2621440
  v_mfma_f32_16x16x32_bf16 a[164:167], a[196:199], v[148:151], a[164:167]
  buffer_load_dwordx4 v253, s[12:15], s53 offen nt lds
  v_add_u32 v5, 32768, v4
  v_xor_b32 v7, 0, v5
  ds_read_b64_tr_b16 a[192:193], v7 offset:0
  ds_read_b64_tr_b16 a[194:195], v7 offset:8192
  s_waitcnt lgkmcnt(12)
  v_mfma_f32_16x16x32_bf16 a[40:43], a[200:203], v[36:39], a[40:43]
  v_mfma_f32_16x16x32_bf16 a[104:107], a[200:203], v[92:95], a[104:107]
  ds_read_b64_tr_b16 a[196:197], v7 offset:8
  v_mfma_f32_16x16x32_bf16 a[168:171], a[200:203], v[148:151], a[168:171]
  ds_read_b64_tr_b16 a[198:199], v7 offset:8200
  s_waitcnt lgkmcnt(12)
  v_mfma_f32_16x16x32_bf16 a[44:47], a[204:207], v[36:39], a[44:47]
  v_xor_b32 v8, 64, v5
  v_mfma_f32_16x16x32_bf16 a[108:111], a[204:207], v[92:95], a[108:111]
  ds_read_b64_tr_b16 a[200:201], v8 offset:0
  v_mfma_f32_16x16x32_bf16 a[172:175], a[204:207], v[148:151], a[172:175]
  ds_read_b64_tr_b16 a[202:203], v8 offset:8192
  s_waitcnt lgkmcnt(12)
  v_mfma_f32_16x16x32_bf16 a[48:51], a[208:211], v[36:39], a[48:51]
  v_mfma_f32_16x16x32_bf16 a[112:115], a[208:211], v[92:95], a[112:115]
  ds_read_b64_tr_b16 a[204:205], v8 offset:8
  v_mfma_f32_16x16x32_bf16 a[176:179], a[208:211], v[148:151], a[176:179]
  ds_read_b64_tr_b16 a[206:207], v8 offset:8200
  s_waitcnt lgkmcnt(12)
  v_mfma_f32_16x16x32_bf16 a[52:55], a[212:215], v[36:39], a[52:55]
  v_xor_b32 v9, 128, v5
  v_mfma_f32_16x16x32_bf16 a[116:119], a[212:215], v[92:95], a[116:119]
  ds_read_b64_tr_b16 a[208:209], v9 offset:0
  v_mfma_f32_16x16x32_bf16 a[180:183], a[212:215], v[148:151], a[180:183]
  ds_read_b64_tr_b16 a[210:211], v9 offset:8192
  s_waitcnt lgkmcnt(12)
  v_mfma_f32_16x16x32_bf16 a[56:59], a[216:219], v[36:39], a[56:59]
  v_mfma_f32_16x16x32_bf16 a[120:123], a[216:219], v[92:95], a[120:123]
  ds_read_b64_tr_b16 a[212:213], v9 offset:8
  v_mfma_f32_16x16x32_bf16 a[184:187], a[216:219], v[148:151], a[184:187]
  ds_read_b64_tr_b16 a[214:215], v9 offset:8200
  s_waitcnt lgkmcnt(12)
  v_mfma_f32_16x16x32_bf16 a[60:63], a[220:223], v[36:39], a[60:63]
  v_xor_b32 v6, 192, v5
  v_mfma_f32_16x16x32_bf16 a[124:127], a[220:223], v[92:95], a[124:127]
  ds_read_b64_tr_b16 a[216:217], v6 offset:0
  v_mfma_f32_16x16x32_bf16 a[188:191], a[220:223], v[148:151], a[188:191]
  ds_read_b64_tr_b16 a[218:219], v6 offset:8192
  s_waitcnt lgkmcnt(12)
  v_mfma_f32_16x16x32_bf16 a[0:3], a[192:195], v[40:43], a[0:3]
  v_mfma_f32_16x16x32_bf16 a[64:67], a[192:195], v[96:99], a[64:67]
  ds_read_b64_tr_b16 a[220:221], v6 offset:8
  v_mfma_f32_16x16x32_bf16 a[128:131], a[192:195], v[152:155], a[128:131]
  ds_read_b64_tr_b16 a[222:223], v6 offset:8200
  s_waitcnt lgkmcnt(12)
  v_mfma_f32_16x16x32_bf16 a[4:7], a[196:199], v[40:43], a[4:7]
  v_xor_b32 v7, 0, v5
  v_mfma_f32_16x16x32_bf16 a[68:71], a[196:199], v[96:99], a[68:71]
  ds_read_b64_tr_b16 a[192:193], v7 offset:256
  v_mfma_f32_16x16x32_bf16 a[132:135], a[196:199], v[152:155], a[132:135]
  ds_read_b64_tr_b16 a[194:195], v7 offset:8448
  s_waitcnt lgkmcnt(12)
  v_mfma_f32_16x16x32_bf16 a[8:11], a[200:203], v[40:43], a[8:11]
  v_mfma_f32_16x16x32_bf16 a[72:75], a[200:203], v[96:99], a[72:75]
  ds_read_b64_tr_b16 a[196:197], v7 offset:264
  v_mfma_f32_16x16x32_bf16 a[136:139], a[200:203], v[152:155], a[136:139]
  ds_read_b64_tr_b16 a[198:199], v7 offset:8456
  s_waitcnt lgkmcnt(12)
  v_mfma_f32_16x16x32_bf16 a[12:15], a[204:207], v[40:43], a[12:15]
  v_xor_b32 v8, 64, v5
  v_mfma_f32_16x16x32_bf16 a[76:79], a[204:207], v[96:99], a[76:79]
  ds_read_b64_tr_b16 a[200:201], v8 offset:256
  v_mfma_f32_16x16x32_bf16 a[140:143], a[204:207], v[152:155], a[140:143]
  ds_read_b64_tr_b16 a[202:203], v8 offset:8448
  s_waitcnt lgkmcnt(12)
  v_mfma_f32_16x16x32_bf16 a[16:19], a[208:211], v[40:43], a[16:19]
  v_mfma_f32_16x16x32_bf16 a[80:83], a[208:211], v[96:99], a[80:83]
  ds_read_b64_tr_b16 a[204:205], v8 offset:264
  v_mfma_f32_16x16x32_bf16 a[144:147], a[208:211], v[152:155], a[144:147]
  ds_read_b64_tr_b16 a[206:207], v8 offset:8456
  s_waitcnt lgkmcnt(12)
  v_mfma_f32_16x16x32_bf16 a[20:23], a[212:215], v[40:43], a[20:23]
  v_xor_b32 v9, 128, v5
  v_mfma_f32_16x16x32_bf16 a[84:87], a[212:215], v[96:99], a[84:87]
  ds_read_b64_tr_b16 a[208:209], v9 offset:256
  v_mfma_f32_16x16x32_bf16 a[148:151], a[212:215], v[152:155], a[148:151]
  ds_read_b64_tr_b16 a[210:211], v9 offset:8448
  s_waitcnt lgkmcnt(12)
  v_mfma_f32_16x16x32_bf16 a[24:27], a[216:219], v[40:43], a[24:27]
  v_mfma_f32_16x16x32_bf16 a[88:91], a[216:219], v[96:99], a[88:91]
  ds_read_b64_tr_b16 a[212:213], v9 offset:264
  v_mfma_f32_16x16x32_bf16 a[152:155], a[216:219], v[152:155], a[152:155]
  ds_read_b64_tr_b16 a[214:215], v9 offset:8456
  s_waitcnt lgkmcnt(12)
  v_mfma_f32_16x16x32_bf16 a[28:31], a[220:223], v[40:43], a[28:31]
  v_xor_b32 v6, 192, v5
  v_mfma_f32_16x16x32_bf16 a[92:95], a[220:223], v[96:99], a[92:95]
  ds_read_b64_tr_b16 a[216:217], v6 offset:256
  v_mfma_f32_16x16x32_bf16 a[156:159], a[220:223], v[152:155], a[156:159]
  ds_read_b64_tr_b16 a[218:219], v6 offset:8448
  s_waitcnt lgkmcnt(12)
  v_mfma_f32_16x16x32_bf16 a[32:35], a[192:195], v[40:43], a[32:35]
  v_mfma_f32_16x16x32_bf16 a[96:99], a[192:195], v[96:99], a[96:99]
  ds_read_b64_tr_b16 a[220:221], v6 offset:264
  v_mfma_f32_16x16x32_bf16 a[160:163], a[192:195], v[152:155], a[160:163]
  ds_read_b64_tr_b16 a[222:223], v6 offset:8456
  s_waitcnt lgkmcnt(12)
  v_mfma_f32_16x16x32_bf16 a[36:39], a[196:199], v[40:43], a[36:39]
  s_waitcnt vmcnt(21)
  s_barrier
  s_add_u32 m0, s50, 16384
  s_mov_b32 s53, 2883584
  buffer_load_dwordx4 v251, s[12:15], s53 offen nt lds
  v_mfma_f32_16x16x32_bf16 a[100:103], a[196:199], v[96:99], a[100:103]
  s_add_u32 m0, s50, 17408
  s_mov_b32 s53, 2883584
  buffer_load_dwordx4 v252, s[12:15], s53 offen nt lds
  s_add_u32 m0, s50, 18432
  s_mov_b32 s53, 2883584
  v_mfma_f32_16x16x32_bf16 a[164:167], a[196:199], v[152:155], a[164:167]
  buffer_load_dwordx4 v253, s[12:15], s53 offen nt lds
  v_add_u32 v5, 49152, v4
  v_xor_b32 v7, 0, v5
  ds_read_b64_tr_b16 a[192:193], v7 offset:0
  ds_read_b64_tr_b16 a[194:195], v7 offset:8192
  s_waitcnt lgkmcnt(12)
  v_mfma_f32_16x16x32_bf16 a[40:43], a[200:203], v[40:43], a[40:43]
  v_mfma_f32_16x16x32_bf16 a[104:107], a[200:203], v[96:99], a[104:107]
  ds_read_b64_tr_b16 a[196:197], v7 offset:8
  v_mfma_f32_16x16x32_bf16 a[168:171], a[200:203], v[152:155], a[168:171]
  ds_read_b64_tr_b16 a[198:199], v7 offset:8200
  s_waitcnt lgkmcnt(12)
  v_mfma_f32_16x16x32_bf16 a[44:47], a[204:207], v[40:43], a[44:47]
  v_xor_b32 v8, 64, v5
  v_mfma_f32_16x16x32_bf16 a[108:111], a[204:207], v[96:99], a[108:111]
  ds_read_b64_tr_b16 a[200:201], v8 offset:0
  v_mfma_f32_16x16x32_bf16 a[172:175], a[204:207], v[152:155], a[172:175]
  ds_read_b64_tr_b16 a[202:203], v8 offset:8192
  s_waitcnt lgkmcnt(12)
  v_mfma_f32_16x16x32_bf16 a[48:51], a[208:211], v[40:43], a[48:51]
  v_mfma_f32_16x16x32_bf16 a[112:115], a[208:211], v[96:99], a[112:115]
  ds_read_b64_tr_b16 a[204:205], v8 offset:8
  v_mfma_f32_16x16x32_bf16 a[176:179], a[208:211], v[152:155], a[176:179]
  ds_read_b64_tr_b16 a[206:207], v8 offset:8200
  s_waitcnt lgkmcnt(12)
  v_mfma_f32_16x16x32_bf16 a[52:55], a[212:215], v[40:43], a[52:55]
  v_xor_b32 v9, 128, v5
  v_mfma_f32_16x16x32_bf16 a[116:119], a[212:215], v[96:99], a[116:119]
  ds_read_b64_tr_b16 a[208:209], v9 offset:0
  v_mfma_f32_16x16x32_bf16 a[180:183], a[212:215], v[152:155], a[180:183]
  ds_read_b64_tr_b16 a[210:211], v9 offset:8192
  s_waitcnt lgkmcnt(12)
  v_mfma_f32_16x16x32_bf16 a[56:59], a[216:219], v[40:43], a[56:59]
  v_mfma_f32_16x16x32_bf16 a[120:123], a[216:219], v[96:99], a[120:123]
  ds_read_b64_tr_b16 a[212:213], v9 offset:8
  v_mfma_f32_16x16x32_bf16 a[184:187], a[216:219], v[152:155], a[184:187]
  ds_read_b64_tr_b16 a[214:215], v9 offset:8200
  s_waitcnt lgkmcnt(12)
  v_mfma_f32_16x16x32_bf16 a[60:63], a[220:223], v[40:43], a[60:63]
  v_xor_b32 v6, 192, v5
  v_mfma_f32_16x16x32_bf16 a[124:127], a[220:223], v[96:99], a[124:127]
  ds_read_b64_tr_b16 a[216:217], v6 offset:0
  v_mfma_f32_16x16x32_bf16 a[188:191], a[220:223], v[152:155], a[188:191]
  ds_read_b64_tr_b16 a[218:219], v6 offset:8192
  s_waitcnt lgkmcnt(12)
  v_mfma_f32_16x16x32_bf16 a[0:3], a[192:195], v[44:47], a[0:3]
  v_mfma_f32_16x16x32_bf16 a[64:67], a[192:195], v[100:103], a[64:67]
  ds_read_b64_tr_b16 a[220:221], v6 offset:8
  v_mfma_f32_16x16x32_bf16 a[128:131], a[192:195], v[156:159], a[128:131]
  ds_read_b64_tr_b16 a[222:223], v6 offset:8200
  s_waitcnt lgkmcnt(12)
  v_mfma_f32_16x16x32_bf16 a[4:7], a[196:199], v[44:47], a[4:7]
  v_xor_b32 v7, 0, v5
  v_mfma_f32_16x16x32_bf16 a[68:71], a[196:199], v[100:103], a[68:71]
  ds_read_b64_tr_b16 a[192:193], v7 offset:256
  v_mfma_f32_16x16x32_bf16 a[132:135], a[196:199], v[156:159], a[132:135]
  ds_read_b64_tr_b16 a[194:195], v7 offset:8448
  s_waitcnt lgkmcnt(12)
  v_mfma_f32_16x16x32_bf16 a[8:11], a[200:203], v[44:47], a[8:11]
  v_mfma_f32_16x16x32_bf16 a[72:75], a[200:203], v[100:103], a[72:75]
  ds_read_b64_tr_b16 a[196:197], v7 offset:264
  v_mfma_f32_16x16x32_bf16 a[136:139], a[200:203], v[156:159], a[136:139]
  ds_read_b64_tr_b16 a[198:199], v7 offset:8456
  s_waitcnt lgkmcnt(12)
  v_mfma_f32_16x16x32_bf16 a[12:15], a[204:207], v[44:47], a[12:15]
  v_xor_b32 v8, 64, v5
  v_mfma_f32_16x16x32_bf16 a[76:79], a[204:207], v[100:103], a[76:79]
  ds_read_b64_tr_b16 a[200:201], v8 offset:256
  v_mfma_f32_16x16x32_bf16 a[140:143], a[204:207], v[156:159], a[140:143]
  ds_read_b64_tr_b16 a[202:203], v8 offset:8448
  s_waitcnt lgkmcnt(12)
  v_mfma_f32_16x16x32_bf16 a[16:19], a[208:211], v[44:47], a[16:19]
  v_mfma_f32_16x16x32_bf16 a[80:83], a[208:211], v[100:103], a[80:83]
  ds_read_b64_tr_b16 a[204:205], v8 offset:264
  v_mfma_f32_16x16x32_bf16 a[144:147], a[208:211], v[156:159], a[144:147]
  ds_read_b64_tr_b16 a[206:207], v8 offset:8456
  s_waitcnt lgkmcnt(12)
  v_mfma_f32_16x16x32_bf16 a[20:23], a[212:215], v[44:47], a[20:23]
  v_xor_b32 v9, 128, v5
  v_mfma_f32_16x16x32_bf16 a[84:87], a[212:215], v[100:103], a[84:87]
  ds_read_b64_tr_b16 a[208:209], v9 offset:256
  v_mfma_f32_16x16x32_bf16 a[148:151], a[212:215], v[156:159], a[148:151]
  ds_read_b64_tr_b16 a[210:211], v9 offset:8448
  s_waitcnt lgkmcnt(12)
  v_mfma_f32_16x16x32_bf16 a[24:27], a[216:219], v[44:47], a[24:27]
  v_mfma_f32_16x16x32_bf16 a[88:91], a[216:219], v[100:103], a[88:91]
  ds_read_b64_tr_b16 a[212:213], v9 offset:264
  v_mfma_f32_16x16x32_bf16 a[152:155], a[216:219], v[156:159], a[152:155]
  ds_read_b64_tr_b16 a[214:215], v9 offset:8456
  s_waitcnt lgkmcnt(12)
  v_mfma_f32_16x16x32_bf16 a[28:31], a[220:223], v[44:47], a[28:31]
  v_xor_b32 v6, 192, v5
  v_mfma_f32_16x16x32_bf16 a[92:95], a[220:223], v[100:103], a[92:95]
  ds_read_b64_tr_b16 a[216:217], v6 offset:256
  v_mfma_f32_16x16x32_bf16 a[156:159], a[220:223], v[156:159], a[156:159]
  ds_read_b64_tr_b16 a[218:219], v6 offset:8448
  s_waitcnt lgkmcnt(12)
  v_mfma_f32_16x16x32_bf16 a[32:35], a[192:195], v[44:47], a[32:35]
  v_mfma_f32_16x16x32_bf16 a[96:99], a[192:195], v[100:103], a[96:99]
  ds_read_b64_tr_b16 a[220:221], v6 offset:264
  v_mfma_f32_16x16x32_bf16 a[160:163], a[192:195], v[156:159], a[160:163]
  ds_read_b64_tr_b16 a[222:223], v6 offset:8456
  s_waitcnt lgkmcnt(12)
  v_mfma_f32_16x16x32_bf16 a[36:39], a[196:199], v[44:47], a[36:39]
  s_waitcnt vmcnt(21)
  s_barrier
  s_add_u32 m0, s50, 32768
  s_mov_b32 s53, 3145728
  buffer_load_dwordx4 v251, s[12:15], s53 offen nt lds
  v_mfma_f32_16x16x32_bf16 a[100:103], a[196:199], v[100:103], a[100:103]
  s_add_u32 m0, s50, 33792
  s_mov_b32 s53, 3145728
  buffer_load_dwordx4 v252, s[12:15], s53 offen nt lds
  s_add_u32 m0, s50, 34816
  s_mov_b32 s53, 3145728
  v_mfma_f32_16x16x32_bf16 a[164:167], a[196:199], v[156:159], a[164:167]
  buffer_load_dwordx4 v253, s[12:15], s53 offen nt lds
  v_add_u32 v5, 65536, v4
  v_xor_b32 v7, 0, v5
  ds_read_b64_tr_b16 a[192:193], v7 offset:0
  ds_read_b64_tr_b16 a[194:195], v7 offset:8192
  s_waitcnt lgkmcnt(12)
  v_mfma_f32_16x16x32_bf16 a[40:43], a[200:203], v[44:47], a[40:43]
  v_mfma_f32_16x16x32_bf16 a[104:107], a[200:203], v[100:103], a[104:107]
  ds_read_b64_tr_b16 a[196:197], v7 offset:8
  v_mfma_f32_16x16x32_bf16 a[168:171], a[200:203], v[156:159], a[168:171]
  ds_read_b64_tr_b16 a[198:199], v7 offset:8200
  s_waitcnt lgkmcnt(12)
  v_mfma_f32_16x16x32_bf16 a[44:47], a[204:207], v[44:47], a[44:47]
  v_xor_b32 v8, 64, v5
  v_mfma_f32_16x16x32_bf16 a[108:111], a[204:207], v[100:103], a[108:111]
  ds_read_b64_tr_b16 a[200:201], v8 offset:0
  v_mfma_f32_16x16x32_bf16 a[172:175], a[204:207], v[156:159], a[172:175]
  ds_read_b64_tr_b16 a[202:203], v8 offset:8192
  s_waitcnt lgkmcnt(12)
  v_mfma_f32_16x16x32_bf16 a[48:51], a[208:211], v[44:47], a[48:51]
  v_mfma_f32_16x16x32_bf16 a[112:115], a[208:211], v[100:103], a[112:115]
  ds_read_b64_tr_b16 a[204:205], v8 offset:8
  v_mfma_f32_16x16x32_bf16 a[176:179], a[208:211], v[156:159], a[176:179]
  ds_read_b64_tr_b16 a[206:207], v8 offset:8200
  s_waitcnt lgkmcnt(12)
  v_mfma_f32_16x16x32_bf16 a[52:55], a[212:215], v[44:47], a[52:55]
  v_xor_b32 v9, 128, v5
  v_mfma_f32_16x16x32_bf16 a[116:119], a[212:215], v[100:103], a[116:119]
  ds_read_b64_tr_b16 a[208:209], v9 offset:0
  v_mfma_f32_16x16x32_bf16 a[180:183], a[212:215], v[156:159], a[180:183]
  ds_read_b64_tr_b16 a[210:211], v9 offset:8192
  s_waitcnt lgkmcnt(12)
  v_mfma_f32_16x16x32_bf16 a[56:59], a[216:219], v[44:47], a[56:59]
  v_mfma_f32_16x16x32_bf16 a[120:123], a[216:219], v[100:103], a[120:123]
  ds_read_b64_tr_b16 a[212:213], v9 offset:8
  v_mfma_f32_16x16x32_bf16 a[184:187], a[216:219], v[156:159], a[184:187]
  ds_read_b64_tr_b16 a[214:215], v9 offset:8200
  s_waitcnt lgkmcnt(12)
  v_mfma_f32_16x16x32_bf16 a[60:63], a[220:223], v[44:47], a[60:63]
  v_xor_b32 v6, 192, v5
  v_mfma_f32_16x16x32_bf16 a[124:127], a[220:223], v[100:103], a[124:127]
  ds_read_b64_tr_b16 a[216:217], v6 offset:0
  v_mfma_f32_16x16x32_bf16 a[188:191], a[220:223], v[156:159], a[188:191]
  ds_read_b64_tr_b16 a[218:219], v6 offset:8192
  s_waitcnt lgkmcnt(12)
  v_mfma_f32_16x16x32_bf16 a[0:3], a[192:195], v[48:51], a[0:3]
  v_mfma_f32_16x16x32_bf16 a[64:67], a[192:195], v[104:107], a[64:67]
  ds_read_b64_tr_b16 a[220:221], v6 offset:8
  v_mfma_f32_16x16x32_bf16 a[128:131], a[192:195], v[160:163], a[128:131]
  ds_read_b64_tr_b16 a[222:223], v6 offset:8200
  s_waitcnt lgkmcnt(12)
  v_mfma_f32_16x16x32_bf16 a[4:7], a[196:199], v[48:51], a[4:7]
  v_xor_b32 v7, 0, v5
  v_mfma_f32_16x16x32_bf16 a[68:71], a[196:199], v[104:107], a[68:71]
  ds_read_b64_tr_b16 a[192:193], v7 offset:256
  v_mfma_f32_16x16x32_bf16 a[132:135], a[196:199], v[160:163], a[132:135]
  ds_read_b64_tr_b16 a[194:195], v7 offset:8448
  s_waitcnt lgkmcnt(12)
  v_mfma_f32_16x16x32_bf16 a[8:11], a[200:203], v[48:51], a[8:11]
  v_mfma_f32_16x16x32_bf16 a[72:75], a[200:203], v[104:107], a[72:75]
  ds_read_b64_tr_b16 a[196:197], v7 offset:264
  v_mfma_f32_16x16x32_bf16 a[136:139], a[200:203], v[160:163], a[136:139]
  ds_read_b64_tr_b16 a[198:199], v7 offset:8456
  s_waitcnt lgkmcnt(12)
  v_mfma_f32_16x16x32_bf16 a[12:15], a[204:207], v[48:51], a[12:15]
  v_xor_b32 v8, 64, v5
  v_mfma_f32_16x16x32_bf16 a[76:79], a[204:207], v[104:107], a[76:79]
  ds_read_b64_tr_b16 a[200:201], v8 offset:256
  v_mfma_f32_16x16x32_bf16 a[140:143], a[204:207], v[160:163], a[140:143]
  ds_read_b64_tr_b16 a[202:203], v8 offset:8448
  s_waitcnt lgkmcnt(12)
  v_mfma_f32_16x16x32_bf16 a[16:19], a[208:211], v[48:51], a[16:19]
  v_mfma_f32_16x16x32_bf16 a[80:83], a[208:211], v[104:107], a[80:83]
  ds_read_b64_tr_b16 a[204:205], v8 offset:264
  v_mfma_f32_16x16x32_bf16 a[144:147], a[208:211], v[160:163], a[144:147]
  ds_read_b64_tr_b16 a[206:207], v8 offset:8456
  s_waitcnt lgkmcnt(12)
  v_mfma_f32_16x16x32_bf16 a[20:23], a[212:215], v[48:51], a[20:23]
  v_xor_b32 v9, 128, v5
  v_mfma_f32_16x16x32_bf16 a[84:87], a[212:215], v[104:107], a[84:87]
  ds_read_b64_tr_b16 a[208:209], v9 offset:256
  v_mfma_f32_16x16x32_bf16 a[148:151], a[212:215], v[160:163], a[148:151]
  ds_read_b64_tr_b16 a[210:211], v9 offset:8448
  s_waitcnt lgkmcnt(12)
  v_mfma_f32_16x16x32_bf16 a[24:27], a[216:219], v[48:51], a[24:27]
  v_mfma_f32_16x16x32_bf16 a[88:91], a[216:219], v[104:107], a[88:91]
  ds_read_b64_tr_b16 a[212:213], v9 offset:264
  v_mfma_f32_16x16x32_bf16 a[152:155], a[216:219], v[160:163], a[152:155]
  ds_read_b64_tr_b16 a[214:215], v9 offset:8456
  s_waitcnt lgkmcnt(12)
  v_mfma_f32_16x16x32_bf16 a[28:31], a[220:223], v[48:51], a[28:31]
  v_xor_b32 v6, 192, v5
  v_mfma_f32_16x16x32_bf16 a[92:95], a[220:223], v[104:107], a[92:95]
  ds_read_b64_tr_b16 a[216:217], v6 offset:256
  v_mfma_f32_16x16x32_bf16 a[156:159], a[220:223], v[160:163], a[156:159]
  ds_read_b64_tr_b16 a[218:219], v6 offset:8448
  s_waitcnt lgkmcnt(12)
  v_mfma_f32_16x16x32_bf16 a[32:35], a[192:195], v[48:51], a[32:35]
  v_mfma_f32_16x16x32_bf16 a[96:99], a[192:195], v[104:107], a[96:99]
  ds_read_b64_tr_b16 a[220:221], v6 offset:264
  v_mfma_f32_16x16x32_bf16 a[160:163], a[192:195], v[160:163], a[160:163]
  ds_read_b64_tr_b16 a[222:223], v6 offset:8456
  s_waitcnt lgkmcnt(12)
  v_mfma_f32_16x16x32_bf16 a[36:39], a[196:199], v[48:51], a[36:39]
  s_waitcnt vmcnt(21)
  s_barrier
  s_add_u32 m0, s50, 49152
  s_mov_b32 s53, 3407872
  buffer_load_dwordx4 v251, s[12:15], s53 offen nt lds
  v_mfma_f32_16x16x32_bf16 a[100:103], a[196:199], v[104:107], a[100:103]
  s_add_u32 m0, s50, 50176
  s_mov_b32 s53, 3407872
  buffer_load_dwordx4 v252, s[12:15], s53 offen nt lds
  s_add_u32 m0, s50, 51200
  s_mov_b32 s53, 3407872
  v_mfma_f32_16x16x32_bf16 a[164:167], a[196:199], v[160:163], a[164:167]
  buffer_load_dwordx4 v253, s[12:15], s53 offen nt lds
  v_add_u32 v5, 81920, v4
  v_xor_b32 v7, 0, v5
  ds_read_b64_tr_b16 a[192:193], v7 offset:0
  ds_read_b64_tr_b16 a[194:195], v7 offset:8192
  s_waitcnt lgkmcnt(12)
  v_mfma_f32_16x16x32_bf16 a[40:43], a[200:203], v[48:51], a[40:43]
  v_mfma_f32_16x16x32_bf16 a[104:107], a[200:203], v[104:107], a[104:107]
  ds_read_b64_tr_b16 a[196:197], v7 offset:8
  v_mfma_f32_16x16x32_bf16 a[168:171], a[200:203], v[160:163], a[168:171]
  ds_read_b64_tr_b16 a[198:199], v7 offset:8200
  s_waitcnt lgkmcnt(12)
  v_mfma_f32_16x16x32_bf16 a[44:47], a[204:207], v[48:51], a[44:47]
  v_xor_b32 v8, 64, v5
  v_mfma_f32_16x16x32_bf16 a[108:111], a[204:207], v[104:107], a[108:111]
  ds_read_b64_tr_b16 a[200:201], v8 offset:0
  v_mfma_f32_16x16x32_bf16 a[172:175], a[204:207], v[160:163], a[172:175]
  ds_read_b64_tr_b16 a[202:203], v8 offset:8192
  s_waitcnt lgkmcnt(12)
  v_mfma_f32_16x16x32_bf16 a[48:51], a[208:211], v[48:51], a[48:51]
  v_mfma_f32_16x16x32_bf16 a[112:115], a[208:211], v[104:107], a[112:115]
  ds_read_b64_tr_b16 a[204:205], v8 offset:8
  v_mfma_f32_16x16x32_bf16 a[176:179], a[208:211], v[160:163], a[176:179]
  ds_read_b64_tr_b16 a[206:207], v8 offset:8200
  s_waitcnt lgkmcnt(12)
  v_mfma_f32_16x16x32_bf16 a[52:55], a[212:215], v[48:51], a[52:55]
  v_xor_b32 v9, 128, v5
  v_mfma_f32_16x16x32_bf16 a[116:119], a[212:215], v[104:107], a[116:119]
  ds_read_b64_tr_b16 a[208:209], v9 offset:0
  v_mfma_f32_16x16x32_bf16 a[180:183], a[212:215], v[160:163], a[180:183]
  ds_read_b64_tr_b16 a[210:211], v9 offset:8192
  s_waitcnt lgkmcnt(12)
  v_mfma_f32_16x16x32_bf16 a[56:59], a[216:219], v[48:51], a[56:59]
  v_mfma_f32_16x16x32_bf16 a[120:123], a[216:219], v[104:107], a[120:123]
  ds_read_b64_tr_b16 a[212:213], v9 offset:8
  v_mfma_f32_16x16x32_bf16 a[184:187], a[216:219], v[160:163], a[184:187]
  ds_read_b64_tr_b16 a[214:215], v9 offset:8200
  s_waitcnt lgkmcnt(12)
  v_mfma_f32_16x16x32_bf16 a[60:63], a[220:223], v[48:51], a[60:63]
  v_xor_b32 v6, 192, v5
  v_mfma_f32_16x16x32_bf16 a[124:127], a[220:223], v[104:107], a[124:127]
  ds_read_b64_tr_b16 a[216:217], v6 offset:0
  v_mfma_f32_16x16x32_bf16 a[188:191], a[220:223], v[160:163], a[188:191]
  ds_read_b64_tr_b16 a[218:219], v6 offset:8192
  s_waitcnt lgkmcnt(12)
  v_mfma_f32_16x16x32_bf16 a[0:3], a[192:195], v[52:55], a[0:3]
  v_mfma_f32_16x16x32_bf16 a[64:67], a[192:195], v[108:111], a[64:67]
  ds_read_b64_tr_b16 a[220:221], v6 offset:8
  v_mfma_f32_16x16x32_bf16 a[128:131], a[192:195], v[164:167], a[128:131]
  ds_read_b64_tr_b16 a[222:223], v6 offset:8200
  s_waitcnt lgkmcnt(12)
  v_mfma_f32_16x16x32_bf16 a[4:7], a[196:199], v[52:55], a[4:7]
  v_xor_b32 v7, 0, v5
  v_mfma_f32_16x16x32_bf16 a[68:71], a[196:199], v[108:111], a[68:71]
  ds_read_b64_tr_b16 a[192:193], v7 offset:256
  v_mfma_f32_16x16x32_bf16 a[132:135], a[196:199], v[164:167], a[132:135]
  ds_read_b64_tr_b16 a[194:195], v7 offset:8448
  s_waitcnt lgkmcnt(12)
  v_mfma_f32_16x16x32_bf16 a[8:11], a[200:203], v[52:55], a[8:11]
  v_mfma_f32_16x16x32_bf16 a[72:75], a[200:203], v[108:111], a[72:75]
  ds_read_b64_tr_b16 a[196:197], v7 offset:264
  v_mfma_f32_16x16x32_bf16 a[136:139], a[200:203], v[164:167], a[136:139]
  ds_read_b64_tr_b16 a[198:199], v7 offset:8456
  s_waitcnt lgkmcnt(12)
  v_mfma_f32_16x16x32_bf16 a[12:15], a[204:207], v[52:55], a[12:15]
  v_xor_b32 v8, 64, v5
  v_mfma_f32_16x16x32_bf16 a[76:79], a[204:207], v[108:111], a[76:79]
  ds_read_b64_tr_b16 a[200:201], v8 offset:256
  v_mfma_f32_16x16x32_bf16 a[140:143], a[204:207], v[164:167], a[140:143]
  ds_read_b64_tr_b16 a[202:203], v8 offset:8448
  s_waitcnt lgkmcnt(12)
  v_mfma_f32_16x16x32_bf16 a[16:19], a[208:211], v[52:55], a[16:19]
  v_mfma_f32_16x16x32_bf16 a[80:83], a[208:211], v[108:111], a[80:83]
  ds_read_b64_tr_b16 a[204:205], v8 offset:264
  v_mfma_f32_16x16x32_bf16 a[144:147], a[208:211], v[164:167], a[144:147]
  ds_read_b64_tr_b16 a[206:207], v8 offset:8456
  s_waitcnt lgkmcnt(12)
  v_mfma_f32_16x16x32_bf16 a[20:23], a[212:215], v[52:55], a[20:23]
  v_xor_b32 v9, 128, v5
  v_mfma_f32_16x16x32_bf16 a[84:87], a[212:215], v[108:111], a[84:87]
  ds_read_b64_tr_b16 a[208:209], v9 offset:256
  v_mfma_f32_16x16x32_bf16 a[148:151], a[212:215], v[164:167], a[148:151]
  ds_read_b64_tr_b16 a[210:211], v9 offset:8448
  s_waitcnt lgkmcnt(12)
  v_mfma_f32_16x16x32_bf16 a[24:27], a[216:219], v[52:55], a[24:27]
  v_mfma_f32_16x16x32_bf16 a[88:91], a[216:219], v[108:111], a[88:91]
  ds_read_b64_tr_b16 a[212:213], v9 offset:264
  v_mfma_f32_16x16x32_bf16 a[152:155], a[216:219], v[164:167], a[152:155]
  ds_read_b64_tr_b16 a[214:215], v9 offset:8456
  s_waitcnt lgkmcnt(12)
  v_mfma_f32_16x16x32_bf16 a[28:31], a[220:223], v[52:55], a[28:31]
  v_xor_b32 v6, 192, v5
  v_mfma_f32_16x16x32_bf16 a[92:95], a[220:223], v[108:111], a[92:95]
  ds_read_b64_tr_b16 a[216:217], v6 offset:256
  v_mfma_f32_16x16x32_bf16 a[156:159], a[220:223], v[164:167], a[156:159]
  ds_read_b64_tr_b16 a[218:219], v6 offset:8448
  s_waitcnt lgkmcnt(12)
  v_mfma_f32_16x16x32_bf16 a[32:35], a[192:195], v[52:55], a[32:35]
  v_mfma_f32_16x16x32_bf16 a[96:99], a[192:195], v[108:111], a[96:99]
  ds_read_b64_tr_b16 a[220:221], v6 offset:264
  v_mfma_f32_16x16x32_bf16 a[160:163], a[192:195], v[164:167], a[160:163]
  ds_read_b64_tr_b16 a[222:223], v6 offset:8456
  s_waitcnt lgkmcnt(12)
  v_mfma_f32_16x16x32_bf16 a[36:39], a[196:199], v[52:55], a[36:39]
  s_waitcnt vmcnt(21)
  s_barrier
  s_add_u32 m0, s50, 65536
  s_mov_b32 s53, 0
  buffer_load_dwordx4 v248, s[16:19], s53 offen nt lds
  v_mfma_f32_16x16x32_bf16 a[100:103], a[196:199], v[108:111], a[100:103]
  s_add_u32 m0, s50, 66560
  s_mov_b32 s53, 0
  buffer_load_dwordx4 v249, s[16:19], s53 offen nt lds
  s_add_u32 m0, s50, 67584
  s_mov_b32 s53, 0
  v_mfma_f32_16x16x32_bf16 a[164:167], a[196:199], v[164:167], a[164:167]
  buffer_load_dwordx4 v250, s[16:19], s53 offen nt lds
  v_add_u32 v5, 98304, v4
  v_xor_b32 v7, 0, v5
  ds_read_b64_tr_b16 a[192:193], v7 offset:0
  ds_read_b64_tr_b16 a[194:195], v7 offset:8192
  s_waitcnt lgkmcnt(12)
  v_mfma_f32_16x16x32_bf16 a[40:43], a[200:203], v[52:55], a[40:43]
  v_mfma_f32_16x16x32_bf16 a[104:107], a[200:203], v[108:111], a[104:107]
  ds_read_b64_tr_b16 a[196:197], v7 offset:8
  v_mfma_f32_16x16x32_bf16 a[168:171], a[200:203], v[164:167], a[168:171]
  ds_read_b64_tr_b16 a[198:199], v7 offset:8200
  s_waitcnt lgkmcnt(12)
  v_mfma_f32_16x16x32_bf16 a[44:47], a[204:207], v[52:55], a[44:47]
  v_xor_b32 v8, 64, v5
  v_mfma_f32_16x16x32_bf16 a[108:111], a[204:207], v[108:111], a[108:111]
  ds_read_b64_tr_b16 a[200:201], v8 offset:0
  v_mfma_f32_16x16x32_bf16 a[172:175], a[204:207], v[164:167], a[172:175]
  ds_read_b64_tr_b16 a[202:203], v8 offset:8192
  s_waitcnt lgkmcnt(12)
  v_mfma_f32_16x16x32_bf16 a[48:51], a[208:211], v[52:55], a[48:51]
  v_mfma_f32_16x16x32_bf16 a[112:115], a[208:211], v[108:111], a[112:115]
  ds_read_b64_tr_b16 a[204:205], v8 offset:8
  v_mfma_f32_16x16x32_bf16 a[176:179], a[208:211], v[164:167], a[176:179]
  ds_read_b64_tr_b16 a[206:207], v8 offset:8200
  s_waitcnt lgkmcnt(12)
  v_mfma_f32_16x16x32_bf16 a[52:55], a[212:215], v[52:55], a[52:55]
  v_xor_b32 v9, 128, v5
  v_mfma_f32_16x16x32_bf16 a[116:119], a[212:215], v[108:111], a[116:119]
  ds_read_b64_tr_b16 a[208:209], v9 offset:0
  v_mfma_f32_16x16x32_bf16 a[180:183], a[212:215], v[164:167], a[180:183]
  ds_read_b64_tr_b16 a[210:211], v9 offset:8192
  s_waitcnt lgkmcnt(12)
  v_mfma_f32_16x16x32_bf16 a[56:59], a[216:219], v[52:55], a[56:59]
  v_mfma_f32_16x16x32_bf16 a[120:123], a[216:219], v[108:111], a[120:123]
  ds_read_b64_tr_b16 a[212:213], v9 offset:8
  v_mfma_f32_16x16x32_bf16 a[184:187], a[216:219], v[164:167], a[184:187]
  ds_read_b64_tr_b16 a[214:215], v9 offset:8200
  s_waitcnt lgkmcnt(12)
  v_mfma_f32_16x16x32_bf16 a[60:63], a[220:223], v[52:55], a[60:63]
  v_xor_b32 v6, 192, v5
  v_mfma_f32_16x16x32_bf16 a[124:127], a[220:223], v[108:111], a[124:127]
  ds_read_b64_tr_b16 a[216:217], v6 offset:0
  v_mfma_f32_16x16x32_bf16 a[188:191], a[220:223], v[164:167], a[188:191]
  ds_read_b64_tr_b16 a[218:219], v6 offset:8192
  s_waitcnt lgkmcnt(12)
  v_mfma_f32_16x16x32_bf16 a[0:3], a[192:195], v[56:59], a[0:3]
  v_mfma_f32_16x16x32_bf16 a[64:67], a[192:195], v[112:115], a[64:67]
  ds_read_b64_tr_b16 a[220:221], v6 offset:8
  v_mfma_f32_16x16x32_bf16 a[128:131], a[192:195], v[168:171], a[128:131]
  ds_read_b64_tr_b16 a[222:223], v6 offset:8200
  s_waitcnt lgkmcnt(12)
  v_mfma_f32_16x16x32_bf16 a[4:7], a[196:199], v[56:59], a[4:7]
  v_xor_b32 v7, 0, v5
  v_mfma_f32_16x16x32_bf16 a[68:71], a[196:199], v[112:115], a[68:71]
  ds_read_b64_tr_b16 a[192:193], v7 offset:256
  v_mfma_f32_16x16x32_bf16 a[132:135], a[196:199], v[168:171], a[132:135]
  ds_read_b64_tr_b16 a[194:195], v7 offset:8448
  s_waitcnt lgkmcnt(12)
  v_mfma_f32_16x16x32_bf16 a[8:11], a[200:203], v[56:59], a[8:11]
  v_mfma_f32_16x16x32_bf16 a[72:75], a[200:203], v[112:115], a[72:75]
  ds_read_b64_tr_b16 a[196:197], v7 offset:264
  v_mfma_f32_16x16x32_bf16 a[136:139], a[200:203], v[168:171], a[136:139]
  ds_read_b64_tr_b16 a[198:199], v7 offset:8456
  s_waitcnt lgkmcnt(12)
  v_mfma_f32_16x16x32_bf16 a[12:15], a[204:207], v[56:59], a[12:15]
  v_xor_b32 v8, 64, v5
  v_mfma_f32_16x16x32_bf16 a[76:79], a[204:207], v[112:115], a[76:79]
  ds_read_b64_tr_b16 a[200:201], v8 offset:256
  v_mfma_f32_16x16x32_bf16 a[140:143], a[204:207], v[168:171], a[140:143]
  ds_read_b64_tr_b16 a[202:203], v8 offset:8448
  s_waitcnt lgkmcnt(12)
  v_mfma_f32_16x16x32_bf16 a[16:19], a[208:211], v[56:59], a[16:19]
  v_mfma_f32_16x16x32_bf16 a[80:83], a[208:211], v[112:115], a[80:83]
  ds_read_b64_tr_b16 a[204:205], v8 offset:264
  v_mfma_f32_16x16x32_bf16 a[144:147], a[208:211], v[168:171], a[144:147]
  ds_read_b64_tr_b16 a[206:207], v8 offset:8456
  s_waitcnt lgkmcnt(12)
  v_mfma_f32_16x16x32_bf16 a[20:23], a[212:215], v[56:59], a[20:23]
  v_xor_b32 v9, 128, v5
  v_mfma_f32_16x16x32_bf16 a[84:87], a[212:215], v[112:115], a[84:87]
  ds_read_b64_tr_b16 a[208:209], v9 offset:256
  v_mfma_f32_16x16x32_bf16 a[148:151], a[212:215], v[168:171], a[148:151]
  ds_read_b64_tr_b16 a[210:211], v9 offset:8448
  s_waitcnt lgkmcnt(12)
  v_mfma_f32_16x16x32_bf16 a[24:27], a[216:219], v[56:59], a[24:27]
  v_mfma_f32_16x16x32_bf16 a[88:91], a[216:219], v[112:115], a[88:91]
  ds_read_b64_tr_b16 a[212:213], v9 offset:264
  v_mfma_f32_16x16x32_bf16 a[152:155], a[216:219], v[168:171], a[152:155]
  ds_read_b64_tr_b16 a[214:215], v9 offset:8456
  s_waitcnt lgkmcnt(12)
  v_mfma_f32_16x16x32_bf16 a[28:31], a[220:223], v[56:59], a[28:31]
  v_xor_b32 v6, 192, v5
  v_mfma_f32_16x16x32_bf16 a[92:95], a[220:223], v[112:115], a[92:95]
  ds_read_b64_tr_b16 a[216:217], v6 offset:256
  v_mfma_f32_16x16x32_bf16 a[156:159], a[220:223], v[168:171], a[156:159]
  ds_read_b64_tr_b16 a[218:219], v6 offset:8448
  s_waitcnt lgkmcnt(12)
  v_mfma_f32_16x16x32_bf16 a[32:35], a[192:195], v[56:59], a[32:35]
  v_mfma_f32_16x16x32_bf16 a[96:99], a[192:195], v[112:115], a[96:99]
  ds_read_b64_tr_b16 a[220:221], v6 offset:264
  v_mfma_f32_16x16x32_bf16 a[160:163], a[192:195], v[168:171], a[160:163]
  ds_read_b64_tr_b16 a[222:223], v6 offset:8456
  s_waitcnt lgkmcnt(12)
  v_mfma_f32_16x16x32_bf16 a[36:39], a[196:199], v[56:59], a[36:39]
  s_waitcnt vmcnt(21)
  s_barrier
  s_add_u32 m0, s50, 81920
  s_mov_b32 s53, 16384
  buffer_load_dwordx4 v248, s[16:19], s53 offen nt lds
  v_mfma_f32_16x16x32_bf16 a[100:103], a[196:199], v[112:115], a[100:103]
  s_add_u32 m0, s50, 82944
  s_mov_b32 s53, 16384
  buffer_load_dwordx4 v249, s[16:19], s53 offen nt lds
  s_add_u32 m0, s50, 83968
  s_mov_b32 s53, 16384
  v_mfma_f32_16x16x32_bf16 a[164:167], a[196:199], v[168:171], a[164:167]
  buffer_load_dwordx4 v250, s[16:19], s53 offen nt lds
  v_add_u32 v5, 114688, v4
  v_xor_b32 v7, 0, v5
  ds_read_b64_tr_b16 a[192:193], v7 offset:0
  ds_read_b64_tr_b16 a[194:195], v7 offset:8192
  s_waitcnt lgkmcnt(12)
  v_mfma_f32_16x16x32_bf16 a[40:43], a[200:203], v[56:59], a[40:43]
  v_mfma_f32_16x16x32_bf16 a[104:107], a[200:203], v[112:115], a[104:107]
  ds_read_b64_tr_b16 a[196:197], v7 offset:8
  v_mfma_f32_16x16x32_bf16 a[168:171], a[200:203], v[168:171], a[168:171]
  ds_read_b64_tr_b16 a[198:199], v7 offset:8200
  s_waitcnt lgkmcnt(12)
  v_mfma_f32_16x16x32_bf16 a[44:47], a[204:207], v[56:59], a[44:47]
  v_xor_b32 v8, 64, v5
  v_mfma_f32_16x16x32_bf16 a[108:111], a[204:207], v[112:115], a[108:111]
  ds_read_b64_tr_b16 a[200:201], v8 offset:0
  v_mfma_f32_16x16x32_bf16 a[172:175], a[204:207], v[168:171], a[172:175]
  ds_read_b64_tr_b16 a[202:203], v8 offset:8192
  s_waitcnt lgkmcnt(12)
  v_mfma_f32_16x16x32_bf16 a[48:51], a[208:211], v[56:59], a[48:51]
  v_mfma_f32_16x16x32_bf16 a[112:115], a[208:211], v[112:115], a[112:115]
  ds_read_b64_tr_b16 a[204:205], v8 offset:8
  v_mfma_f32_16x16x32_bf16 a[176:179], a[208:211], v[168:171], a[176:179]
  ds_read_b64_tr_b16 a[206:207], v8 offset:8200
  s_waitcnt lgkmcnt(12)
  v_mfma_f32_16x16x32_bf16 a[52:55], a[212:215], v[56:59], a[52:55]
  v_xor_b32 v9, 128, v5
  v_mfma_f32_16x16x32_bf16 a[116:119], a[212:215], v[112:115], a[116:119]
  ds_read_b64_tr_b16 a[208:209], v9 offset:0
  v_mfma_f32_16x16x32_bf16 a[180:183], a[212:215], v[168:171], a[180:183]
  ds_read_b64_tr_b16 a[210:211], v9 offset:8192
  s_waitcnt lgkmcnt(12)
  v_mfma_f32_16x16x32_bf16 a[56:59], a[216:219], v[56:59], a[56:59]
  v_mfma_f32_16x16x32_bf16 a[120:123], a[216:219], v[112:115], a[120:123]
  ds_read_b64_tr_b16 a[212:213], v9 offset:8
  v_mfma_f32_16x16x32_bf16 a[184:187], a[216:219], v[168:171], a[184:187]
  ds_read_b64_tr_b16 a[214:215], v9 offset:8200
  s_waitcnt lgkmcnt(12)
  v_mfma_f32_16x16x32_bf16 a[60:63], a[220:223], v[56:59], a[60:63]
  v_xor_b32 v6, 192, v5
  v_mfma_f32_16x16x32_bf16 a[124:127], a[220:223], v[112:115], a[124:127]
  ds_read_b64_tr_b16 a[216:217], v6 offset:0
  v_mfma_f32_16x16x32_bf16 a[188:191], a[220:223], v[168:171], a[188:191]
  ds_read_b64_tr_b16 a[218:219], v6 offset:8192
  s_waitcnt lgkmcnt(12)
  v_mfma_f32_16x16x32_bf16 a[0:3], a[192:195], v[60:63], a[0:3]
  v_mfma_f32_16x16x32_bf16 a[64:67], a[192:195], v[116:119], a[64:67]
  ds_read_b64_tr_b16 a[220:221], v6 offset:8
  v_mfma_f32_16x16x32_bf16 a[128:131], a[192:195], v[172:175], a[128:131]
  ds_read_b64_tr_b16 a[222:223], v6 offset:8200
  s_waitcnt lgkmcnt(12)
  v_mfma_f32_16x16x32_bf16 a[4:7], a[196:199], v[60:63], a[4:7]
  v_xor_b32 v7, 0, v5
  v_mfma_f32_16x16x32_bf16 a[68:71], a[196:199], v[116:119], a[68:71]
  ds_read_b64_tr_b16 a[192:193], v7 offset:256
  v_mfma_f32_16x16x32_bf16 a[132:135], a[196:199], v[172:175], a[132:135]
  ds_read_b64_tr_b16 a[194:195], v7 offset:8448
  s_waitcnt lgkmcnt(12)
  v_mfma_f32_16x16x32_bf16 a[8:11], a[200:203], v[60:63], a[8:11]
  v_mfma_f32_16x16x32_bf16 a[72:75], a[200:203], v[116:119], a[72:75]
  ds_read_b64_tr_b16 a[196:197], v7 offset:264
  v_mfma_f32_16x16x32_bf16 a[136:139], a[200:203], v[172:175], a[136:139]
  ds_read_b64_tr_b16 a[198:199], v7 offset:8456
  s_waitcnt lgkmcnt(12)
  v_mfma_f32_16x16x32_bf16 a[12:15], a[204:207], v[60:63], a[12:15]
  v_xor_b32 v8, 64, v5
  v_mfma_f32_16x16x32_bf16 a[76:79], a[204:207], v[116:119], a[76:79]
  ds_read_b64_tr_b16 a[200:201], v8 offset:256
  v_mfma_f32_16x16x32_bf16 a[140:143], a[204:207], v[172:175], a[140:143]
  ds_read_b64_tr_b16 a[202:203], v8 offset:8448
  s_waitcnt lgkmcnt(12)
  v_mfma_f32_16x16x32_bf16 a[16:19], a[208:211], v[60:63], a[16:19]
  v_mfma_f32_16x16x32_bf16 a[80:83], a[208:211], v[116:119], a[80:83]
  ds_read_b64_tr_b16 a[204:205], v8 offset:264
  v_mfma_f32_16x16x32_bf16 a[144:147], a[208:211], v[172:175], a[144:147]
  ds_read_b64_tr_b16 a[206:207], v8 offset:8456
  s_waitcnt lgkmcnt(12)
  v_mfma_f32_16x16x32_bf16 a[20:23], a[212:215], v[60:63], a[20:23]
  v_xor_b32 v9, 128, v5
  v_mfma_f32_16x16x32_bf16 a[84:87], a[212:215], v[116:119], a[84:87]
  ds_read_b64_tr_b16 a[208:209], v9 offset:256
  v_mfma_f32_16x16x32_bf16 a[148:151], a[212:215], v[172:175], a[148:151]
  ds_read_b64_tr_b16 a[210:211], v9 offset:8448
  s_waitcnt lgkmcnt(12)
  v_mfma_f32_16x16x32_bf16 a[24:27], a[216:219], v[60:63], a[24:27]
  v_mfma_f32_16x16x32_bf16 a[88:91], a[216:219], v[116:119], a[88:91]
  ds_read_b64_tr_b16 a[212:213], v9 offset:264
  v_mfma_f32_16x16x32_bf16 a[152:155], a[216:219], v[172:175], a[152:155]
  ds_read_b64_tr_b16 a[214:215], v9 offset:8456
  s_waitcnt lgkmcnt(12)
  v_mfma_f32_16x16x32_bf16 a[28:31], a[220:223], v[60:63], a[28:31]
  v_xor_b32 v6, 192, v5
  v_mfma_f32_16x16x32_bf16 a[92:95], a[220:223], v[116:119], a[92:95]
  ds_read_b64_tr_b16 a[216:217], v6 offset:256
  v_mfma_f32_16x16x32_bf16 a[156:159], a[220:223], v[172:175], a[156:159]
  ds_read_b64_tr_b16 a[218:219], v6 offset:8448
  s_waitcnt lgkmcnt(12)
  v_mfma_f32_16x16x32_bf16 a[32:35], a[192:195], v[60:63], a[32:35]
  v_mfma_f32_16x16x32_bf16 a[96:99], a[192:195], v[116:119], a[96:99]
  ds_read_b64_tr_b16 a[220:221], v6 offset:264
  v_mfma_f32_16x16x32_bf16 a[160:163], a[192:195], v[172:175], a[160:163]
  ds_read_b64_tr_b16 a[222:223], v6 offset:8456
  s_waitcnt lgkmcnt(12)
  v_mfma_f32_16x16x32_bf16 a[36:39], a[196:199], v[60:63], a[36:39]
  s_waitcnt vmcnt(21)
  s_barrier
  s_add_u32 m0, s50, 98304
  s_mov_b32 s53, 32768
  buffer_load_dwordx4 v248, s[16:19], s53 offen nt lds
  v_mfma_f32_16x16x32_bf16 a[100:103], a[196:199], v[116:119], a[100:103]
  s_add_u32 m0, s50, 99328
  s_mov_b32 s53, 32768
  buffer_load_dwordx4 v249, s[16:19], s53 offen nt lds
  s_add_u32 m0, s50, 100352
  s_mov_b32 s53, 32768
  v_mfma_f32_16x16x32_bf16 a[164:167], a[196:199], v[172:175], a[164:167]
  buffer_load_dwordx4 v250, s[16:19], s53 offen nt lds
  v_add_u32 v5, 131072, v4
  v_xor_b32 v7, 0, v5
  ds_read_b64_tr_b16 a[192:193], v7 offset:0
  ds_read_b64_tr_b16 a[194:195], v7 offset:8192
  s_waitcnt lgkmcnt(12)
  v_mfma_f32_16x16x32_bf16 a[40:43], a[200:203], v[60:63], a[40:43]
  v_mfma_f32_16x16x32_bf16 a[104:107], a[200:203], v[116:119], a[104:107]
  ds_read_b64_tr_b16 a[196:197], v7 offset:8
  v_mfma_f32_16x16x32_bf16 a[168:171], a[200:203], v[172:175], a[168:171]
  ds_read_b64_tr_b16 a[198:199], v7 offset:8200
  s_waitcnt lgkmcnt(12)
  v_mfma_f32_16x16x32_bf16 a[44:47], a[204:207], v[60:63], a[44:47]
  v_xor_b32 v8, 64, v5
  v_mfma_f32_16x16x32_bf16 a[108:111], a[204:207], v[116:119], a[108:111]
  ds_read_b64_tr_b16 a[200:201], v8 offset:0
  v_mfma_f32_16x16x32_bf16 a[172:175], a[204:207], v[172:175], a[172:175]
  ds_read_b64_tr_b16 a[202:203], v8 offset:8192
  s_waitcnt lgkmcnt(12)
  v_mfma_f32_16x16x32_bf16 a[48:51], a[208:211], v[60:63], a[48:51]
  v_mfma_f32_16x16x32_bf16 a[112:115], a[208:211], v[116:119], a[112:115]
  ds_read_b64_tr_b16 a[204:205], v8 offset:8
  v_mfma_f32_16x16x32_bf16 a[176:179], a[208:211], v[172:175], a[176:179]
  ds_read_b64_tr_b16 a[206:207], v8 offset:8200
  s_waitcnt lgkmcnt(12)
  v_mfma_f32_16x16x32_bf16 a[52:55], a[212:215], v[60:63], a[52:55]
  v_xor_b32 v9, 128, v5
  v_mfma_f32_16x16x32_bf16 a[116:119], a[212:215], v[116:119], a[116:119]
  ds_read_b64_tr_b16 a[208:209], v9 offset:0
  v_mfma_f32_16x16x32_bf16 a[180:183], a[212:215], v[172:175], a[180:183]
  ds_read_b64_tr_b16 a[210:211], v9 offset:8192
  s_waitcnt lgkmcnt(12)
  v_mfma_f32_16x16x32_bf16 a[56:59], a[216:219], v[60:63], a[56:59]
  v_mfma_f32_16x16x32_bf16 a[120:123], a[216:219], v[116:119], a[120:123]
  ds_read_b64_tr_b16 a[212:213], v9 offset:8
  v_mfma_f32_16x16x32_bf16 a[184:187], a[216:219], v[172:175], a[184:187]
  ds_read_b64_tr_b16 a[214:215], v9 offset:8200
  s_waitcnt lgkmcnt(12)
  v_mfma_f32_16x16x32_bf16 a[60:63], a[220:223], v[60:63], a[60:63]
  v_xor_b32 v6, 192, v5
  v_mfma_f32_16x16x32_bf16 a[124:127], a[220:223], v[116:119], a[124:127]
  ds_read_b64_tr_b16 a[216:217], v6 offset:0
  v_mfma_f32_16x16x32_bf16 a[188:191], a[220:223], v[172:175], a[188:191]
  ds_read_b64_tr_b16 a[218:219], v6 offset:8192
  s_waitcnt lgkmcnt(12)
  v_mfma_f32_16x16x32_bf16 a[0:3], a[192:195], v[64:67], a[0:3]
  v_mfma_f32_16x16x32_bf16 a[64:67], a[192:195], v[120:123], a[64:67]
  ds_read_b64_tr_b16 a[220:221], v6 offset:8
  v_mfma_f32_16x16x32_bf16 a[128:131], a[192:195], v[176:179], a[128:131]
  ds_read_b64_tr_b16 a[222:223], v6 offset:8200
  s_waitcnt lgkmcnt(12)
  v_mfma_f32_16x16x32_bf16 a[4:7], a[196:199], v[64:67], a[4:7]
  v_xor_b32 v7, 0, v5
  v_mfma_f32_16x16x32_bf16 a[68:71], a[196:199], v[120:123], a[68:71]
  ds_read_b64_tr_b16 a[192:193], v7 offset:256
  v_mfma_f32_16x16x32_bf16 a[132:135], a[196:199], v[176:179], a[132:135]
  ds_read_b64_tr_b16 a[194:195], v7 offset:8448
  s_waitcnt lgkmcnt(12)
  v_mfma_f32_16x16x32_bf16 a[8:11], a[200:203], v[64:67], a[8:11]
  v_mfma_f32_16x16x32_bf16 a[72:75], a[200:203], v[120:123], a[72:75]
  ds_read_b64_tr_b16 a[196:197], v7 offset:264
  v_mfma_f32_16x16x32_bf16 a[136:139], a[200:203], v[176:179], a[136:139]
  ds_read_b64_tr_b16 a[198:199], v7 offset:8456
  s_waitcnt lgkmcnt(12)
  v_mfma_f32_16x16x32_bf16 a[12:15], a[204:207], v[64:67], a[12:15]
  v_xor_b32 v8, 64, v5
  v_mfma_f32_16x16x32_bf16 a[76:79], a[204:207], v[120:123], a[76:79]
  ds_read_b64_tr_b16 a[200:201], v8 offset:256
  v_mfma_f32_16x16x32_bf16 a[140:143], a[204:207], v[176:179], a[140:143]
  ds_read_b64_tr_b16 a[202:203], v8 offset:8448
  s_waitcnt lgkmcnt(12)
  v_mfma_f32_16x16x32_bf16 a[16:19], a[208:211], v[64:67], a[16:19]
  v_mfma_f32_16x16x32_bf16 a[80:83], a[208:211], v[120:123], a[80:83]
  ds_read_b64_tr_b16 a[204:205], v8 offset:264
  v_mfma_f32_16x16x32_bf16 a[144:147], a[208:211], v[176:179], a[144:147]
  ds_read_b64_tr_b16 a[206:207], v8 offset:8456
  s_waitcnt lgkmcnt(12)
  v_mfma_f32_16x16x32_bf16 a[20:23], a[212:215], v[64:67], a[20:23]
  v_xor_b32 v9, 128, v5
  v_mfma_f32_16x16x32_bf16 a[84:87], a[212:215], v[120:123], a[84:87]
  ds_read_b64_tr_b16 a[208:209], v9 offset:256
  v_mfma_f32_16x16x32_bf16 a[148:151], a[212:215], v[176:179], a[148:151]
  ds_read_b64_tr_b16 a[210:211], v9 offset:8448
  s_waitcnt lgkmcnt(12)
  v_mfma_f32_16x16x32_bf16 a[24:27], a[216:219], v[64:67], a[24:27]
  v_mfma_f32_16x16x32_bf16 a[88:91], a[216:219], v[120:123], a[88:91]
  ds_read_b64_tr_b16 a[212:213], v9 offset:264
  v_mfma_f32_16x16x32_bf16 a[152:155], a[216:219], v[176:179], a[152:155]
  ds_read_b64_tr_b16 a[214:215], v9 offset:8456
  s_waitcnt lgkmcnt(12)
  v_mfma_f32_16x16x32_bf16 a[28:31], a[220:223], v[64:67], a[28:31]
  v_xor_b32 v6, 192, v5
  v_mfma_f32_16x16x32_bf16 a[92:95], a[220:223], v[120:123], a[92:95]
  ds_read_b64_tr_b16 a[216:217], v6 offset:256
  v_mfma_f32_16x16x32_bf16 a[156:159], a[220:223], v[176:179], a[156:159]
  ds_read_b64_tr_b16 a[218:219], v6 offset:8448
  s_waitcnt lgkmcnt(12)
  v_mfma_f32_16x16x32_bf16 a[32:35], a[192:195], v[64:67], a[32:35]
  v_mfma_f32_16x16x32_bf16 a[96:99], a[192:195], v[120:123], a[96:99]
  ds_read_b64_tr_b16 a[220:221], v6 offset:264
  v_mfma_f32_16x16x32_bf16 a[160:163], a[192:195], v[176:179], a[160:163]
  ds_read_b64_tr_b16 a[222:223], v6 offset:8456
  s_waitcnt lgkmcnt(12)
  v_mfma_f32_16x16x32_bf16 a[36:39], a[196:199], v[64:67], a[36:39]
  s_waitcnt vmcnt(21)
  s_barrier
  s_add_u32 m0, s50, 114688
  s_mov_b32 s53, 49152
  buffer_load_dwordx4 v248, s[16:19], s53 offen nt lds
  v_mfma_f32_16x16x32_bf16 a[100:103], a[196:199], v[120:123], a[100:103]
  s_add_u32 m0, s50, 115712
  s_mov_b32 s53, 49152
  buffer_load_dwordx4 v249, s[16:19], s53 offen nt lds
  s_add_u32 m0, s50, 116736
  s_mov_b32 s53, 49152
  v_mfma_f32_16x16x32_bf16 a[164:167], a[196:199], v[176:179], a[164:167]
  buffer_load_dwordx4 v250, s[16:19], s53 offen nt lds
  v_add_u32 v5, 147456, v4
  v_xor_b32 v7, 0, v5
  ds_read_b64_tr_b16 a[192:193], v7 offset:0
  ds_read_b64_tr_b16 a[194:195], v7 offset:8192
  s_waitcnt lgkmcnt(12)
  v_mfma_f32_16x16x32_bf16 a[40:43], a[200:203], v[64:67], a[40:43]
  v_mfma_f32_16x16x32_bf16 a[104:107], a[200:203], v[120:123], a[104:107]
  ds_read_b64_tr_b16 a[196:197], v7 offset:8
  v_mfma_f32_16x16x32_bf16 a[168:171], a[200:203], v[176:179], a[168:171]
  ds_read_b64_tr_b16 a[198:199], v7 offset:8200
  s_waitcnt lgkmcnt(12)
  v_mfma_f32_16x16x32_bf16 a[44:47], a[204:207], v[64:67], a[44:47]
  v_xor_b32 v8, 64, v5
  v_mfma_f32_16x16x32_bf16 a[108:111], a[204:207], v[120:123], a[108:111]
  ds_read_b64_tr_b16 a[200:201], v8 offset:0
  v_mfma_f32_16x16x32_bf16 a[172:175], a[204:207], v[176:179], a[172:175]
  ds_read_b64_tr_b16 a[202:203], v8 offset:8192
  s_waitcnt lgkmcnt(12)
  v_mfma_f32_16x16x32_bf16 a[48:51], a[208:211], v[64:67], a[48:51]
  v_mfma_f32_16x16x32_bf16 a[112:115], a[208:211], v[120:123], a[112:115]
  ds_read_b64_tr_b16 a[204:205], v8 offset:8
  v_mfma_f32_16x16x32_bf16 a[176:179], a[208:211], v[176:179], a[176:179]
  ds_read_b64_tr_b16 a[206:207], v8 offset:8200
  s_waitcnt lgkmcnt(12)
  v_mfma_f32_16x16x32_bf16 a[52:55], a[212:215], v[64:67], a[52:55]
  v_xor_b32 v9, 128, v5
  v_mfma_f32_16x16x32_bf16 a[116:119], a[212:215], v[120:123], a[116:119]
  ds_read_b64_tr_b16 a[208:209], v9 offset:0
  v_mfma_f32_16x16x32_bf16 a[180:183], a[212:215], v[176:179], a[180:183]
  ds_read_b64_tr_b16 a[210:211], v9 offset:8192
  s_waitcnt lgkmcnt(12)
  v_mfma_f32_16x16x32_bf16 a[56:59], a[216:219], v[64:67], a[56:59]
  v_mfma_f32_16x16x32_bf16 a[120:123], a[216:219], v[120:123], a[120:123]
  ds_read_b64_tr_b16 a[212:213], v9 offset:8
  v_mfma_f32_16x16x32_bf16 a[184:187], a[216:219], v[176:179], a[184:187]
  ds_read_b64_tr_b16 a[214:215], v9 offset:8200
  s_waitcnt lgkmcnt(12)
  v_mfma_f32_16x16x32_bf16 a[60:63], a[220:223], v[64:67], a[60:63]
  v_xor_b32 v6, 192, v5
  v_mfma_f32_16x16x32_bf16 a[124:127], a[220:223], v[120:123], a[124:127]
  ds_read_b64_tr_b16 a[216:217], v6 offset:0
  v_mfma_f32_16x16x32_bf16 a[188:191], a[220:223], v[176:179], a[188:191]
  ds_read_b64_tr_b16 a[218:219], v6 offset:8192
  s_waitcnt lgkmcnt(12)
  v_mfma_f32_16x16x32_bf16 a[0:3], a[192:195], v[68:71], a[0:3]
  v_mfma_f32_16x16x32_bf16 a[64:67], a[192:195], v[124:127], a[64:67]
  ds_read_b64_tr_b16 a[220:221], v6 offset:8
  v_mfma_f32_16x16x32_bf16 a[128:131], a[192:195], v[180:183], a[128:131]
  ds_read_b64_tr_b16 a[222:223], v6 offset:8200
  s_waitcnt lgkmcnt(12)
  v_mfma_f32_16x16x32_bf16 a[4:7], a[196:199], v[68:71], a[4:7]
  v_xor_b32 v7, 0, v5
  v_mfma_f32_16x16x32_bf16 a[68:71], a[196:199], v[124:127], a[68:71]
  ds_read_b64_tr_b16 a[192:193], v7 offset:256
  v_mfma_f32_16x16x32_bf16 a[132:135], a[196:199], v[180:183], a[132:135]
  ds_read_b64_tr_b16 a[194:195], v7 offset:8448
  s_waitcnt lgkmcnt(12)
  v_mfma_f32_16x16x32_bf16 a[8:11], a[200:203], v[68:71], a[8:11]
  v_mfma_f32_16x16x32_bf16 a[72:75], a[200:203], v[124:127], a[72:75]
  ds_read_b64_tr_b16 a[196:197], v7 offset:264
  v_mfma_f32_16x16x32_bf16 a[136:139], a[200:203], v[180:183], a[136:139]
  ds_read_b64_tr_b16 a[198:199], v7 offset:8456
  s_waitcnt lgkmcnt(12)
  v_mfma_f32_16x16x32_bf16 a[12:15], a[204:207], v[68:71], a[12:15]
  v_xor_b32 v8, 64, v5
  v_mfma_f32_16x16x32_bf16 a[76:79], a[204:207], v[124:127], a[76:79]
  ds_read_b64_tr_b16 a[200:201], v8 offset:256
  v_mfma_f32_16x16x32_bf16 a[140:143], a[204:207], v[180:183], a[140:143]
  ds_read_b64_tr_b16 a[202:203], v8 offset:8448
  s_waitcnt lgkmcnt(12)
  v_mfma_f32_16x16x32_bf16 a[16:19], a[208:211], v[68:71], a[16:19]
  v_mfma_f32_16x16x32_bf16 a[80:83], a[208:211], v[124:127], a[80:83]
  ds_read_b64_tr_b16 a[204:205], v8 offset:264
  v_mfma_f32_16x16x32_bf16 a[144:147], a[208:211], v[180:183], a[144:147]
  ds_read_b64_tr_b16 a[206:207], v8 offset:8456
  s_waitcnt lgkmcnt(12)
  v_mfma_f32_16x16x32_bf16 a[20:23], a[212:215], v[68:71], a[20:23]
  v_xor_b32 v9, 128, v5
  v_mfma_f32_16x16x32_bf16 a[84:87], a[212:215], v[124:127], a[84:87]
  ds_read_b64_tr_b16 a[208:209], v9 offset:256
  v_mfma_f32_16x16x32_bf16 a[148:151], a[212:215], v[180:183], a[148:151]
  ds_read_b64_tr_b16 a[210:211], v9 offset:8448
  s_waitcnt lgkmcnt(12)
  v_mfma_f32_16x16x32_bf16 a[24:27], a[216:219], v[68:71], a[24:27]
  v_mfma_f32_16x16x32_bf16 a[88:91], a[216:219], v[124:127], a[88:91]
  ds_read_b64_tr_b16 a[212:213], v9 offset:264
  v_mfma_f32_16x16x32_bf16 a[152:155], a[216:219], v[180:183], a[152:155]
  ds_read_b64_tr_b16 a[214:215], v9 offset:8456
  s_waitcnt lgkmcnt(12)
  v_mfma_f32_16x16x32_bf16 a[28:31], a[220:223], v[68:71], a[28:31]
  v_xor_b32 v6, 192, v5
  v_mfma_f32_16x16x32_bf16 a[92:95], a[220:223], v[124:127], a[92:95]
  ds_read_b64_tr_b16 a[216:217], v6 offset:256
  v_mfma_f32_16x16x32_bf16 a[156:159], a[220:223], v[180:183], a[156:159]
  ds_read_b64_tr_b16 a[218:219], v6 offset:8448
  s_waitcnt lgkmcnt(12)
  v_mfma_f32_16x16x32_bf16 a[32:35], a[192:195], v[68:71], a[32:35]
  v_mfma_f32_16x16x32_bf16 a[96:99], a[192:195], v[124:127], a[96:99]
  ds_read_b64_tr_b16 a[220:221], v6 offset:264
  v_mfma_f32_16x16x32_bf16 a[160:163], a[192:195], v[180:183], a[160:163]
  ds_read_b64_tr_b16 a[222:223], v6 offset:8456
  s_waitcnt lgkmcnt(12)
  v_mfma_f32_16x16x32_bf16 a[36:39], a[196:199], v[68:71], a[36:39]
  s_waitcnt vmcnt(21)
  s_barrier
  s_add_u32 m0, s50, 131072
  s_mov_b32 s53, 0
  buffer_load_dwordx4 v248, s[20:23], s53 offen nt lds
  v_mfma_f32_16x16x32_bf16 a[100:103], a[196:199], v[124:127], a[100:103]
  s_add_u32 m0, s50, 132096
  s_mov_b32 s53, 0
  buffer_load_dwordx4 v249, s[20:23], s53 offen nt lds
  s_add_u32 m0, s50, 133120
  s_mov_b32 s53, 0
  v_mfma_f32_16x16x32_bf16 a[164:167], a[196:199], v[180:183], a[164:167]
  buffer_load_dwordx4 v250, s[20:23], s53 offen nt lds
  v_add_u32 v5, 0, v4
  v_xor_b32 v7, 0, v5
  ds_read_b64_tr_b16 a[192:193], v7 offset:0
  ds_read_b64_tr_b16 a[194:195], v7 offset:8192
  s_waitcnt lgkmcnt(12)
  v_mfma_f32_16x16x32_bf16 a[40:43], a[200:203], v[68:71], a[40:43]
  v_mfma_f32_16x16x32_bf16 a[104:107], a[200:203], v[124:127], a[104:107]
  ds_read_b64_tr_b16 a[196:197], v7 offset:8
  v_mfma_f32_16x16x32_bf16 a[168:171], a[200:203], v[180:183], a[168:171]
  ds_read_b64_tr_b16 a[198:199], v7 offset:8200
  s_waitcnt lgkmcnt(12)
  v_mfma_f32_16x16x32_bf16 a[44:47], a[204:207], v[68:71], a[44:47]
  v_xor_b32 v8, 64, v5
  v_mfma_f32_16x16x32_bf16 a[108:111], a[204:207], v[124:127], a[108:111]
  ds_read_b64_tr_b16 a[200:201], v8 offset:0
  v_mfma_f32_16x16x32_bf16 a[172:175], a[204:207], v[180:183], a[172:175]
  ds_read_b64_tr_b16 a[202:203], v8 offset:8192
  s_waitcnt lgkmcnt(12)
  v_mfma_f32_16x16x32_bf16 a[48:51], a[208:211], v[68:71], a[48:51]
  v_mfma_f32_16x16x32_bf16 a[112:115], a[208:211], v[124:127], a[112:115]
  ds_read_b64_tr_b16 a[204:205], v8 offset:8
  v_mfma_f32_16x16x32_bf16 a[176:179], a[208:211], v[180:183], a[176:179]
  ds_read_b64_tr_b16 a[206:207], v8 offset:8200
  s_waitcnt lgkmcnt(12)
  v_mfma_f32_16x16x32_bf16 a[52:55], a[212:215], v[68:71], a[52:55]
  v_xor_b32 v9, 128, v5
  v_mfma_f32_16x16x32_bf16 a[116:119], a[212:215], v[124:127], a[116:119]
  ds_read_b64_tr_b16 a[208:209], v9 offset:0
  v_mfma_f32_16x16x32_bf16 a[180:183], a[212:215], v[180:183], a[180:183]
  ds_read_b64_tr_b16 a[210:211], v9 offset:8192
  s_waitcnt lgkmcnt(12)
  v_mfma_f32_16x16x32_bf16 a[56:59], a[216:219], v[68:71], a[56:59]
  v_mfma_f32_16x16x32_bf16 a[120:123], a[216:219], v[124:127], a[120:123]
  ds_read_b64_tr_b16 a[212:213], v9 offset:8
  v_mfma_f32_16x16x32_bf16 a[184:187], a[216:219], v[180:183], a[184:187]
  ds_read_b64_tr_b16 a[214:215], v9 offset:8200
  s_waitcnt lgkmcnt(12)
  v_mfma_f32_16x16x32_bf16 a[60:63], a[220:223], v[68:71], a[60:63]
  v_xor_b32 v6, 192, v5
  v_mfma_f32_16x16x32_bf16 a[124:127], a[220:223], v[124:127], a[124:127]
  ds_read_b64_tr_b16 a[216:217], v6 offset:0
  v_mfma_f32_16x16x32_bf16 a[188:191], a[220:223], v[180:183], a[188:191]
  ds_read_b64_tr_b16 a[218:219], v6 offset:8192
  s_waitcnt lgkmcnt(12)
  v_mfma_f32_16x16x32_bf16 a[0:3], a[192:195], v[72:75], a[0:3]
  v_mfma_f32_16x16x32_bf16 a[64:67], a[192:195], v[128:131], a[64:67]
  ds_read_b64_tr_b16 a[220:221], v6 offset:8
  v_mfma_f32_16x16x32_bf16 a[128:131], a[192:195], v[184:187], a[128:131]
  ds_read_b64_tr_b16 a[222:223], v6 offset:8200
  s_waitcnt lgkmcnt(12)
  v_mfma_f32_16x16x32_bf16 a[4:7], a[196:199], v[72:75], a[4:7]
  v_xor_b32 v7, 0, v5
  v_mfma_f32_16x16x32_bf16 a[68:71], a[196:199], v[128:131], a[68:71]
  ds_read_b64_tr_b16 a[192:193], v7 offset:256
  v_mfma_f32_16x16x32_bf16 a[132:135], a[196:199], v[184:187], a[132:135]
  ds_read_b64_tr_b16 a[194:195], v7 offset:8448
  s_waitcnt lgkmcnt(12)
  v_mfma_f32_16x16x32_bf16 a[8:11], a[200:203], v[72:75], a[8:11]
  v_mfma_f32_16x16x32_bf16 a[72:75], a[200:203], v[128:131], a[72:75]
  ds_read_b64_tr_b16 a[196:197], v7 offset:264
  v_mfma_f32_16x16x32_bf16 a[136:139], a[200:203], v[184:187], a[136:139]
  ds_read_b64_tr_b16 a[198:199], v7 offset:8456
  s_waitcnt lgkmcnt(12)
  v_mfma_f32_16x16x32_bf16 a[12:15], a[204:207], v[72:75], a[12:15]
  v_xor_b32 v8, 64, v5
  v_mfma_f32_16x16x32_bf16 a[76:79], a[204:207], v[128:131], a[76:79]
  ds_read_b64_tr_b16 a[200:201], v8 offset:256
  v_mfma_f32_16x16x32_bf16 a[140:143], a[204:207], v[184:187], a[140:143]
  ds_read_b64_tr_b16 a[202:203], v8 offset:8448
  s_waitcnt lgkmcnt(12)
  v_mfma_f32_16x16x32_bf16 a[16:19], a[208:211], v[72:75], a[16:19]
  v_mfma_f32_16x16x32_bf16 a[80:83], a[208:211], v[128:131], a[80:83]
  ds_read_b64_tr_b16 a[204:205], v8 offset:264
  v_mfma_f32_16x16x32_bf16 a[144:147], a[208:211], v[184:187], a[144:147]
  ds_read_b64_tr_b16 a[206:207], v8 offset:8456
  s_waitcnt lgkmcnt(12)
  v_mfma_f32_16x16x32_bf16 a[20:23], a[212:215], v[72:75], a[20:23]
  v_xor_b32 v9, 128, v5
  v_mfma_f32_16x16x32_bf16 a[84:87], a[212:215], v[128:131], a[84:87]
  ds_read_b64_tr_b16 a[208:209], v9 offset:256
  v_mfma_f32_16x16x32_bf16 a[148:151], a[212:215], v[184:187], a[148:151]
  ds_read_b64_tr_b16 a[210:211], v9 offset:8448
  s_waitcnt lgkmcnt(12)
  v_mfma_f32_16x16x32_bf16 a[24:27], a[216:219], v[72:75], a[24:27]
  v_mfma_f32_16x16x32_bf16 a[88:91], a[216:219], v[128:131], a[88:91]
  ds_read_b64_tr_b16 a[212:213], v9 offset:264
  v_mfma_f32_16x16x32_bf16 a[152:155], a[216:219], v[184:187], a[152:155]
  ds_read_b64_tr_b16 a[214:215], v9 offset:8456
  s_waitcnt lgkmcnt(12)
  v_mfma_f32_16x16x32_bf16 a[28:31], a[220:223], v[72:75], a[28:31]
  v_xor_b32 v6, 192, v5
  v_mfma_f32_16x16x32_bf16 a[92:95], a[220:223], v[128:131], a[92:95]
  ds_read_b64_tr_b16 a[216:217], v6 offset:256
  v_mfma_f32_16x16x32_bf16 a[156:159], a[220:223], v[184:187], a[156:159]
  ds_read_b64_tr_b16 a[218:219], v6 offset:8448
  s_waitcnt lgkmcnt(12)
  v_mfma_f32_16x16x32_bf16 a[32:35], a[192:195], v[72:75], a[32:35]
  v_mfma_f32_16x16x32_bf16 a[96:99], a[192:195], v[128:131], a[96:99]
  ds_read_b64_tr_b16 a[220:221], v6 offset:264
  v_mfma_f32_16x16x32_bf16 a[160:163], a[192:195], v[184:187], a[160:163]
  ds_read_b64_tr_b16 a[222:223], v6 offset:8456
  s_waitcnt lgkmcnt(12)
  v_mfma_f32_16x16x32_bf16 a[36:39], a[196:199], v[72:75], a[36:39]
  s_waitcnt vmcnt(21)
  s_barrier
  s_add_u32 m0, s50, 147456
  s_mov_b32 s53, 16384
  buffer_load_dwordx4 v248, s[20:23], s53 offen nt lds
  v_mfma_f32_16x16x32_bf16 a[100:103], a[196:199], v[128:131], a[100:103]
  s_add_u32 m0, s50, 148480
  s_mov_b32 s53, 16384
  buffer_load_dwordx4 v249, s[20:23], s53 offen nt lds
  s_add_u32 m0, s50, 149504
  s_mov_b32 s53, 16384
  v_mfma_f32_16x16x32_bf16 a[164:167], a[196:199], v[184:187], a[164:167]
  buffer_load_dwordx4 v250, s[20:23], s53 offen nt lds
  v_add_u32 v5, 16384, v4
  v_xor_b32 v7, 0, v5
  ds_read_b64_tr_b16 a[192:193], v7 offset:0
  ds_read_b64_tr_b16 a[194:195], v7 offset:8192
  s_waitcnt lgkmcnt(12)
  v_mfma_f32_16x16x32_bf16 a[40:43], a[200:203], v[72:75], a[40:43]
  v_mfma_f32_16x16x32_bf16 a[104:107], a[200:203], v[128:131], a[104:107]
  ds_read_b64_tr_b16 a[196:197], v7 offset:8
  v_mfma_f32_16x16x32_bf16 a[168:171], a[200:203], v[184:187], a[168:171]
  ds_read_b64_tr_b16 a[198:199], v7 offset:8200
  s_waitcnt lgkmcnt(12)
  v_mfma_f32_16x16x32_bf16 a[44:47], a[204:207], v[72:75], a[44:47]
  v_xor_b32 v8, 64, v5
  v_mfma_f32_16x16x32_bf16 a[108:111], a[204:207], v[128:131], a[108:111]
  ds_read_b64_tr_b16 a[200:201], v8 offset:0
  v_mfma_f32_16x16x32_bf16 a[172:175], a[204:207], v[184:187], a[172:175]
  ds_read_b64_tr_b16 a[202:203], v8 offset:8192
  s_waitcnt lgkmcnt(12)
  v_mfma_f32_16x16x32_bf16 a[48:51], a[208:211], v[72:75], a[48:51]
  v_mfma_f32_16x16x32_bf16 a[112:115], a[208:211], v[128:131], a[112:115]
  ds_read_b64_tr_b16 a[204:205], v8 offset:8
  v_mfma_f32_16x16x32_bf16 a[176:179], a[208:211], v[184:187], a[176:179]
  ds_read_b64_tr_b16 a[206:207], v8 offset:8200
  s_waitcnt lgkmcnt(12)
  v_mfma_f32_16x16x32_bf16 a[52:55], a[212:215], v[72:75], a[52:55]
  v_xor_b32 v9, 128, v5
  v_mfma_f32_16x16x32_bf16 a[116:119], a[212:215], v[128:131], a[116:119]
  ds_read_b64_tr_b16 a[208:209], v9 offset:0
  v_mfma_f32_16x16x32_bf16 a[180:183], a[212:215], v[184:187], a[180:183]
  ds_read_b64_tr_b16 a[210:211], v9 offset:8192
  s_waitcnt lgkmcnt(12)
  v_mfma_f32_16x16x32_bf16 a[56:59], a[216:219], v[72:75], a[56:59]
  v_mfma_f32_16x16x32_bf16 a[120:123], a[216:219], v[128:131], a[120:123]
  ds_read_b64_tr_b16 a[212:213], v9 offset:8
  v_mfma_f32_16x16x32_bf16 a[184:187], a[216:219], v[184:187], a[184:187]
  ds_read_b64_tr_b16 a[214:215], v9 offset:8200
  s_waitcnt lgkmcnt(12)
  v_mfma_f32_16x16x32_bf16 a[60:63], a[220:223], v[72:75], a[60:63]
  v_xor_b32 v6, 192, v5
  v_mfma_f32_16x16x32_bf16 a[124:127], a[220:223], v[128:131], a[124:127]
  ds_read_b64_tr_b16 a[216:217], v6 offset:0
  v_mfma_f32_16x16x32_bf16 a[188:191], a[220:223], v[184:187], a[188:191]
  ds_read_b64_tr_b16 a[218:219], v6 offset:8192
  s_waitcnt lgkmcnt(12)
  v_mfma_f32_16x16x32_bf16 a[0:3], a[192:195], v[76:79], a[0:3]
  v_mfma_f32_16x16x32_bf16 a[64:67], a[192:195], v[132:135], a[64:67]
  ds_read_b64_tr_b16 a[220:221], v6 offset:8
  v_mfma_f32_16x16x32_bf16 a[128:131], a[192:195], v[188:191], a[128:131]
  ds_read_b64_tr_b16 a[222:223], v6 offset:8200
  s_waitcnt lgkmcnt(12)
  v_mfma_f32_16x16x32_bf16 a[4:7], a[196:199], v[76:79], a[4:7]
  v_xor_b32 v7, 0, v5
  v_mfma_f32_16x16x32_bf16 a[68:71], a[196:199], v[132:135], a[68:71]
  ds_read_b64_tr_b16 a[192:193], v7 offset:256
  v_mfma_f32_16x16x32_bf16 a[132:135], a[196:199], v[188:191], a[132:135]
  ds_read_b64_tr_b16 a[194:195], v7 offset:8448
  s_waitcnt lgkmcnt(12)
  v_mfma_f32_16x16x32_bf16 a[8:11], a[200:203], v[76:79], a[8:11]
  v_mfma_f32_16x16x32_bf16 a[72:75], a[200:203], v[132:135], a[72:75]
  ds_read_b64_tr_b16 a[196:197], v7 offset:264
  v_mfma_f32_16x16x32_bf16 a[136:139], a[200:203], v[188:191], a[136:139]
  ds_read_b64_tr_b16 a[198:199], v7 offset:8456
  s_waitcnt lgkmcnt(12)
  v_mfma_f32_16x16x32_bf16 a[12:15], a[204:207], v[76:79], a[12:15]
  v_xor_b32 v8, 64, v5
  v_mfma_f32_16x16x32_bf16 a[76:79], a[204:207], v[132:135], a[76:79]
  ds_read_b64_tr_b16 a[200:201], v8 offset:256
  v_mfma_f32_16x16x32_bf16 a[140:143], a[204:207], v[188:191], a[140:143]
  ds_read_b64_tr_b16 a[202:203], v8 offset:8448
  s_waitcnt lgkmcnt(12)
  v_mfma_f32_16x16x32_bf16 a[16:19], a[208:211], v[76:79], a[16:19]
  v_mfma_f32_16x16x32_bf16 a[80:83], a[208:211], v[132:135], a[80:83]
  ds_read_b64_tr_b16 a[204:205], v8 offset:264
  v_mfma_f32_16x16x32_bf16 a[144:147], a[208:211], v[188:191], a[144:147]
  ds_read_b64_tr_b16 a[206:207], v8 offset:8456
  s_waitcnt lgkmcnt(12)
  v_mfma_f32_16x16x32_bf16 a[20:23], a[212:215], v[76:79], a[20:23]
  v_xor_b32 v9, 128, v5
  v_mfma_f32_16x16x32_bf16 a[84:87], a[212:215], v[132:135], a[84:87]
  ds_read_b64_tr_b16 a[208:209], v9 offset:256
  v_mfma_f32_16x16x32_bf16 a[148:151], a[212:215], v[188:191], a[148:151]
  ds_read_b64_tr_b16 a[210:211], v9 offset:8448
  s_waitcnt lgkmcnt(12)
  v_mfma_f32_16x16x32_bf16 a[24:27], a[216:219], v[76:79], a[24:27]
  v_mfma_f32_16x16x32_bf16 a[88:91], a[216:219], v[132:135], a[88:91]
  ds_read_b64_tr_b16 a[212:213], v9 offset:264
  v_mfma_f32_16x16x32_bf16 a[152:155], a[216:219], v[188:191], a[152:155]
  ds_read_b64_tr_b16 a[214:215], v9 offset:8456
  s_waitcnt lgkmcnt(12)
  v_mfma_f32_16x16x32_bf16 a[28:31], a[220:223], v[76:79], a[28:31]
  v_xor_b32 v6, 192, v5
  v_mfma_f32_16x16x32_bf16 a[92:95], a[220:223], v[132:135], a[92:95]
  ds_read_b64_tr_b16 a[216:217], v6 offset:256
  v_mfma_f32_16x16x32_bf16 a[156:159], a[220:223], v[188:191], a[156:159]
  ds_read_b64_tr_b16 a[218:219], v6 offset:8448
  s_waitcnt lgkmcnt(12)
  v_mfma_f32_16x16x32_bf16 a[32:35], a[192:195], v[76:79], a[32:35]
  v_mfma_f32_16x16x32_bf16 a[96:99], a[192:195], v[132:135], a[96:99]
  ds_read_b64_tr_b16 a[220:221], v6 offset:264
  v_mfma_f32_16x16x32_bf16 a[160:163], a[192:195], v[188:191], a[160:163]
  ds_read_b64_tr_b16 a[222:223], v6 offset:8456
  s_waitcnt lgkmcnt(12)
  v_mfma_f32_16x16x32_bf16 a[36:39], a[196:199], v[76:79], a[36:39]
  s_waitcnt vmcnt(21)
  s_barrier
  s_add_u32 m0, s50, 0
  s_mov_b32 s53, 65536
  buffer_load_dwordx4 v248, s[16:19], s53 offen nt lds
  v_mfma_f32_16x16x32_bf16 a[100:103], a[196:199], v[132:135], a[100:103]
  s_add_u32 m0, s50, 1024
  s_mov_b32 s53, 65536
  buffer_load_dwordx4 v249, s[16:19], s53 offen nt lds
  s_add_u32 m0, s50, 2048
  s_mov_b32 s53, 65536
  v_mfma_f32_16x16x32_bf16 a[164:167], a[196:199], v[188:191], a[164:167]
  buffer_load_dwordx4 v250, s[16:19], s53 offen nt lds
  v_add_u32 v5, 32768, v4
  v_xor_b32 v7, 0, v5
  ds_read_b64_tr_b16 a[192:193], v7 offset:0
  ds_read_b64_tr_b16 a[194:195], v7 offset:8192
  s_waitcnt lgkmcnt(12)
  v_mfma_f32_16x16x32_bf16 a[40:43], a[200:203], v[76:79], a[40:43]
  v_mfma_f32_16x16x32_bf16 a[104:107], a[200:203], v[132:135], a[104:107]
  ds_read_b64_tr_b16 a[196:197], v7 offset:8
  v_mfma_f32_16x16x32_bf16 a[168:171], a[200:203], v[188:191], a[168:171]
  ds_read_b64_tr_b16 a[198:199], v7 offset:8200
  s_waitcnt lgkmcnt(12)
  v_mfma_f32_16x16x32_bf16 a[44:47], a[204:207], v[76:79], a[44:47]
  v_xor_b32 v8, 64, v5
  v_mfma_f32_16x16x32_bf16 a[108:111], a[204:207], v[132:135], a[108:111]
  ds_read_b64_tr_b16 a[200:201], v8 offset:0
  v_mfma_f32_16x16x32_bf16 a[172:175], a[204:207], v[188:191], a[172:175]
  ds_read_b64_tr_b16 a[202:203], v8 offset:8192
  s_waitcnt lgkmcnt(12)
  v_mfma_f32_16x16x32_bf16 a[48:51], a[208:211], v[76:79], a[48:51]
  v_mfma_f32_16x16x32_bf16 a[112:115], a[208:211], v[132:135], a[112:115]
  ds_read_b64_tr_b16 a[204:205], v8 offset:8
  v_mfma_f32_16x16x32_bf16 a[176:179], a[208:211], v[188:191], a[176:179]
  ds_read_b64_tr_b16 a[206:207], v8 offset:8200
  s_waitcnt lgkmcnt(12)
  v_mfma_f32_16x16x32_bf16 a[52:55], a[212:215], v[76:79], a[52:55]
  v_xor_b32 v9, 128, v5
  v_mfma_f32_16x16x32_bf16 a[116:119], a[212:215], v[132:135], a[116:119]
  ds_read_b64_tr_b16 a[208:209], v9 offset:0
  v_mfma_f32_16x16x32_bf16 a[180:183], a[212:215], v[188:191], a[180:183]
  ds_read_b64_tr_b16 a[210:211], v9 offset:8192
  s_waitcnt lgkmcnt(12)
  v_mfma_f32_16x16x32_bf16 a[56:59], a[216:219], v[76:79], a[56:59]
  v_mfma_f32_16x16x32_bf16 a[120:123], a[216:219], v[132:135], a[120:123]
  ds_read_b64_tr_b16 a[212:213], v9 offset:8
  v_mfma_f32_16x16x32_bf16 a[184:187], a[216:219], v[188:191], a[184:187]
  ds_read_b64_tr_b16 a[214:215], v9 offset:8200
  s_waitcnt lgkmcnt(12)
  v_mfma_f32_16x16x32_bf16 a[60:63], a[220:223], v[76:79], a[60:63]
  v_xor_b32 v6, 192, v5
  v_mfma_f32_16x16x32_bf16 a[124:127], a[220:223], v[132:135], a[124:127]
  ds_read_b64_tr_b16 a[216:217], v6 offset:0
  v_mfma_f32_16x16x32_bf16 a[188:191], a[220:223], v[188:191], a[188:191]
  ds_read_b64_tr_b16 a[218:219], v6 offset:8192
  s_waitcnt lgkmcnt(12)
  v_mfma_f32_16x16x32_bf16 a[0:3], a[192:195], v[80:83], a[0:3]
  v_mfma_f32_16x16x32_bf16 a[64:67], a[192:195], v[136:139], a[64:67]
  ds_read_b64_tr_b16 a[220:221], v6 offset:8
  v_mfma_f32_16x16x32_bf16 a[128:131], a[192:195], v[192:195], a[128:131]
  ds_read_b64_tr_b16 a[222:223], v6 offset:8200
  s_waitcnt lgkmcnt(12)
  v_mfma_f32_16x16x32_bf16 a[4:7], a[196:199], v[80:83], a[4:7]
  v_xor_b32 v7, 0, v5
  v_mfma_f32_16x16x32_bf16 a[68:71], a[196:199], v[136:139], a[68:71]
  ds_read_b64_tr_b16 a[192:193], v7 offset:256
  v_mfma_f32_16x16x32_bf16 a[132:135], a[196:199], v[192:195], a[132:135]
  ds_read_b64_tr_b16 a[194:195], v7 offset:8448
  s_waitcnt lgkmcnt(12)
  v_mfma_f32_16x16x32_bf16 a[8:11], a[200:203], v[80:83], a[8:11]
  v_mfma_f32_16x16x32_bf16 a[72:75], a[200:203], v[136:139], a[72:75]
  ds_read_b64_tr_b16 a[196:197], v7 offset:264
  v_mfma_f32_16x16x32_bf16 a[136:139], a[200:203], v[192:195], a[136:139]
  ds_read_b64_tr_b16 a[198:199], v7 offset:8456
  s_waitcnt lgkmcnt(12)
  v_mfma_f32_16x16x32_bf16 a[12:15], a[204:207], v[80:83], a[12:15]
  v_xor_b32 v8, 64, v5
  v_mfma_f32_16x16x32_bf16 a[76:79], a[204:207], v[136:139], a[76:79]
  ds_read_b64_tr_b16 a[200:201], v8 offset:256
  v_mfma_f32_16x16x32_bf16 a[140:143], a[204:207], v[192:195], a[140:143]
  ds_read_b64_tr_b16 a[202:203], v8 offset:8448
  s_waitcnt lgkmcnt(12)
  v_mfma_f32_16x16x32_bf16 a[16:19], a[208:211], v[80:83], a[16:19]
  v_mfma_f32_16x16x32_bf16 a[80:83], a[208:211], v[136:139], a[80:83]
  ds_read_b64_tr_b16 a[204:205], v8 offset:264
  v_mfma_f32_16x16x32_bf16 a[144:147], a[208:211], v[192:195], a[144:147]
  ds_read_b64_tr_b16 a[206:207], v8 offset:8456
  s_waitcnt lgkmcnt(12)
  v_mfma_f32_16x16x32_bf16 a[20:23], a[212:215], v[80:83], a[20:23]
  v_xor_b32 v9, 128, v5
  v_mfma_f32_16x16x32_bf16 a[84:87], a[212:215], v[136:139], a[84:87]
  ds_read_b64_tr_b16 a[208:209], v9 offset:256
  v_mfma_f32_16x16x32_bf16 a[148:151], a[212:215], v[192:195], a[148:151]
  ds_read_b64_tr_b16 a[210:211], v9 offset:8448
  s_waitcnt lgkmcnt(12)
  v_mfma_f32_16x16x32_bf16 a[24:27], a[216:219], v[80:83], a[24:27]
  v_mfma_f32_16x16x32_bf16 a[88:91], a[216:219], v[136:139], a[88:91]
  ds_read_b64_tr_b16 a[212:213], v9 offset:264
  v_mfma_f32_16x16x32_bf16 a[152:155], a[216:219], v[192:195], a[152:155]
  ds_read_b64_tr_b16 a[214:215], v9 offset:8456
  s_waitcnt lgkmcnt(12)
  v_mfma_f32_16x16x32_bf16 a[28:31], a[220:223], v[80:83], a[28:31]
  v_xor_b32 v6, 192, v5
  v_mfma_f32_16x16x32_bf16 a[92:95], a[220:223], v[136:139], a[92:95]
  ds_read_b64_tr_b16 a[216:217], v6 offset:256
  v_mfma_f32_16x16x32_bf16 a[156:159], a[220:223], v[192:195], a[156:159]
  ds_read_b64_tr_b16 a[218:219], v6 offset:8448
  s_waitcnt lgkmcnt(12)
  v_mfma_f32_16x16x32_bf16 a[32:35], a[192:195], v[80:83], a[32:35]
  v_mfma_f32_16x16x32_bf16 a[96:99], a[192:195], v[136:139], a[96:99]
  ds_read_b64_tr_b16 a[220:221], v6 offset:264
  v_mfma_f32_16x16x32_bf16 a[160:163], a[192:195], v[192:195], a[160:163]
  ds_read_b64_tr_b16 a[222:223], v6 offset:8456
  s_waitcnt lgkmcnt(12)
  v_mfma_f32_16x16x32_bf16 a[36:39], a[196:199], v[80:83], a[36:39]
  s_waitcnt vmcnt(21)
  s_barrier
  s_add_u32 m0, s50, 16384
  s_mov_b32 s53, 81920
  buffer_load_dwordx4 v248, s[16:19], s53 offen nt lds
  v_mfma_f32_16x16x32_bf16 a[100:103], a[196:199], v[136:139], a[100:103]
  s_add_u32 m0, s50, 17408
  s_mov_b32 s53, 81920
  buffer_load_dwordx4 v249, s[16:19], s53 offen nt lds
  s_add_u32 m0, s50, 18432
  s_mov_b32 s53, 81920
  v_mfma_f32_16x16x32_bf16 a[164:167], a[196:199], v[192:195], a[164:167]
  buffer_load_dwordx4 v250, s[16:19], s53 offen nt lds
  v_add_u32 v5, 49152, v4
  v_xor_b32 v7, 0, v5
  ds_read_b64_tr_b16 a[192:193], v7 offset:0
  ds_read_b64_tr_b16 a[194:195], v7 offset:8192
  s_waitcnt lgkmcnt(12)
  v_mfma_f32_16x16x32_bf16 a[40:43], a[200:203], v[80:83], a[40:43]
  v_mfma_f32_16x16x32_bf16 a[104:107], a[200:203], v[136:139], a[104:107]
  ds_read_b64_tr_b16 a[196:197], v7 offset:8
  v_mfma_f32_16x16x32_bf16 a[168:171], a[200:203], v[192:195], a[168:171]
  ds_read_b64_tr_b16 a[198:199], v7 offset:8200
  s_waitcnt lgkmcnt(12)
  v_mfma_f32_16x16x32_bf16 a[44:47], a[204:207], v[80:83], a[44:47]
  v_xor_b32 v8, 64, v5
  v_mfma_f32_16x16x32_bf16 a[108:111], a[204:207], v[136:139], a[108:111]
  ds_read_b64_tr_b16 a[200:201], v8 offset:0
  v_mfma_f32_16x16x32_bf16 a[172:175], a[204:207], v[192:195], a[172:175]
  ds_read_b64_tr_b16 a[202:203], v8 offset:8192
  s_waitcnt lgkmcnt(12)
  v_mfma_f32_16x16x32_bf16 a[48:51], a[208:211], v[80:83], a[48:51]
  v_mfma_f32_16x16x32_bf16 a[112:115], a[208:211], v[136:139], a[112:115]
  ds_read_b64_tr_b16 a[204:205], v8 offset:8
  v_mfma_f32_16x16x32_bf16 a[176:179], a[208:211], v[192:195], a[176:179]
  ds_read_b64_tr_b16 a[206:207], v8 offset:8200
  s_waitcnt lgkmcnt(12)
  v_mfma_f32_16x16x32_bf16 a[52:55], a[212:215], v[80:83], a[52:55]
  v_xor_b32 v9, 128, v5
  v_mfma_f32_16x16x32_bf16 a[116:119], a[212:215], v[136:139], a[116:119]
  ds_read_b64_tr_b16 a[208:209], v9 offset:0
  v_mfma_f32_16x16x32_bf16 a[180:183], a[212:215], v[192:195], a[180:183]
  ds_read_b64_tr_b16 a[210:211], v9 offset:8192
  s_waitcnt lgkmcnt(12)
  v_mfma_f32_16x16x32_bf16 a[56:59], a[216:219], v[80:83], a[56:59]
  v_mfma_f32_16x16x32_bf16 a[120:123], a[216:219], v[136:139], a[120:123]
  ds_read_b64_tr_b16 a[212:213], v9 offset:8
  v_mfma_f32_16x16x32_bf16 a[184:187], a[216:219], v[192:195], a[184:187]
  ds_read_b64_tr_b16 a[214:215], v9 offset:8200
  s_waitcnt lgkmcnt(12)
  v_mfma_f32_16x16x32_bf16 a[60:63], a[220:223], v[80:83], a[60:63]
  v_xor_b32 v6, 192, v5
  v_mfma_f32_16x16x32_bf16 a[124:127], a[220:223], v[136:139], a[124:127]
  ds_read_b64_tr_b16 a[216:217], v6 offset:0
  v_mfma_f32_16x16x32_bf16 a[188:191], a[220:223], v[192:195], a[188:191]
  ds_read_b64_tr_b16 a[218:219], v6 offset:8192
  s_waitcnt lgkmcnt(12)
  v_mfma_f32_16x16x32_bf16 a[0:3], a[192:195], v[84:87], a[0:3]
  v_mfma_f32_16x16x32_bf16 a[64:67], a[192:195], v[140:143], a[64:67]
  ds_read_b64_tr_b16 a[220:221], v6 offset:8
  v_mfma_f32_16x16x32_bf16 a[128:131], a[192:195], v[196:199], a[128:131]
  ds_read_b64_tr_b16 a[222:223], v6 offset:8200
  s_waitcnt lgkmcnt(12)
  v_mfma_f32_16x16x32_bf16 a[4:7], a[196:199], v[84:87], a[4:7]
  v_xor_b32 v7, 0, v5
  v_mfma_f32_16x16x32_bf16 a[68:71], a[196:199], v[140:143], a[68:71]
  ds_read_b64_tr_b16 a[192:193], v7 offset:256
  v_mfma_f32_16x16x32_bf16 a[132:135], a[196:199], v[196:199], a[132:135]
  ds_read_b64_tr_b16 a[194:195], v7 offset:8448
  s_waitcnt lgkmcnt(12)
  v_mfma_f32_16x16x32_bf16 a[8:11], a[200:203], v[84:87], a[8:11]
  v_mfma_f32_16x16x32_bf16 a[72:75], a[200:203], v[140:143], a[72:75]
  ds_read_b64_tr_b16 a[196:197], v7 offset:264
  v_mfma_f32_16x16x32_bf16 a[136:139], a[200:203], v[196:199], a[136:139]
  ds_read_b64_tr_b16 a[198:199], v7 offset:8456
  s_waitcnt lgkmcnt(12)
  v_mfma_f32_16x16x32_bf16 a[12:15], a[204:207], v[84:87], a[12:15]
  v_xor_b32 v8, 64, v5
  v_mfma_f32_16x16x32_bf16 a[76:79], a[204:207], v[140:143], a[76:79]
  ds_read_b64_tr_b16 a[200:201], v8 offset:256
  v_mfma_f32_16x16x32_bf16 a[140:143], a[204:207], v[196:199], a[140:143]
  ds_read_b64_tr_b16 a[202:203], v8 offset:8448
  s_waitcnt lgkmcnt(12)
  v_mfma_f32_16x16x32_bf16 a[16:19], a[208:211], v[84:87], a[16:19]
  v_mfma_f32_16x16x32_bf16 a[80:83], a[208:211], v[140:143], a[80:83]
  ds_read_b64_tr_b16 a[204:205], v8 offset:264
  v_mfma_f32_16x16x32_bf16 a[144:147], a[208:211], v[196:199], a[144:147]
  ds_read_b64_tr_b16 a[206:207], v8 offset:8456
  s_waitcnt lgkmcnt(12)
  v_mfma_f32_16x16x32_bf16 a[20:23], a[212:215], v[84:87], a[20:23]
  v_xor_b32 v9, 128, v5
  v_mfma_f32_16x16x32_bf16 a[84:87], a[212:215], v[140:143], a[84:87]
  ds_read_b64_tr_b16 a[208:209], v9 offset:256
  v_mfma_f32_16x16x32_bf16 a[148:151], a[212:215], v[196:199], a[148:151]
  ds_read_b64_tr_b16 a[210:211], v9 offset:8448
  s_waitcnt lgkmcnt(12)
  v_mfma_f32_16x16x32_bf16 a[24:27], a[216:219], v[84:87], a[24:27]
  v_mfma_f32_16x16x32_bf16 a[88:91], a[216:219], v[140:143], a[88:91]
  ds_read_b64_tr_b16 a[212:213], v9 offset:264
  v_mfma_f32_16x16x32_bf16 a[152:155], a[216:219], v[196:199], a[152:155]
  ds_read_b64_tr_b16 a[214:215], v9 offset:8456
  s_waitcnt lgkmcnt(12)
  v_mfma_f32_16x16x32_bf16 a[28:31], a[220:223], v[84:87], a[28:31]
  v_xor_b32 v6, 192, v5
  v_mfma_f32_16x16x32_bf16 a[92:95], a[220:223], v[140:143], a[92:95]
  ds_read_b64_tr_b16 a[216:217], v6 offset:256
  v_mfma_f32_16x16x32_bf16 a[156:159], a[220:223], v[196:199], a[156:159]
  ds_read_b64_tr_b16 a[218:219], v6 offset:8448
  s_waitcnt lgkmcnt(12)
  v_mfma_f32_16x16x32_bf16 a[32:35], a[192:195], v[84:87], a[32:35]
  v_mfma_f32_16x16x32_bf16 a[96:99], a[192:195], v[140:143], a[96:99]
  ds_read_b64_tr_b16 a[220:221], v6 offset:264
  v_mfma_f32_16x16x32_bf16 a[160:163], a[192:195], v[196:199], a[160:163]
  ds_read_b64_tr_b16 a[222:223], v6 offset:8456
  s_waitcnt lgkmcnt(12)
  v_mfma_f32_16x16x32_bf16 a[36:39], a[196:199], v[84:87], a[36:39]
  s_waitcnt vmcnt(21)
  s_barrier
  s_add_u32 m0, s50, 32768
  s_mov_b32 s53, 32768
  v_mfma_f32_16x16x32_bf16 a[100:103], a[196:199], v[140:143], a[100:103]
  buffer_load_dwordx4 v248, s[20:23], s53 offen nt lds
  s_add_u32 m0, s50, 33792
  s_mov_b32 s53, 32768
  buffer_load_dwordx4 v249, s[20:23], s53 offen nt lds
  s_add_u32 m0, s50, 34816
  v_mfma_f32_16x16x32_bf16 a[164:167], a[196:199], v[196:199], a[164:167]
  s_mov_b32 s53, 32768
  buffer_load_dwordx4 v250, s[20:23], s53 offen nt lds
  v_add_u32 v5, 65536, v2
  v_xor_b32 v7, 0, v5
  ds_read_b128 a[192:195], v7 offset:0
  s_waitcnt lgkmcnt(11)
  v_mfma_f32_16x16x32_bf16 a[40:43], a[200:203], v[84:87], a[40:43]
  v_mfma_f32_16x16x32_bf16 a[104:107], a[200:203], v[140:143], a[104:107]
  v_mfma_f32_16x16x32_bf16 a[168:171], a[200:203], v[196:199], a[168:171]
  ds_read_b128 a[196:199], v7 offset:8192
  s_waitcnt lgkmcnt(10)
  v_mfma_f32_16x16x32_bf16 a[44:47], a[204:207], v[84:87], a[44:47]
  v_mfma_f32_16x16x32_bf16 a[108:111], a[204:207], v[140:143], a[108:111]
  v_xor_b32 v8, 64, v5
  v_mfma_f32_16x16x32_bf16 a[172:175], a[204:207], v[196:199], a[172:175]
  ds_read_b128 a[200:203], v8 offset:0
  s_waitcnt lgkmcnt(9)
  v_mfma_f32_16x16x32_bf16 a[48:51], a[208:211], v[84:87], a[48:51]
  v_mfma_f32_16x16x32_bf16 a[112:115], a[208:211], v[140:143], a[112:115]
  v_mfma_f32_16x16x32_bf16 a[176:179], a[208:211], v[196:199], a[176:179]
  ds_read_b128 a[204:207], v8 offset:8192
  s_waitcnt lgkmcnt(8)
  v_mfma_f32_16x16x32_bf16 a[52:55], a[212:215], v[84:87], a[52:55]
  v_mfma_f32_16x16x32_bf16 a[116:119], a[212:215], v[140:143], a[116:119]
  v_xor_b32 v9, 128, v5
  v_mfma_f32_16x16x32_bf16 a[180:183], a[212:215], v[196:199], a[180:183]
  ds_read_b128 a[208:211], v9 offset:0
  s_waitcnt lgkmcnt(7)
  v_mfma_f32_16x16x32_bf16 a[56:59], a[216:219], v[84:87], a[56:59]
  v_mfma_f32_16x16x32_bf16 a[120:123], a[216:219], v[140:143], a[120:123]
  v_mfma_f32_16x16x32_bf16 a[184:187], a[216:219], v[196:199], a[184:187]
  ds_read_b128 a[212:215], v9 offset:8192
  s_waitcnt lgkmcnt(6)
  v_mfma_f32_16x16x32_bf16 a[60:63], a[220:223], v[84:87], a[60:63]
  v_mfma_f32_16x16x32_bf16 a[124:127], a[220:223], v[140:143], a[124:127]
  v_xor_b32 v6, 192, v5
  v_mfma_f32_16x16x32_bf16 a[188:191], a[220:223], v[196:199], a[188:191]
  ds_read_b128 a[216:219], v6 offset:0
  s_nop 7
  s_nop 1
  v_accvgpr_read_b32 v19, a0
  v_accvgpr_read_b32 v20, a1
  v_cvt_pk_bf16_f32 v32, v19, v20
  v_accvgpr_read_b32 v19, a2
  v_accvgpr_read_b32 v20, a3
  v_cvt_pk_bf16_f32 v33, v19, v20
  v_accvgpr_read_b32 v19, a4
  v_accvgpr_read_b32 v20, a5
  v_cvt_pk_bf16_f32 v34, v19, v20
  v_accvgpr_read_b32 v19, a6
  v_accvgpr_read_b32 v20, a7
  v_cvt_pk_bf16_f32 v35, v19, v20
  v_accvgpr_read_b32 v19, a8
  v_accvgpr_read_b32 v20, a9
  v_cvt_pk_bf16_f32 v36, v19, v20
  v_accvgpr_read_b32 v19, a10
  v_accvgpr_read_b32 v20, a11
  v_cvt_pk_bf16_f32 v37, v19, v20
  v_accvgpr_read_b32 v19, a12
  v_accvgpr_read_b32 v20, a13
  v_cvt_pk_bf16_f32 v38, v19, v20
  v_accvgpr_read_b32 v19, a14
  v_accvgpr_read_b32 v20, a15
  v_cvt_pk_bf16_f32 v39, v19, v20
  v_accvgpr_read_b32 v19, a16
  v_accvgpr_read_b32 v20, a17
  v_cvt_pk_bf16_f32 v40, v19, v20
  v_accvgpr_read_b32 v19, a18
  v_accvgpr_read_b32 v20, a19
  v_cvt_pk_bf16_f32 v41, v19, v20
  v_accvgpr_read_b32 v19, a20
  v_accvgpr_read_b32 v20, a21
  v_cvt_pk_bf16_f32 v42, v19, v20
  v_accvgpr_read_b32 v19, a22
  v_accvgpr_read_b32 v20, a23
  v_cvt_pk_bf16_f32 v43, v19, v20
  v_accvgpr_read_b32 v19, a24
  v_accvgpr_read_b32 v20, a25
  v_cvt_pk_bf16_f32 v44, v19, v20
  v_accvgpr_read_b32 v19, a26
  v_accvgpr_read_b32 v20, a27
  v_cvt_pk_bf16_f32 v45, v19, v20
  v_accvgpr_read_b32 v19, a28
  v_accvgpr_read_b32 v20, a29
  v_cvt_pk_bf16_f32 v46, v19, v20
  v_accvgpr_read_b32 v19, a30
  v_accvgpr_read_b32 v20, a31
  v_cvt_pk_bf16_f32 v47, v19, v20
  v_accvgpr_read_b32 v19, a32
  v_accvgpr_read_b32 v20, a33
  v_cvt_pk_bf16_f32 v48, v19, v20
  v_accvgpr_read_b32 v19, a34
  v_accvgpr_read_b32 v20, a35
  v_cvt_pk_bf16_f32 v49, v19, v20
  v_accvgpr_read_b32 v19, a36
  v_accvgpr_read_b32 v20, a37
  v_cvt_pk_bf16_f32 v50, v19, v20
  v_accvgpr_read_b32 v19, a38
  v_accvgpr_read_b32 v20, a39
  v_cvt_pk_bf16_f32 v51, v19, v20
  v_accvgpr_read_b32 v19, a40
  v_accvgpr_read_b32 v20, a41
  v_cvt_pk_bf16_f32 v52, v19, v20
  v_accvgpr_read_b32 v19, a42
  v_accvgpr_read_b32 v20, a43
  v_cvt_pk_bf16_f32 v53, v19, v20
  v_accvgpr_read_b32 v19, a44
  v_accvgpr_read_b32 v20, a45
  v_cvt_pk_bf16_f32 v54, v19, v20
  v_accvgpr_read_b32 v19, a46
  v_accvgpr_read_b32 v20, a47
  v_cvt_pk_bf16_f32 v55, v19, v20
  v_accvgpr_read_b32 v19, a48
  v_accvgpr_read_b32 v20, a49
  v_cvt_pk_bf16_f32 v56, v19, v20
  v_accvgpr_read_b32 v19, a50
  v_accvgpr_read_b32 v20, a51
  v_cvt_pk_bf16_f32 v57, v19, v20
  v_accvgpr_read_b32 v19, a52
  v_accvgpr_read_b32 v20, a53
  v_cvt_pk_bf16_f32 v58, v19, v20
  v_accvgpr_read_b32 v19, a54
  v_accvgpr_read_b32 v20, a55
  v_cvt_pk_bf16_f32 v59, v19, v20
  v_accvgpr_read_b32 v19, a56
  v_accvgpr_read_b32 v20, a57
  v_cvt_pk_bf16_f32 v60, v19, v20
  v_accvgpr_read_b32 v19, a58
  v_accvgpr_read_b32 v20, a59
  v_cvt_pk_bf16_f32 v61, v19, v20
  v_accvgpr_read_b32 v19, a60
  v_accvgpr_read_b32 v20, a61
  v_cvt_pk_bf16_f32 v62, v19, v20
  v_accvgpr_read_b32 v19, a62
  v_accvgpr_read_b32 v20, a63
  v_cvt_pk_bf16_f32 v63, v19, v20
  v_accvgpr_read_b32 v19, a64
  v_accvgpr_read_b32 v20, a65
  v_cvt_pk_bf16_f32 v64, v19, v20
  v_accvgpr_read_b32 v19, a66
  v_accvgpr_read_b32 v20, a67
  v_cvt_pk_bf16_f32 v65, v19, v20
  v_accvgpr_read_b32 v19, a68
  v_accvgpr_read_b32 v20, a69
  v_cvt_pk_bf16_f32 v66, v19, v20
  v_accvgpr_read_b32 v19, a70
  v_accvgpr_read_b32 v20, a71
  v_cvt_pk_bf16_f32 v67, v19, v20
  v_accvgpr_read_b32 v19, a72
  v_accvgpr_read_b32 v20, a73
  v_cvt_pk_bf16_f32 v68, v19, v20
  v_accvgpr_read_b32 v19, a74
  v_accvgpr_read_b32 v20, a75
  v_cvt_pk_bf16_f32 v69, v19, v20
  v_accvgpr_read_b32 v19, a76
  v_accvgpr_read_b32 v20, a77
  v_cvt_pk_bf16_f32 v70, v19, v20
  v_accvgpr_read_b32 v19, a78
  v_accvgpr_read_b32 v20, a79
  v_cvt_pk_bf16_f32 v71, v19, v20
  v_accvgpr_read_b32 v19, a80
  v_accvgpr_read_b32 v20, a81
  v_cvt_pk_bf16_f32 v72, v19, v20
  v_accvgpr_read_b32 v19, a82
  v_accvgpr_read_b32 v20, a83
  v_cvt_pk_bf16_f32 v73, v19, v20
  v_accvgpr_read_b32 v19, a84
  v_accvgpr_read_b32 v20, a85
  v_cvt_pk_bf16_f32 v74, v19, v20
  v_accvgpr_read_b32 v19, a86
  v_accvgpr_read_b32 v20, a87
  v_cvt_pk_bf16_f32 v75, v19, v20
  v_accvgpr_read_b32 v19, a88
  v_accvgpr_read_b32 v20, a89
  v_cvt_pk_bf16_f32 v76, v19, v20
  v_accvgpr_read_b32 v19, a90
  v_accvgpr_read_b32 v20, a91
  v_cvt_pk_bf16_f32 v77, v19, v20
  v_accvgpr_read_b32 v19, a92
  v_accvgpr_read_b32 v20, a93
  v_cvt_pk_bf16_f32 v78, v19, v20
  v_accvgpr_read_b32 v19, a94
  v_accvgpr_read_b32 v20, a95
  v_cvt_pk_bf16_f32 v79, v19, v20
  v_accvgpr_read_b32 v19, a96
  v_accvgpr_read_b32 v20, a97
  v_cvt_pk_bf16_f32 v80, v19, v20
  v_accvgpr_read_b32 v19, a98
  v_accvgpr_read_b32 v20, a99
  v_cvt_pk_bf16_f32 v81, v19, v20
  v_accvgpr_read_b32 v19, a100
  v_accvgpr_read_b32 v20, a101
  v_cvt_pk_bf16_f32 v82, v19, v20
  v_accvgpr_read_b32 v19, a102
  v_accvgpr_read_b32 v20, a103
  v_cvt_pk_bf16_f32 v83, v19, v20
  v_accvgpr_read_b32 v19, a104
  v_accvgpr_read_b32 v20, a105
  v_cvt_pk_bf16_f32 v84, v19, v20
  v_accvgpr_read_b32 v19, a106
  v_accvgpr_read_b32 v20, a107
  v_cvt_pk_bf16_f32 v85, v19, v20
  v_accvgpr_read_b32 v19, a108
  v_accvgpr_read_b32 v20, a109
  v_cvt_pk_bf16_f32 v86, v19, v20
  v_accvgpr_read_b32 v19, a110
  v_accvgpr_read_b32 v20, a111
  v_cvt_pk_bf16_f32 v87, v19, v20
  v_accvgpr_read_b32 v19, a112
  v_accvgpr_read_b32 v20, a113
  v_cvt_pk_bf16_f32 v88, v19, v20
  v_accvgpr_read_b32 v19, a114
  v_accvgpr_read_b32 v20, a115
  v_cvt_pk_bf16_f32 v89, v19, v20
  v_accvgpr_read_b32 v19, a116
  v_accvgpr_read_b32 v20, a117
  v_cvt_pk_bf16_f32 v90, v19, v20
  v_accvgpr_read_b32 v19, a118
  v_accvgpr_read_b32 v20, a119
  v_cvt_pk_bf16_f32 v91, v19, v20
  v_accvgpr_read_b32 v19, a120
  v_accvgpr_read_b32 v20, a121
  v_cvt_pk_bf16_f32 v92, v19, v20
  v_accvgpr_read_b32 v19, a122
  v_accvgpr_read_b32 v20, a123
  v_cvt_pk_bf16_f32 v93, v19, v20
  v_accvgpr_read_b32 v19, a124
  v_accvgpr_read_b32 v20, a125
  v_cvt_pk_bf16_f32 v94, v19, v20
  v_accvgpr_read_b32 v19, a126
  v_accvgpr_read_b32 v20, a127
  v_cvt_pk_bf16_f32 v95, v19, v20
  v_accvgpr_read_b32 v19, a128
  v_accvgpr_read_b32 v20, a129
  v_cvt_pk_bf16_f32 v96, v19, v20
  v_accvgpr_read_b32 v19, a130
  v_accvgpr_read_b32 v20, a131
  v_cvt_pk_bf16_f32 v97, v19, v20
  v_accvgpr_read_b32 v19, a132
  v_accvgpr_read_b32 v20, a133
  v_cvt_pk_bf16_f32 v98, v19, v20
  v_accvgpr_read_b32 v19, a134
  v_accvgpr_read_b32 v20, a135
  v_cvt_pk_bf16_f32 v99, v19, v20
  v_accvgpr_read_b32 v19, a136
  v_accvgpr_read_b32 v20, a137
  v_cvt_pk_bf16_f32 v100, v19, v20
  v_accvgpr_read_b32 v19, a138
  v_accvgpr_read_b32 v20, a139
  v_cvt_pk_bf16_f32 v101, v19, v20
  v_accvgpr_read_b32 v19, a140
  v_accvgpr_read_b32 v20, a141
  v_cvt_pk_bf16_f32 v102, v19, v20
  v_accvgpr_read_b32 v19, a142
  v_accvgpr_read_b32 v20, a143
  v_cvt_pk_bf16_f32 v103, v19, v20
  v_accvgpr_read_b32 v19, a144
  v_accvgpr_read_b32 v20, a145
  v_cvt_pk_bf16_f32 v104, v19, v20
  v_accvgpr_read_b32 v19, a146
  v_accvgpr_read_b32 v20, a147
  v_cvt_pk_bf16_f32 v105, v19, v20
  v_accvgpr_read_b32 v19, a148
  v_accvgpr_read_b32 v20, a149
  v_cvt_pk_bf16_f32 v106, v19, v20
  v_accvgpr_read_b32 v19, a150
  v_accvgpr_read_b32 v20, a151
  v_cvt_pk_bf16_f32 v107, v19, v20
  v_accvgpr_read_b32 v19, a152
  v_accvgpr_read_b32 v20, a153
  v_cvt_pk_bf16_f32 v108, v19, v20
  v_accvgpr_read_b32 v19, a154
  v_accvgpr_read_b32 v20, a155
  v_cvt_pk_bf16_f32 v109, v19, v20
  v_accvgpr_read_b32 v19, a156
  v_accvgpr_read_b32 v20, a157
  v_cvt_pk_bf16_f32 v110, v19, v20
  v_accvgpr_read_b32 v19, a158
  v_accvgpr_read_b32 v20, a159
  v_cvt_pk_bf16_f32 v111, v19, v20
  v_accvgpr_read_b32 v19, a160
  v_accvgpr_read_b32 v20, a161
  v_cvt_pk_bf16_f32 v112, v19, v20
  v_accvgpr_read_b32 v19, a162
  v_accvgpr_read_b32 v20, a163
  v_cvt_pk_bf16_f32 v113, v19, v20
  v_accvgpr_read_b32 v19, a164
  v_accvgpr_read_b32 v20, a165
  v_cvt_pk_bf16_f32 v114, v19, v20
  v_accvgpr_read_b32 v19, a166
  v_accvgpr_read_b32 v20, a167
  v_cvt_pk_bf16_f32 v115, v19, v20
  v_accvgpr_read_b32 v19, a168
  v_accvgpr_read_b32 v20, a169
  v_cvt_pk_bf16_f32 v116, v19, v20
  v_accvgpr_read_b32 v19, a170
  v_accvgpr_read_b32 v20, a171
  v_cvt_pk_bf16_f32 v117, v19, v20
  v_accvgpr_read_b32 v19, a172
  v_accvgpr_read_b32 v20, a173
  v_cvt_pk_bf16_f32 v118, v19, v20
  v_accvgpr_read_b32 v19, a174
  v_accvgpr_read_b32 v20, a175
  v_cvt_pk_bf16_f32 v119, v19, v20
  v_accvgpr_read_b32 v19, a176
  v_accvgpr_read_b32 v20, a177
  v_cvt_pk_bf16_f32 v120, v19, v20
  v_accvgpr_read_b32 v19, a178
  v_accvgpr_read_b32 v20, a179
  v_cvt_pk_bf16_f32 v121, v19, v20
  v_accvgpr_read_b32 v19, a180
  v_accvgpr_read_b32 v20, a181
  v_cvt_pk_bf16_f32 v122, v19, v20
  v_accvgpr_read_b32 v19, a182
  v_accvgpr_read_b32 v20, a183
  v_cvt_pk_bf16_f32 v123, v19, v20
  v_accvgpr_read_b32 v19, a184
  v_accvgpr_read_b32 v20, a185
  v_cvt_pk_bf16_f32 v124, v19, v20
  v_accvgpr_read_b32 v19, a186
  v_accvgpr_read_b32 v20, a187
  v_cvt_pk_bf16_f32 v125, v19, v20
  v_accvgpr_read_b32 v19, a188
  v_accvgpr_read_b32 v20, a189
  v_cvt_pk_bf16_f32 v126, v19, v20
  v_accvgpr_read_b32 v19, a190
  v_accvgpr_read_b32 v20, a191
  v_cvt_pk_bf16_f32 v127, v19, v20
  s_nop 1
  s_waitcnt lgkmcnt(6)
  v_mfma_f32_16x16x32_bf16 v[128:131], a[192:195], v[32:35], 0
  v_mfma_f32_16x16x32_bf16 v[144:147], a[192:195], v[64:67], 0
  v_mfma_f32_16x16x32_bf16 v[160:163], a[192:195], v[96:99], 0
  ds_read_b128 a[220:223], v6 offset:8192
  s_waitcnt lgkmcnt(6)
  v_mfma_f32_16x16x32_bf16 v[132:135], a[196:199], v[32:35], 0
  v_mfma_f32_16x16x32_bf16 v[148:151], a[196:199], v[64:67], 0
  v_xor_b32 v7, 0, v5
  v_mfma_f32_16x16x32_bf16 v[164:167], a[196:199], v[96:99], 0
  ds_read_b128 a[192:195], v7 offset:256
  s_waitcnt lgkmcnt(6)
  v_mfma_f32_16x16x32_bf16 v[128:131], a[200:203], v[36:39], v[128:131]
  v_mfma_f32_16x16x32_bf16 v[144:147], a[200:203], v[68:71], v[144:147]
  v_mfma_f32_16x16x32_bf16 v[160:163], a[200:203], v[100:103], v[160:163]
  ds_read_b128 a[196:199], v7 offset:8448
  s_waitcnt lgkmcnt(6)
  v_mfma_f32_16x16x32_bf16 v[132:135], a[204:207], v[36:39], v[132:135]
  v_mfma_f32_16x16x32_bf16 v[148:151], a[204:207], v[68:71], v[148:151]
  v_xor_b32 v8, 64, v5
  v_mfma_f32_16x16x32_bf16 v[164:167], a[204:207], v[100:103], v[164:167]
  ds_read_b128 a[200:203], v8 offset:256
  s_waitcnt lgkmcnt(6)
  v_mfma_f32_16x16x32_bf16 v[128:131], a[208:211], v[40:43], v[128:131]
  v_mfma_f32_16x16x32_bf16 v[144:147], a[208:211], v[72:75], v[144:147]
  v_mfma_f32_16x16x32_bf16 v[160:163], a[208:211], v[104:107], v[160:163]
  ds_read_b128 a[204:207], v8 offset:8448
  s_waitcnt lgkmcnt(6)
  v_mfma_f32_16x16x32_bf16 v[132:135], a[212:215], v[40:43], v[132:135]
  v_mfma_f32_16x16x32_bf16 v[148:151], a[212:215], v[72:75], v[148:151]
  v_xor_b32 v9, 128, v5
  v_mfma_f32_16x16x32_bf16 v[164:167], a[212:215], v[104:107], v[164:167]
  ds_read_b128 a[208:211], v9 offset:256
  s_waitcnt lgkmcnt(6)
  v_mfma_f32_16x16x32_bf16 v[128:131], a[216:219], v[44:47], v[128:131]
  v_mfma_f32_16x16x32_bf16 v[144:147], a[216:219], v[76:79], v[144:147]
  v_mfma_f32_16x16x32_bf16 v[160:163], a[216:219], v[108:111], v[160:163]
  ds_read_b128 a[212:215], v9 offset:8448
  s_waitcnt lgkmcnt(6)
  v_mfma_f32_16x16x32_bf16 v[132:135], a[220:223], v[44:47], v[132:135]
  v_mfma_f32_16x16x32_bf16 v[148:151], a[220:223], v[76:79], v[148:151]
  v_xor_b32 v6, 192, v5
  v_mfma_f32_16x16x32_bf16 v[164:167], a[220:223], v[108:111], v[164:167]
  ds_read_b128 a[216:219], v6 offset:256
  s_waitcnt lgkmcnt(6)
  v_mfma_f32_16x16x32_bf16 v[128:131], a[192:195], v[48:51], v[128:131]
  v_mfma_f32_16x16x32_bf16 v[144:147], a[192:195], v[80:83], v[144:147]
  v_mfma_f32_16x16x32_bf16 v[160:163], a[192:195], v[112:115], v[160:163]
  ds_read_b128 a[220:223], v6 offset:8448
  s_waitcnt lgkmcnt(6)
  v_mfma_f32_16x16x32_bf16 v[132:135], a[196:199], v[48:51], v[132:135]
  s_waitcnt vmcnt(21)
  s_barrier
  s_add_u32 m0, s50, 49152
  s_mov_b32 s53, 49152
  v_mfma_f32_16x16x32_bf16 v[148:151], a[196:199], v[80:83], v[148:151]
  buffer_load_dwordx4 v248, s[20:23], s53 offen nt lds
  s_add_u32 m0, s50, 50176
  s_mov_b32 s53, 49152
  buffer_load_dwordx4 v249, s[20:23], s53 offen nt lds
  s_add_u32 m0, s50, 51200
  v_mfma_f32_16x16x32_bf16 v[164:167], a[196:199], v[112:115], v[164:167]
  s_mov_b32 s53, 49152
  buffer_load_dwordx4 v250, s[20:23], s53 offen nt lds
  v_add_u32 v5, 81920, v2
  v_xor_b32 v7, 0, v5
  ds_read_b128 a[192:195], v7 offset:0
  s_waitcnt lgkmcnt(6)
  v_mfma_f32_16x16x32_bf16 v[128:131], a[200:203], v[52:55], v[128:131]
  v_mfma_f32_16x16x32_bf16 v[144:147], a[200:203], v[84:87], v[144:147]
  v_mfma_f32_16x16x32_bf16 v[160:163], a[200:203], v[116:119], v[160:163]
  ds_read_b128 a[196:199], v7 offset:8192
  s_waitcnt lgkmcnt(6)
  v_mfma_f32_16x16x32_bf16 v[132:135], a[204:207], v[52:55], v[132:135]
  v_mfma_f32_16x16x32_bf16 v[148:151], a[204:207], v[84:87], v[148:151]
  v_xor_b32 v8, 64, v5
  v_mfma_f32_16x16x32_bf16 v[164:167], a[204:207], v[116:119], v[164:167]
  ds_read_b128 a[200:203], v8 offset:0
  s_waitcnt lgkmcnt(6)
  v_mfma_f32_16x16x32_bf16 v[128:131], a[208:211], v[56:59], v[128:131]
  v_mfma_f32_16x16x32_bf16 v[144:147], a[208:211], v[88:91], v[144:147]
  v_mfma_f32_16x16x32_bf16 v[160:163], a[208:211], v[120:123], v[160:163]
  ds_read_b128 a[204:207], v8 offset:8192
  s_waitcnt lgkmcnt(6)
  v_mfma_f32_16x16x32_bf16 v[132:135], a[212:215], v[56:59], v[132:135]
  v_mfma_f32_16x16x32_bf16 v[148:151], a[212:215], v[88:91], v[148:151]
  v_xor_b32 v9, 128, v5
  v_mfma_f32_16x16x32_bf16 v[164:167], a[212:215], v[120:123], v[164:167]
  ds_read_b128 a[208:211], v9 offset:0
  s_waitcnt lgkmcnt(6)
  v_mfma_f32_16x16x32_bf16 v[128:131], a[216:219], v[60:63], v[128:131]
  v_mfma_f32_16x16x32_bf16 v[144:147], a[216:219], v[92:95], v[144:147]
  v_mfma_f32_16x16x32_bf16 v[160:163], a[216:219], v[124:127], v[160:163]
  ds_read_b128 a[212:215], v9 offset:8192
  s_waitcnt lgkmcnt(6)
  v_mfma_f32_16x16x32_bf16 v[132:135], a[220:223], v[60:63], v[132:135]
  v_mfma_f32_16x16x32_bf16 v[148:151], a[220:223], v[92:95], v[148:151]
  v_xor_b32 v6, 192, v5
  v_mfma_f32_16x16x32_bf16 v[164:167], a[220:223], v[124:127], v[164:167]
  ds_read_b128 a[216:219], v6 offset:0
  s_waitcnt lgkmcnt(6)
  v_mfma_f32_16x16x32_bf16 v[136:139], a[192:195], v[32:35], 0
  v_mfma_f32_16x16x32_bf16 v[152:155], a[192:195], v[64:67], 0
  v_mfma_f32_16x16x32_bf16 v[168:171], a[192:195], v[96:99], 0
  ds_read_b128 a[220:223], v6 offset:8192
  s_waitcnt lgkmcnt(6)
  v_mfma_f32_16x16x32_bf16 v[140:143], a[196:199], v[32:35], 0
  v_mfma_f32_16x16x32_bf16 v[156:159], a[196:199], v[64:67], 0
  v_xor_b32 v7, 0, v5
  v_mfma_f32_16x16x32_bf16 v[172:175], a[196:199], v[96:99], 0
  ds_read_b128 a[192:195], v7 offset:256
  s_waitcnt lgkmcnt(6)
  v_mfma_f32_16x16x32_bf16 v[136:139], a[200:203], v[36:39], v[136:139]
  v_mfma_f32_16x16x32_bf16 v[152:155], a[200:203], v[68:71], v[152:155]
  v_mfma_f32_16x16x32_bf16 v[168:171], a[200:203], v[100:103], v[168:171]
  ds_read_b128 a[196:199], v7 offset:8448
  s_waitcnt lgkmcnt(6)
  v_mfma_f32_16x16x32_bf16 v[140:143], a[204:207], v[36:39], v[140:143]
  v_mfma_f32_16x16x32_bf16 v[156:159], a[204:207], v[68:71], v[156:159]
  v_xor_b32 v8, 64, v5
  v_mfma_f32_16x16x32_bf16 v[172:175], a[204:207], v[100:103], v[172:175]
  ds_read_b128 a[200:203], v8 offset:256
  s_waitcnt lgkmcnt(6)
  v_mfma_f32_16x16x32_bf16 v[136:139], a[208:211], v[40:43], v[136:139]
  v_mfma_f32_16x16x32_bf16 v[152:155], a[208:211], v[72:75], v[152:155]
  v_mfma_f32_16x16x32_bf16 v[168:171], a[208:211], v[104:107], v[168:171]
  ds_read_b128 a[204:207], v8 offset:8448
  s_waitcnt lgkmcnt(6)
  v_mfma_f32_16x16x32_bf16 v[140:143], a[212:215], v[40:43], v[140:143]
  v_mfma_f32_16x16x32_bf16 v[156:159], a[212:215], v[72:75], v[156:159]
  v_xor_b32 v9, 128, v5
  v_mfma_f32_16x16x32_bf16 v[172:175], a[212:215], v[104:107], v[172:175]
  ds_read_b128 a[208:211], v9 offset:256
  s_waitcnt lgkmcnt(6)
  v_mfma_f32_16x16x32_bf16 v[136:139], a[216:219], v[44:47], v[136:139]
  v_mfma_f32_16x16x32_bf16 v[152:155], a[216:219], v[76:79], v[152:155]
  v_mfma_f32_16x16x32_bf16 v[168:171], a[216:219], v[108:111], v[168:171]
  ds_read_b128 a[212:215], v9 offset:8448
  s_waitcnt lgkmcnt(6)
  v_mfma_f32_16x16x32_bf16 v[140:143], a[220:223], v[44:47], v[140:143]
  v_mfma_f32_16x16x32_bf16 v[156:159], a[220:223], v[76:79], v[156:159]
  v_xor_b32 v6, 192, v5
  v_mfma_f32_16x16x32_bf16 v[172:175], a[220:223], v[108:111], v[172:175]
  ds_read_b128 a[216:219], v6 offset:256
  s_waitcnt lgkmcnt(6)
  v_mfma_f32_16x16x32_bf16 v[136:139], a[192:195], v[48:51], v[136:139]
  v_mfma_f32_16x16x32_bf16 v[152:155], a[192:195], v[80:83], v[152:155]
  v_mfma_f32_16x16x32_bf16 v[168:171], a[192:195], v[112:115], v[168:171]
  ds_read_b128 a[220:223], v6 offset:8448
  s_waitcnt lgkmcnt(6)
  v_mfma_f32_16x16x32_bf16 v[140:143], a[196:199], v[48:51], v[140:143]
  s_waitcnt vmcnt(21)
  s_barrier
  s_add_u32 m0, s50, 65536
  s_mov_b32 s53, 98304
  v_mfma_f32_16x16x32_bf16 v[156:159], a[196:199], v[80:83], v[156:159]
  buffer_load_dwordx4 v248, s[16:19], s53 offen nt lds
  s_add_u32 m0, s50, 66560
  s_mov_b32 s53, 98304
  buffer_load_dwordx4 v249, s[16:19], s53 offen nt lds
  s_add_u32 m0, s50, 67584
  v_mfma_f32_16x16x32_bf16 v[172:175], a[196:199], v[112:115], v[172:175]
  s_mov_b32 s53, 98304
  buffer_load_dwordx4 v250, s[16:19], s53 offen nt lds
  v_add_u32 v5, 98304, v2
  v_xor_b32 v7, 0, v5
  ds_read_b128 a[192:195], v7 offset:0
  s_waitcnt lgkmcnt(6)
  v_mfma_f32_16x16x32_bf16 v[136:139], a[200:203], v[52:55], v[136:139]
  v_mfma_f32_16x16x32_bf16 v[152:155], a[200:203], v[84:87], v[152:155]
  v_mfma_f32_16x16x32_bf16 v[168:171], a[200:203], v[116:119], v[168:171]
  ds_read_b128 a[196:199], v7 offset:8192
  s_waitcnt lgkmcnt(6)
  v_mfma_f32_16x16x32_bf16 v[140:143], a[204:207], v[52:55], v[140:143]
  v_mfma_f32_16x16x32_bf16 v[156:159], a[204:207], v[84:87], v[156:159]
  v_xor_b32 v8, 64, v5
  v_mfma_f32_16x16x32_bf16 v[172:175], a[204:207], v[116:119], v[172:175]
  ds_read_b128 a[200:203], v8 offset:0
  s_waitcnt lgkmcnt(6)
  v_mfma_f32_16x16x32_bf16 v[136:139], a[208:211], v[56:59], v[136:139]
  v_mfma_f32_16x16x32_bf16 v[152:155], a[208:211], v[88:91], v[152:155]
  v_mfma_f32_16x16x32_bf16 v[168:171], a[208:211], v[120:123], v[168:171]
  ds_read_b128 a[204:207], v8 offset:8192
  s_waitcnt lgkmcnt(6)
  v_mfma_f32_16x16x32_bf16 v[140:143], a[212:215], v[56:59], v[140:143]
  v_mfma_f32_16x16x32_bf16 v[156:159], a[212:215], v[88:91], v[156:159]
  v_xor_b32 v9, 128, v5
  v_mfma_f32_16x16x32_bf16 v[172:175], a[212:215], v[120:123], v[172:175]
  ds_read_b128 a[208:211], v9 offset:0
  s_waitcnt lgkmcnt(6)
  v_mfma_f32_16x16x32_bf16 v[136:139], a[216:219], v[60:63], v[136:139]
  v_mfma_f32_16x16x32_bf16 v[152:155], a[216:219], v[92:95], v[152:155]
  v_mfma_f32_16x16x32_bf16 v[168:171], a[216:219], v[124:127], v[168:171]
  ds_read_b128 a[212:215], v9 offset:8192
  s_waitcnt lgkmcnt(6)
  v_mfma_f32_16x16x32_bf16 v[140:143], a[220:223], v[60:63], v[140:143]
  v_mfma_f32_16x16x32_bf16 v[156:159], a[220:223], v[92:95], v[156:159]
  v_xor_b32 v6, 192, v5
  v_mfma_f32_16x16x32_bf16 v[172:175], a[220:223], v[124:127], v[172:175]
  ds_read_b128 a[216:219], v6 offset:0
  s_waitcnt lgkmcnt(6)
  v_mfma_f32_16x16x32_bf16 v[176:179], a[192:195], v[32:35], 0
  v_mfma_f32_16x16x32_bf16 v[192:195], a[192:195], v[64:67], 0
  v_mfma_f32_16x16x32_bf16 v[208:211], a[192:195], v[96:99], 0
  ds_read_b128 a[220:223], v6 offset:8192
  s_waitcnt lgkmcnt(6)
  v_mfma_f32_16x16x32_bf16 v[180:183], a[196:199], v[32:35], 0
  v_max3_f32 v19, v128, v129, v130
  v_max3_f32 v20, v131, v132, v133
  v_mfma_f32_16x16x32_bf16 v[196:199], a[196:199], v[64:67], 0
  v_xor_b32 v7, 0, v5
  v_max3_f32 v21, v134, v135, v136
  v_max3_f32 v19, v19, v137, v138
  v_mfma_f32_16x16x32_bf16 v[212:215], a[196:199], v[96:99], 0
  ds_read_b128 a[192:195], v7 offset:256
  v_max3_f32 v20, v20, v139, v140
  v_max3_f32 v21, v21, v141, v142
  v_max3_f32 v19, v19, v20, v143
  s_waitcnt lgkmcnt(6)
  v_mfma_f32_16x16x32_bf16 v[176:179], a[200:203], v[36:39], v[176:179]
  v_max_f32 v16, v19, v21
  v_mov_b32 v19, v16
  v_mfma_f32_16x16x32_bf16 v[192:195], a[200:203], v[68:71], v[192:195]
  s_nop 1
  v_permlane32_swap_b32 v16, v19
  v_max_f32 v16, v16, v19
  v_mfma_f32_16x16x32_bf16 v[208:211], a[200:203], v[100:103], v[208:211]
  ds_read_b128 a[196:199], v7 offset:8448
  v_mov_b32 v19, v16
  s_nop 1
  s_waitcnt lgkmcnt(6)
  v_mfma_f32_16x16x32_bf16 v[180:183], a[204:207], v[36:39], v[180:183]
  v_permlane16_swap_b32 v16, v19
  v_max_f32 v16, v16, v19
  v_mul_f32 v16, s51, v16
  v_mfma_f32_16x16x32_bf16 v[196:199], a[204:207], v[68:71], v[196:199]
  v_xor_b32 v8, 64, v5
  v_max3_f32 v22, v144, v145, v146
  v_max3_f32 v23, v147, v148, v149
  v_mfma_f32_16x16x32_bf16 v[212:215], a[204:207], v[100:103], v[212:215]
  ds_read_b128 a[200:203], v8 offset:256
  v_max3_f32 v24, v150, v151, v152
  v_max3_f32 v22, v22, v153, v154
  v_max3_f32 v23, v23, v155, v156
  s_waitcnt lgkmcnt(6)
  v_mfma_f32_16x16x32_bf16 v[176:179], a[208:211], v[40:43], v[176:179]
  v_max3_f32 v24, v24, v157, v158
  v_max3_f32 v22, v22, v23, v159
  v_mfma_f32_16x16x32_bf16 v[192:195], a[208:211], v[72:75], v[192:195]
  v_max_f32 v17, v22, v24
  v_mov_b32 v22, v17
  s_nop 1
  v_mfma_f32_16x16x32_bf16 v[208:211], a[208:211], v[104:107], v[208:211]
  ds_read_b128 a[204:207], v8 offset:8448
  v_permlane32_swap_b32 v17, v22
  v_max_f32 v17, v17, v22
  s_waitcnt lgkmcnt(6)
  v_mfma_f32_16x16x32_bf16 v[180:183], a[212:215], v[40:43], v[180:183]
  v_mov_b32 v22, v17
  s_nop 1
  v_permlane16_swap_b32 v17, v22
  v_mfma_f32_16x16x32_bf16 v[196:199], a[212:215], v[72:75], v[196:199]
  v_xor_b32 v9, 128, v5
  v_max_f32 v17, v17, v22
  v_mul_f32 v17, s51, v17
  v_mfma_f32_16x16x32_bf16 v[212:215], a[212:215], v[104:107], v[212:215]
  ds_read_b128 a[208:211], v9 offset:256
  v_max3_f32 v25, v160, v161, v162
  v_max3_f32 v26, v163, v164, v165
  v_max3_f32 v27, v166, v167, v168
  s_waitcnt lgkmcnt(6)
  v_mfma_f32_16x16x32_bf16 v[176:179], a[216:219], v[44:47], v[176:179]
  v_max3_f32 v25, v25, v169, v170
  v_max3_f32 v26, v26, v171, v172
  v_mfma_f32_16x16x32_bf16 v[192:195], a[216:219], v[76:79], v[192:195]
  v_max3_f32 v27, v27, v173, v174
  v_max3_f32 v25, v25, v26, v175
  v_mfma_f32_16x16x32_bf16 v[208:211], a[216:219], v[108:111], v[208:211]
  ds_read_b128 a[212:215], v9 offset:8448
  v_max_f32 v18, v25, v27
  v_mov_b32 v25, v18
  s_nop 1
  s_waitcnt lgkmcnt(6)
  v_mfma_f32_16x16x32_bf16 v[180:183], a[220:223], v[44:47], v[180:183]
  v_permlane32_swap_b32 v18, v25
  v_max_f32 v18, v18, v25
  v_mfma_f32_16x16x32_bf16 v[196:199], a[220:223], v[76:79], v[196:199]
  v_xor_b32 v6, 192, v5
  v_mov_b32 v25, v18
  s_nop 1
  v_permlane16_swap_b32 v18, v25
  v_mfma_f32_16x16x32_bf16 v[212:215], a[220:223], v[108:111], v[212:215]
  ds_read_b128 a[216:219], v6 offset:256
  v_max_f32 v18, v18, v25
  v_mul_f32 v18, s51, v18
  s_waitcnt lgkmcnt(6)
  v_mfma_f32_16x16x32_bf16 v[176:179], a[192:195], v[48:51], v[176:179]
  v_mov_b32 v10, v16
  v_mov_b32 v11, v17
  v_mov_b32 v12, v18
  v_mfma_f32_16x16x32_bf16 v[192:195], a[192:195], v[80:83], v[192:195]
  v_fma_f32 v128, v128, s51, -v10
  v_fma_f32 v129, v129, s51, -v10
  v_mfma_f32_16x16x32_bf16 v[208:211], a[192:195], v[112:115], v[208:211]
  ds_read_b128 a[220:223], v6 offset:8448
  v_fma_f32 v130, v130, s51, -v10
  v_fma_f32 v131, v131, s51, -v10
  v_fma_f32 v132, v132, s51, -v10
  s_waitcnt lgkmcnt(6)
  v_mfma_f32_16x16x32_bf16 v[180:183], a[196:199], v[48:51], v[180:183]
  s_waitcnt vmcnt(21)
  s_barrier
  s_add_u32 m0, s50, 81920
  s_mov_b32 s53, 114688
  v_fma_f32 v133, v133, s51, -v10
  v_fma_f32 v134, v134, s51, -v10
  v_mfma_f32_16x16x32_bf16 v[196:199], a[196:199], v[80:83], v[196:199]
  buffer_load_dwordx4 v248, s[16:19], s53 offen nt lds
  s_add_u32 m0, s50, 82944
  s_mov_b32 s53, 114688
  buffer_load_dwordx4 v249, s[16:19], s53 offen nt lds
  s_add_u32 m0, s50, 83968
  v_fma_f32 v135, v135, s51, -v10
  v_fma_f32 v136, v136, s51, -v10
  v_fma_f32 v137, v137, s51, -v10
  v_mfma_f32_16x16x32_bf16 v[212:215], a[196:199], v[112:115], v[212:215]
  s_mov_b32 s53, 114688
  buffer_load_dwordx4 v250, s[16:19], s53 offen nt lds
  v_add_u32 v5, 114688, v2
  v_xor_b32 v7, 0, v5
  ds_read_b128 a[192:195], v7 offset:0
  v_fma_f32 v138, v138, s51, -v10
  v_fma_f32 v139, v139, s51, -v10
  s_waitcnt lgkmcnt(6)
  v_mfma_f32_16x16x32_bf16 v[176:179], a[200:203], v[52:55], v[176:179]
  v_fma_f32 v140, v140, s51, -v10
  v_fma_f32 v141, v141, s51, -v10
  v_fma_f32 v142, v142, s51, -v10
  v_mfma_f32_16x16x32_bf16 v[192:195], a[200:203], v[84:87], v[192:195]
  v_fma_f32 v143, v143, s51, -v10
  v_exp_f32 v128, v128
  v_mfma_f32_16x16x32_bf16 v[208:211], a[200:203], v[116:119], v[208:211]
  ds_read_b128 a[196:199], v7 offset:8192
  v_exp_f32 v129, v129
  v_exp_f32 v130, v130
  v_exp_f32 v131, v131
  s_waitcnt lgkmcnt(6)
  v_mfma_f32_16x16x32_bf16 v[180:183], a[204:207], v[52:55], v[180:183]
  v_exp_f32 v132, v132
  v_exp_f32 v133, v133
  v_mfma_f32_16x16x32_bf16 v[196:199], a[204:207], v[84:87], v[196:199]
  v_xor_b32 v8, 64, v5
  v_exp_f32 v134, v134
  v_exp_f32 v135, v135
  v_mfma_f32_16x16x32_bf16 v[212:215], a[204:207], v[116:119], v[212:215]
  ds_read_b128 a[200:203], v8 offset:0
  v_exp_f32 v136, v136
  v_exp_f32 v137, v137
  v_exp_f32 v138, v138
  s_waitcnt lgkmcnt(6)
  v_mfma_f32_16x16x32_bf16 v[176:179], a[208:211], v[56:59], v[176:179]
  v_exp_f32 v139, v139
  v_exp_f32 v140, v140
  v_mfma_f32_16x16x32_bf16 v[192:195], a[208:211], v[88:91], v[192:195]
  v_exp_f32 v141, v141
  v_exp_f32 v142, v142
  v_exp_f32 v143, v143
  v_mfma_f32_16x16x32_bf16 v[208:211], a[208:211], v[120:123], v[208:211]
  ds_read_b128 a[204:207], v8 offset:8192
  v_fma_f32 v144, v144, s51, -v11
  v_fma_f32 v145, v145, s51, -v11
  s_waitcnt lgkmcnt(6)
  v_mfma_f32_16x16x32_bf16 v[180:183], a[212:215], v[56:59], v[180:183]
  v_fma_f32 v146, v146, s51, -v11
  v_fma_f32 v147, v147, s51, -v11
  v_fma_f32 v148, v148, s51, -v11
  v_mfma_f32_16x16x32_bf16 v[196:199], a[212:215], v[88:91], v[196:199]
  v_xor_b32 v9, 128, v5
  v_fma_f32 v149, v149, s51, -v11
  v_fma_f32 v150, v150, s51, -v11
  v_mfma_f32_16x16x32_bf16 v[212:215], a[212:215], v[120:123], v[212:215]
  ds_read_b128 a[208:211], v9 offset:0
  v_fma_f32 v151, v151, s51, -v11
  v_fma_f32 v152, v152, s51, -v11
  v_fma_f32 v153, v153, s51, -v11
  s_waitcnt lgkmcnt(6)
  v_mfma_f32_16x16x32_bf16 v[176:179], a[216:219], v[60:63], v[176:179]
  v_fma_f32 v154, v154, s51, -v11
  v_fma_f32 v155, v155, s51, -v11
  v_mfma_f32_16x16x32_bf16 v[192:195], a[216:219], v[92:95], v[192:195]
  v_fma_f32 v156, v156, s51, -v11
  v_fma_f32 v157, v157, s51, -v11
  v_fma_f32 v158, v158, s51, -v11
  v_mfma_f32_16x16x32_bf16 v[208:211], a[216:219], v[124:127], v[208:211]
  ds_read_b128 a[212:215], v9 offset:8192
  v_fma_f32 v159, v159, s51, -v11
  v_exp_f32 v144, v144
  s_waitcnt lgkmcnt(6)
  v_mfma_f32_16x16x32_bf16 v[180:183], a[220:223], v[60:63], v[180:183]
  v_exp_f32 v145, v145
  v_exp_f32 v146, v146
  v_exp_f32 v147, v147
  v_mfma_f32_16x16x32_bf16 v[196:199], a[220:223], v[92:95], v[196:199]
  v_xor_b32 v6, 192, v5
  v_exp_f32 v148, v148
  v_exp_f32 v149, v149
  v_mfma_f32_16x16x32_bf16 v[212:215], a[220:223], v[124:127], v[212:215]
  ds_read_b128 a[216:219], v6 offset:0
  v_exp_f32 v150, v150
  v_exp_f32 v151, v151
  v_exp_f32 v152, v152
  s_waitcnt lgkmcnt(6)
  v_mfma_f32_16x16x32_bf16 v[184:187], a[192:195], v[32:35], 0
  v_mfma_f32_16x16x32_bf16 v[200:203], a[192:195], v[64:67], 0
  v_mfma_f32_16x16x32_bf16 v[216:219], a[192:195], v[96:99], 0
  ds_read_b128 a[220:223], v6 offset:8192
  s_waitcnt lgkmcnt(6)
  v_mfma_f32_16x16x32_bf16 v[188:191], a[196:199], v[32:35], 0
  v_exp_f32 v153, v153
  v_exp_f32 v154, v154
  v_mfma_f32_16x16x32_bf16 v[204:207], a[196:199], v[64:67], 0
  v_xor_b32 v7, 0, v5
  v_exp_f32 v155, v155
  v_exp_f32 v156, v156
  v_mfma_f32_16x16x32_bf16 v[220:223], a[196:199], v[96:99], 0
  ds_read_b128 a[192:195], v7 offset:256
  v_exp_f32 v157, v157
  v_exp_f32 v158, v158
  v_exp_f32 v159, v159
  s_waitcnt lgkmcnt(6)
  v_mfma_f32_16x16x32_bf16 v[184:187], a[200:203], v[36:39], v[184:187]
  v_fma_f32 v160, v160, s51, -v12
  v_fma_f32 v161, v161, s51, -v12
  v_mfma_f32_16x16x32_bf16 v[200:203], a[200:203], v[68:71], v[200:203]
  v_fma_f32 v162, v162, s51, -v12
  v_fma_f32 v163, v163, s51, -v12
  v_fma_f32 v164, v164, s51, -v12
  v_mfma_f32_16x16x32_bf16 v[216:219], a[200:203], v[100:103], v[216:219]
  ds_read_b128 a[196:199], v7 offset:8448
  v_fma_f32 v165, v165, s51, -v12
  v_fma_f32 v166, v166, s51, -v12
  s_waitcnt lgkmcnt(6)
  v_mfma_f32_16x16x32_bf16 v[188:191], a[204:207], v[36:39], v[188:191]
  v_fma_f32 v167, v167, s51, -v12
  v_fma_f32 v168, v168, s51, -v12
  v_fma_f32 v169, v169, s51, -v12
  v_mfma_f32_16x16x32_bf16 v[204:207], a[204:207], v[68:71], v[204:207]
  v_xor_b32 v8, 64, v5
  v_fma_f32 v170, v170, s51, -v12
  v_fma_f32 v171, v171, s51, -v12
  v_mfma_f32_16x16x32_bf16 v[220:223], a[204:207], v[100:103], v[220:223]
  ds_read_b128 a[200:203], v8 offset:256
  v_fma_f32 v172, v172, s51, -v12
  v_fma_f32 v173, v173, s51, -v12
  v_fma_f32 v174, v174, s51, -v12
  s_waitcnt lgkmcnt(6)
  v_mfma_f32_16x16x32_bf16 v[184:187], a[208:211], v[40:43], v[184:187]
  v_fma_f32 v175, v175, s51, -v12
  v_exp_f32 v160, v160
  v_mfma_f32_16x16x32_bf16 v[200:203], a[208:211], v[72:75], v[200:203]
  v_exp_f32 v161, v161
  v_exp_f32 v162, v162
  v_exp_f32 v163, v163
  v_mfma_f32_16x16x32_bf16 v[216:219], a[208:211], v[104:107], v[216:219]
  ds_read_b128 a[204:207], v8 offset:8448
  v_exp_f32 v164, v164
  v_exp_f32 v165, v165
  s_waitcnt lgkmcnt(6)
  v_mfma_f32_16x16x32_bf16 v[188:191], a[212:215], v[40:43], v[188:191]
  v_exp_f32 v166, v166
  v_exp_f32 v167, v167
  v_exp_f32 v168, v168
  v_mfma_f32_16x16x32_bf16 v[204:207], a[212:215], v[72:75], v[204:207]
  v_xor_b32 v9, 128, v5
  v_exp_f32 v169, v169
  v_exp_f32 v170, v170
  v_mfma_f32_16x16x32_bf16 v[220:223], a[212:215], v[104:107], v[220:223]
  ds_read_b128 a[208:211], v9 offset:256
  v_exp_f32 v171, v171
  v_exp_f32 v172, v172
  v_exp_f32 v173, v173
  s_waitcnt lgkmcnt(6)
  v_mfma_f32_16x16x32_bf16 v[184:187], a[216:219], v[44:47], v[184:187]
  v_exp_f32 v174, v174
  v_exp_f32 v175, v175
  v_mfma_f32_16x16x32_bf16 v[200:203], a[216:219], v[76:79], v[200:203]
  v_add_f32 v19, v128, v129
  v_add_f32 v20, v130, v131
  v_mfma_f32_16x16x32_bf16 v[216:219], a[216:219], v[108:111], v[216:219]
  ds_read_b128 a[212:215], v9 offset:8448
  v_add_f32 v19, v19, v132
  v_add_f32 v20, v20, v133
  v_add_f32 v19, v19, v134
  s_waitcnt lgkmcnt(6)
  v_mfma_f32_16x16x32_bf16 v[188:191], a[220:223], v[44:47], v[188:191]
  v_add_f32 v20, v20, v135
  v_add_f32 v19, v19, v136
  v_mfma_f32_16x16x32_bf16 v[204:207], a[220:223], v[76:79], v[204:207]
  v_xor_b32 v6, 192, v5
  v_add_f32 v20, v20, v137
  v_add_f32 v19, v19, v138
  v_add_f32 v20, v20, v139
  v_mfma_f32_16x16x32_bf16 v[220:223], a[220:223], v[108:111], v[220:223]
  ds_read_b128 a[216:219], v6 offset:256
  v_add_f32 v19, v19, v140
  v_add_f32 v20, v20, v141
  s_waitcnt lgkmcnt(6)
  v_mfma_f32_16x16x32_bf16 v[184:187], a[192:195], v[48:51], v[184:187]
  v_add_f32 v19, v19, v142
  v_add_f32 v20, v20, v143
  v_add_f32 v19, v19, v20
  v_mfma_f32_16x16x32_bf16 v[200:203], a[192:195], v[80:83], v[200:203]
  v_mov_b32 v13, v19
  v_add_f32 v22, v144, v145
  v_mfma_f32_16x16x32_bf16 v[216:219], a[192:195], v[112:115], v[216:219]
  ds_read_b128 a[220:223], v6 offset:8448
  v_add_f32 v23, v146, v147
  v_add_f32 v22, v22, v148
  v_add_f32 v23, v23, v149
  s_waitcnt lgkmcnt(6)
  v_mfma_f32_16x16x32_bf16 v[188:191], a[196:199], v[48:51], v[188:191]
  s_waitcnt vmcnt(21)
  s_barrier
  s_add_u32 m0, s50, 98304
  s_mov_b32 s53, 65536
  buffer_load_dwordx4 v248, s[20:23], s53 offen nt lds
  v_add_f32 v22, v22, v150
  v_add_f32 v23, v23, v151
  v_mfma_f32_16x16x32_bf16 v[204:207], a[196:199], v[80:83], v[204:207]
  s_add_u32 m0, s50, 99328
  s_mov_b32 s53, 65536
  buffer_load_dwordx4 v249, s[20:23], s53 offen nt lds
  s_add_u32 m0, s50, 100352
  s_mov_b32 s53, 65536
  v_add_f32 v22, v22, v152
  v_add_f32 v23, v23, v153
  v_add_f32 v22, v22, v154
  v_mfma_f32_16x16x32_bf16 v[220:223], a[196:199], v[112:115], v[220:223]
  buffer_load_dwordx4 v250, s[20:23], s53 offen nt lds
  v_add_u32 v5, 131072, v3
  v_xor_b32 v7, 0, v5
  ds_read_b64_tr_b16 a[192:193], v7 offset:0
  ds_read_b64_tr_b16 a[194:195], v7 offset:8192
  v_add_f32 v23, v23, v155
  v_add_f32 v22, v22, v156
  s_waitcnt lgkmcnt(7)
  v_mfma_f32_16x16x32_bf16 v[184:187], a[200:203], v[52:55], v[184:187]
  v_xor_b32 v8, 32, v5
  v_add_f32 v23, v23, v157
  v_add_f32 v22, v22, v158
  v_add_f32 v23, v23, v159
  v_mfma_f32_16x16x32_bf16 v[200:203], a[200:203], v[84:87], v[200:203]
  ds_read_b64_tr_b16 a[196:197], v8 offset:0
  v_add_f32 v22, v22, v23
  v_mov_b32 v14, v22
  v_mfma_f32_16x16x32_bf16 v[216:219], a[200:203], v[116:119], v[216:219]
  ds_read_b64_tr_b16 a[198:199], v8 offset:8192
  v_add_f32 v25, v160, v161
  v_add_f32 v26, v162, v163
  v_add_f32 v25, v25, v164
  s_waitcnt lgkmcnt(8)
  v_mfma_f32_16x16x32_bf16 v[188:191], a[204:207], v[52:55], v[188:191]
  v_xor_b32 v9, 64, v5
  v_add_f32 v26, v26, v165
  v_add_f32 v25, v25, v166
  v_mfma_f32_16x16x32_bf16 v[204:207], a[204:207], v[84:87], v[204:207]
  ds_read_b64_tr_b16 a[200:201], v9 offset:0
  v_add_f32 v26, v26, v167
  v_add_f32 v25, v25, v168
  v_mfma_f32_16x16x32_bf16 v[220:223], a[204:207], v[116:119], v[220:223]
  ds_read_b64_tr_b16 a[202:203], v9 offset:8192
  v_add_f32 v26, v26, v169
  v_add_f32 v25, v25, v170
  v_add_f32 v26, v26, v171
  s_waitcnt lgkmcnt(9)
  v_mfma_f32_16x16x32_bf16 v[184:187], a[208:211], v[56:59], v[184:187]
  v_xor_b32 v6, 96, v5
  v_add_f32 v25, v25, v172
  v_add_f32 v26, v26, v173
  v_mfma_f32_16x16x32_bf16 v[200:203], a[208:211], v[88:91], v[200:203]
  ds_read_b64_tr_b16 a[204:205], v6 offset:0
  v_add_f32 v25, v25, v174
  v_add_f32 v26, v26, v175
  v_add_f32 v25, v25, v26
  v_mfma_f32_16x16x32_bf16 v[216:219], a[208:211], v[120:123], v[216:219]
  ds_read_b64_tr_b16 a[206:207], v6 offset:8192
  v_mov_b32 v15, v25
  v_cvt_pk_bf16_f32 v224, v128, v129
  s_waitcnt lgkmcnt(10)
  v_mfma_f32_16x16x32_bf16 v[188:191], a[212:215], v[56:59], v[188:191]
  v_xor_b32 v7, 128, v5
  v_cvt_pk_bf16_f32 v225, v130, v131
  v_cvt_pk_bf16_f32 v226, v132, v133
  v_cvt_pk_bf16_f32 v227, v134, v135
  v_mfma_f32_16x16x32_bf16 v[204:207], a[212:215], v[88:91], v[204:207]
  ds_read_b64_tr_b16 a[208:209], v7 offset:0
  v_cvt_pk_bf16_f32 v228, v136, v137
  v_cvt_pk_bf16_f32 v229, v138, v139
  v_mfma_f32_16x16x32_bf16 v[220:223], a[212:215], v[120:123], v[220:223]
  ds_read_b64_tr_b16 a[210:211], v7 offset:8192
  v_cvt_pk_bf16_f32 v230, v140, v141
  v_cvt_pk_bf16_f32 v231, v142, v143
  v_cvt_pk_bf16_f32 v232, v144, v145
  s_waitcnt lgkmcnt(11)
  v_mfma_f32_16x16x32_bf16 v[184:187], a[216:219], v[60:63], v[184:187]
  v_xor_b32 v8, 160, v5
  v_cvt_pk_bf16_f32 v233, v146, v147
  v_cvt_pk_bf16_f32 v234, v148, v149
  v_mfma_f32_16x16x32_bf16 v[200:203], a[216:219], v[92:95], v[200:203]
  ds_read_b64_tr_b16 a[212:213], v8 offset:0
  v_cvt_pk_bf16_f32 v235, v150, v151
  v_cvt_pk_bf16_f32 v236, v152, v153
  v_cvt_pk_bf16_f32 v237, v154, v155
  v_mfma_f32_16x16x32_bf16 v[216:219], a[216:219], v[124:127], v[216:219]
  ds_read_b64_tr_b16 a[214:215], v8 offset:8192
  v_cvt_pk_bf16_f32 v238, v156, v157
  v_cvt_pk_bf16_f32 v239, v158, v159
  s_waitcnt lgkmcnt(12)
  v_mfma_f32_16x16x32_bf16 v[188:191], a[220:223], v[60:63], v[188:191]
  v_xor_b32 v9, 192, v5
  v_cvt_pk_bf16_f32 v240, v160, v161
  v_cvt_pk_bf16_f32 v241, v162, v163
  v_cvt_pk_bf16_f32 v242, v164, v165
  v_mfma_f32_16x16x32_bf16 v[204:207], a[220:223], v[92:95], v[204:207]
  ds_read_b64_tr_b16 a[216:217], v9 offset:0
  v_cvt_pk_bf16_f32 v243, v166, v167
  v_cvt_pk_bf16_f32 v244, v168, v169
  v_mfma_f32_16x16x32_bf16 v[220:223], a[220:223], v[124:127], v[220:223]
  ds_read_b64_tr_b16 a[218:219], v9 offset:8192
  v_cvt_pk_bf16_f32 v245, v170, v171
  v_cvt_pk_bf16_f32 v246, v172, v173
  v_cvt_pk_bf16_f32 v247, v174, v175
  s_waitcnt lgkmcnt(12)
  v_mfma_f32_16x16x32_bf16 a[0:3], a[192:195], v[224:227], 0
  v_xor_b32 v6, 224, v5
  v_mfma_f32_16x16x32_bf16 a[64:67], a[192:195], v[232:235], 0
  ds_read_b64_tr_b16 a[220:221], v6 offset:0
  v_mfma_f32_16x16x32_bf16 a[128:131], a[192:195], v[240:243], 0
  ds_read_b64_tr_b16 a[222:223], v6 offset:8192
  s_waitcnt lgkmcnt(12)
  v_mfma_f32_16x16x32_bf16 a[4:7], a[196:199], v[224:227], 0
  v_xor_b32 v7, 0, v5
  v_mfma_f32_16x16x32_bf16 a[68:71], a[196:199], v[232:235], 0
  ds_read_b64_tr_b16 a[192:193], v7 offset:256
  v_mfma_f32_16x16x32_bf16 a[132:135], a[196:199], v[240:243], 0
  ds_read_b64_tr_b16 a[194:195], v7 offset:8448
  s_waitcnt lgkmcnt(12)
  v_mfma_f32_16x16x32_bf16 a[8:11], a[200:203], v[224:227], 0
  v_xor_b32 v8, 32, v5
  v_mfma_f32_16x16x32_bf16 a[72:75], a[200:203], v[232:235], 0
  ds_read_b64_tr_b16 a[196:197], v8 offset:256
  v_mfma_f32_16x16x32_bf16 a[136:139], a[200:203], v[240:243], 0
  ds_read_b64_tr_b16 a[198:199], v8 offset:8448
  s_waitcnt lgkmcnt(12)
  v_mfma_f32_16x16x32_bf16 a[12:15], a[204:207], v[224:227], 0
  v_xor_b32 v9, 64, v5
  v_mfma_f32_16x16x32_bf16 a[76:79], a[204:207], v[232:235], 0
  ds_read_b64_tr_b16 a[200:201], v9 offset:256
  v_mfma_f32_16x16x32_bf16 a[140:143], a[204:207], v[240:243], 0
  ds_read_b64_tr_b16 a[202:203], v9 offset:8448
  s_waitcnt lgkmcnt(12)
  v_mfma_f32_16x16x32_bf16 a[16:19], a[208:211], v[224:227], 0
  v_xor_b32 v6, 96, v5
  v_mfma_f32_16x16x32_bf16 a[80:83], a[208:211], v[232:235], 0
  ds_read_b64_tr_b16 a[204:205], v6 offset:256
  v_mfma_f32_16x16x32_bf16 a[144:147], a[208:211], v[240:243], 0
  ds_read_b64_tr_b16 a[206:207], v6 offset:8448
  s_waitcnt lgkmcnt(12)
  v_mfma_f32_16x16x32_bf16 a[20:23], a[212:215], v[224:227], 0
  v_xor_b32 v7, 128, v5
  v_mfma_f32_16x16x32_bf16 a[84:87], a[212:215], v[232:235], 0
  ds_read_b64_tr_b16 a[208:209], v7 offset:256
  v_mfma_f32_16x16x32_bf16 a[148:151], a[212:215], v[240:243], 0
  ds_read_b64_tr_b16 a[210:211], v7 offset:8448
  s_waitcnt lgkmcnt(12)
  v_mfma_f32_16x16x32_bf16 a[24:27], a[216:219], v[224:227], 0
  v_xor_b32 v8, 160, v5
  v_mfma_f32_16x16x32_bf16 a[88:91], a[216:219], v[232:235], 0
  ds_read_b64_tr_b16 a[212:213], v8 offset:256
  v_mfma_f32_16x16x32_bf16 a[152:155], a[216:219], v[240:243], 0
  ds_read_b64_tr_b16 a[214:215], v8 offset:8448
  s_waitcnt lgkmcnt(12)
  v_mfma_f32_16x16x32_bf16 a[28:31], a[220:223], v[224:227], 0
  v_xor_b32 v9, 192, v5
  v_mfma_f32_16x16x32_bf16 a[92:95], a[220:223], v[232:235], 0
  ds_read_b64_tr_b16 a[216:217], v9 offset:256
  v_mfma_f32_16x16x32_bf16 a[156:159], a[220:223], v[240:243], 0
  ds_read_b64_tr_b16 a[218:219], v9 offset:8448
  s_waitcnt lgkmcnt(12)
  v_mfma_f32_16x16x32_bf16 a[32:35], a[192:195], v[224:227], 0
  v_xor_b32 v6, 224, v5
  v_mfma_f32_16x16x32_bf16 a[96:99], a[192:195], v[232:235], 0
  ds_read_b64_tr_b16 a[220:221], v6 offset:256
  v_mfma_f32_16x16x32_bf16 a[160:163], a[192:195], v[240:243], 0
  ds_read_b64_tr_b16 a[222:223], v6 offset:8448
  s_waitcnt lgkmcnt(12)
  v_mfma_f32_16x16x32_bf16 a[36:39], a[196:199], v[224:227], 0
  s_waitcnt vmcnt(21)
  s_barrier
  s_add_u32 m0, s50, 114688
  s_mov_b32 s53, 81920
  buffer_load_dwordx4 v248, s[20:23], s53 offen nt lds
  v_mfma_f32_16x16x32_bf16 a[100:103], a[196:199], v[232:235], 0
  s_add_u32 m0, s50, 115712
  s_mov_b32 s53, 81920
  buffer_load_dwordx4 v249, s[20:23], s53 offen nt lds
  s_add_u32 m0, s50, 116736
  s_mov_b32 s53, 81920
  v_mfma_f32_16x16x32_bf16 a[164:167], a[196:199], v[240:243], 0
  buffer_load_dwordx4 v250, s[20:23], s53 offen nt lds
  v_add_u32 v5, 147456, v3
  v_xor_b32 v7, 0, v5
  ds_read_b64_tr_b16 a[192:193], v7 offset:0
  ds_read_b64_tr_b16 a[194:195], v7 offset:8192
  s_waitcnt lgkmcnt(12)
  v_mfma_f32_16x16x32_bf16 a[40:43], a[200:203], v[224:227], 0
  v_xor_b32 v8, 32, v5
  v_mfma_f32_16x16x32_bf16 a[104:107], a[200:203], v[232:235], 0
  ds_read_b64_tr_b16 a[196:197], v8 offset:0
  v_mfma_f32_16x16x32_bf16 a[168:171], a[200:203], v[240:243], 0
  ds_read_b64_tr_b16 a[198:199], v8 offset:8192
  s_waitcnt lgkmcnt(12)
  v_mfma_f32_16x16x32_bf16 a[44:47], a[204:207], v[224:227], 0
  v_xor_b32 v9, 64, v5
  v_mfma_f32_16x16x32_bf16 a[108:111], a[204:207], v[232:235], 0
  ds_read_b64_tr_b16 a[200:201], v9 offset:0
  v_mfma_f32_16x16x32_bf16 a[172:175], a[204:207], v[240:243], 0
  ds_read_b64_tr_b16 a[202:203], v9 offset:8192
  s_waitcnt lgkmcnt(12)
  v_mfma_f32_16x16x32_bf16 a[48:51], a[208:211], v[224:227], 0
  v_xor_b32 v6, 96, v5
  v_mfma_f32_16x16x32_bf16 a[112:115], a[208:211], v[232:235], 0
  ds_read_b64_tr_b16 a[204:205], v6 offset:0
  v_mfma_f32_16x16x32_bf16 a[176:179], a[208:211], v[240:243], 0
  ds_read_b64_tr_b16 a[206:207], v6 offset:8192
  s_waitcnt lgkmcnt(12)
  v_mfma_f32_16x16x32_bf16 a[52:55], a[212:215], v[224:227], 0
  v_xor_b32 v7, 128, v5
  v_mfma_f32_16x16x32_bf16 a[116:119], a[212:215], v[232:235], 0
  ds_read_b64_tr_b16 a[208:209], v7 offset:0
  v_mfma_f32_16x16x32_bf16 a[180:183], a[212:215], v[240:243], 0
  ds_read_b64_tr_b16 a[210:211], v7 offset:8192
  s_waitcnt lgkmcnt(12)
  v_mfma_f32_16x16x32_bf16 a[56:59], a[216:219], v[224:227], 0
  v_xor_b32 v8, 160, v5
  v_mfma_f32_16x16x32_bf16 a[120:123], a[216:219], v[232:235], 0
  ds_read_b64_tr_b16 a[212:213], v8 offset:0
  v_mfma_f32_16x16x32_bf16 a[184:187], a[216:219], v[240:243], 0
  ds_read_b64_tr_b16 a[214:215], v8 offset:8192
  s_waitcnt lgkmcnt(12)
  v_mfma_f32_16x16x32_bf16 a[60:63], a[220:223], v[224:227], 0
  v_xor_b32 v9, 192, v5
  v_mfma_f32_16x16x32_bf16 a[124:127], a[220:223], v[232:235], 0
  ds_read_b64_tr_b16 a[216:217], v9 offset:0
  v_mfma_f32_16x16x32_bf16 a[188:191], a[220:223], v[240:243], 0
  ds_read_b64_tr_b16 a[218:219], v9 offset:8192
  s_waitcnt lgkmcnt(12)
  v_mfma_f32_16x16x32_bf16 a[0:3], a[192:195], v[228:231], a[0:3]
  v_xor_b32 v6, 224, v5
  v_mfma_f32_16x16x32_bf16 a[64:67], a[192:195], v[236:239], a[64:67]
  ds_read_b64_tr_b16 a[220:221], v6 offset:0
  v_mfma_f32_16x16x32_bf16 a[128:131], a[192:195], v[244:247], a[128:131]
  ds_read_b64_tr_b16 a[222:223], v6 offset:8192
  s_waitcnt lgkmcnt(12)
  v_mfma_f32_16x16x32_bf16 a[4:7], a[196:199], v[228:231], a[4:7]
  v_xor_b32 v7, 0, v5
  v_mfma_f32_16x16x32_bf16 a[68:71], a[196:199], v[236:239], a[68:71]
  ds_read_b64_tr_b16 a[192:193], v7 offset:256
  v_mfma_f32_16x16x32_bf16 a[132:135], a[196:199], v[244:247], a[132:135]
  ds_read_b64_tr_b16 a[194:195], v7 offset:8448
  s_waitcnt lgkmcnt(12)
  v_mfma_f32_16x16x32_bf16 a[8:11], a[200:203], v[228:231], a[8:11]
  v_xor_b32 v8, 32, v5
  v_mfma_f32_16x16x32_bf16 a[72:75], a[200:203], v[236:239], a[72:75]
  ds_read_b64_tr_b16 a[196:197], v8 offset:256
  v_mfma_f32_16x16x32_bf16 a[136:139], a[200:203], v[244:247], a[136:139]
  ds_read_b64_tr_b16 a[198:199], v8 offset:8448
  s_waitcnt lgkmcnt(12)
  v_mfma_f32_16x16x32_bf16 a[12:15], a[204:207], v[228:231], a[12:15]
  v_xor_b32 v9, 64, v5
  v_mfma_f32_16x16x32_bf16 a[76:79], a[204:207], v[236:239], a[76:79]
  ds_read_b64_tr_b16 a[200:201], v9 offset:256
  v_mfma_f32_16x16x32_bf16 a[140:143], a[204:207], v[244:247], a[140:143]
  ds_read_b64_tr_b16 a[202:203], v9 offset:8448
  s_waitcnt lgkmcnt(12)
  v_mfma_f32_16x16x32_bf16 a[16:19], a[208:211], v[228:231], a[16:19]
  v_xor_b32 v6, 96, v5
  v_mfma_f32_16x16x32_bf16 a[80:83], a[208:211], v[236:239], a[80:83]
  ds_read_b64_tr_b16 a[204:205], v6 offset:256
  v_mfma_f32_16x16x32_bf16 a[144:147], a[208:211], v[244:247], a[144:147]
  ds_read_b64_tr_b16 a[206:207], v6 offset:8448
  s_waitcnt lgkmcnt(12)
  v_mfma_f32_16x16x32_bf16 a[20:23], a[212:215], v[228:231], a[20:23]
  v_xor_b32 v7, 128, v5
  v_mfma_f32_16x16x32_bf16 a[84:87], a[212:215], v[236:239], a[84:87]
  ds_read_b64_tr_b16 a[208:209], v7 offset:256
  v_mfma_f32_16x16x32_bf16 a[148:151], a[212:215], v[244:247], a[148:151]
  ds_read_b64_tr_b16 a[210:211], v7 offset:8448
  s_waitcnt lgkmcnt(12)
  v_mfma_f32_16x16x32_bf16 a[24:27], a[216:219], v[228:231], a[24:27]
  v_xor_b32 v8, 160, v5
  v_mfma_f32_16x16x32_bf16 a[88:91], a[216:219], v[236:239], a[88:91]
  ds_read_b64_tr_b16 a[212:213], v8 offset:256
  v_mfma_f32_16x16x32_bf16 a[152:155], a[216:219], v[244:247], a[152:155]
  ds_read_b64_tr_b16 a[214:215], v8 offset:8448
  s_waitcnt lgkmcnt(12)
  v_mfma_f32_16x16x32_bf16 a[28:31], a[220:223], v[228:231], a[28:31]
  v_xor_b32 v9, 192, v5
  v_mfma_f32_16x16x32_bf16 a[92:95], a[220:223], v[236:239], a[92:95]
  ds_read_b64_tr_b16 a[216:217], v9 offset:256
  v_mfma_f32_16x16x32_bf16 a[156:159], a[220:223], v[244:247], a[156:159]
  ds_read_b64_tr_b16 a[218:219], v9 offset:8448
  s_waitcnt lgkmcnt(12)
  v_mfma_f32_16x16x32_bf16 a[32:35], a[192:195], v[228:231], a[32:35]
  v_xor_b32 v6, 224, v5
  v_mfma_f32_16x16x32_bf16 a[96:99], a[192:195], v[236:239], a[96:99]
  ds_read_b64_tr_b16 a[220:221], v6 offset:256
  v_mfma_f32_16x16x32_bf16 a[160:163], a[192:195], v[244:247], a[160:163]
  ds_read_b64_tr_b16 a[222:223], v6 offset:8448
  s_waitcnt lgkmcnt(12)
  v_mfma_f32_16x16x32_bf16 a[36:39], a[196:199], v[228:231], a[36:39]
  s_waitcnt vmcnt(21)
  s_barrier
  s_add_u32 m0, s50, 131072
  s_mov_b32 s53, 131072
  v_mfma_f32_16x16x32_bf16 a[100:103], a[196:199], v[236:239], a[100:103]
  buffer_load_dwordx4 v248, s[16:19], s53 offen nt lds
  s_add_u32 m0, s50, 132096
  s_mov_b32 s53, 131072
  buffer_load_dwordx4 v249, s[16:19], s53 offen nt lds
  s_add_u32 m0, s50, 133120
  v_mfma_f32_16x16x32_bf16 a[164:167], a[196:199], v[244:247], a[164:167]
  s_mov_b32 s53, 131072
  buffer_load_dwordx4 v250, s[16:19], s53 offen nt lds
  v_add_u32 v5, 0, v2
  v_xor_b32 v7, 0, v5
  ds_read_b128 a[192:195], v7 offset:0
  s_waitcnt lgkmcnt(11)
  v_mfma_f32_16x16x32_bf16 a[40:43], a[200:203], v[228:231], a[40:43]
  v_mfma_f32_16x16x32_bf16 a[104:107], a[200:203], v[236:239], a[104:107]
  v_mfma_f32_16x16x32_bf16 a[168:171], a[200:203], v[244:247], a[168:171]
  ds_read_b128 a[196:199], v7 offset:8192
  s_waitcnt lgkmcnt(10)
  v_mfma_f32_16x16x32_bf16 a[44:47], a[204:207], v[228:231], a[44:47]
  v_mfma_f32_16x16x32_bf16 a[108:111], a[204:207], v[236:239], a[108:111]
  v_xor_b32 v8, 64, v5
  v_mfma_f32_16x16x32_bf16 a[172:175], a[204:207], v[244:247], a[172:175]
  ds_read_b128 a[200:203], v8 offset:0
  s_waitcnt lgkmcnt(9)
  v_mfma_f32_16x16x32_bf16 a[48:51], a[208:211], v[228:231], a[48:51]
  v_mfma_f32_16x16x32_bf16 a[112:115], a[208:211], v[236:239], a[112:115]
  v_mfma_f32_16x16x32_bf16 a[176:179], a[208:211], v[244:247], a[176:179]
  ds_read_b128 a[204:207], v8 offset:8192
  s_waitcnt lgkmcnt(8)
  v_mfma_f32_16x16x32_bf16 a[52:55], a[212:215], v[228:231], a[52:55]
  v_mfma_f32_16x16x32_bf16 a[116:119], a[212:215], v[236:239], a[116:119]
  v_xor_b32 v9, 128, v5
  v_mfma_f32_16x16x32_bf16 a[180:183], a[212:215], v[244:247], a[180:183]
  ds_read_b128 a[208:211], v9 offset:0
  s_waitcnt lgkmcnt(7)
  v_mfma_f32_16x16x32_bf16 a[56:59], a[216:219], v[228:231], a[56:59]
  v_mfma_f32_16x16x32_bf16 a[120:123], a[216:219], v[236:239], a[120:123]
  v_mfma_f32_16x16x32_bf16 a[184:187], a[216:219], v[244:247], a[184:187]
  ds_read_b128 a[212:215], v9 offset:8192
  s_waitcnt lgkmcnt(6)
  v_mfma_f32_16x16x32_bf16 a[60:63], a[220:223], v[228:231], a[60:63]
  v_mfma_f32_16x16x32_bf16 a[124:127], a[220:223], v[236:239], a[124:127]
  v_xor_b32 v6, 192, v5
  v_mfma_f32_16x16x32_bf16 a[188:191], a[220:223], v[244:247], a[188:191]
  ds_read_b128 a[216:219], v6 offset:0
  s_waitcnt lgkmcnt(6)
  v_mfma_f32_16x16x32_bf16 v[128:131], a[192:195], v[32:35], 0
  v_mfma_f32_16x16x32_bf16 v[144:147], a[192:195], v[64:67], 0
  v_mfma_f32_16x16x32_bf16 v[160:163], a[192:195], v[96:99], 0
  ds_read_b128 a[220:223], v6 offset:8192
  s_waitcnt lgkmcnt(6)
  v_mfma_f32_16x16x32_bf16 v[132:135], a[196:199], v[32:35], 0
  v_max3_f32 v19, v176, v177, v178
  v_max3_f32 v20, v179, v180, v181
  v_mfma_f32_16x16x32_bf16 v[148:151], a[196:199], v[64:67], 0
  v_xor_b32 v7, 0, v5
  v_max3_f32 v21, v182, v183, v184
  v_max3_f32 v19, v19, v185, v186
  v_mfma_f32_16x16x32_bf16 v[164:167], a[196:199], v[96:99], 0
  ds_read_b128 a[192:195], v7 offset:256
  v_max3_f32 v20, v20, v187, v188
  v_max3_f32 v21, v21, v189, v190
  v_max3_f32 v19, v19, v20, v191
  s_waitcnt lgkmcnt(6)
  v_mfma_f32_16x16x32_bf16 v[128:131], a[200:203], v[36:39], v[128:131]
  v_max_f32 v16, v19, v21
  v_mov_b32 v19, v16
  v_mfma_f32_16x16x32_bf16 v[144:147], a[200:203], v[68:71], v[144:147]
  s_nop 1
  v_permlane32_swap_b32 v16, v19
  v_max_f32 v16, v16, v19
  v_mfma_f32_16x16x32_bf16 v[160:163], a[200:203], v[100:103], v[160:163]
  ds_read_b128 a[196:199], v7 offset:8448
  v_mov_b32 v19, v16
  s_nop 1
  s_waitcnt lgkmcnt(6)
  v_mfma_f32_16x16x32_bf16 v[132:135], a[204:207], v[36:39], v[132:135]
  v_permlane16_swap_b32 v16, v19
  v_max_f32 v16, v16, v19
  v_mul_f32 v16, s51, v16
  v_mfma_f32_16x16x32_bf16 v[148:151], a[204:207], v[68:71], v[148:151]
  v_xor_b32 v8, 64, v5
  v_max3_f32 v22, v192, v193, v194
  v_max3_f32 v23, v195, v196, v197
  v_mfma_f32_16x16x32_bf16 v[164:167], a[204:207], v[100:103], v[164:167]
  ds_read_b128 a[200:203], v8 offset:256
  v_max3_f32 v24, v198, v199, v200
  v_max3_f32 v22, v22, v201, v202
  v_max3_f32 v23, v23, v203, v204
  s_waitcnt lgkmcnt(6)
  v_mfma_f32_16x16x32_bf16 v[128:131], a[208:211], v[40:43], v[128:131]
  v_max3_f32 v24, v24, v205, v206
  v_max3_f32 v22, v22, v23, v207
  v_mfma_f32_16x16x32_bf16 v[144:147], a[208:211], v[72:75], v[144:147]
  v_max_f32 v17, v22, v24
  v_mov_b32 v22, v17
  s_nop 1
  v_mfma_f32_16x16x32_bf16 v[160:163], a[208:211], v[104:107], v[160:163]
  ds_read_b128 a[204:207], v8 offset:8448
  v_permlane32_swap_b32 v17, v22
  v_max_f32 v17, v17, v22
  s_waitcnt lgkmcnt(6)
  v_mfma_f32_16x16x32_bf16 v[132:135], a[212:215], v[40:43], v[132:135]
  v_mov_b32 v22, v17
  s_nop 1
  v_permlane16_swap_b32 v17, v22
  v_mfma_f32_16x16x32_bf16 v[148:151], a[212:215], v[72:75], v[148:151]
  v_xor_b32 v9, 128, v5
  v_max_f32 v17, v17, v22
  v_mul_f32 v17, s51, v17
  v_mfma_f32_16x16x32_bf16 v[164:167], a[212:215], v[104:107], v[164:167]
  ds_read_b128 a[208:211], v9 offset:256
  v_max3_f32 v25, v208, v209, v210
  v_max3_f32 v26, v211, v212, v213
  v_max3_f32 v27, v214, v215, v216
  s_waitcnt lgkmcnt(6)
  v_mfma_f32_16x16x32_bf16 v[128:131], a[216:219], v[44:47], v[128:131]
  v_max3_f32 v25, v25, v217, v218
  v_max3_f32 v26, v26, v219, v220
  v_mfma_f32_16x16x32_bf16 v[144:147], a[216:219], v[76:79], v[144:147]
  v_max3_f32 v27, v27, v221, v222
  v_max3_f32 v25, v25, v26, v223
  v_max_f32 v18, v25, v27
  v_mfma_f32_16x16x32_bf16 v[160:163], a[216:219], v[108:111], v[160:163]
  ds_read_b128 a[212:215], v9 offset:8448
  v_mov_b32 v25, v18
  s_nop 1
  s_waitcnt lgkmcnt(6)
  v_mfma_f32_16x16x32_bf16 v[132:135], a[220:223], v[44:47], v[132:135]
  v_permlane32_swap_b32 v18, v25
  v_max_f32 v18, v18, v25
  v_mov_b32 v25, v18
  v_mfma_f32_16x16x32_bf16 v[148:151], a[220:223], v[76:79], v[148:151]
  v_xor_b32 v6, 192, v5
  s_nop 1
  v_permlane16_swap_b32 v18, v25
  v_mfma_f32_16x16x32_bf16 v[164:167], a[220:223], v[108:111], v[164:167]
  ds_read_b128 a[216:219], v6 offset:256
  v_max_f32 v18, v18, v25
  v_mul_f32 v18, s51, v18
  v_sub_f32 v19, v16, v10
  s_waitcnt lgkmcnt(6)
  v_mfma_f32_16x16x32_bf16 v[128:131], a[192:195], v[48:51], v[128:131]
  v_sub_f32 v20, v17, v11
  v_sub_f32 v21, v18, v12
  v_mfma_f32_16x16x32_bf16 v[144:147], a[192:195], v[80:83], v[144:147]
  v_max3_f32 v19, v19, v20, v21
  v_cmp_lt_f32 vcc, s52, v19
  s_cbranch_vccnz Lrare_1
Lrare_1_ret:
  v_mfma_f32_16x16x32_bf16 v[160:163], a[192:195], v[112:115], v[160:163]
  ds_read_b128 a[220:223], v6 offset:8448
  v_fma_f32 v176, v176, s51, -v10
  v_fma_f32 v177, v177, s51, -v10
  s_waitcnt lgkmcnt(6)
  v_mfma_f32_16x16x32_bf16 v[132:135], a[196:199], v[48:51], v[132:135]
  s_waitcnt vmcnt(21)
  s_barrier
  s_add_u32 m0, s50, 147456
  s_mov_b32 s53, 147456
  v_fma_f32 v178, v178, s51, -v10
  v_fma_f32 v179, v179, s51, -v10
  v_fma_f32 v180, v180, s51, -v10
  v_mfma_f32_16x16x32_bf16 v[148:151], a[196:199], v[80:83], v[148:151]
  buffer_load_dwordx4 v248, s[16:19], s53 offen nt lds
  s_add_u32 m0, s50, 148480
  s_mov_b32 s53, 147456
  buffer_load_dwordx4 v249, s[16:19], s53 offen nt lds
  s_add_u32 m0, s50, 149504
  v_fma_f32 v181, v181, s51, -v10
  v_fma_f32 v182, v182, s51, -v10
  v_mfma_f32_16x16x32_bf16 v[164:167], a[196:199], v[112:115], v[164:167]
  s_mov_b32 s53, 147456
  buffer_load_dwordx4 v250, s[16:19], s53 offen nt lds
  v_add_u32 v5, 16384, v2
  v_xor_b32 v7, 0, v5
  ds_read_b128 a[192:195], v7 offset:0
  v_fma_f32 v183, v183, s51, -v10
  v_fma_f32 v184, v184, s51, -v10
  v_fma_f32 v185, v185, s51, -v10
  s_waitcnt lgkmcnt(6)
  v_mfma_f32_16x16x32_bf16 v[128:131], a[200:203], v[52:55], v[128:131]
  v_fma_f32 v186, v186, s51, -v10
  v_fma_f32 v187, v187, s51, -v10
  v_mfma_f32_16x16x32_bf16 v[144:147], a[200:203], v[84:87], v[144:147]
  v_fma_f32 v188, v188, s51, -v10
  v_fma_f32 v189, v189, s51, -v10
  v_fma_f32 v190, v190, s51, -v10
  v_mfma_f32_16x16x32_bf16 v[160:163], a[200:203], v[116:119], v[160:163]
  ds_read_b128 a[196:199], v7 offset:8192
  v_fma_f32 v191, v191, s51, -v10
  v_exp_f32 v176, v176
  s_waitcnt lgkmcnt(6)
  v_mfma_f32_16x16x32_bf16 v[132:135], a[204:207], v[52:55], v[132:135]
  v_exp_f32 v177, v177
  v_exp_f32 v178, v178
  v_exp_f32 v179, v179
  v_mfma_f32_16x16x32_bf16 v[148:151], a[204:207], v[84:87], v[148:151]
  v_xor_b32 v8, 64, v5
  v_exp_f32 v180, v180
  v_exp_f32 v181, v181
  v_mfma_f32_16x16x32_bf16 v[164:167], a[204:207], v[116:119], v[164:167]
  ds_read_b128 a[200:203], v8 offset:0
  v_exp_f32 v182, v182
  v_exp_f32 v183, v183
  v_exp_f32 v184, v184
  s_waitcnt lgkmcnt(6)
  v_mfma_f32_16x16x32_bf16 v[128:131], a[208:211], v[56:59], v[128:131]
  v_exp_f32 v185, v185
  v_exp_f32 v186, v186
  v_mfma_f32_16x16x32_bf16 v[144:147], a[208:211], v[88:91], v[144:147]
  v_exp_f32 v187, v187
  v_exp_f32 v188, v188
  v_exp_f32 v189, v189
  v_mfma_f32_16x16x32_bf16 v[160:163], a[208:211], v[120:123], v[160:163]
  ds_read_b128 a[204:207], v8 offset:8192
  v_exp_f32 v190, v190
  v_exp_f32 v191, v191
  s_waitcnt lgkmcnt(6)
  v_mfma_f32_16x16x32_bf16 v[132:135], a[212:215], v[56:59], v[132:135]
  v_fma_f32 v192, v192, s51, -v11
  v_fma_f32 v193, v193, s51, -v11
  v_fma_f32 v194, v194, s51, -v11
  v_mfma_f32_16x16x32_bf16 v[148:151], a[212:215], v[88:91], v[148:151]
  v_xor_b32 v9, 128, v5
  v_fma_f32 v195, v195, s51, -v11
  v_fma_f32 v196, v196, s51, -v11
  v_mfma_f32_16x16x32_bf16 v[164:167], a[212:215], v[120:123], v[164:167]
  ds_read_b128 a[208:211], v9 offset:0
  v_fma_f32 v197, v197, s51, -v11
  v_fma_f32 v198, v198, s51, -v11
  v_fma_f32 v199, v199, s51, -v11
  s_waitcnt lgkmcnt(6)
  v_mfma_f32_16x16x32_bf16 v[128:131], a[216:219], v[60:63], v[128:131]
  v_fma_f32 v200, v200, s51, -v11
  v_fma_f32 v201, v201, s51, -v11
  v_mfma_f32_16x16x32_bf16 v[144:147], a[216:219], v[92:95], v[144:147]
  v_fma_f32 v202, v202, s51, -v11
  v_fma_f32 v203, v203, s51, -v11
  v_fma_f32 v204, v204, s51, -v11
  v_mfma_f32_16x16x32_bf16 v[160:163], a[216:219], v[124:127], v[160:163]
  ds_read_b128 a[212:215], v9 offset:8192
  v_fma_f32 v205, v205, s51, -v11
  v_fma_f32 v206, v206, s51, -v11
  s_waitcnt lgkmcnt(6)
  v_mfma_f32_16x16x32_bf16 v[132:135], a[220:223], v[60:63], v[132:135]
  v_fma_f32 v207, v207, s51, -v11
  v_exp_f32 v192, v192
  v_exp_f32 v193, v193
  v_mfma_f32_16x16x32_bf16 v[148:151], a[220:223], v[92:95], v[148:151]
  v_xor_b32 v6, 192, v5
  v_exp_f32 v194, v194
  v_exp_f32 v195, v195
  v_mfma_f32_16x16x32_bf16 v[164:167], a[220:223], v[124:127], v[164:167]
  ds_read_b128 a[216:219], v6 offset:0
  v_exp_f32 v196, v196
  v_exp_f32 v197, v197
  v_exp_f32 v198, v198
  s_waitcnt lgkmcnt(6)
  v_mfma_f32_16x16x32_bf16 v[136:139], a[192:195], v[32:35], 0
  v_mfma_f32_16x16x32_bf16 v[152:155], a[192:195], v[64:67], 0
  v_mfma_f32_16x16x32_bf16 v[168:171], a[192:195], v[96:99], 0
  ds_read_b128 a[220:223], v6 offset:8192
  s_waitcnt lgkmcnt(6)
  v_mfma_f32_16x16x32_bf16 v[140:143], a[196:199], v[32:35], 0
  v_exp_f32 v199, v199
  v_exp_f32 v200, v200
  v_mfma_f32_16x16x32_bf16 v[156:159], a[196:199], v[64:67], 0
  v_xor_b32 v7, 0, v5
  v_exp_f32 v201, v201
  v_exp_f32 v202, v202
  v_exp_f32 v203, v203
  v_mfma_f32_16x16x32_bf16 v[172:175], a[196:199], v[96:99], 0
  ds_read_b128 a[192:195], v7 offset:256
  v_exp_f32 v204, v204
  v_exp_f32 v205, v205
  s_waitcnt lgkmcnt(6)
  v_mfma_f32_16x16x32_bf16 v[136:139], a[200:203], v[36:39], v[136:139]
  v_exp_f32 v206, v206
  v_exp_f32 v207, v207
  v_fma_f32 v208, v208, s51, -v12
  v_mfma_f32_16x16x32_bf16 v[152:155], a[200:203], v[68:71], v[152:155]
  v_fma_f32 v209, v209, s51, -v12
  v_fma_f32 v210, v210, s51, -v12
  v_mfma_f32_16x16x32_bf16 v[168:171], a[200:203], v[100:103], v[168:171]
  ds_read_b128 a[196:199], v7 offset:8448
  v_fma_f32 v211, v211, s51, -v12
  v_fma_f32 v212, v212, s51, -v12
  v_fma_f32 v213, v213, s51, -v12
  s_waitcnt lgkmcnt(6)
  v_mfma_f32_16x16x32_bf16 v[140:143], a[204:207], v[36:39], v[140:143]
  v_fma_f32 v214, v214, s51, -v12
  v_fma_f32 v215, v215, s51, -v12
  v_mfma_f32_16x16x32_bf16 v[156:159], a[204:207], v[68:71], v[156:159]
  v_xor_b32 v8, 64, v5
  v_fma_f32 v216, v216, s51, -v12
  v_fma_f32 v217, v217, s51, -v12
  v_fma_f32 v218, v218, s51, -v12
  v_mfma_f32_16x16x32_bf16 v[172:175], a[204:207], v[100:103], v[172:175]
  ds_read_b128 a[200:203], v8 offset:256
  v_fma_f32 v219, v219, s51, -v12
  v_fma_f32 v220, v220, s51, -v12
  s_waitcnt lgkmcnt(6)
  v_mfma_f32_16x16x32_bf16 v[136:139], a[208:211], v[40:43], v[136:139]
  v_fma_f32 v221, v221, s51, -v12
  v_fma_f32 v222, v222, s51, -v12
  v_fma_f32 v223, v223, s51, -v12
  v_mfma_f32_16x16x32_bf16 v[152:155], a[208:211], v[72:75], v[152:155]
  v_exp_f32 v208, v208
  v_exp_f32 v209, v209
  v_mfma_f32_16x16x32_bf16 v[168:171], a[208:211], v[104:107], v[168:171]
  ds_read_b128 a[204:207], v8 offset:8448
  v_exp_f32 v210, v210
  v_exp_f32 v211, v211
  v_exp_f32 v212, v212
  s_waitcnt lgkmcnt(6)
  v_mfma_f32_16x16x32_bf16 v[140:143], a[212:215], v[40:43], v[140:143]
  v_exp_f32 v213, v213
  v_exp_f32 v214, v214
  v_mfma_f32_16x16x32_bf16 v[156:159], a[212:215], v[72:75], v[156:159]
  v_xor_b32 v9, 128, v5
  v_exp_f32 v215, v215
  v_exp_f32 v216, v216
  v_exp_f32 v217, v217
  v_mfma_f32_16x16x32_bf16 v[172:175], a[212:215], v[104:107], v[172:175]
  ds_read_b128 a[208:211], v9 offset:256
  v_exp_f32 v218, v218
  v_exp_f32 v219, v219
  s_waitcnt lgkmcnt(6)
  v_mfma_f32_16x16x32_bf16 v[136:139], a[216:219], v[44:47], v[136:139]
  v_exp_f32 v220, v220
  v_exp_f32 v221, v221
  v_exp_f32 v222, v222
  v_mfma_f32_16x16x32_bf16 v[152:155], a[216:219], v[76:79], v[152:155]
  v_exp_f32 v223, v223
  v_add_f32 v19, v176, v177
  v_mfma_f32_16x16x32_bf16 v[168:171], a[216:219], v[108:111], v[168:171]
  ds_read_b128 a[212:215], v9 offset:8448
  v_add_f32 v20, v178, v179
  v_add_f32 v19, v19, v180
  v_add_f32 v20, v20, v181
  s_waitcnt lgkmcnt(6)
  v_mfma_f32_16x16x32_bf16 v[140:143], a[220:223], v[44:47], v[140:143]
  v_add_f32 v19, v19, v182
  v_add_f32 v20, v20, v183
  v_mfma_f32_16x16x32_bf16 v[156:159], a[220:223], v[76:79], v[156:159]
  v_xor_b32 v6, 192, v5
  v_add_f32 v19, v19, v184
  v_add_f32 v20, v20, v185
  v_add_f32 v19, v19, v186
  v_mfma_f32_16x16x32_bf16 v[172:175], a[220:223], v[108:111], v[172:175]
  ds_read_b128 a[216:219], v6 offset:256
  v_add_f32 v20, v20, v187
  v_add_f32 v19, v19, v188
  s_waitcnt lgkmcnt(6)
  v_mfma_f32_16x16x32_bf16 v[136:139], a[192:195], v[48:51], v[136:139]
  v_add_f32 v20, v20, v189
  v_add_f32 v19, v19, v190
  v_add_f32 v20, v20, v191
  v_mfma_f32_16x16x32_bf16 v[152:155], a[192:195], v[80:83], v[152:155]
  v_add_f32 v19, v19, v20
  v_add_f32 v13, v13, v19
  v_mfma_f32_16x16x32_bf16 v[168:171], a[192:195], v[112:115], v[168:171]
  ds_read_b128 a[220:223], v6 offset:8448
  v_add_f32 v22, v192, v193
  v_add_f32 v23, v194, v195
  v_add_f32 v22, v22, v196
  s_waitcnt lgkmcnt(6)
  v_mfma_f32_16x16x32_bf16 v[140:143], a[196:199], v[48:51], v[140:143]
  s_waitcnt vmcnt(21)
  s_barrier
  s_add_u32 m0, s50, 0
  s_mov_b32 s53, 98304
  buffer_load_dwordx4 v248, s[20:23], s53 offen nt lds
  v_add_f32 v23, v23, v197
  v_add_f32 v22, v22, v198
  v_mfma_f32_16x16x32_bf16 v[156:159], a[196:199], v[80:83], v[156:159]
  s_add_u32 m0, s50, 1024
  s_mov_b32 s53, 98304
  buffer_load_dwordx4 v249, s[20:23], s53 offen nt lds
  s_add_u32 m0, s50, 2048
  s_mov_b32 s53, 98304
  v_add_f32 v23, v23, v199
  v_add_f32 v22, v22, v200
  v_add_f32 v23, v23, v201
  v_mfma_f32_16x16x32_bf16 v[172:175], a[196:199], v[112:115], v[172:175]
  buffer_load_dwordx4 v250, s[20:23], s53 offen nt lds
  v_add_u32 v5, 32768, v3
  v_xor_b32 v7, 0, v5
  ds_read_b64_tr_b16 a[192:193], v7 offset:0
  ds_read_b64_tr_b16 a[194:195], v7 offset:8192
  v_add_f32 v22, v22, v202
  v_add_f32 v23, v23, v203
  s_waitcnt lgkmcnt(7)
  v_mfma_f32_16x16x32_bf16 v[136:139], a[200:203], v[52:55], v[136:139]
  v_xor_b32 v8, 32, v5
  v_add_f32 v22, v22, v204
  v_add_f32 v23, v23, v205
  v_add_f32 v22, v22, v206
  v_mfma_f32_16x16x32_bf16 v[152:155], a[200:203], v[84:87], v[152:155]
  ds_read_b64_tr_b16 a[196:197], v8 offset:0
  v_add_f32 v23, v23, v207
  v_add_f32 v22, v22, v23
  v_mfma_f32_16x16x32_bf16 v[168:171], a[200:203], v[116:119], v[168:171]
  ds_read_b64_tr_b16 a[198:199], v8 offset:8192
  v_add_f32 v14, v14, v22
  v_add_f32 v25, v208, v209
  v_add_f32 v26, v210, v211
  s_waitcnt lgkmcnt(8)
  v_mfma_f32_16x16x32_bf16 v[140:143], a[204:207], v[52:55], v[140:143]
  v_xor_b32 v9, 64, v5
  v_add_f32 v25, v25, v212
  v_add_f32 v26, v26, v213
  v_mfma_f32_16x16x32_bf16 v[156:159], a[204:207], v[84:87], v[156:159]
  ds_read_b64_tr_b16 a[200:201], v9 offset:0
  v_add_f32 v25, v25, v214
  v_add_f32 v26, v26, v215
  v_add_f32 v25, v25, v216
  v_mfma_f32_16x16x32_bf16 v[172:175], a[204:207], v[116:119], v[172:175]
  ds_read_b64_tr_b16 a[202:203], v9 offset:8192
  v_add_f32 v26, v26, v217
  v_add_f32 v25, v25, v218
  s_waitcnt lgkmcnt(9)
  v_mfma_f32_16x16x32_bf16 v[136:139], a[208:211], v[56:59], v[136:139]
  v_xor_b32 v6, 96, v5
  v_add_f32 v26, v26, v219
  v_add_f32 v25, v25, v220
  v_add_f32 v26, v26, v221
  v_mfma_f32_16x16x32_bf16 v[152:155], a[208:211], v[88:91], v[152:155]
  ds_read_b64_tr_b16 a[204:205], v6 offset:0
  v_add_f32 v25, v25, v222
  v_add_f32 v26, v26, v223
  v_mfma_f32_16x16x32_bf16 v[168:171], a[208:211], v[120:123], v[168:171]
  ds_read_b64_tr_b16 a[206:207], v6 offset:8192
  v_add_f32 v25, v25, v26
  v_add_f32 v15, v15, v25
  v_cvt_pk_bf16_f32 v224, v176, v177
  s_waitcnt lgkmcnt(10)
  v_mfma_f32_16x16x32_bf16 v[140:143], a[212:215], v[56:59], v[140:143]
  v_xor_b32 v7, 128, v5
  v_cvt_pk_bf16_f32 v225, v178, v179
  v_cvt_pk_bf16_f32 v226, v180, v181
  v_mfma_f32_16x16x32_bf16 v[156:159], a[212:215], v[88:91], v[156:159]
  ds_read_b64_tr_b16 a[208:209], v7 offset:0
  v_cvt_pk_bf16_f32 v227, v182, v183
  v_cvt_pk_bf16_f32 v228, v184, v185
  v_cvt_pk_bf16_f32 v229, v186, v187
  v_mfma_f32_16x16x32_bf16 v[172:175], a[212:215], v[120:123], v[172:175]
  ds_read_b64_tr_b16 a[210:211], v7 offset:8192
  v_cvt_pk_bf16_f32 v230, v188, v189
  v_cvt_pk_bf16_f32 v231, v190, v191
  s_waitcnt lgkmcnt(11)
  v_mfma_f32_16x16x32_bf16 v[136:139], a[216:219], v[60:63], v[136:139]
  v_xor_b32 v8, 160, v5
  v_cvt_pk_bf16_f32 v232, v192, v193
  v_cvt_pk_bf16_f32 v233, v194, v195
  v_cvt_pk_bf16_f32 v234, v196, v197
  v_mfma_f32_16x16x32_bf16 v[152:155], a[216:219], v[92:95], v[152:155]
  ds_read_b64_tr_b16 a[212:213], v8 offset:0
  v_cvt_pk_bf16_f32 v235, v198, v199
  v_cvt_pk_bf16_f32 v236, v200, v201
  v_mfma_f32_16x16x32_bf16 v[168:171], a[216:219], v[124:127], v[168:171]
  ds_read_b64_tr_b16 a[214:215], v8 offset:8192
  v_cvt_pk_bf16_f32 v237, v202, v203
  v_cvt_pk_bf16_f32 v238, v204, v205
  v_cvt_pk_bf16_f32 v239, v206, v207
  s_waitcnt lgkmcnt(12)
  v_mfma_f32_16x16x32_bf16 v[140:143], a[220:223], v[60:63], v[140:143]
  v_xor_b32 v9, 192, v5
  v_cvt_pk_bf16_f32 v240, v208, v209
  v_cvt_pk_bf16_f32 v241, v210, v211
  v_mfma_f32_16x16x32_bf16 v[156:159], a[220:223], v[92:95], v[156:159]
  ds_read_b64_tr_b16 a[216:217], v9 offset:0
  v_cvt_pk_bf16_f32 v242, v212, v213
  v_cvt_pk_bf16_f32 v243, v214, v215
  v_cvt_pk_bf16_f32 v244, v216, v217
  v_mfma_f32_16x16x32_bf16 v[172:175], a[220:223], v[124:127], v[172:175]
  ds_read_b64_tr_b16 a[218:219], v9 offset:8192
  v_cvt_pk_bf16_f32 v245, v218, v219
  v_cvt_pk_bf16_f32 v246, v220, v221
  v_cvt_pk_bf16_f32 v247, v222, v223
  s_waitcnt lgkmcnt(12)
  v_mfma_f32_16x16x32_bf16 a[0:3], a[192:195], v[224:227], a[0:3]
  v_xor_b32 v6, 224, v5
  v_mfma_f32_16x16x32_bf16 a[64:67], a[192:195], v[232:235], a[64:67]
  ds_read_b64_tr_b16 a[220:221], v6 offset:0
  v_mfma_f32_16x16x32_bf16 a[128:131], a[192:195], v[240:243], a[128:131]
  ds_read_b64_tr_b16 a[222:223], v6 offset:8192
  s_waitcnt lgkmcnt(12)
  v_mfma_f32_16x16x32_bf16 a[4:7], a[196:199], v[224:227], a[4:7]
  v_xor_b32 v7, 0, v5
  v_mfma_f32_16x16x32_bf16 a[68:71], a[196:199], v[232:235], a[68:71]
  ds_read_b64_tr_b16 a[192:193], v7 offset:256
  v_mfma_f32_16x16x32_bf16 a[132:135], a[196:199], v[240:243], a[132:135]
  ds_read_b64_tr_b16 a[194:195], v7 offset:8448
  s_waitcnt lgkmcnt(12)
  v_mfma_f32_16x16x32_bf16 a[8:11], a[200:203], v[224:227], a[8:11]
  v_xor_b32 v8, 32, v5
  v_mfma_f32_16x16x32_bf16 a[72:75], a[200:203], v[232:235], a[72:75]
  ds_read_b64_tr_b16 a[196:197], v8 offset:256
  v_mfma_f32_16x16x32_bf16 a[136:139], a[200:203], v[240:243], a[136:139]
  ds_read_b64_tr_b16 a[198:199], v8 offset:8448
  s_waitcnt lgkmcnt(12)
  v_mfma_f32_16x16x32_bf16 a[12:15], a[204:207], v[224:227], a[12:15]
  v_xor_b32 v9, 64, v5
  v_mfma_f32_16x16x32_bf16 a[76:79], a[204:207], v[232:235], a[76:79]
  ds_read_b64_tr_b16 a[200:201], v9 offset:256
  v_mfma_f32_16x16x32_bf16 a[140:143], a[204:207], v[240:243], a[140:143]
  ds_read_b64_tr_b16 a[202:203], v9 offset:8448
  s_waitcnt lgkmcnt(12)
  v_mfma_f32_16x16x32_bf16 a[16:19], a[208:211], v[224:227], a[16:19]
  v_xor_b32 v6, 96, v5
  v_mfma_f32_16x16x32_bf16 a[80:83], a[208:211], v[232:235], a[80:83]
  ds_read_b64_tr_b16 a[204:205], v6 offset:256
  v_mfma_f32_16x16x32_bf16 a[144:147], a[208:211], v[240:243], a[144:147]
  ds_read_b64_tr_b16 a[206:207], v6 offset:8448
  s_waitcnt lgkmcnt(12)
  v_mfma_f32_16x16x32_bf16 a[20:23], a[212:215], v[224:227], a[20:23]
  v_xor_b32 v7, 128, v5
  v_mfma_f32_16x16x32_bf16 a[84:87], a[212:215], v[232:235], a[84:87]
  ds_read_b64_tr_b16 a[208:209], v7 offset:256
  v_mfma_f32_16x16x32_bf16 a[148:151], a[212:215], v[240:243], a[148:151]
  ds_read_b64_tr_b16 a[210:211], v7 offset:8448
  s_waitcnt lgkmcnt(12)
  v_mfma_f32_16x16x32_bf16 a[24:27], a[216:219], v[224:227], a[24:27]
  v_xor_b32 v8, 160, v5
  v_mfma_f32_16x16x32_bf16 a[88:91], a[216:219], v[232:235], a[88:91]
  ds_read_b64_tr_b16 a[212:213], v8 offset:256
  v_mfma_f32_16x16x32_bf16 a[152:155], a[216:219], v[240:243], a[152:155]
  ds_read_b64_tr_b16 a[214:215], v8 offset:8448
  s_waitcnt lgkmcnt(12)
  v_mfma_f32_16x16x32_bf16 a[28:31], a[220:223], v[224:227], a[28:31]
  v_xor_b32 v9, 192, v5
  v_mfma_f32_16x16x32_bf16 a[92:95], a[220:223], v[232:235], a[92:95]
  ds_read_b64_tr_b16 a[216:217], v9 offset:256
  v_mfma_f32_16x16x32_bf16 a[156:159], a[220:223], v[240:243], a[156:159]
  ds_read_b64_tr_b16 a[218:219], v9 offset:8448
  s_waitcnt lgkmcnt(12)
  v_mfma_f32_16x16x32_bf16 a[32:35], a[192:195], v[224:227], a[32:35]
  v_xor_b32 v6, 224, v5
  v_mfma_f32_16x16x32_bf16 a[96:99], a[192:195], v[232:235], a[96:99]
  ds_read_b64_tr_b16 a[220:221], v6 offset:256
  v_mfma_f32_16x16x32_bf16 a[160:163], a[192:195], v[240:243], a[160:163]
  ds_read_b64_tr_b16 a[222:223], v6 offset:8448
  s_waitcnt lgkmcnt(12)
  v_mfma_f32_16x16x32_bf16 a[36:39], a[196:199], v[224:227], a[36:39]
  s_waitcnt vmcnt(21)
  s_barrier
  s_add_u32 m0, s50, 16384
  s_mov_b32 s53, 114688
  buffer_load_dwordx4 v248, s[20:23], s53 offen nt lds
  v_mfma_f32_16x16x32_bf16 a[100:103], a[196:199], v[232:235], a[100:103]
  s_add_u32 m0, s50, 17408
  s_mov_b32 s53, 114688
  buffer_load_dwordx4 v249, s[20:23], s53 offen nt lds
  s_add_u32 m0, s50, 18432
  s_mov_b32 s53, 114688
  v_mfma_f32_16x16x32_bf16 a[164:167], a[196:199], v[240:243], a[164:167]
  buffer_load_dwordx4 v250, s[20:23], s53 offen nt lds
  v_add_u32 v5, 49152, v3
  v_xor_b32 v7, 0, v5
  ds_read_b64_tr_b16 a[192:193], v7 offset:0
  ds_read_b64_tr_b16 a[194:195], v7 offset:8192
  s_waitcnt lgkmcnt(12)
  v_mfma_f32_16x16x32_bf16 a[40:43], a[200:203], v[224:227], a[40:43]
  v_xor_b32 v8, 32, v5
  v_mfma_f32_16x16x32_bf16 a[104:107], a[200:203], v[232:235], a[104:107]
  ds_read_b64_tr_b16 a[196:197], v8 offset:0
  v_mfma_f32_16x16x32_bf16 a[168:171], a[200:203], v[240:243], a[168:171]
  ds_read_b64_tr_b16 a[198:199], v8 offset:8192
  s_waitcnt lgkmcnt(12)
  v_mfma_f32_16x16x32_bf16 a[44:47], a[204:207], v[224:227], a[44:47]
  v_xor_b32 v9, 64, v5
  v_mfma_f32_16x16x32_bf16 a[108:111], a[204:207], v[232:235], a[108:111]
  ds_read_b64_tr_b16 a[200:201], v9 offset:0
  v_mfma_f32_16x16x32_bf16 a[172:175], a[204:207], v[240:243], a[172:175]
  ds_read_b64_tr_b16 a[202:203], v9 offset:8192
  s_waitcnt lgkmcnt(12)
  v_mfma_f32_16x16x32_bf16 a[48:51], a[208:211], v[224:227], a[48:51]
  v_xor_b32 v6, 96, v5
  v_mfma_f32_16x16x32_bf16 a[112:115], a[208:211], v[232:235], a[112:115]
  ds_read_b64_tr_b16 a[204:205], v6 offset:0
  v_mfma_f32_16x16x32_bf16 a[176:179], a[208:211], v[240:243], a[176:179]
  ds_read_b64_tr_b16 a[206:207], v6 offset:8192
  s_waitcnt lgkmcnt(12)
  v_mfma_f32_16x16x32_bf16 a[52:55], a[212:215], v[224:227], a[52:55]
  v_xor_b32 v7, 128, v5
  v_mfma_f32_16x16x32_bf16 a[116:119], a[212:215], v[232:235], a[116:119]
  ds_read_b64_tr_b16 a[208:209], v7 offset:0
  v_mfma_f32_16x16x32_bf16 a[180:183], a[212:215], v[240:243], a[180:183]
  ds_read_b64_tr_b16 a[210:211], v7 offset:8192
  s_waitcnt lgkmcnt(12)
  v_mfma_f32_16x16x32_bf16 a[56:59], a[216:219], v[224:227], a[56:59]
  v_xor_b32 v8, 160, v5
  v_mfma_f32_16x16x32_bf16 a[120:123], a[216:219], v[232:235], a[120:123]
  ds_read_b64_tr_b16 a[212:213], v8 offset:0
  v_mfma_f32_16x16x32_bf16 a[184:187], a[216:219], v[240:243], a[184:187]
  ds_read_b64_tr_b16 a[214:215], v8 offset:8192
  s_waitcnt lgkmcnt(12)
  v_mfma_f32_16x16x32_bf16 a[60:63], a[220:223], v[224:227], a[60:63]
  v_xor_b32 v9, 192, v5
  v_mfma_f32_16x16x32_bf16 a[124:127], a[220:223], v[232:235], a[124:127]
  ds_read_b64_tr_b16 a[216:217], v9 offset:0
  v_mfma_f32_16x16x32_bf16 a[188:191], a[220:223], v[240:243], a[188:191]
  ds_read_b64_tr_b16 a[218:219], v9 offset:8192
  s_waitcnt lgkmcnt(12)
  v_mfma_f32_16x16x32_bf16 a[0:3], a[192:195], v[228:231], a[0:3]
  v_xor_b32 v6, 224, v5
  v_mfma_f32_16x16x32_bf16 a[64:67], a[192:195], v[236:239], a[64:67]
  ds_read_b64_tr_b16 a[220:221], v6 offset:0
  v_mfma_f32_16x16x32_bf16 a[128:131], a[192:195], v[244:247], a[128:131]
  ds_read_b64_tr_b16 a[222:223], v6 offset:8192
  s_waitcnt lgkmcnt(12)
  v_mfma_f32_16x16x32_bf16 a[4:7], a[196:199], v[228:231], a[4:7]
  v_xor_b32 v7, 0, v5
  v_mfma_f32_16x16x32_bf16 a[68:71], a[196:199], v[236:239], a[68:71]
  ds_read_b64_tr_b16 a[192:193], v7 offset:256
  v_mfma_f32_16x16x32_bf16 a[132:135], a[196:199], v[244:247], a[132:135]
  ds_read_b64_tr_b16 a[194:195], v7 offset:8448
  s_waitcnt lgkmcnt(12)
  v_mfma_f32_16x16x32_bf16 a[8:11], a[200:203], v[228:231], a[8:11]
  v_xor_b32 v8, 32, v5
  v_mfma_f32_16x16x32_bf16 a[72:75], a[200:203], v[236:239], a[72:75]
  ds_read_b64_tr_b16 a[196:197], v8 offset:256
  v_mfma_f32_16x16x32_bf16 a[136:139], a[200:203], v[244:247], a[136:139]
  ds_read_b64_tr_b16 a[198:199], v8 offset:8448
  s_waitcnt lgkmcnt(12)
  v_mfma_f32_16x16x32_bf16 a[12:15], a[204:207], v[228:231], a[12:15]
  v_xor_b32 v9, 64, v5
  v_mfma_f32_16x16x32_bf16 a[76:79], a[204:207], v[236:239], a[76:79]
  ds_read_b64_tr_b16 a[200:201], v9 offset:256
  v_mfma_f32_16x16x32_bf16 a[140:143], a[204:207], v[244:247], a[140:143]
  ds_read_b64_tr_b16 a[202:203], v9 offset:8448
  s_waitcnt lgkmcnt(12)
  v_mfma_f32_16x16x32_bf16 a[16:19], a[208:211], v[228:231], a[16:19]
  v_xor_b32 v6, 96, v5
  v_mfma_f32_16x16x32_bf16 a[80:83], a[208:211], v[236:239], a[80:83]
  ds_read_b64_tr_b16 a[204:205], v6 offset:256
  v_mfma_f32_16x16x32_bf16 a[144:147], a[208:211], v[244:247], a[144:147]
  ds_read_b64_tr_b16 a[206:207], v6 offset:8448
  s_waitcnt lgkmcnt(12)
  v_mfma_f32_16x16x32_bf16 a[20:23], a[212:215], v[228:231], a[20:23]
  v_xor_b32 v7, 128, v5
  v_mfma_f32_16x16x32_bf16 a[84:87], a[212:215], v[236:239], a[84:87]
  ds_read_b64_tr_b16 a[208:209], v7 offset:256
  v_mfma_f32_16x16x32_bf16 a[148:151], a[212:215], v[244:247], a[148:151]
  ds_read_b64_tr_b16 a[210:211], v7 offset:8448
  s_waitcnt lgkmcnt(12)
  v_mfma_f32_16x16x32_bf16 a[24:27], a[216:219], v[228:231], a[24:27]
  v_xor_b32 v8, 160, v5
  v_mfma_f32_16x16x32_bf16 a[88:91], a[216:219], v[236:239], a[88:91]
  ds_read_b64_tr_b16 a[212:213], v8 offset:256
  v_mfma_f32_16x16x32_bf16 a[152:155], a[216:219], v[244:247], a[152:155]
  ds_read_b64_tr_b16 a[214:215], v8 offset:8448
  s_waitcnt lgkmcnt(12)
  v_mfma_f32_16x16x32_bf16 a[28:31], a[220:223], v[228:231], a[28:31]
  v_xor_b32 v9, 192, v5
  v_mfma_f32_16x16x32_bf16 a[92:95], a[220:223], v[236:239], a[92:95]
  ds_read_b64_tr_b16 a[216:217], v9 offset:256
  v_mfma_f32_16x16x32_bf16 a[156:159], a[220:223], v[244:247], a[156:159]
  ds_read_b64_tr_b16 a[218:219], v9 offset:8448
  s_waitcnt lgkmcnt(12)
  v_mfma_f32_16x16x32_bf16 a[32:35], a[192:195], v[228:231], a[32:35]
  v_xor_b32 v6, 224, v5
  v_mfma_f32_16x16x32_bf16 a[96:99], a[192:195], v[236:239], a[96:99]
  ds_read_b64_tr_b16 a[220:221], v6 offset:256
  v_mfma_f32_16x16x32_bf16 a[160:163], a[192:195], v[244:247], a[160:163]
  ds_read_b64_tr_b16 a[222:223], v6 offset:8448
  s_waitcnt lgkmcnt(12)
  v_mfma_f32_16x16x32_bf16 a[36:39], a[196:199], v[228:231], a[36:39]
  s_waitcnt vmcnt(21)
  s_barrier
  s_add_u32 m0, s50, 32768
  s_mov_b32 s53, 163840
  v_mfma_f32_16x16x32_bf16 a[100:103], a[196:199], v[236:239], a[100:103]
  buffer_load_dwordx4 v248, s[16:19], s53 offen nt lds
  s_add_u32 m0, s50, 33792
  s_mov_b32 s53, 163840
  buffer_load_dwordx4 v249, s[16:19], s53 offen nt lds
  s_add_u32 m0, s50, 34816
  v_mfma_f32_16x16x32_bf16 a[164:167], a[196:199], v[244:247], a[164:167]
  s_mov_b32 s53, 163840
  buffer_load_dwordx4 v250, s[16:19], s53 offen nt lds
  v_add_u32 v5, 65536, v2
  v_xor_b32 v7, 0, v5
  ds_read_b128 a[192:195], v7 offset:0
  s_waitcnt lgkmcnt(11)
  v_mfma_f32_16x16x32_bf16 a[40:43], a[200:203], v[228:231], a[40:43]
  v_mfma_f32_16x16x32_bf16 a[104:107], a[200:203], v[236:239], a[104:107]
  v_mfma_f32_16x16x32_bf16 a[168:171], a[200:203], v[244:247], a[168:171]
  ds_read_b128 a[196:199], v7 offset:8192
  s_waitcnt lgkmcnt(10)
  v_mfma_f32_16x16x32_bf16 a[44:47], a[204:207], v[228:231], a[44:47]
  v_mfma_f32_16x16x32_bf16 a[108:111], a[204:207], v[236:239], a[108:111]
  v_xor_b32 v8, 64, v5
  v_mfma_f32_16x16x32_bf16 a[172:175], a[204:207], v[244:247], a[172:175]
  ds_read_b128 a[200:203], v8 offset:0
  s_waitcnt lgkmcnt(9)
  v_mfma_f32_16x16x32_bf16 a[48:51], a[208:211], v[228:231], a[48:51]
  v_mfma_f32_16x16x32_bf16 a[112:115], a[208:211], v[236:239], a[112:115]
  v_mfma_f32_16x16x32_bf16 a[176:179], a[208:211], v[244:247], a[176:179]
  ds_read_b128 a[204:207], v8 offset:8192
  s_waitcnt lgkmcnt(8)
  v_mfma_f32_16x16x32_bf16 a[52:55], a[212:215], v[228:231], a[52:55]
  v_mfma_f32_16x16x32_bf16 a[116:119], a[212:215], v[236:239], a[116:119]
  v_xor_b32 v9, 128, v5
  v_mfma_f32_16x16x32_bf16 a[180:183], a[212:215], v[244:247], a[180:183]
  ds_read_b128 a[208:211], v9 offset:0
  s_waitcnt lgkmcnt(7)
  v_mfma_f32_16x16x32_bf16 a[56:59], a[216:219], v[228:231], a[56:59]
  v_mfma_f32_16x16x32_bf16 a[120:123], a[216:219], v[236:239], a[120:123]
  v_mfma_f32_16x16x32_bf16 a[184:187], a[216:219], v[244:247], a[184:187]
  ds_read_b128 a[212:215], v9 offset:8192
  s_waitcnt lgkmcnt(6)
  v_mfma_f32_16x16x32_bf16 a[60:63], a[220:223], v[228:231], a[60:63]
  v_mfma_f32_16x16x32_bf16 a[124:127], a[220:223], v[236:239], a[124:127]
  v_xor_b32 v6, 192, v5
  v_mfma_f32_16x16x32_bf16 a[188:191], a[220:223], v[244:247], a[188:191]
  ds_read_b128 a[216:219], v6 offset:0
  s_waitcnt lgkmcnt(6)
  v_mfma_f32_16x16x32_bf16 v[176:179], a[192:195], v[32:35], 0
  v_mfma_f32_16x16x32_bf16 v[192:195], a[192:195], v[64:67], 0
  v_mfma_f32_16x16x32_bf16 v[208:211], a[192:195], v[96:99], 0
  ds_read_b128 a[220:223], v6 offset:8192
  s_waitcnt lgkmcnt(6)
  v_mfma_f32_16x16x32_bf16 v[180:183], a[196:199], v[32:35], 0
  v_max3_f32 v19, v128, v129, v130
  v_max3_f32 v20, v131, v132, v133
  v_mfma_f32_16x16x32_bf16 v[196:199], a[196:199], v[64:67], 0
  v_xor_b32 v7, 0, v5
  v_max3_f32 v21, v134, v135, v136
  v_max3_f32 v19, v19, v137, v138
  v_mfma_f32_16x16x32_bf16 v[212:215], a[196:199], v[96:99], 0
  ds_read_b128 a[192:195], v7 offset:256
  v_max3_f32 v20, v20, v139, v140
  v_max3_f32 v21, v21, v141, v142
  v_max3_f32 v19, v19, v20, v143
  s_waitcnt lgkmcnt(6)
  v_mfma_f32_16x16x32_bf16 v[176:179], a[200:203], v[36:39], v[176:179]
  v_max_f32 v16, v19, v21
  v_mov_b32 v19, v16
  v_mfma_f32_16x16x32_bf16 v[192:195], a[200:203], v[68:71], v[192:195]
  s_nop 1
  v_permlane32_swap_b32 v16, v19
  v_max_f32 v16, v16, v19
  v_mfma_f32_16x16x32_bf16 v[208:211], a[200:203], v[100:103], v[208:211]
  ds_read_b128 a[196:199], v7 offset:8448
  v_mov_b32 v19, v16
  s_nop 1
  s_waitcnt lgkmcnt(6)
  v_mfma_f32_16x16x32_bf16 v[180:183], a[204:207], v[36:39], v[180:183]
  v_permlane16_swap_b32 v16, v19
  v_max_f32 v16, v16, v19
  v_mul_f32 v16, s51, v16
  v_mfma_f32_16x16x32_bf16 v[196:199], a[204:207], v[68:71], v[196:199]
  v_xor_b32 v8, 64, v5
  v_max3_f32 v22, v144, v145, v146
  v_max3_f32 v23, v147, v148, v149
  v_mfma_f32_16x16x32_bf16 v[212:215], a[204:207], v[100:103], v[212:215]
  ds_read_b128 a[200:203], v8 offset:256
  v_max3_f32 v24, v150, v151, v152
  v_max3_f32 v22, v22, v153, v154
  v_max3_f32 v23, v23, v155, v156
  s_waitcnt lgkmcnt(6)
  v_mfma_f32_16x16x32_bf16 v[176:179], a[208:211], v[40:43], v[176:179]
  v_max3_f32 v24, v24, v157, v158
  v_max3_f32 v22, v22, v23, v159
  v_mfma_f32_16x16x32_bf16 v[192:195], a[208:211], v[72:75], v[192:195]
  v_max_f32 v17, v22, v24
  v_mov_b32 v22, v17
  s_nop 1
  v_mfma_f32_16x16x32_bf16 v[208:211], a[208:211], v[104:107], v[208:211]
  ds_read_b128 a[204:207], v8 offset:8448
  v_permlane32_swap_b32 v17, v22
  v_max_f32 v17, v17, v22
  s_waitcnt lgkmcnt(6)
  v_mfma_f32_16x16x32_bf16 v[180:183], a[212:215], v[40:43], v[180:183]
  v_mov_b32 v22, v17
  s_nop 1
  v_permlane16_swap_b32 v17, v22
  v_mfma_f32_16x16x32_bf16 v[196:199], a[212:215], v[72:75], v[196:199]
  v_xor_b32 v9, 128, v5
  v_max_f32 v17, v17, v22
  v_mul_f32 v17, s51, v17
  v_mfma_f32_16x16x32_bf16 v[212:215], a[212:215], v[104:107], v[212:215]
  ds_read_b128 a[208:211], v9 offset:256
  v_max3_f32 v25, v160, v161, v162
  v_max3_f32 v26, v163, v164, v165
  v_max3_f32 v27, v166, v167, v168
  s_waitcnt lgkmcnt(6)
  v_mfma_f32_16x16x32_bf16 v[176:179], a[216:219], v[44:47], v[176:179]
  v_max3_f32 v25, v25, v169, v170
  v_max3_f32 v26, v26, v171, v172
  v_mfma_f32_16x16x32_bf16 v[192:195], a[216:219], v[76:79], v[192:195]
  v_max3_f32 v27, v27, v173, v174
  v_max3_f32 v25, v25, v26, v175
  v_max_f32 v18, v25, v27
  v_mfma_f32_16x16x32_bf16 v[208:211], a[216:219], v[108:111], v[208:211]
  ds_read_b128 a[212:215], v9 offset:8448
  v_mov_b32 v25, v18
  s_nop 1
  s_waitcnt lgkmcnt(6)
  v_mfma_f32_16x16x32_bf16 v[180:183], a[220:223], v[44:47], v[180:183]
  v_permlane32_swap_b32 v18, v25
  v_max_f32 v18, v18, v25
  v_mov_b32 v25, v18
  v_mfma_f32_16x16x32_bf16 v[196:199], a[220:223], v[76:79], v[196:199]
  v_xor_b32 v6, 192, v5
  s_nop 1
  v_permlane16_swap_b32 v18, v25
  v_mfma_f32_16x16x32_bf16 v[212:215], a[220:223], v[108:111], v[212:215]
  ds_read_b128 a[216:219], v6 offset:256
  v_max_f32 v18, v18, v25
  v_mul_f32 v18, s51, v18
  v_sub_f32 v19, v16, v10
  s_waitcnt lgkmcnt(6)
  v_mfma_f32_16x16x32_bf16 v[176:179], a[192:195], v[48:51], v[176:179]
  v_sub_f32 v20, v17, v11
  v_sub_f32 v21, v18, v12
  v_mfma_f32_16x16x32_bf16 v[192:195], a[192:195], v[80:83], v[192:195]
  v_max3_f32 v19, v19, v20, v21
  v_cmp_lt_f32 vcc, s52, v19
  s_cbranch_vccnz Lrare_2
Lrare_2_ret:
  v_mfma_f32_16x16x32_bf16 v[208:211], a[192:195], v[112:115], v[208:211]
  ds_read_b128 a[220:223], v6 offset:8448
  v_fma_f32 v128, v128, s51, -v10
  v_fma_f32 v129, v129, s51, -v10
  s_waitcnt lgkmcnt(6)
  v_mfma_f32_16x16x32_bf16 v[180:183], a[196:199], v[48:51], v[180:183]
  s_waitcnt vmcnt(21)
  s_barrier
  s_add_u32 m0, s50, 49152
  s_mov_b32 s53, 180224
  v_fma_f32 v130, v130, s51, -v10
  v_fma_f32 v131, v131, s51, -v10
  v_fma_f32 v132, v132, s51, -v10
  v_mfma_f32_16x16x32_bf16 v[196:199], a[196:199], v[80:83], v[196:199]
  buffer_load_dwordx4 v248, s[16:19], s53 offen nt lds
  s_add_u32 m0, s50, 50176
  s_mov_b32 s53, 180224
  buffer_load_dwordx4 v249, s[16:19], s53 offen nt lds
  s_add_u32 m0, s50, 51200
  v_fma_f32 v133, v133, s51, -v10
  v_fma_f32 v134, v134, s51, -v10
  v_mfma_f32_16x16x32_bf16 v[212:215], a[196:199], v[112:115], v[212:215]
  s_mov_b32 s53, 180224
  buffer_load_dwordx4 v250, s[16:19], s53 offen nt lds
  v_add_u32 v5, 81920, v2
  v_xor_b32 v7, 0, v5
  ds_read_b128 a[192:195], v7 offset:0
  v_fma_f32 v135, v135, s51, -v10
  v_fma_f32 v136, v136, s51, -v10
  v_fma_f32 v137, v137, s51, -v10
  s_waitcnt lgkmcnt(6)
  v_mfma_f32_16x16x32_bf16 v[176:179], a[200:203], v[52:55], v[176:179]
  v_fma_f32 v138, v138, s51, -v10
  v_fma_f32 v139, v139, s51, -v10
  v_mfma_f32_16x16x32_bf16 v[192:195], a[200:203], v[84:87], v[192:195]
  v_fma_f32 v140, v140, s51, -v10
  v_fma_f32 v141, v141, s51, -v10
  v_fma_f32 v142, v142, s51, -v10
  v_mfma_f32_16x16x32_bf16 v[208:211], a[200:203], v[116:119], v[208:211]
  ds_read_b128 a[196:199], v7 offset:8192
  v_fma_f32 v143, v143, s51, -v10
  v_exp_f32 v128, v128
  s_waitcnt lgkmcnt(6)
  v_mfma_f32_16x16x32_bf16 v[180:183], a[204:207], v[52:55], v[180:183]
  v_exp_f32 v129, v129
  v_exp_f32 v130, v130
  v_exp_f32 v131, v131
  v_mfma_f32_16x16x32_bf16 v[196:199], a[204:207], v[84:87], v[196:199]
  v_xor_b32 v8, 64, v5
  v_exp_f32 v132, v132
  v_exp_f32 v133, v133
  v_mfma_f32_16x16x32_bf16 v[212:215], a[204:207], v[116:119], v[212:215]
  ds_read_b128 a[200:203], v8 offset:0
  v_exp_f32 v134, v134
  v_exp_f32 v135, v135
  v_exp_f32 v136, v136
  s_waitcnt lgkmcnt(6)
  v_mfma_f32_16x16x32_bf16 v[176:179], a[208:211], v[56:59], v[176:179]
  v_exp_f32 v137, v137
  v_exp_f32 v138, v138
  v_mfma_f32_16x16x32_bf16 v[192:195], a[208:211], v[88:91], v[192:195]
  v_exp_f32 v139, v139
  v_exp_f32 v140, v140
  v_exp_f32 v141, v141
  v_mfma_f32_16x16x32_bf16 v[208:211], a[208:211], v[120:123], v[208:211]
  ds_read_b128 a[204:207], v8 offset:8192
  v_exp_f32 v142, v142
  v_exp_f32 v143, v143
  s_waitcnt lgkmcnt(6)
  v_mfma_f32_16x16x32_bf16 v[180:183], a[212:215], v[56:59], v[180:183]
  v_fma_f32 v144, v144, s51, -v11
  v_fma_f32 v145, v145, s51, -v11
  v_fma_f32 v146, v146, s51, -v11
  v_mfma_f32_16x16x32_bf16 v[196:199], a[212:215], v[88:91], v[196:199]
  v_xor_b32 v9, 128, v5
  v_fma_f32 v147, v147, s51, -v11
  v_fma_f32 v148, v148, s51, -v11
  v_mfma_f32_16x16x32_bf16 v[212:215], a[212:215], v[120:123], v[212:215]
  ds_read_b128 a[208:211], v9 offset:0
  v_fma_f32 v149, v149, s51, -v11
  v_fma_f32 v150, v150, s51, -v11
  v_fma_f32 v151, v151, s51, -v11
  s_waitcnt lgkmcnt(6)
  v_mfma_f32_16x16x32_bf16 v[176:179], a[216:219], v[60:63], v[176:179]
  v_fma_f32 v152, v152, s51, -v11
  v_fma_f32 v153, v153, s51, -v11
  v_mfma_f32_16x16x32_bf16 v[192:195], a[216:219], v[92:95], v[192:195]
  v_fma_f32 v154, v154, s51, -v11
  v_fma_f32 v155, v155, s51, -v11
  v_fma_f32 v156, v156, s51, -v11
  v_mfma_f32_16x16x32_bf16 v[208:211], a[216:219], v[124:127], v[208:211]
  ds_read_b128 a[212:215], v9 offset:8192
  v_fma_f32 v157, v157, s51, -v11
  v_fma_f32 v158, v158, s51, -v11
  s_waitcnt lgkmcnt(6)
  v_mfma_f32_16x16x32_bf16 v[180:183], a[220:223], v[60:63], v[180:183]
  v_fma_f32 v159, v159, s51, -v11
  v_exp_f32 v144, v144
  v_exp_f32 v145, v145
  v_mfma_f32_16x16x32_bf16 v[196:199], a[220:223], v[92:95], v[196:199]
  v_xor_b32 v6, 192, v5
  v_exp_f32 v146, v146
  v_exp_f32 v147, v147
  v_mfma_f32_16x16x32_bf16 v[212:215], a[220:223], v[124:127], v[212:215]
  ds_read_b128 a[216:219], v6 offset:0
  v_exp_f32 v148, v148
  v_exp_f32 v149, v149
  v_exp_f32 v150, v150
  s_waitcnt lgkmcnt(6)
  v_mfma_f32_16x16x32_bf16 v[184:187], a[192:195], v[32:35], 0
  v_mfma_f32_16x16x32_bf16 v[200:203], a[192:195], v[64:67], 0
  v_mfma_f32_16x16x32_bf16 v[216:219], a[192:195], v[96:99], 0
  ds_read_b128 a[220:223], v6 offset:8192
  s_waitcnt lgkmcnt(6)
  v_mfma_f32_16x16x32_bf16 v[188:191], a[196:199], v[32:35], 0
  v_exp_f32 v151, v151
  v_exp_f32 v152, v152
  v_mfma_f32_16x16x32_bf16 v[204:207], a[196:199], v[64:67], 0
  v_xor_b32 v7, 0, v5
  v_exp_f32 v153, v153
  v_exp_f32 v154, v154
  v_exp_f32 v155, v155
  v_mfma_f32_16x16x32_bf16 v[220:223], a[196:199], v[96:99], 0
  ds_read_b128 a[192:195], v7 offset:256
  v_exp_f32 v156, v156
  v_exp_f32 v157, v157
  s_waitcnt lgkmcnt(6)
  v_mfma_f32_16x16x32_bf16 v[184:187], a[200:203], v[36:39], v[184:187]
  v_exp_f32 v158, v158
  v_exp_f32 v159, v159
  v_fma_f32 v160, v160, s51, -v12
  v_mfma_f32_16x16x32_bf16 v[200:203], a[200:203], v[68:71], v[200:203]
  v_fma_f32 v161, v161, s51, -v12
  v_fma_f32 v162, v162, s51, -v12
  v_mfma_f32_16x16x32_bf16 v[216:219], a[200:203], v[100:103], v[216:219]
  ds_read_b128 a[196:199], v7 offset:8448
  v_fma_f32 v163, v163, s51, -v12
  v_fma_f32 v164, v164, s51, -v12
  v_fma_f32 v165, v165, s51, -v12
  s_waitcnt lgkmcnt(6)
  v_mfma_f32_16x16x32_bf16 v[188:191], a[204:207], v[36:39], v[188:191]
  v_fma_f32 v166, v166, s51, -v12
  v_fma_f32 v167, v167, s51, -v12
  v_mfma_f32_16x16x32_bf16 v[204:207], a[204:207], v[68:71], v[204:207]
  v_xor_b32 v8, 64, v5
  v_fma_f32 v168, v168, s51, -v12
  v_fma_f32 v169, v169, s51, -v12
  v_fma_f32 v170, v170, s51, -v12
  v_mfma_f32_16x16x32_bf16 v[220:223], a[204:207], v[100:103], v[220:223]
  ds_read_b128 a[200:203], v8 offset:256
  v_fma_f32 v171, v171, s51, -v12
  v_fma_f32 v172, v172, s51, -v12
  s_waitcnt lgkmcnt(6)
  v_mfma_f32_16x16x32_bf16 v[184:187], a[208:211], v[40:43], v[184:187]
  v_fma_f32 v173, v173, s51, -v12
  v_fma_f32 v174, v174, s51, -v12
  v_fma_f32 v175, v175, s51, -v12
  v_mfma_f32_16x16x32_bf16 v[200:203], a[208:211], v[72:75], v[200:203]
  v_exp_f32 v160, v160
  v_exp_f32 v161, v161
  v_mfma_f32_16x16x32_bf16 v[216:219], a[208:211], v[104:107], v[216:219]
  ds_read_b128 a[204:207], v8 offset:8448
  v_exp_f32 v162, v162
  v_exp_f32 v163, v163
  v_exp_f32 v164, v164
  s_waitcnt lgkmcnt(6)
  v_mfma_f32_16x16x32_bf16 v[188:191], a[212:215], v[40:43], v[188:191]
  v_exp_f32 v165, v165
  v_exp_f32 v166, v166
  v_mfma_f32_16x16x32_bf16 v[204:207], a[212:215], v[72:75], v[204:207]
  v_xor_b32 v9, 128, v5
  v_exp_f32 v167, v167
  v_exp_f32 v168, v168
  v_exp_f32 v169, v169
  v_mfma_f32_16x16x32_bf16 v[220:223], a[212:215], v[104:107], v[220:223]
  ds_read_b128 a[208:211], v9 offset:256
  v_exp_f32 v170, v170
  v_exp_f32 v171, v171
  s_waitcnt lgkmcnt(6)
  v_mfma_f32_16x16x32_bf16 v[184:187], a[216:219], v[44:47], v[184:187]
  v_exp_f32 v172, v172
  v_exp_f32 v173, v173
  v_exp_f32 v174, v174
  v_mfma_f32_16x16x32_bf16 v[200:203], a[216:219], v[76:79], v[200:203]
  v_exp_f32 v175, v175
  v_add_f32 v19, v128, v129
  v_mfma_f32_16x16x32_bf16 v[216:219], a[216:219], v[108:111], v[216:219]
  ds_read_b128 a[212:215], v9 offset:8448
  v_add_f32 v20, v130, v131
  v_add_f32 v19, v19, v132
  v_add_f32 v20, v20, v133
  s_waitcnt lgkmcnt(6)
  v_mfma_f32_16x16x32_bf16 v[188:191], a[220:223], v[44:47], v[188:191]
  v_add_f32 v19, v19, v134
  v_add_f32 v20, v20, v135
  v_mfma_f32_16x16x32_bf16 v[204:207], a[220:223], v[76:79], v[204:207]
  v_xor_b32 v6, 192, v5
  v_add_f32 v19, v19, v136
  v_add_f32 v20, v20, v137
  v_add_f32 v19, v19, v138
  v_mfma_f32_16x16x32_bf16 v[220:223], a[220:223], v[108:111], v[220:223]
  ds_read_b128 a[216:219], v6 offset:256
  v_add_f32 v20, v20, v139
  v_add_f32 v19, v19, v140
  s_waitcnt lgkmcnt(6)
  v_mfma_f32_16x16x32_bf16 v[184:187], a[192:195], v[48:51], v[184:187]
  v_add_f32 v20, v20, v141
  v_add_f32 v19, v19, v142
  v_add_f32 v20, v20, v143
  v_mfma_f32_16x16x32_bf16 v[200:203], a[192:195], v[80:83], v[200:203]
  v_add_f32 v19, v19, v20
  v_add_f32 v13, v13, v19
  v_mfma_f32_16x16x32_bf16 v[216:219], a[192:195], v[112:115], v[216:219]
  ds_read_b128 a[220:223], v6 offset:8448
  v_add_f32 v22, v144, v145
  v_add_f32 v23, v146, v147
  v_add_f32 v22, v22, v148
  s_waitcnt lgkmcnt(6)
  v_mfma_f32_16x16x32_bf16 v[188:191], a[196:199], v[48:51], v[188:191]
  s_waitcnt vmcnt(21)
  s_barrier
  s_add_u32 m0, s50, 65536
  s_mov_b32 s53, 131072
  buffer_load_dwordx4 v248, s[20:23], s53 offen nt lds
  v_add_f32 v23, v23, v149
  v_add_f32 v22, v22, v150
  v_mfma_f32_16x16x32_bf16 v[204:207], a[196:199], v[80:83], v[204:207]
  s_add_u32 m0, s50, 66560
  s_mov_b32 s53, 131072
  buffer_load_dwordx4 v249, s[20:23], s53 offen nt lds
  s_add_u32 m0, s50, 67584
  s_mov_b32 s53, 131072
  v_add_f32 v23, v23, v151
  v_add_f32 v22, v22, v152
  v_add_f32 v23, v23, v153
  v_mfma_f32_16x16x32_bf16 v[220:223], a[196:199], v[112:115], v[220:223]
  buffer_load_dwordx4 v250, s[20:23], s53 offen nt lds
  v_add_u32 v5, 98304, v3
  v_xor_b32 v7, 0, v5
  ds_read_b64_tr_b16 a[192:193], v7 offset:0
  ds_read_b64_tr_b16 a[194:195], v7 offset:8192
  v_add_f32 v22, v22, v154
  v_add_f32 v23, v23, v155
  s_waitcnt lgkmcnt(7)
  v_mfma_f32_16x16x32_bf16 v[184:187], a[200:203], v[52:55], v[184:187]
  v_xor_b32 v8, 32, v5
  v_add_f32 v22, v22, v156
  v_add_f32 v23, v23, v157
  v_add_f32 v22, v22, v158
  v_mfma_f32_16x16x32_bf16 v[200:203], a[200:203], v[84:87], v[200:203]
  ds_read_b64_tr_b16 a[196:197], v8 offset:0
  v_add_f32 v23, v23, v159
  v_add_f32 v22, v22, v23
  v_mfma_f32_16x16x32_bf16 v[216:219], a[200:203], v[116:119], v[216:219]
  ds_read_b64_tr_b16 a[198:199], v8 offset:8192
  v_add_f32 v14, v14, v22
  v_add_f32 v25, v160, v161
  v_add_f32 v26, v162, v163
  s_waitcnt lgkmcnt(8)
  v_mfma_f32_16x16x32_bf16 v[188:191], a[204:207], v[52:55], v[188:191]
  v_xor_b32 v9, 64, v5
  v_add_f32 v25, v25, v164
  v_add_f32 v26, v26, v165
  v_mfma_f32_16x16x32_bf16 v[204:207], a[204:207], v[84:87], v[204:207]
  ds_read_b64_tr_b16 a[200:201], v9 offset:0
  v_add_f32 v25, v25, v166
  v_add_f32 v26, v26, v167
  v_add_f32 v25, v25, v168
  v_mfma_f32_16x16x32_bf16 v[220:223], a[204:207], v[116:119], v[220:223]
  ds_read_b64_tr_b16 a[202:203], v9 offset:8192
  v_add_f32 v26, v26, v169
  v_add_f32 v25, v25, v170
  s_waitcnt lgkmcnt(9)
  v_mfma_f32_16x16x32_bf16 v[184:187], a[208:211], v[56:59], v[184:187]
  v_xor_b32 v6, 96, v5
  v_add_f32 v26, v26, v171
  v_add_f32 v25, v25, v172
  v_add_f32 v26, v26, v173
  v_mfma_f32_16x16x32_bf16 v[200:203], a[208:211], v[88:91], v[200:203]
  ds_read_b64_tr_b16 a[204:205], v6 offset:0
  v_add_f32 v25, v25, v174
  v_add_f32 v26, v26, v175
  v_mfma_f32_16x16x32_bf16 v[216:219], a[208:211], v[120:123], v[216:219]
  ds_read_b64_tr_b16 a[206:207], v6 offset:8192
  v_add_f32 v25, v25, v26
  v_add_f32 v15, v15, v25
  v_cvt_pk_bf16_f32 v224, v128, v129
  s_waitcnt lgkmcnt(10)
  v_mfma_f32_16x16x32_bf16 v[188:191], a[212:215], v[56:59], v[188:191]
  v_xor_b32 v7, 128, v5
  v_cvt_pk_bf16_f32 v225, v130, v131
  v_cvt_pk_bf16_f32 v226, v132, v133
  v_mfma_f32_16x16x32_bf16 v[204:207], a[212:215], v[88:91], v[204:207]
  ds_read_b64_tr_b16 a[208:209], v7 offset:0
  v_cvt_pk_bf16_f32 v227, v134, v135
  v_cvt_pk_bf16_f32 v228, v136, v137
  v_cvt_pk_bf16_f32 v229, v138, v139
  v_mfma_f32_16x16x32_bf16 v[220:223], a[212:215], v[120:123], v[220:223]
  ds_read_b64_tr_b16 a[210:211], v7 offset:8192
  v_cvt_pk_bf16_f32 v230, v140, v141
  v_cvt_pk_bf16_f32 v231, v142, v143
  s_waitcnt lgkmcnt(11)
  v_mfma_f32_16x16x32_bf16 v[184:187], a[216:219], v[60:63], v[184:187]
  v_xor_b32 v8, 160, v5
  v_cvt_pk_bf16_f32 v232, v144, v145
  v_cvt_pk_bf16_f32 v233, v146, v147
  v_cvt_pk_bf16_f32 v234, v148, v149
  v_mfma_f32_16x16x32_bf16 v[200:203], a[216:219], v[92:95], v[200:203]
  ds_read_b64_tr_b16 a[212:213], v8 offset:0
  v_cvt_pk_bf16_f32 v235, v150, v151
  v_cvt_pk_bf16_f32 v236, v152, v153
  v_mfma_f32_16x16x32_bf16 v[216:219], a[216:219], v[124:127], v[216:219]
  ds_read_b64_tr_b16 a[214:215], v8 offset:8192
  v_cvt_pk_bf16_f32 v237, v154, v155
  v_cvt_pk_bf16_f32 v238, v156, v157
  v_cvt_pk_bf16_f32 v239, v158, v159
  s_waitcnt lgkmcnt(12)
  v_mfma_f32_16x16x32_bf16 v[188:191], a[220:223], v[60:63], v[188:191]
  v_xor_b32 v9, 192, v5
  v_cvt_pk_bf16_f32 v240, v160, v161
  v_cvt_pk_bf16_f32 v241, v162, v163
  v_mfma_f32_16x16x32_bf16 v[204:207], a[220:223], v[92:95], v[204:207]
  ds_read_b64_tr_b16 a[216:217], v9 offset:0
  v_cvt_pk_bf16_f32 v242, v164, v165
  v_cvt_pk_bf16_f32 v243, v166, v167
  v_cvt_pk_bf16_f32 v244, v168, v169
  v_mfma_f32_16x16x32_bf16 v[220:223], a[220:223], v[124:127], v[220:223]
  ds_read_b64_tr_b16 a[218:219], v9 offset:8192
  v_cvt_pk_bf16_f32 v245, v170, v171
  v_cvt_pk_bf16_f32 v246, v172, v173
  v_cvt_pk_bf16_f32 v247, v174, v175
  s_waitcnt lgkmcnt(12)
  v_mfma_f32_16x16x32_bf16 a[0:3], a[192:195], v[224:227], a[0:3]
  v_xor_b32 v6, 224, v5
  v_mfma_f32_16x16x32_bf16 a[64:67], a[192:195], v[232:235], a[64:67]
  ds_read_b64_tr_b16 a[220:221], v6 offset:0
  v_mfma_f32_16x16x32_bf16 a[128:131], a[192:195], v[240:243], a[128:131]
  ds_read_b64_tr_b16 a[222:223], v6 offset:8192
  s_waitcnt lgkmcnt(12)
  v_mfma_f32_16x16x32_bf16 a[4:7], a[196:199], v[224:227], a[4:7]
  v_xor_b32 v7, 0, v5
  v_mfma_f32_16x16x32_bf16 a[68:71], a[196:199], v[232:235], a[68:71]
  ds_read_b64_tr_b16 a[192:193], v7 offset:256
  v_mfma_f32_16x16x32_bf16 a[132:135], a[196:199], v[240:243], a[132:135]
  ds_read_b64_tr_b16 a[194:195], v7 offset:8448
  s_waitcnt lgkmcnt(12)
  v_mfma_f32_16x16x32_bf16 a[8:11], a[200:203], v[224:227], a[8:11]
  v_xor_b32 v8, 32, v5
  v_mfma_f32_16x16x32_bf16 a[72:75], a[200:203], v[232:235], a[72:75]
  ds_read_b64_tr_b16 a[196:197], v8 offset:256
  v_mfma_f32_16x16x32_bf16 a[136:139], a[200:203], v[240:243], a[136:139]
  ds_read_b64_tr_b16 a[198:199], v8 offset:8448
  s_waitcnt lgkmcnt(12)
  v_mfma_f32_16x16x32_bf16 a[12:15], a[204:207], v[224:227], a[12:15]
  v_xor_b32 v9, 64, v5
  v_mfma_f32_16x16x32_bf16 a[76:79], a[204:207], v[232:235], a[76:79]
  ds_read_b64_tr_b16 a[200:201], v9 offset:256
  v_mfma_f32_16x16x32_bf16 a[140:143], a[204:207], v[240:243], a[140:143]
  ds_read_b64_tr_b16 a[202:203], v9 offset:8448
  s_waitcnt lgkmcnt(12)
  v_mfma_f32_16x16x32_bf16 a[16:19], a[208:211], v[224:227], a[16:19]
  v_xor_b32 v6, 96, v5
  v_mfma_f32_16x16x32_bf16 a[80:83], a[208:211], v[232:235], a[80:83]
  ds_read_b64_tr_b16 a[204:205], v6 offset:256
  v_mfma_f32_16x16x32_bf16 a[144:147], a[208:211], v[240:243], a[144:147]
  ds_read_b64_tr_b16 a[206:207], v6 offset:8448
  s_waitcnt lgkmcnt(12)
  v_mfma_f32_16x16x32_bf16 a[20:23], a[212:215], v[224:227], a[20:23]
  v_xor_b32 v7, 128, v5
  v_mfma_f32_16x16x32_bf16 a[84:87], a[212:215], v[232:235], a[84:87]
  ds_read_b64_tr_b16 a[208:209], v7 offset:256
  v_mfma_f32_16x16x32_bf16 a[148:151], a[212:215], v[240:243], a[148:151]
  ds_read_b64_tr_b16 a[210:211], v7 offset:8448
  s_waitcnt lgkmcnt(12)
  v_mfma_f32_16x16x32_bf16 a[24:27], a[216:219], v[224:227], a[24:27]
  v_xor_b32 v8, 160, v5
  v_mfma_f32_16x16x32_bf16 a[88:91], a[216:219], v[232:235], a[88:91]
  ds_read_b64_tr_b16 a[212:213], v8 offset:256
  v_mfma_f32_16x16x32_bf16 a[152:155], a[216:219], v[240:243], a[152:155]
  ds_read_b64_tr_b16 a[214:215], v8 offset:8448
  s_waitcnt lgkmcnt(12)
  v_mfma_f32_16x16x32_bf16 a[28:31], a[220:223], v[224:227], a[28:31]
  v_xor_b32 v9, 192, v5
  v_mfma_f32_16x16x32_bf16 a[92:95], a[220:223], v[232:235], a[92:95]
  ds_read_b64_tr_b16 a[216:217], v9 offset:256
  v_mfma_f32_16x16x32_bf16 a[156:159], a[220:223], v[240:243], a[156:159]
  ds_read_b64_tr_b16 a[218:219], v9 offset:8448
  s_waitcnt lgkmcnt(12)
  v_mfma_f32_16x16x32_bf16 a[32:35], a[192:195], v[224:227], a[32:35]
  v_xor_b32 v6, 224, v5
  v_mfma_f32_16x16x32_bf16 a[96:99], a[192:195], v[232:235], a[96:99]
  ds_read_b64_tr_b16 a[220:221], v6 offset:256
  v_mfma_f32_16x16x32_bf16 a[160:163], a[192:195], v[240:243], a[160:163]
  ds_read_b64_tr_b16 a[222:223], v6 offset:8448
  s_waitcnt lgkmcnt(12)
  v_mfma_f32_16x16x32_bf16 a[36:39], a[196:199], v[224:227], a[36:39]
  s_waitcnt vmcnt(21)
  s_barrier
  s_add_u32 m0, s50, 81920
  s_mov_b32 s53, 147456
  buffer_load_dwordx4 v248, s[20:23], s53 offen nt lds
  v_mfma_f32_16x16x32_bf16 a[100:103], a[196:199], v[232:235], a[100:103]
  s_add_u32 m0, s50, 82944
  s_mov_b32 s53, 147456
  buffer_load_dwordx4 v249, s[20:23], s53 offen nt lds
  s_add_u32 m0, s50, 83968
  s_mov_b32 s53, 147456
  v_mfma_f32_16x16x32_bf16 a[164:167], a[196:199], v[240:243], a[164:167]
  buffer_load_dwordx4 v250, s[20:23], s53 offen nt lds
  v_add_u32 v5, 114688, v3
  v_xor_b32 v7, 0, v5
  ds_read_b64_tr_b16 a[192:193], v7 offset:0
  ds_read_b64_tr_b16 a[194:195], v7 offset:8192
  s_waitcnt lgkmcnt(12)
  v_mfma_f32_16x16x32_bf16 a[40:43], a[200:203], v[224:227], a[40:43]
  v_xor_b32 v8, 32, v5
  v_mfma_f32_16x16x32_bf16 a[104:107], a[200:203], v[232:235], a[104:107]
  ds_read_b64_tr_b16 a[196:197], v8 offset:0
  v_mfma_f32_16x16x32_bf16 a[168:171], a[200:203], v[240:243], a[168:171]
  ds_read_b64_tr_b16 a[198:199], v8 offset:8192
  s_waitcnt lgkmcnt(12)
  v_mfma_f32_16x16x32_bf16 a[44:47], a[204:207], v[224:227], a[44:47]
  v_xor_b32 v9, 64, v5
  v_mfma_f32_16x16x32_bf16 a[108:111], a[204:207], v[232:235], a[108:111]
  ds_read_b64_tr_b16 a[200:201], v9 offset:0
  v_mfma_f32_16x16x32_bf16 a[172:175], a[204:207], v[240:243], a[172:175]
  ds_read_b64_tr_b16 a[202:203], v9 offset:8192
  s_waitcnt lgkmcnt(12)
  v_mfma_f32_16x16x32_bf16 a[48:51], a[208:211], v[224:227], a[48:51]
  v_xor_b32 v6, 96, v5
  v_mfma_f32_16x16x32_bf16 a[112:115], a[208:211], v[232:235], a[112:115]
  ds_read_b64_tr_b16 a[204:205], v6 offset:0
  v_mfma_f32_16x16x32_bf16 a[176:179], a[208:211], v[240:243], a[176:179]
  ds_read_b64_tr_b16 a[206:207], v6 offset:8192
  s_waitcnt lgkmcnt(12)
  v_mfma_f32_16x16x32_bf16 a[52:55], a[212:215], v[224:227], a[52:55]
  v_xor_b32 v7, 128, v5
  v_mfma_f32_16x16x32_bf16 a[116:119], a[212:215], v[232:235], a[116:119]
  ds_read_b64_tr_b16 a[208:209], v7 offset:0
  v_mfma_f32_16x16x32_bf16 a[180:183], a[212:215], v[240:243], a[180:183]
  ds_read_b64_tr_b16 a[210:211], v7 offset:8192
  s_waitcnt lgkmcnt(12)
  v_mfma_f32_16x16x32_bf16 a[56:59], a[216:219], v[224:227], a[56:59]
  v_xor_b32 v8, 160, v5
  v_mfma_f32_16x16x32_bf16 a[120:123], a[216:219], v[232:235], a[120:123]
  ds_read_b64_tr_b16 a[212:213], v8 offset:0
  v_mfma_f32_16x16x32_bf16 a[184:187], a[216:219], v[240:243], a[184:187]
  ds_read_b64_tr_b16 a[214:215], v8 offset:8192
  s_waitcnt lgkmcnt(12)
  v_mfma_f32_16x16x32_bf16 a[60:63], a[220:223], v[224:227], a[60:63]
  v_xor_b32 v9, 192, v5
  v_mfma_f32_16x16x32_bf16 a[124:127], a[220:223], v[232:235], a[124:127]
  ds_read_b64_tr_b16 a[216:217], v9 offset:0
  v_mfma_f32_16x16x32_bf16 a[188:191], a[220:223], v[240:243], a[188:191]
  ds_read_b64_tr_b16 a[218:219], v9 offset:8192
  s_waitcnt lgkmcnt(12)
  v_mfma_f32_16x16x32_bf16 a[0:3], a[192:195], v[228:231], a[0:3]
  v_xor_b32 v6, 224, v5
  v_mfma_f32_16x16x32_bf16 a[64:67], a[192:195], v[236:239], a[64:67]
  ds_read_b64_tr_b16 a[220:221], v6 offset:0
  v_mfma_f32_16x16x32_bf16 a[128:131], a[192:195], v[244:247], a[128:131]
  ds_read_b64_tr_b16 a[222:223], v6 offset:8192
  s_waitcnt lgkmcnt(12)
  v_mfma_f32_16x16x32_bf16 a[4:7], a[196:199], v[228:231], a[4:7]
  v_xor_b32 v7, 0, v5
  v_mfma_f32_16x16x32_bf16 a[68:71], a[196:199], v[236:239], a[68:71]
  ds_read_b64_tr_b16 a[192:193], v7 offset:256
  v_mfma_f32_16x16x32_bf16 a[132:135], a[196:199], v[244:247], a[132:135]
  ds_read_b64_tr_b16 a[194:195], v7 offset:8448
  s_waitcnt lgkmcnt(12)
  v_mfma_f32_16x16x32_bf16 a[8:11], a[200:203], v[228:231], a[8:11]
  v_xor_b32 v8, 32, v5
  v_mfma_f32_16x16x32_bf16 a[72:75], a[200:203], v[236:239], a[72:75]
  ds_read_b64_tr_b16 a[196:197], v8 offset:256
  v_mfma_f32_16x16x32_bf16 a[136:139], a[200:203], v[244:247], a[136:139]
  ds_read_b64_tr_b16 a[198:199], v8 offset:8448
  s_waitcnt lgkmcnt(12)
  v_mfma_f32_16x16x32_bf16 a[12:15], a[204:207], v[228:231], a[12:15]
  v_xor_b32 v9, 64, v5
  v_mfma_f32_16x16x32_bf16 a[76:79], a[204:207], v[236:239], a[76:79]
  ds_read_b64_tr_b16 a[200:201], v9 offset:256
  v_mfma_f32_16x16x32_bf16 a[140:143], a[204:207], v[244:247], a[140:143]
  ds_read_b64_tr_b16 a[202:203], v9 offset:8448
  s_waitcnt lgkmcnt(12)
  v_mfma_f32_16x16x32_bf16 a[16:19], a[208:211], v[228:231], a[16:19]
  v_xor_b32 v6, 96, v5
  v_mfma_f32_16x16x32_bf16 a[80:83], a[208:211], v[236:239], a[80:83]
  ds_read_b64_tr_b16 a[204:205], v6 offset:256
  v_mfma_f32_16x16x32_bf16 a[144:147], a[208:211], v[244:247], a[144:147]
  ds_read_b64_tr_b16 a[206:207], v6 offset:8448
  s_waitcnt lgkmcnt(12)
  v_mfma_f32_16x16x32_bf16 a[20:23], a[212:215], v[228:231], a[20:23]
  v_xor_b32 v7, 128, v5
  v_mfma_f32_16x16x32_bf16 a[84:87], a[212:215], v[236:239], a[84:87]
  ds_read_b64_tr_b16 a[208:209], v7 offset:256
  v_mfma_f32_16x16x32_bf16 a[148:151], a[212:215], v[244:247], a[148:151]
  ds_read_b64_tr_b16 a[210:211], v7 offset:8448
  s_waitcnt lgkmcnt(12)
  v_mfma_f32_16x16x32_bf16 a[24:27], a[216:219], v[228:231], a[24:27]
  v_xor_b32 v8, 160, v5
  v_mfma_f32_16x16x32_bf16 a[88:91], a[216:219], v[236:239], a[88:91]
  ds_read_b64_tr_b16 a[212:213], v8 offset:256
  v_mfma_f32_16x16x32_bf16 a[152:155], a[216:219], v[244:247], a[152:155]
  ds_read_b64_tr_b16 a[214:215], v8 offset:8448
  s_waitcnt lgkmcnt(12)
  v_mfma_f32_16x16x32_bf16 a[28:31], a[220:223], v[228:231], a[28:31]
  v_xor_b32 v9, 192, v5
  v_mfma_f32_16x16x32_bf16 a[92:95], a[220:223], v[236:239], a[92:95]
  ds_read_b64_tr_b16 a[216:217], v9 offset:256
  v_mfma_f32_16x16x32_bf16 a[156:159], a[220:223], v[244:247], a[156:159]
  ds_read_b64_tr_b16 a[218:219], v9 offset:8448
  s_waitcnt lgkmcnt(12)
  v_mfma_f32_16x16x32_bf16 a[32:35], a[192:195], v[228:231], a[32:35]
  v_xor_b32 v6, 224, v5
  v_mfma_f32_16x16x32_bf16 a[96:99], a[192:195], v[236:239], a[96:99]
  ds_read_b64_tr_b16 a[220:221], v6 offset:256
  v_mfma_f32_16x16x32_bf16 a[160:163], a[192:195], v[244:247], a[160:163]
  ds_read_b64_tr_b16 a[222:223], v6 offset:8448
  s_waitcnt lgkmcnt(12)
  v_mfma_f32_16x16x32_bf16 a[36:39], a[196:199], v[228:231], a[36:39]
  s_waitcnt vmcnt(21)
  s_barrier
  s_add_u32 m0, s50, 98304
  s_mov_b32 s53, 196608
  v_mfma_f32_16x16x32_bf16 a[100:103], a[196:199], v[236:239], a[100:103]
  buffer_load_dwordx4 v248, s[16:19], s53 offen nt lds
  s_add_u32 m0, s50, 99328
  s_mov_b32 s53, 196608
  buffer_load_dwordx4 v249, s[16:19], s53 offen nt lds
  s_add_u32 m0, s50, 100352
  v_mfma_f32_16x16x32_bf16 a[164:167], a[196:199], v[244:247], a[164:167]
  s_mov_b32 s53, 196608
  buffer_load_dwordx4 v250, s[16:19], s53 offen nt lds
  v_add_u32 v5, 131072, v2
  v_xor_b32 v7, 0, v5
  ds_read_b128 a[192:195], v7 offset:0
  s_waitcnt lgkmcnt(11)
  v_mfma_f32_16x16x32_bf16 a[40:43], a[200:203], v[228:231], a[40:43]
  v_mfma_f32_16x16x32_bf16 a[104:107], a[200:203], v[236:239], a[104:107]
  v_mfma_f32_16x16x32_bf16 a[168:171], a[200:203], v[244:247], a[168:171]
  ds_read_b128 a[196:199], v7 offset:8192
  s_waitcnt lgkmcnt(10)
  v_mfma_f32_16x16x32_bf16 a[44:47], a[204:207], v[228:231], a[44:47]
  v_mfma_f32_16x16x32_bf16 a[108:111], a[204:207], v[236:239], a[108:111]
  v_xor_b32 v8, 64, v5
  v_mfma_f32_16x16x32_bf16 a[172:175], a[204:207], v[244:247], a[172:175]
  ds_read_b128 a[200:203], v8 offset:0
  s_waitcnt lgkmcnt(9)
  v_mfma_f32_16x16x32_bf16 a[48:51], a[208:211], v[228:231], a[48:51]
  v_mfma_f32_16x16x32_bf16 a[112:115], a[208:211], v[236:239], a[112:115]
  v_mfma_f32_16x16x32_bf16 a[176:179], a[208:211], v[244:247], a[176:179]
  ds_read_b128 a[204:207], v8 offset:8192
  s_waitcnt lgkmcnt(8)
  v_mfma_f32_16x16x32_bf16 a[52:55], a[212:215], v[228:231], a[52:55]
  v_mfma_f32_16x16x32_bf16 a[116:119], a[212:215], v[236:239], a[116:119]
  v_xor_b32 v9, 128, v5
  v_mfma_f32_16x16x32_bf16 a[180:183], a[212:215], v[244:247], a[180:183]
  ds_read_b128 a[208:211], v9 offset:0
  s_waitcnt lgkmcnt(7)
  v_mfma_f32_16x16x32_bf16 a[56:59], a[216:219], v[228:231], a[56:59]
  v_mfma_f32_16x16x32_bf16 a[120:123], a[216:219], v[236:239], a[120:123]
  v_mfma_f32_16x16x32_bf16 a[184:187], a[216:219], v[244:247], a[184:187]
  ds_read_b128 a[212:215], v9 offset:8192
  s_waitcnt lgkmcnt(6)
  v_mfma_f32_16x16x32_bf16 a[60:63], a[220:223], v[228:231], a[60:63]
  v_mfma_f32_16x16x32_bf16 a[124:127], a[220:223], v[236:239], a[124:127]
  v_xor_b32 v6, 192, v5
  v_mfma_f32_16x16x32_bf16 a[188:191], a[220:223], v[244:247], a[188:191]
  ds_read_b128 a[216:219], v6 offset:0
  s_waitcnt lgkmcnt(6)
  v_mfma_f32_16x16x32_bf16 v[128:131], a[192:195], v[32:35], 0
  v_mfma_f32_16x16x32_bf16 v[144:147], a[192:195], v[64:67], 0
  v_mfma_f32_16x16x32_bf16 v[160:163], a[192:195], v[96:99], 0
  ds_read_b128 a[220:223], v6 offset:8192
  s_waitcnt lgkmcnt(6)
  v_mfma_f32_16x16x32_bf16 v[132:135], a[196:199], v[32:35], 0
  v_max3_f32 v19, v176, v177, v178
  v_max3_f32 v20, v179, v180, v181
  v_mfma_f32_16x16x32_bf16 v[148:151], a[196:199], v[64:67], 0
  v_xor_b32 v7, 0, v5
  v_max3_f32 v21, v182, v183, v184
  v_max3_f32 v19, v19, v185, v186
  v_mfma_f32_16x16x32_bf16 v[164:167], a[196:199], v[96:99], 0
  ds_read_b128 a[192:195], v7 offset:256
  v_max3_f32 v20, v20, v187, v188
  v_max3_f32 v21, v21, v189, v190
  v_max3_f32 v19, v19, v20, v191
  s_waitcnt lgkmcnt(6)
  v_mfma_f32_16x16x32_bf16 v[128:131], a[200:203], v[36:39], v[128:131]
  v_max_f32 v16, v19, v21
  v_mov_b32 v19, v16
  v_mfma_f32_16x16x32_bf16 v[144:147], a[200:203], v[68:71], v[144:147]
  s_nop 1
  v_permlane32_swap_b32 v16, v19
  v_max_f32 v16, v16, v19
  v_mfma_f32_16x16x32_bf16 v[160:163], a[200:203], v[100:103], v[160:163]
  ds_read_b128 a[196:199], v7 offset:8448
  v_mov_b32 v19, v16
  s_nop 1
  s_waitcnt lgkmcnt(6)
  v_mfma_f32_16x16x32_bf16 v[132:135], a[204:207], v[36:39], v[132:135]
  v_permlane16_swap_b32 v16, v19
  v_max_f32 v16, v16, v19
  v_mul_f32 v16, s51, v16
  v_mfma_f32_16x16x32_bf16 v[148:151], a[204:207], v[68:71], v[148:151]
  v_xor_b32 v8, 64, v5
  v_max3_f32 v22, v192, v193, v194
  v_max3_f32 v23, v195, v196, v197
  v_mfma_f32_16x16x32_bf16 v[164:167], a[204:207], v[100:103], v[164:167]
  ds_read_b128 a[200:203], v8 offset:256
  v_max3_f32 v24, v198, v199, v200
  v_max3_f32 v22, v22, v201, v202
  v_max3_f32 v23, v23, v203, v204
  s_waitcnt lgkmcnt(6)
  v_mfma_f32_16x16x32_bf16 v[128:131], a[208:211], v[40:43], v[128:131]
  v_max3_f32 v24, v24, v205, v206
  v_max3_f32 v22, v22, v23, v207
  v_mfma_f32_16x16x32_bf16 v[144:147], a[208:211], v[72:75], v[144:147]
  v_max_f32 v17, v22, v24
  v_mov_b32 v22, v17
  s_nop 1
  v_mfma_f32_16x16x32_bf16 v[160:163], a[208:211], v[104:107], v[160:163]
  ds_read_b128 a[204:207], v8 offset:8448
  v_permlane32_swap_b32 v17, v22
  v_max_f32 v17, v17, v22
  s_waitcnt lgkmcnt(6)
  v_mfma_f32_16x16x32_bf16 v[132:135], a[212:215], v[40:43], v[132:135]
  v_mov_b32 v22, v17
  s_nop 1
  v_permlane16_swap_b32 v17, v22
  v_mfma_f32_16x16x32_bf16 v[148:151], a[212:215], v[72:75], v[148:151]
  v_xor_b32 v9, 128, v5
  v_max_f32 v17, v17, v22
  v_mul_f32 v17, s51, v17
  v_mfma_f32_16x16x32_bf16 v[164:167], a[212:215], v[104:107], v[164:167]
  ds_read_b128 a[208:211], v9 offset:256
  v_max3_f32 v25, v208, v209, v210
  v_max3_f32 v26, v211, v212, v213
  v_max3_f32 v27, v214, v215, v216
  s_waitcnt lgkmcnt(6)
  v_mfma_f32_16x16x32_bf16 v[128:131], a[216:219], v[44:47], v[128:131]
  v_max3_f32 v25, v25, v217, v218
  v_max3_f32 v26, v26, v219, v220
  v_mfma_f32_16x16x32_bf16 v[144:147], a[216:219], v[76:79], v[144:147]
  v_max3_f32 v27, v27, v221, v222
  v_max3_f32 v25, v25, v26, v223
  v_max_f32 v18, v25, v27
  v_mfma_f32_16x16x32_bf16 v[160:163], a[216:219], v[108:111], v[160:163]
  ds_read_b128 a[212:215], v9 offset:8448
  v_mov_b32 v25, v18
  s_nop 1
  s_waitcnt lgkmcnt(6)
  v_mfma_f32_16x16x32_bf16 v[132:135], a[220:223], v[44:47], v[132:135]
  v_permlane32_swap_b32 v18, v25
  v_max_f32 v18, v18, v25
  v_mov_b32 v25, v18
  v_mfma_f32_16x16x32_bf16 v[148:151], a[220:223], v[76:79], v[148:151]
  v_xor_b32 v6, 192, v5
  s_nop 1
  v_permlane16_swap_b32 v18, v25
  v_mfma_f32_16x16x32_bf16 v[164:167], a[220:223], v[108:111], v[164:167]
  ds_read_b128 a[216:219], v6 offset:256
  v_max_f32 v18, v18, v25
  v_mul_f32 v18, s51, v18
  v_sub_f32 v19, v16, v10
  s_waitcnt lgkmcnt(6)
  v_mfma_f32_16x16x32_bf16 v[128:131], a[192:195], v[48:51], v[128:131]
  v_sub_f32 v20, v17, v11
  v_sub_f32 v21, v18, v12
  v_mfma_f32_16x16x32_bf16 v[144:147], a[192:195], v[80:83], v[144:147]
  v_max3_f32 v19, v19, v20, v21
  v_cmp_lt_f32 vcc, s52, v19
  s_cbranch_vccnz Lrare_3
Lrare_3_ret:
  v_mfma_f32_16x16x32_bf16 v[160:163], a[192:195], v[112:115], v[160:163]
  ds_read_b128 a[220:223], v6 offset:8448
  v_fma_f32 v176, v176, s51, -v10
  v_fma_f32 v177, v177, s51, -v10
  s_waitcnt lgkmcnt(6)
  v_mfma_f32_16x16x32_bf16 v[132:135], a[196:199], v[48:51], v[132:135]
  s_waitcnt vmcnt(21)
  s_barrier
  s_add_u32 m0, s50, 114688
  s_mov_b32 s53, 212992
  v_fma_f32 v178, v178, s51, -v10
  v_fma_f32 v179, v179, s51, -v10
  v_fma_f32 v180, v180, s51, -v10
  v_mfma_f32_16x16x32_bf16 v[148:151], a[196:199], v[80:83], v[148:151]
  buffer_load_dwordx4 v248, s[16:19], s53 offen nt lds
  s_add_u32 m0, s50, 115712
  s_mov_b32 s53, 212992
  buffer_load_dwordx4 v249, s[16:19], s53 offen nt lds
  s_add_u32 m0, s50, 116736
  v_fma_f32 v181, v181, s51, -v10
  v_fma_f32 v182, v182, s51, -v10
  v_mfma_f32_16x16x32_bf16 v[164:167], a[196:199], v[112:115], v[164:167]
  s_mov_b32 s53, 212992
  buffer_load_dwordx4 v250, s[16:19], s53 offen nt lds
  v_add_u32 v5, 147456, v2
  v_xor_b32 v7, 0, v5
  ds_read_b128 a[192:195], v7 offset:0
  v_fma_f32 v183, v183, s51, -v10
  v_fma_f32 v184, v184, s51, -v10
  v_fma_f32 v185, v185, s51, -v10
  s_waitcnt lgkmcnt(6)
  v_mfma_f32_16x16x32_bf16 v[128:131], a[200:203], v[52:55], v[128:131]
  v_fma_f32 v186, v186, s51, -v10
  v_fma_f32 v187, v187, s51, -v10
  v_mfma_f32_16x16x32_bf16 v[144:147], a[200:203], v[84:87], v[144:147]
  v_fma_f32 v188, v188, s51, -v10
  v_fma_f32 v189, v189, s51, -v10
  v_fma_f32 v190, v190, s51, -v10
  v_mfma_f32_16x16x32_bf16 v[160:163], a[200:203], v[116:119], v[160:163]
  ds_read_b128 a[196:199], v7 offset:8192
  v_fma_f32 v191, v191, s51, -v10
  v_exp_f32 v176, v176
  s_waitcnt lgkmcnt(6)
  v_mfma_f32_16x16x32_bf16 v[132:135], a[204:207], v[52:55], v[132:135]
  v_exp_f32 v177, v177
  v_exp_f32 v178, v178
  v_exp_f32 v179, v179
  v_mfma_f32_16x16x32_bf16 v[148:151], a[204:207], v[84:87], v[148:151]
  v_xor_b32 v8, 64, v5
  v_exp_f32 v180, v180
  v_exp_f32 v181, v181
  v_mfma_f32_16x16x32_bf16 v[164:167], a[204:207], v[116:119], v[164:167]
  ds_read_b128 a[200:203], v8 offset:0
  v_exp_f32 v182, v182
  v_exp_f32 v183, v183
  v_exp_f32 v184, v184
  s_waitcnt lgkmcnt(6)
  v_mfma_f32_16x16x32_bf16 v[128:131], a[208:211], v[56:59], v[128:131]
  v_exp_f32 v185, v185
  v_exp_f32 v186, v186
  v_mfma_f32_16x16x32_bf16 v[144:147], a[208:211], v[88:91], v[144:147]
  v_exp_f32 v187, v187
  v_exp_f32 v188, v188
  v_exp_f32 v189, v189
  v_mfma_f32_16x16x32_bf16 v[160:163], a[208:211], v[120:123], v[160:163]
  ds_read_b128 a[204:207], v8 offset:8192
  v_exp_f32 v190, v190
  v_exp_f32 v191, v191
  s_waitcnt lgkmcnt(6)
  v_mfma_f32_16x16x32_bf16 v[132:135], a[212:215], v[56:59], v[132:135]
  v_fma_f32 v192, v192, s51, -v11
  v_fma_f32 v193, v193, s51, -v11
  v_fma_f32 v194, v194, s51, -v11
  v_mfma_f32_16x16x32_bf16 v[148:151], a[212:215], v[88:91], v[148:151]
  v_xor_b32 v9, 128, v5
  v_fma_f32 v195, v195, s51, -v11
  v_fma_f32 v196, v196, s51, -v11
  v_mfma_f32_16x16x32_bf16 v[164:167], a[212:215], v[120:123], v[164:167]
  ds_read_b128 a[208:211], v9 offset:0
  v_fma_f32 v197, v197, s51, -v11
  v_fma_f32 v198, v198, s51, -v11
  v_fma_f32 v199, v199, s51, -v11
  s_waitcnt lgkmcnt(6)
  v_mfma_f32_16x16x32_bf16 v[128:131], a[216:219], v[60:63], v[128:131]
  v_fma_f32 v200, v200, s51, -v11
  v_fma_f32 v201, v201, s51, -v11
  v_mfma_f32_16x16x32_bf16 v[144:147], a[216:219], v[92:95], v[144:147]
  v_fma_f32 v202, v202, s51, -v11
  v_fma_f32 v203, v203, s51, -v11
  v_fma_f32 v204, v204, s51, -v11
  v_mfma_f32_16x16x32_bf16 v[160:163], a[216:219], v[124:127], v[160:163]
  ds_read_b128 a[212:215], v9 offset:8192
  v_fma_f32 v205, v205, s51, -v11
  v_fma_f32 v206, v206, s51, -v11
  s_waitcnt lgkmcnt(6)
  v_mfma_f32_16x16x32_bf16 v[132:135], a[220:223], v[60:63], v[132:135]
  v_fma_f32 v207, v207, s51, -v11
  v_exp_f32 v192, v192
  v_exp_f32 v193, v193
  v_mfma_f32_16x16x32_bf16 v[148:151], a[220:223], v[92:95], v[148:151]
  v_xor_b32 v6, 192, v5
  v_exp_f32 v194, v194
  v_exp_f32 v195, v195
  v_mfma_f32_16x16x32_bf16 v[164:167], a[220:223], v[124:127], v[164:167]
  ds_read_b128 a[216:219], v6 offset:0
  v_exp_f32 v196, v196
  v_exp_f32 v197, v197
  v_exp_f32 v198, v198
  s_waitcnt lgkmcnt(6)
  v_mfma_f32_16x16x32_bf16 v[136:139], a[192:195], v[32:35], 0
  v_mfma_f32_16x16x32_bf16 v[152:155], a[192:195], v[64:67], 0
  v_mfma_f32_16x16x32_bf16 v[168:171], a[192:195], v[96:99], 0
  ds_read_b128 a[220:223], v6 offset:8192
  s_waitcnt lgkmcnt(6)
  v_mfma_f32_16x16x32_bf16 v[140:143], a[196:199], v[32:35], 0
  v_exp_f32 v199, v199
  v_exp_f32 v200, v200
  v_mfma_f32_16x16x32_bf16 v[156:159], a[196:199], v[64:67], 0
  v_xor_b32 v7, 0, v5
  v_exp_f32 v201, v201
  v_exp_f32 v202, v202
  v_exp_f32 v203, v203
  v_mfma_f32_16x16x32_bf16 v[172:175], a[196:199], v[96:99], 0
  ds_read_b128 a[192:195], v7 offset:256
  v_exp_f32 v204, v204
  v_exp_f32 v205, v205
  s_waitcnt lgkmcnt(6)
  v_mfma_f32_16x16x32_bf16 v[136:139], a[200:203], v[36:39], v[136:139]
  v_exp_f32 v206, v206
  v_exp_f32 v207, v207
  v_fma_f32 v208, v208, s51, -v12
  v_mfma_f32_16x16x32_bf16 v[152:155], a[200:203], v[68:71], v[152:155]
  v_fma_f32 v209, v209, s51, -v12
  v_fma_f32 v210, v210, s51, -v12
  v_mfma_f32_16x16x32_bf16 v[168:171], a[200:203], v[100:103], v[168:171]
  ds_read_b128 a[196:199], v7 offset:8448
  v_fma_f32 v211, v211, s51, -v12
  v_fma_f32 v212, v212, s51, -v12
  v_fma_f32 v213, v213, s51, -v12
  s_waitcnt lgkmcnt(6)
  v_mfma_f32_16x16x32_bf16 v[140:143], a[204:207], v[36:39], v[140:143]
  v_fma_f32 v214, v214, s51, -v12
  v_fma_f32 v215, v215, s51, -v12
  v_mfma_f32_16x16x32_bf16 v[156:159], a[204:207], v[68:71], v[156:159]
  v_xor_b32 v8, 64, v5
  v_fma_f32 v216, v216, s51, -v12
  v_fma_f32 v217, v217, s51, -v12
  v_fma_f32 v218, v218, s51, -v12
  v_mfma_f32_16x16x32_bf16 v[172:175], a[204:207], v[100:103], v[172:175]
  ds_read_b128 a[200:203], v8 offset:256
  v_fma_f32 v219, v219, s51, -v12
  v_fma_f32 v220, v220, s51, -v12
  s_waitcnt lgkmcnt(6)
  v_mfma_f32_16x16x32_bf16 v[136:139], a[208:211], v[40:43], v[136:139]
  v_fma_f32 v221, v221, s51, -v12
  v_fma_f32 v222, v222, s51, -v12
  v_fma_f32 v223, v223, s51, -v12
  v_mfma_f32_16x16x32_bf16 v[152:155], a[208:211], v[72:75], v[152:155]
  v_exp_f32 v208, v208
  v_exp_f32 v209, v209
  v_mfma_f32_16x16x32_bf16 v[168:171], a[208:211], v[104:107], v[168:171]
  ds_read_b128 a[204:207], v8 offset:8448
  v_exp_f32 v210, v210
  v_exp_f32 v211, v211
  v_exp_f32 v212, v212
  s_waitcnt lgkmcnt(6)
  v_mfma_f32_16x16x32_bf16 v[140:143], a[212:215], v[40:43], v[140:143]
  v_exp_f32 v213, v213
  v_exp_f32 v214, v214
  v_mfma_f32_16x16x32_bf16 v[156:159], a[212:215], v[72:75], v[156:159]
  v_xor_b32 v9, 128, v5
  v_exp_f32 v215, v215
  v_exp_f32 v216, v216
  v_exp_f32 v217, v217
  v_mfma_f32_16x16x32_bf16 v[172:175], a[212:215], v[104:107], v[172:175]
  ds_read_b128 a[208:211], v9 offset:256
  v_exp_f32 v218, v218
  v_exp_f32 v219, v219
  s_waitcnt lgkmcnt(6)
  v_mfma_f32_16x16x32_bf16 v[136:139], a[216:219], v[44:47], v[136:139]
  v_exp_f32 v220, v220
  v_exp_f32 v221, v221
  v_exp_f32 v222, v222
  v_mfma_f32_16x16x32_bf16 v[152:155], a[216:219], v[76:79], v[152:155]
  v_exp_f32 v223, v223
  v_add_f32 v19, v176, v177
  v_mfma_f32_16x16x32_bf16 v[168:171], a[216:219], v[108:111], v[168:171]
  ds_read_b128 a[212:215], v9 offset:8448
  v_add_f32 v20, v178, v179
  v_add_f32 v19, v19, v180
  v_add_f32 v20, v20, v181
  s_waitcnt lgkmcnt(6)
  v_mfma_f32_16x16x32_bf16 v[140:143], a[220:223], v[44:47], v[140:143]
  v_add_f32 v19, v19, v182
  v_add_f32 v20, v20, v183
  v_mfma_f32_16x16x32_bf16 v[156:159], a[220:223], v[76:79], v[156:159]
  v_xor_b32 v6, 192, v5
  v_add_f32 v19, v19, v184
  v_add_f32 v20, v20, v185
  v_add_f32 v19, v19, v186
  v_mfma_f32_16x16x32_bf16 v[172:175], a[220:223], v[108:111], v[172:175]
  ds_read_b128 a[216:219], v6 offset:256
  v_add_f32 v20, v20, v187
  v_add_f32 v19, v19, v188
  s_waitcnt lgkmcnt(6)
  v_mfma_f32_16x16x32_bf16 v[136:139], a[192:195], v[48:51], v[136:139]
  v_add_f32 v20, v20, v189
  v_add_f32 v19, v19, v190
  v_add_f32 v20, v20, v191
  v_mfma_f32_16x16x32_bf16 v[152:155], a[192:195], v[80:83], v[152:155]
  v_add_f32 v19, v19, v20
  v_add_f32 v13, v13, v19
  v_mfma_f32_16x16x32_bf16 v[168:171], a[192:195], v[112:115], v[168:171]
  ds_read_b128 a[220:223], v6 offset:8448
  v_add_f32 v22, v192, v193
  v_add_f32 v23, v194, v195
  v_add_f32 v22, v22, v196
  s_waitcnt lgkmcnt(6)
  v_mfma_f32_16x16x32_bf16 v[140:143], a[196:199], v[48:51], v[140:143]
  s_waitcnt vmcnt(21)
  s_barrier
  s_add_u32 m0, s50, 131072
  s_mov_b32 s53, 163840
  buffer_load_dwordx4 v248, s[20:23], s53 offen nt lds
  v_add_f32 v23, v23, v197
  v_add_f32 v22, v22, v198
  v_mfma_f32_16x16x32_bf16 v[156:159], a[196:199], v[80:83], v[156:159]
  s_add_u32 m0, s50, 132096
  s_mov_b32 s53, 163840
  buffer_load_dwordx4 v249, s[20:23], s53 offen nt lds
  s_add_u32 m0, s50, 133120
  s_mov_b32 s53, 163840
  v_add_f32 v23, v23, v199
  v_add_f32 v22, v22, v200
  v_add_f32 v23, v23, v201
  v_mfma_f32_16x16x32_bf16 v[172:175], a[196:199], v[112:115], v[172:175]
  buffer_load_dwordx4 v250, s[20:23], s53 offen nt lds
  v_add_u32 v5, 0, v3
  v_xor_b32 v7, 0, v5
  ds_read_b64_tr_b16 a[192:193], v7 offset:0
  ds_read_b64_tr_b16 a[194:195], v7 offset:8192
  v_add_f32 v22, v22, v202
  v_add_f32 v23, v23, v203
  s_waitcnt lgkmcnt(7)
  v_mfma_f32_16x16x32_bf16 v[136:139], a[200:203], v[52:55], v[136:139]
  v_xor_b32 v8, 32, v5
  v_add_f32 v22, v22, v204
  v_add_f32 v23, v23, v205
  v_add_f32 v22, v22, v206
  v_mfma_f32_16x16x32_bf16 v[152:155], a[200:203], v[84:87], v[152:155]
  ds_read_b64_tr_b16 a[196:197], v8 offset:0
  v_add_f32 v23, v23, v207
  v_add_f32 v22, v22, v23
  v_mfma_f32_16x16x32_bf16 v[168:171], a[200:203], v[116:119], v[168:171]
  ds_read_b64_tr_b16 a[198:199], v8 offset:8192
  v_add_f32 v14, v14, v22
  v_add_f32 v25, v208, v209
  v_add_f32 v26, v210, v211
  s_waitcnt lgkmcnt(8)
  v_mfma_f32_16x16x32_bf16 v[140:143], a[204:207], v[52:55], v[140:143]
  v_xor_b32 v9, 64, v5
  v_add_f32 v25, v25, v212
  v_add_f32 v26, v26, v213
  v_mfma_f32_16x16x32_bf16 v[156:159], a[204:207], v[84:87], v[156:159]
  ds_read_b64_tr_b16 a[200:201], v9 offset:0
  v_add_f32 v25, v25, v214
  v_add_f32 v26, v26, v215
  v_add_f32 v25, v25, v216
  v_mfma_f32_16x16x32_bf16 v[172:175], a[204:207], v[116:119], v[172:175]
  ds_read_b64_tr_b16 a[202:203], v9 offset:8192
  v_add_f32 v26, v26, v217
  v_add_f32 v25, v25, v218
  s_waitcnt lgkmcnt(9)
  v_mfma_f32_16x16x32_bf16 v[136:139], a[208:211], v[56:59], v[136:139]
  v_xor_b32 v6, 96, v5
  v_add_f32 v26, v26, v219
  v_add_f32 v25, v25, v220
  v_add_f32 v26, v26, v221
  v_mfma_f32_16x16x32_bf16 v[152:155], a[208:211], v[88:91], v[152:155]
  ds_read_b64_tr_b16 a[204:205], v6 offset:0
  v_add_f32 v25, v25, v222
  v_add_f32 v26, v26, v223
  v_mfma_f32_16x16x32_bf16 v[168:171], a[208:211], v[120:123], v[168:171]
  ds_read_b64_tr_b16 a[206:207], v6 offset:8192
  v_add_f32 v25, v25, v26
  v_add_f32 v15, v15, v25
  v_cvt_pk_bf16_f32 v224, v176, v177
  s_waitcnt lgkmcnt(10)
  v_mfma_f32_16x16x32_bf16 v[140:143], a[212:215], v[56:59], v[140:143]
  v_xor_b32 v7, 128, v5
  v_cvt_pk_bf16_f32 v225, v178, v179
  v_cvt_pk_bf16_f32 v226, v180, v181
  v_mfma_f32_16x16x32_bf16 v[156:159], a[212:215], v[88:91], v[156:159]
  ds_read_b64_tr_b16 a[208:209], v7 offset:0
  v_cvt_pk_bf16_f32 v227, v182, v183
  v_cvt_pk_bf16_f32 v228, v184, v185
  v_cvt_pk_bf16_f32 v229, v186, v187
  v_mfma_f32_16x16x32_bf16 v[172:175], a[212:215], v[120:123], v[172:175]
  ds_read_b64_tr_b16 a[210:211], v7 offset:8192
  v_cvt_pk_bf16_f32 v230, v188, v189
  v_cvt_pk_bf16_f32 v231, v190, v191
  s_waitcnt lgkmcnt(11)
  v_mfma_f32_16x16x32_bf16 v[136:139], a[216:219], v[60:63], v[136:139]
  v_xor_b32 v8, 160, v5
  v_cvt_pk_bf16_f32 v232, v192, v193
  v_cvt_pk_bf16_f32 v233, v194, v195
  v_cvt_pk_bf16_f32 v234, v196, v197
  v_mfma_f32_16x16x32_bf16 v[152:155], a[216:219], v[92:95], v[152:155]
  ds_read_b64_tr_b16 a[212:213], v8 offset:0
  v_cvt_pk_bf16_f32 v235, v198, v199
  v_cvt_pk_bf16_f32 v236, v200, v201
  v_mfma_f32_16x16x32_bf16 v[168:171], a[216:219], v[124:127], v[168:171]
  ds_read_b64_tr_b16 a[214:215], v8 offset:8192
  v_cvt_pk_bf16_f32 v237, v202, v203
  v_cvt_pk_bf16_f32 v238, v204, v205
  v_cvt_pk_bf16_f32 v239, v206, v207
  s_waitcnt lgkmcnt(12)
  v_mfma_f32_16x16x32_bf16 v[140:143], a[220:223], v[60:63], v[140:143]
  v_xor_b32 v9, 192, v5
  v_cvt_pk_bf16_f32 v240, v208, v209
  v_cvt_pk_bf16_f32 v241, v210, v211
  v_mfma_f32_16x16x32_bf16 v[156:159], a[220:223], v[92:95], v[156:159]
  ds_read_b64_tr_b16 a[216:217], v9 offset:0
  v_cvt_pk_bf16_f32 v242, v212, v213
  v_cvt_pk_bf16_f32 v243, v214, v215
  v_cvt_pk_bf16_f32 v244, v216, v217
  v_mfma_f32_16x16x32_bf16 v[172:175], a[220:223], v[124:127], v[172:175]
  ds_read_b64_tr_b16 a[218:219], v9 offset:8192
  v_cvt_pk_bf16_f32 v245, v218, v219
  v_cvt_pk_bf16_f32 v246, v220, v221
  v_cvt_pk_bf16_f32 v247, v222, v223
  s_waitcnt lgkmcnt(12)
  v_mfma_f32_16x16x32_bf16 a[0:3], a[192:195], v[224:227], a[0:3]
  v_xor_b32 v6, 224, v5
  v_mfma_f32_16x16x32_bf16 a[64:67], a[192:195], v[232:235], a[64:67]
  ds_read_b64_tr_b16 a[220:221], v6 offset:0
  v_mfma_f32_16x16x32_bf16 a[128:131], a[192:195], v[240:243], a[128:131]
  ds_read_b64_tr_b16 a[222:223], v6 offset:8192
  s_waitcnt lgkmcnt(12)
  v_mfma_f32_16x16x32_bf16 a[4:7], a[196:199], v[224:227], a[4:7]
  v_xor_b32 v7, 0, v5
  v_mfma_f32_16x16x32_bf16 a[68:71], a[196:199], v[232:235], a[68:71]
  ds_read_b64_tr_b16 a[192:193], v7 offset:256
  v_mfma_f32_16x16x32_bf16 a[132:135], a[196:199], v[240:243], a[132:135]
  ds_read_b64_tr_b16 a[194:195], v7 offset:8448
  s_waitcnt lgkmcnt(12)
  v_mfma_f32_16x16x32_bf16 a[8:11], a[200:203], v[224:227], a[8:11]
  v_xor_b32 v8, 32, v5
  v_mfma_f32_16x16x32_bf16 a[72:75], a[200:203], v[232:235], a[72:75]
  ds_read_b64_tr_b16 a[196:197], v8 offset:256
  v_mfma_f32_16x16x32_bf16 a[136:139], a[200:203], v[240:243], a[136:139]
  ds_read_b64_tr_b16 a[198:199], v8 offset:8448
  s_waitcnt lgkmcnt(12)
  v_mfma_f32_16x16x32_bf16 a[12:15], a[204:207], v[224:227], a[12:15]
  v_xor_b32 v9, 64, v5
  v_mfma_f32_16x16x32_bf16 a[76:79], a[204:207], v[232:235], a[76:79]
  ds_read_b64_tr_b16 a[200:201], v9 offset:256
  v_mfma_f32_16x16x32_bf16 a[140:143], a[204:207], v[240:243], a[140:143]
  ds_read_b64_tr_b16 a[202:203], v9 offset:8448
  s_waitcnt lgkmcnt(12)
  v_mfma_f32_16x16x32_bf16 a[16:19], a[208:211], v[224:227], a[16:19]
  v_xor_b32 v6, 96, v5
  v_mfma_f32_16x16x32_bf16 a[80:83], a[208:211], v[232:235], a[80:83]
  ds_read_b64_tr_b16 a[204:205], v6 offset:256
  v_mfma_f32_16x16x32_bf16 a[144:147], a[208:211], v[240:243], a[144:147]
  ds_read_b64_tr_b16 a[206:207], v6 offset:8448
  s_waitcnt lgkmcnt(12)
  v_mfma_f32_16x16x32_bf16 a[20:23], a[212:215], v[224:227], a[20:23]
  v_xor_b32 v7, 128, v5
  v_mfma_f32_16x16x32_bf16 a[84:87], a[212:215], v[232:235], a[84:87]
  ds_read_b64_tr_b16 a[208:209], v7 offset:256
  v_mfma_f32_16x16x32_bf16 a[148:151], a[212:215], v[240:243], a[148:151]
  ds_read_b64_tr_b16 a[210:211], v7 offset:8448
  s_waitcnt lgkmcnt(12)
  v_mfma_f32_16x16x32_bf16 a[24:27], a[216:219], v[224:227], a[24:27]
  v_xor_b32 v8, 160, v5
  v_mfma_f32_16x16x32_bf16 a[88:91], a[216:219], v[232:235], a[88:91]
  ds_read_b64_tr_b16 a[212:213], v8 offset:256
  v_mfma_f32_16x16x32_bf16 a[152:155], a[216:219], v[240:243], a[152:155]
  ds_read_b64_tr_b16 a[214:215], v8 offset:8448
  s_waitcnt lgkmcnt(12)
  v_mfma_f32_16x16x32_bf16 a[28:31], a[220:223], v[224:227], a[28:31]
  v_xor_b32 v9, 192, v5
  v_mfma_f32_16x16x32_bf16 a[92:95], a[220:223], v[232:235], a[92:95]
  ds_read_b64_tr_b16 a[216:217], v9 offset:256
  v_mfma_f32_16x16x32_bf16 a[156:159], a[220:223], v[240:243], a[156:159]
  ds_read_b64_tr_b16 a[218:219], v9 offset:8448
  s_waitcnt lgkmcnt(12)
  v_mfma_f32_16x16x32_bf16 a[32:35], a[192:195], v[224:227], a[32:35]
  v_xor_b32 v6, 224, v5
  v_mfma_f32_16x16x32_bf16 a[96:99], a[192:195], v[232:235], a[96:99]
  ds_read_b64_tr_b16 a[220:221], v6 offset:256
  v_mfma_f32_16x16x32_bf16 a[160:163], a[192:195], v[240:243], a[160:163]
  ds_read_b64_tr_b16 a[222:223], v6 offset:8448
  s_waitcnt lgkmcnt(12)
  v_mfma_f32_16x16x32_bf16 a[36:39], a[196:199], v[224:227], a[36:39]
  s_waitcnt vmcnt(21)
  s_barrier
  s_add_u32 m0, s50, 147456
  s_mov_b32 s53, 180224
  buffer_load_dwordx4 v248, s[20:23], s53 offen nt lds
  v_mfma_f32_16x16x32_bf16 a[100:103], a[196:199], v[232:235], a[100:103]
  s_add_u32 m0, s50, 148480
  s_mov_b32 s53, 180224
  buffer_load_dwordx4 v249, s[20:23], s53 offen nt lds
  s_add_u32 m0, s50, 149504
  s_mov_b32 s53, 180224
  v_mfma_f32_16x16x32_bf16 a[164:167], a[196:199], v[240:243], a[164:167]
  buffer_load_dwordx4 v250, s[20:23], s53 offen nt lds
  v_add_u32 v5, 16384, v3
  v_xor_b32 v7, 0, v5
  ds_read_b64_tr_b16 a[192:193], v7 offset:0
  ds_read_b64_tr_b16 a[194:195], v7 offset:8192
  s_waitcnt lgkmcnt(12)
  v_mfma_f32_16x16x32_bf16 a[40:43], a[200:203], v[224:227], a[40:43]
  v_xor_b32 v8, 32, v5
  v_mfma_f32_16x16x32_bf16 a[104:107], a[200:203], v[232:235], a[104:107]
  ds_read_b64_tr_b16 a[196:197], v8 offset:0
  v_mfma_f32_16x16x32_bf16 a[168:171], a[200:203], v[240:243], a[168:171]
  ds_read_b64_tr_b16 a[198:199], v8 offset:8192
  s_waitcnt lgkmcnt(12)
  v_mfma_f32_16x16x32_bf16 a[44:47], a[204:207], v[224:227], a[44:47]
  v_xor_b32 v9, 64, v5
  v_mfma_f32_16x16x32_bf16 a[108:111], a[204:207], v[232:235], a[108:111]
  ds_read_b64_tr_b16 a[200:201], v9 offset:0
  v_mfma_f32_16x16x32_bf16 a[172:175], a[204:207], v[240:243], a[172:175]
  ds_read_b64_tr_b16 a[202:203], v9 offset:8192
  s_waitcnt lgkmcnt(12)
  v_mfma_f32_16x16x32_bf16 a[48:51], a[208:211], v[224:227], a[48:51]
  v_xor_b32 v6, 96, v5
  v_mfma_f32_16x16x32_bf16 a[112:115], a[208:211], v[232:235], a[112:115]
  ds_read_b64_tr_b16 a[204:205], v6 offset:0
  v_mfma_f32_16x16x32_bf16 a[176:179], a[208:211], v[240:243], a[176:179]
  ds_read_b64_tr_b16 a[206:207], v6 offset:8192
  s_waitcnt lgkmcnt(12)
  v_mfma_f32_16x16x32_bf16 a[52:55], a[212:215], v[224:227], a[52:55]
  v_xor_b32 v7, 128, v5
  v_mfma_f32_16x16x32_bf16 a[116:119], a[212:215], v[232:235], a[116:119]
  ds_read_b64_tr_b16 a[208:209], v7 offset:0
  v_mfma_f32_16x16x32_bf16 a[180:183], a[212:215], v[240:243], a[180:183]
  ds_read_b64_tr_b16 a[210:211], v7 offset:8192
  s_waitcnt lgkmcnt(12)
  v_mfma_f32_16x16x32_bf16 a[56:59], a[216:219], v[224:227], a[56:59]
  v_xor_b32 v8, 160, v5
  v_mfma_f32_16x16x32_bf16 a[120:123], a[216:219], v[232:235], a[120:123]
  ds_read_b64_tr_b16 a[212:213], v8 offset:0
  v_mfma_f32_16x16x32_bf16 a[184:187], a[216:219], v[240:243], a[184:187]
  ds_read_b64_tr_b16 a[214:215], v8 offset:8192
  s_waitcnt lgkmcnt(12)
  v_mfma_f32_16x16x32_bf16 a[60:63], a[220:223], v[224:227], a[60:63]
  v_xor_b32 v9, 192, v5
  v_mfma_f32_16x16x32_bf16 a[124:127], a[220:223], v[232:235], a[124:127]
  ds_read_b64_tr_b16 a[216:217], v9 offset:0
  v_mfma_f32_16x16x32_bf16 a[188:191], a[220:223], v[240:243], a[188:191]
  ds_read_b64_tr_b16 a[218:219], v9 offset:8192
  s_waitcnt lgkmcnt(12)
  v_mfma_f32_16x16x32_bf16 a[0:3], a[192:195], v[228:231], a[0:3]
  v_xor_b32 v6, 224, v5
  v_mfma_f32_16x16x32_bf16 a[64:67], a[192:195], v[236:239], a[64:67]
  ds_read_b64_tr_b16 a[220:221], v6 offset:0
  v_mfma_f32_16x16x32_bf16 a[128:131], a[192:195], v[244:247], a[128:131]
  ds_read_b64_tr_b16 a[222:223], v6 offset:8192
  s_waitcnt lgkmcnt(12)
  v_mfma_f32_16x16x32_bf16 a[4:7], a[196:199], v[228:231], a[4:7]
  v_xor_b32 v7, 0, v5
  v_mfma_f32_16x16x32_bf16 a[68:71], a[196:199], v[236:239], a[68:71]
  ds_read_b64_tr_b16 a[192:193], v7 offset:256
  v_mfma_f32_16x16x32_bf16 a[132:135], a[196:199], v[244:247], a[132:135]
  ds_read_b64_tr_b16 a[194:195], v7 offset:8448
  s_waitcnt lgkmcnt(12)
  v_mfma_f32_16x16x32_bf16 a[8:11], a[200:203], v[228:231], a[8:11]
  v_xor_b32 v8, 32, v5
  v_mfma_f32_16x16x32_bf16 a[72:75], a[200:203], v[236:239], a[72:75]
  ds_read_b64_tr_b16 a[196:197], v8 offset:256
  v_mfma_f32_16x16x32_bf16 a[136:139], a[200:203], v[244:247], a[136:139]
  ds_read_b64_tr_b16 a[198:199], v8 offset:8448
  s_waitcnt lgkmcnt(12)
  v_mfma_f32_16x16x32_bf16 a[12:15], a[204:207], v[228:231], a[12:15]
  v_xor_b32 v9, 64, v5
  v_mfma_f32_16x16x32_bf16 a[76:79], a[204:207], v[236:239], a[76:79]
  ds_read_b64_tr_b16 a[200:201], v9 offset:256
  v_mfma_f32_16x16x32_bf16 a[140:143], a[204:207], v[244:247], a[140:143]
  ds_read_b64_tr_b16 a[202:203], v9 offset:8448
  s_waitcnt lgkmcnt(12)
  v_mfma_f32_16x16x32_bf16 a[16:19], a[208:211], v[228:231], a[16:19]
  v_xor_b32 v6, 96, v5
  v_mfma_f32_16x16x32_bf16 a[80:83], a[208:211], v[236:239], a[80:83]
  ds_read_b64_tr_b16 a[204:205], v6 offset:256
  v_mfma_f32_16x16x32_bf16 a[144:147], a[208:211], v[244:247], a[144:147]
  ds_read_b64_tr_b16 a[206:207], v6 offset:8448
  s_waitcnt lgkmcnt(12)
  v_mfma_f32_16x16x32_bf16 a[20:23], a[212:215], v[228:231], a[20:23]
  v_xor_b32 v7, 128, v5
  v_mfma_f32_16x16x32_bf16 a[84:87], a[212:215], v[236:239], a[84:87]
  ds_read_b64_tr_b16 a[208:209], v7 offset:256
  v_mfma_f32_16x16x32_bf16 a[148:151], a[212:215], v[244:247], a[148:151]
  ds_read_b64_tr_b16 a[210:211], v7 offset:8448
  s_waitcnt lgkmcnt(12)
  v_mfma_f32_16x16x32_bf16 a[24:27], a[216:219], v[228:231], a[24:27]
  v_xor_b32 v8, 160, v5
  v_mfma_f32_16x16x32_bf16 a[88:91], a[216:219], v[236:239], a[88:91]
  ds_read_b64_tr_b16 a[212:213], v8 offset:256
  v_mfma_f32_16x16x32_bf16 a[152:155], a[216:219], v[244:247], a[152:155]
  ds_read_b64_tr_b16 a[214:215], v8 offset:8448
  s_waitcnt lgkmcnt(12)
  v_mfma_f32_16x16x32_bf16 a[28:31], a[220:223], v[228:231], a[28:31]
  v_xor_b32 v9, 192, v5
  v_mfma_f32_16x16x32_bf16 a[92:95], a[220:223], v[236:239], a[92:95]
  ds_read_b64_tr_b16 a[216:217], v9 offset:256
  v_mfma_f32_16x16x32_bf16 a[156:159], a[220:223], v[244:247], a[156:159]
  ds_read_b64_tr_b16 a[218:219], v9 offset:8448
  s_waitcnt lgkmcnt(12)
  v_mfma_f32_16x16x32_bf16 a[32:35], a[192:195], v[228:231], a[32:35]
  v_xor_b32 v6, 224, v5
  v_mfma_f32_16x16x32_bf16 a[96:99], a[192:195], v[236:239], a[96:99]
  ds_read_b64_tr_b16 a[220:221], v6 offset:256
  v_mfma_f32_16x16x32_bf16 a[160:163], a[192:195], v[244:247], a[160:163]
  ds_read_b64_tr_b16 a[222:223], v6 offset:8448
  s_waitcnt lgkmcnt(12)
  v_mfma_f32_16x16x32_bf16 a[36:39], a[196:199], v[228:231], a[36:39]
  s_waitcnt vmcnt(21)
  s_barrier
  s_add_u32 m0, s50, 0
  s_mov_b32 s53, 229376
  v_mfma_f32_16x16x32_bf16 a[100:103], a[196:199], v[236:239], a[100:103]
  buffer_load_dwordx4 v248, s[16:19], s53 offen nt lds
  s_add_u32 m0, s50, 1024
  s_mov_b32 s53, 229376
  buffer_load_dwordx4 v249, s[16:19], s53 offen nt lds
  s_add_u32 m0, s50, 2048
  v_mfma_f32_16x16x32_bf16 a[164:167], a[196:199], v[244:247], a[164:167]
  s_mov_b32 s53, 229376
  buffer_load_dwordx4 v250, s[16:19], s53 offen nt lds
  v_add_u32 v5, 32768, v2
  v_xor_b32 v7, 0, v5
  ds_read_b128 a[192:195], v7 offset:0
  s_waitcnt lgkmcnt(11)
  v_mfma_f32_16x16x32_bf16 a[40:43], a[200:203], v[228:231], a[40:43]
  v_mfma_f32_16x16x32_bf16 a[104:107], a[200:203], v[236:239], a[104:107]
  v_mfma_f32_16x16x32_bf16 a[168:171], a[200:203], v[244:247], a[168:171]
  ds_read_b128 a[196:199], v7 offset:8192
  s_waitcnt lgkmcnt(10)
  v_mfma_f32_16x16x32_bf16 a[44:47], a[204:207], v[228:231], a[44:47]
  v_mfma_f32_16x16x32_bf16 a[108:111], a[204:207], v[236:239], a[108:111]
  v_xor_b32 v8, 64, v5
  v_mfma_f32_16x16x32_bf16 a[172:175], a[204:207], v[244:247], a[172:175]
  ds_read_b128 a[200:203], v8 offset:0
  s_waitcnt lgkmcnt(9)
  v_mfma_f32_16x16x32_bf16 a[48:51], a[208:211], v[228:231], a[48:51]
  v_mfma_f32_16x16x32_bf16 a[112:115], a[208:211], v[236:239], a[112:115]
  v_mfma_f32_16x16x32_bf16 a[176:179], a[208:211], v[244:247], a[176:179]
  ds_read_b128 a[204:207], v8 offset:8192
  s_waitcnt lgkmcnt(8)
  v_mfma_f32_16x16x32_bf16 a[52:55], a[212:215], v[228:231], a[52:55]
  v_mfma_f32_16x16x32_bf16 a[116:119], a[212:215], v[236:239], a[116:119]
  v_xor_b32 v9, 128, v5
  v_mfma_f32_16x16x32_bf16 a[180:183], a[212:215], v[244:247], a[180:183]
  ds_read_b128 a[208:211], v9 offset:0
  s_waitcnt lgkmcnt(7)
  v_mfma_f32_16x16x32_bf16 a[56:59], a[216:219], v[228:231], a[56:59]
  v_mfma_f32_16x16x32_bf16 a[120:123], a[216:219], v[236:239], a[120:123]
  v_mfma_f32_16x16x32_bf16 a[184:187], a[216:219], v[244:247], a[184:187]
  ds_read_b128 a[212:215], v9 offset:8192
  s_waitcnt lgkmcnt(6)
  v_mfma_f32_16x16x32_bf16 a[60:63], a[220:223], v[228:231], a[60:63]
  v_mfma_f32_16x16x32_bf16 a[124:127], a[220:223], v[236:239], a[124:127]
  v_xor_b32 v6, 192, v5
  v_mfma_f32_16x16x32_bf16 a[188:191], a[220:223], v[244:247], a[188:191]
  ds_read_b128 a[216:219], v6 offset:0
  s_waitcnt lgkmcnt(6)
  v_mfma_f32_16x16x32_bf16 v[176:179], a[192:195], v[32:35], 0
  v_mfma_f32_16x16x32_bf16 v[192:195], a[192:195], v[64:67], 0
  v_mfma_f32_16x16x32_bf16 v[208:211], a[192:195], v[96:99], 0
  ds_read_b128 a[220:223], v6 offset:8192
  s_waitcnt lgkmcnt(6)
  v_mfma_f32_16x16x32_bf16 v[180:183], a[196:199], v[32:35], 0
  v_max3_f32 v19, v128, v129, v130
  v_max3_f32 v20, v131, v132, v133
  v_mfma_f32_16x16x32_bf16 v[196:199], a[196:199], v[64:67], 0
  v_xor_b32 v7, 0, v5
  v_max3_f32 v21, v134, v135, v136
  v_max3_f32 v19, v19, v137, v138
  v_mfma_f32_16x16x32_bf16 v[212:215], a[196:199], v[96:99], 0
  ds_read_b128 a[192:195], v7 offset:256
  v_max3_f32 v20, v20, v139, v140
  v_max3_f32 v21, v21, v141, v142
  v_max3_f32 v19, v19, v20, v143
  s_waitcnt lgkmcnt(6)
  v_mfma_f32_16x16x32_bf16 v[176:179], a[200:203], v[36:39], v[176:179]
  v_max_f32 v16, v19, v21
  v_mov_b32 v19, v16
  v_mfma_f32_16x16x32_bf16 v[192:195], a[200:203], v[68:71], v[192:195]
  s_nop 1
  v_permlane32_swap_b32 v16, v19
  v_max_f32 v16, v16, v19
  v_mfma_f32_16x16x32_bf16 v[208:211], a[200:203], v[100:103], v[208:211]
  ds_read_b128 a[196:199], v7 offset:8448
  v_mov_b32 v19, v16
  s_nop 1
  s_waitcnt lgkmcnt(6)
  v_mfma_f32_16x16x32_bf16 v[180:183], a[204:207], v[36:39], v[180:183]
  v_permlane16_swap_b32 v16, v19
  v_max_f32 v16, v16, v19
  v_mul_f32 v16, s51, v16
  v_mfma_f32_16x16x32_bf16 v[196:199], a[204:207], v[68:71], v[196:199]
  v_xor_b32 v8, 64, v5
  v_max3_f32 v22, v144, v145, v146
  v_max3_f32 v23, v147, v148, v149
  v_mfma_f32_16x16x32_bf16 v[212:215], a[204:207], v[100:103], v[212:215]
  ds_read_b128 a[200:203], v8 offset:256
  v_max3_f32 v24, v150, v151, v152
  v_max3_f32 v22, v22, v153, v154
  v_max3_f32 v23, v23, v155, v156
  s_waitcnt lgkmcnt(6)
  v_mfma_f32_16x16x32_bf16 v[176:179], a[208:211], v[40:43], v[176:179]
  v_max3_f32 v24, v24, v157, v158
  v_max3_f32 v22, v22, v23, v159
  v_mfma_f32_16x16x32_bf16 v[192:195], a[208:211], v[72:75], v[192:195]
  v_max_f32 v17, v22, v24
  v_mov_b32 v22, v17
  s_nop 1
  v_mfma_f32_16x16x32_bf16 v[208:211], a[208:211], v[104:107], v[208:211]
  ds_read_b128 a[204:207], v8 offset:8448
  v_permlane32_swap_b32 v17, v22
  v_max_f32 v17, v17, v22
  s_waitcnt lgkmcnt(6)
  v_mfma_f32_16x16x32_bf16 v[180:183], a[212:215], v[40:43], v[180:183]
  v_mov_b32 v22, v17
  s_nop 1
  v_permlane16_swap_b32 v17, v22
  v_mfma_f32_16x16x32_bf16 v[196:199], a[212:215], v[72:75], v[196:199]
  v_xor_b32 v9, 128, v5
  v_max_f32 v17, v17, v22
  v_mul_f32 v17, s51, v17
  v_mfma_f32_16x16x32_bf16 v[212:215], a[212:215], v[104:107], v[212:215]
  ds_read_b128 a[208:211], v9 offset:256
  v_max3_f32 v25, v160, v161, v162
  v_max3_f32 v26, v163, v164, v165
  v_max3_f32 v27, v166, v167, v168
  s_waitcnt lgkmcnt(6)
  v_mfma_f32_16x16x32_bf16 v[176:179], a[216:219], v[44:47], v[176:179]
  v_max3_f32 v25, v25, v169, v170
  v_max3_f32 v26, v26, v171, v172
  v_mfma_f32_16x16x32_bf16 v[192:195], a[216:219], v[76:79], v[192:195]
  v_max3_f32 v27, v27, v173, v174
  v_max3_f32 v25, v25, v26, v175
  v_max_f32 v18, v25, v27
  v_mfma_f32_16x16x32_bf16 v[208:211], a[216:219], v[108:111], v[208:211]
  ds_read_b128 a[212:215], v9 offset:8448
  v_mov_b32 v25, v18
  s_nop 1
  s_waitcnt lgkmcnt(6)
  v_mfma_f32_16x16x32_bf16 v[180:183], a[220:223], v[44:47], v[180:183]
  v_permlane32_swap_b32 v18, v25
  v_max_f32 v18, v18, v25
  v_mov_b32 v25, v18
  v_mfma_f32_16x16x32_bf16 v[196:199], a[220:223], v[76:79], v[196:199]
  v_xor_b32 v6, 192, v5
  s_nop 1
  v_permlane16_swap_b32 v18, v25
  v_mfma_f32_16x16x32_bf16 v[212:215], a[220:223], v[108:111], v[212:215]
  ds_read_b128 a[216:219], v6 offset:256
  v_max_f32 v18, v18, v25
  v_mul_f32 v18, s51, v18
  v_sub_f32 v19, v16, v10
  s_waitcnt lgkmcnt(6)
  v_mfma_f32_16x16x32_bf16 v[176:179], a[192:195], v[48:51], v[176:179]
  v_sub_f32 v20, v17, v11
  v_sub_f32 v21, v18, v12
  v_mfma_f32_16x16x32_bf16 v[192:195], a[192:195], v[80:83], v[192:195]
  v_max3_f32 v19, v19, v20, v21
  v_cmp_lt_f32 vcc, s52, v19
  s_cbranch_vccnz Lrare_4
Lrare_4_ret:
  v_mfma_f32_16x16x32_bf16 v[208:211], a[192:195], v[112:115], v[208:211]
  ds_read_b128 a[220:223], v6 offset:8448
  v_fma_f32 v128, v128, s51, -v10
  v_fma_f32 v129, v129, s51, -v10
  s_waitcnt lgkmcnt(6)
  v_mfma_f32_16x16x32_bf16 v[180:183], a[196:199], v[48:51], v[180:183]
  s_waitcnt vmcnt(21)
  s_barrier
  s_add_u32 m0, s50, 16384
  s_mov_b32 s53, 245760
  v_fma_f32 v130, v130, s51, -v10
  v_fma_f32 v131, v131, s51, -v10
  v_fma_f32 v132, v132, s51, -v10
  v_mfma_f32_16x16x32_bf16 v[196:199], a[196:199], v[80:83], v[196:199]
  buffer_load_dwordx4 v248, s[16:19], s53 offen nt lds
  s_add_u32 m0, s50, 17408
  s_mov_b32 s53, 245760
  buffer_load_dwordx4 v249, s[16:19], s53 offen nt lds
  s_add_u32 m0, s50, 18432
  v_fma_f32 v133, v133, s51, -v10
  v_fma_f32 v134, v134, s51, -v10
  v_mfma_f32_16x16x32_bf16 v[212:215], a[196:199], v[112:115], v[212:215]
  s_mov_b32 s53, 245760
  buffer_load_dwordx4 v250, s[16:19], s53 offen nt lds
  v_add_u32 v5, 49152, v2
  v_xor_b32 v7, 0, v5
  ds_read_b128 a[192:195], v7 offset:0
  v_fma_f32 v135, v135, s51, -v10
  v_fma_f32 v136, v136, s51, -v10
  v_fma_f32 v137, v137, s51, -v10
  s_waitcnt lgkmcnt(6)
  v_mfma_f32_16x16x32_bf16 v[176:179], a[200:203], v[52:55], v[176:179]
  v_fma_f32 v138, v138, s51, -v10
  v_fma_f32 v139, v139, s51, -v10
  v_mfma_f32_16x16x32_bf16 v[192:195], a[200:203], v[84:87], v[192:195]
  v_fma_f32 v140, v140, s51, -v10
  v_fma_f32 v141, v141, s51, -v10
  v_fma_f32 v142, v142, s51, -v10
  v_mfma_f32_16x16x32_bf16 v[208:211], a[200:203], v[116:119], v[208:211]
  ds_read_b128 a[196:199], v7 offset:8192
  v_fma_f32 v143, v143, s51, -v10
  v_exp_f32 v128, v128
  s_waitcnt lgkmcnt(6)
  v_mfma_f32_16x16x32_bf16 v[180:183], a[204:207], v[52:55], v[180:183]
  v_exp_f32 v129, v129
  v_exp_f32 v130, v130
  v_exp_f32 v131, v131
  v_mfma_f32_16x16x32_bf16 v[196:199], a[204:207], v[84:87], v[196:199]
  v_xor_b32 v8, 64, v5
  v_exp_f32 v132, v132
  v_exp_f32 v133, v133
  v_mfma_f32_16x16x32_bf16 v[212:215], a[204:207], v[116:119], v[212:215]
  ds_read_b128 a[200:203], v8 offset:0
  v_exp_f32 v134, v134
  v_exp_f32 v135, v135
  v_exp_f32 v136, v136
  s_waitcnt lgkmcnt(6)
  v_mfma_f32_16x16x32_bf16 v[176:179], a[208:211], v[56:59], v[176:179]
  v_exp_f32 v137, v137
  v_exp_f32 v138, v138
  v_mfma_f32_16x16x32_bf16 v[192:195], a[208:211], v[88:91], v[192:195]
  v_exp_f32 v139, v139
  v_exp_f32 v140, v140
  v_exp_f32 v141, v141
  v_mfma_f32_16x16x32_bf16 v[208:211], a[208:211], v[120:123], v[208:211]
  ds_read_b128 a[204:207], v8 offset:8192
  v_exp_f32 v142, v142
  v_exp_f32 v143, v143
  s_waitcnt lgkmcnt(6)
  v_mfma_f32_16x16x32_bf16 v[180:183], a[212:215], v[56:59], v[180:183]
  v_fma_f32 v144, v144, s51, -v11
  v_fma_f32 v145, v145, s51, -v11
  v_fma_f32 v146, v146, s51, -v11
  v_mfma_f32_16x16x32_bf16 v[196:199], a[212:215], v[88:91], v[196:199]
  v_xor_b32 v9, 128, v5
  v_fma_f32 v147, v147, s51, -v11
  v_fma_f32 v148, v148, s51, -v11
  v_mfma_f32_16x16x32_bf16 v[212:215], a[212:215], v[120:123], v[212:215]
  ds_read_b128 a[208:211], v9 offset:0
  v_fma_f32 v149, v149, s51, -v11
  v_fma_f32 v150, v150, s51, -v11
  v_fma_f32 v151, v151, s51, -v11
  s_waitcnt lgkmcnt(6)
  v_mfma_f32_16x16x32_bf16 v[176:179], a[216:219], v[60:63], v[176:179]
  v_fma_f32 v152, v152, s51, -v11
  v_fma_f32 v153, v153, s51, -v11
  v_mfma_f32_16x16x32_bf16 v[192:195], a[216:219], v[92:95], v[192:195]
  v_fma_f32 v154, v154, s51, -v11
  v_fma_f32 v155, v155, s51, -v11
  v_fma_f32 v156, v156, s51, -v11
  v_mfma_f32_16x16x32_bf16 v[208:211], a[216:219], v[124:127], v[208:211]
  ds_read_b128 a[212:215], v9 offset:8192
  v_fma_f32 v157, v157, s51, -v11
  v_fma_f32 v158, v158, s51, -v11
  s_waitcnt lgkmcnt(6)
  v_mfma_f32_16x16x32_bf16 v[180:183], a[220:223], v[60:63], v[180:183]
  v_fma_f32 v159, v159, s51, -v11
  v_exp_f32 v144, v144
  v_exp_f32 v145, v145
  v_mfma_f32_16x16x32_bf16 v[196:199], a[220:223], v[92:95], v[196:199]
  v_xor_b32 v6, 192, v5
  v_exp_f32 v146, v146
  v_exp_f32 v147, v147
  v_mfma_f32_16x16x32_bf16 v[212:215], a[220:223], v[124:127], v[212:215]
  ds_read_b128 a[216:219], v6 offset:0
  v_exp_f32 v148, v148
  v_exp_f32 v149, v149
  v_exp_f32 v150, v150
  s_waitcnt lgkmcnt(6)
  v_mfma_f32_16x16x32_bf16 v[184:187], a[192:195], v[32:35], 0
  v_mfma_f32_16x16x32_bf16 v[200:203], a[192:195], v[64:67], 0
  v_mfma_f32_16x16x32_bf16 v[216:219], a[192:195], v[96:99], 0
  ds_read_b128 a[220:223], v6 offset:8192
  s_waitcnt lgkmcnt(6)
  v_mfma_f32_16x16x32_bf16 v[188:191], a[196:199], v[32:35], 0
  v_exp_f32 v151, v151
  v_exp_f32 v152, v152
  v_mfma_f32_16x16x32_bf16 v[204:207], a[196:199], v[64:67], 0
  v_xor_b32 v7, 0, v5
  v_exp_f32 v153, v153
  v_exp_f32 v154, v154
  v_exp_f32 v155, v155
  v_mfma_f32_16x16x32_bf16 v[220:223], a[196:199], v[96:99], 0
  ds_read_b128 a[192:195], v7 offset:256
  v_exp_f32 v156, v156
  v_exp_f32 v157, v157
  s_waitcnt lgkmcnt(6)
  v_mfma_f32_16x16x32_bf16 v[184:187], a[200:203], v[36:39], v[184:187]
  v_exp_f32 v158, v158
  v_exp_f32 v159, v159
  v_fma_f32 v160, v160, s51, -v12
  v_mfma_f32_16x16x32_bf16 v[200:203], a[200:203], v[68:71], v[200:203]
  v_fma_f32 v161, v161, s51, -v12
  v_fma_f32 v162, v162, s51, -v12
  v_mfma_f32_16x16x32_bf16 v[216:219], a[200:203], v[100:103], v[216:219]
  ds_read_b128 a[196:199], v7 offset:8448
  v_fma_f32 v163, v163, s51, -v12
  v_fma_f32 v164, v164, s51, -v12
  v_fma_f32 v165, v165, s51, -v12
  s_waitcnt lgkmcnt(6)
  v_mfma_f32_16x16x32_bf16 v[188:191], a[204:207], v[36:39], v[188:191]
  v_fma_f32 v166, v166, s51, -v12
  v_fma_f32 v167, v167, s51, -v12
  v_mfma_f32_16x16x32_bf16 v[204:207], a[204:207], v[68:71], v[204:207]
  v_xor_b32 v8, 64, v5
  v_fma_f32 v168, v168, s51, -v12
  v_fma_f32 v169, v169, s51, -v12
  v_fma_f32 v170, v170, s51, -v12
  v_mfma_f32_16x16x32_bf16 v[220:223], a[204:207], v[100:103], v[220:223]
  ds_read_b128 a[200:203], v8 offset:256
  v_fma_f32 v171, v171, s51, -v12
  v_fma_f32 v172, v172, s51, -v12
  s_waitcnt lgkmcnt(6)
  v_mfma_f32_16x16x32_bf16 v[184:187], a[208:211], v[40:43], v[184:187]
  v_fma_f32 v173, v173, s51, -v12
  v_fma_f32 v174, v174, s51, -v12
  v_fma_f32 v175, v175, s51, -v12
  v_mfma_f32_16x16x32_bf16 v[200:203], a[208:211], v[72:75], v[200:203]
  v_exp_f32 v160, v160
  v_exp_f32 v161, v161
  v_mfma_f32_16x16x32_bf16 v[216:219], a[208:211], v[104:107], v[216:219]
  ds_read_b128 a[204:207], v8 offset:8448
  v_exp_f32 v162, v162
  v_exp_f32 v163, v163
  v_exp_f32 v164, v164
  s_waitcnt lgkmcnt(6)
  v_mfma_f32_16x16x32_bf16 v[188:191], a[212:215], v[40:43], v[188:191]
  v_exp_f32 v165, v165
  v_exp_f32 v166, v166
  v_mfma_f32_16x16x32_bf16 v[204:207], a[212:215], v[72:75], v[204:207]
  v_xor_b32 v9, 128, v5
  v_exp_f32 v167, v167
  v_exp_f32 v168, v168
  v_exp_f32 v169, v169
  v_mfma_f32_16x16x32_bf16 v[220:223], a[212:215], v[104:107], v[220:223]
  ds_read_b128 a[208:211], v9 offset:256
  v_exp_f32 v170, v170
  v_exp_f32 v171, v171
  s_waitcnt lgkmcnt(6)
  v_mfma_f32_16x16x32_bf16 v[184:187], a[216:219], v[44:47], v[184:187]
  v_exp_f32 v172, v172
  v_exp_f32 v173, v173
  v_exp_f32 v174, v174
  v_mfma_f32_16x16x32_bf16 v[200:203], a[216:219], v[76:79], v[200:203]
  v_exp_f32 v175, v175
  v_add_f32 v19, v128, v129
  v_mfma_f32_16x16x32_bf16 v[216:219], a[216:219], v[108:111], v[216:219]
  ds_read_b128 a[212:215], v9 offset:8448
  v_add_f32 v20, v130, v131
  v_add_f32 v19, v19, v132
  v_add_f32 v20, v20, v133
  s_waitcnt lgkmcnt(6)
  v_mfma_f32_16x16x32_bf16 v[188:191], a[220:223], v[44:47], v[188:191]
  v_add_f32 v19, v19, v134
  v_add_f32 v20, v20, v135
  v_mfma_f32_16x16x32_bf16 v[204:207], a[220:223], v[76:79], v[204:207]
  v_xor_b32 v6, 192, v5
  v_add_f32 v19, v19, v136
  v_add_f32 v20, v20, v137
  v_add_f32 v19, v19, v138
  v_mfma_f32_16x16x32_bf16 v[220:223], a[220:223], v[108:111], v[220:223]
  ds_read_b128 a[216:219], v6 offset:256
  v_add_f32 v20, v20, v139
  v_add_f32 v19, v19, v140
  s_waitcnt lgkmcnt(6)
  v_mfma_f32_16x16x32_bf16 v[184:187], a[192:195], v[48:51], v[184:187]
  v_add_f32 v20, v20, v141
  v_add_f32 v19, v19, v142
  v_add_f32 v20, v20, v143
  v_mfma_f32_16x16x32_bf16 v[200:203], a[192:195], v[80:83], v[200:203]
  v_add_f32 v19, v19, v20
  v_add_f32 v13, v13, v19
  v_mfma_f32_16x16x32_bf16 v[216:219], a[192:195], v[112:115], v[216:219]
  ds_read_b128 a[220:223], v6 offset:8448
  v_add_f32 v22, v144, v145
  v_add_f32 v23, v146, v147
  v_add_f32 v22, v22, v148
  s_waitcnt lgkmcnt(6)
  v_mfma_f32_16x16x32_bf16 v[188:191], a[196:199], v[48:51], v[188:191]
  s_waitcnt vmcnt(21)
  s_barrier
  s_add_u32 m0, s50, 32768
  s_mov_b32 s53, 196608
  buffer_load_dwordx4 v248, s[20:23], s53 offen nt lds
  v_add_f32 v23, v23, v149
  v_add_f32 v22, v22, v150
  v_mfma_f32_16x16x32_bf16 v[204:207], a[196:199], v[80:83], v[204:207]
  s_add_u32 m0, s50, 33792
  s_mov_b32 s53, 196608
  buffer_load_dwordx4 v249, s[20:23], s53 offen nt lds
  s_add_u32 m0, s50, 34816
  s_mov_b32 s53, 196608
  v_add_f32 v23, v23, v151
  v_add_f32 v22, v22, v152
  v_add_f32 v23, v23, v153
  v_mfma_f32_16x16x32_bf16 v[220:223], a[196:199], v[112:115], v[220:223]
  buffer_load_dwordx4 v250, s[20:23], s53 offen nt lds
  v_add_u32 v5, 65536, v3
  v_xor_b32 v7, 0, v5
  ds_read_b64_tr_b16 a[192:193], v7 offset:0
  ds_read_b64_tr_b16 a[194:195], v7 offset:8192
  v_add_f32 v22, v22, v154
  v_add_f32 v23, v23, v155
  s_waitcnt lgkmcnt(7)
  v_mfma_f32_16x16x32_bf16 v[184:187], a[200:203], v[52:55], v[184:187]
  v_xor_b32 v8, 32, v5
  v_add_f32 v22, v22, v156
  v_add_f32 v23, v23, v157
  v_add_f32 v22, v22, v158
  v_mfma_f32_16x16x32_bf16 v[200:203], a[200:203], v[84:87], v[200:203]
  ds_read_b64_tr_b16 a[196:197], v8 offset:0
  v_add_f32 v23, v23, v159
  v_add_f32 v22, v22, v23
  v_mfma_f32_16x16x32_bf16 v[216:219], a[200:203], v[116:119], v[216:219]
  ds_read_b64_tr_b16 a[198:199], v8 offset:8192
  v_add_f32 v14, v14, v22
  v_add_f32 v25, v160, v161
  v_add_f32 v26, v162, v163
  s_waitcnt lgkmcnt(8)
  v_mfma_f32_16x16x32_bf16 v[188:191], a[204:207], v[52:55], v[188:191]
  v_xor_b32 v9, 64, v5
  v_add_f32 v25, v25, v164
  v_add_f32 v26, v26, v165
  v_mfma_f32_16x16x32_bf16 v[204:207], a[204:207], v[84:87], v[204:207]
  ds_read_b64_tr_b16 a[200:201], v9 offset:0
  v_add_f32 v25, v25, v166
  v_add_f32 v26, v26, v167
  v_add_f32 v25, v25, v168
  v_mfma_f32_16x16x32_bf16 v[220:223], a[204:207], v[116:119], v[220:223]
  ds_read_b64_tr_b16 a[202:203], v9 offset:8192
  v_add_f32 v26, v26, v169
  v_add_f32 v25, v25, v170
  s_waitcnt lgkmcnt(9)
  v_mfma_f32_16x16x32_bf16 v[184:187], a[208:211], v[56:59], v[184:187]
  v_xor_b32 v6, 96, v5
  v_add_f32 v26, v26, v171
  v_add_f32 v25, v25, v172
  v_add_f32 v26, v26, v173
  v_mfma_f32_16x16x32_bf16 v[200:203], a[208:211], v[88:91], v[200:203]
  ds_read_b64_tr_b16 a[204:205], v6 offset:0
  v_add_f32 v25, v25, v174
  v_add_f32 v26, v26, v175
  v_mfma_f32_16x16x32_bf16 v[216:219], a[208:211], v[120:123], v[216:219]
  ds_read_b64_tr_b16 a[206:207], v6 offset:8192
  v_add_f32 v25, v25, v26
  v_add_f32 v15, v15, v25
  v_cvt_pk_bf16_f32 v224, v128, v129
  s_waitcnt lgkmcnt(10)
  v_mfma_f32_16x16x32_bf16 v[188:191], a[212:215], v[56:59], v[188:191]
  v_xor_b32 v7, 128, v5
  v_cvt_pk_bf16_f32 v225, v130, v131
  v_cvt_pk_bf16_f32 v226, v132, v133
  v_mfma_f32_16x16x32_bf16 v[204:207], a[212:215], v[88:91], v[204:207]
  ds_read_b64_tr_b16 a[208:209], v7 offset:0
  v_cvt_pk_bf16_f32 v227, v134, v135
  v_cvt_pk_bf16_f32 v228, v136, v137
  v_cvt_pk_bf16_f32 v229, v138, v139
  v_mfma_f32_16x16x32_bf16 v[220:223], a[212:215], v[120:123], v[220:223]
  ds_read_b64_tr_b16 a[210:211], v7 offset:8192
  v_cvt_pk_bf16_f32 v230, v140, v141
  v_cvt_pk_bf16_f32 v231, v142, v143
  s_waitcnt lgkmcnt(11)
  v_mfma_f32_16x16x32_bf16 v[184:187], a[216:219], v[60:63], v[184:187]
  v_xor_b32 v8, 160, v5
  v_cvt_pk_bf16_f32 v232, v144, v145
  v_cvt_pk_bf16_f32 v233, v146, v147
  v_cvt_pk_bf16_f32 v234, v148, v149
  v_mfma_f32_16x16x32_bf16 v[200:203], a[216:219], v[92:95], v[200:203]
  ds_read_b64_tr_b16 a[212:213], v8 offset:0
  v_cvt_pk_bf16_f32 v235, v150, v151
  v_cvt_pk_bf16_f32 v236, v152, v153
  v_mfma_f32_16x16x32_bf16 v[216:219], a[216:219], v[124:127], v[216:219]
  ds_read_b64_tr_b16 a[214:215], v8 offset:8192
  v_cvt_pk_bf16_f32 v237, v154, v155
  v_cvt_pk_bf16_f32 v238, v156, v157
  v_cvt_pk_bf16_f32 v239, v158, v159
  s_waitcnt lgkmcnt(12)
  v_mfma_f32_16x16x32_bf16 v[188:191], a[220:223], v[60:63], v[188:191]
  v_xor_b32 v9, 192, v5
  v_cvt_pk_bf16_f32 v240, v160, v161
  v_cvt_pk_bf16_f32 v241, v162, v163
  v_mfma_f32_16x16x32_bf16 v[204:207], a[220:223], v[92:95], v[204:207]
  ds_read_b64_tr_b16 a[216:217], v9 offset:0
  v_cvt_pk_bf16_f32 v242, v164, v165
  v_cvt_pk_bf16_f32 v243, v166, v167
  v_cvt_pk_bf16_f32 v244, v168, v169
  v_mfma_f32_16x16x32_bf16 v[220:223], a[220:223], v[124:127], v[220:223]
  ds_read_b64_tr_b16 a[218:219], v9 offset:8192
  v_cvt_pk_bf16_f32 v245, v170, v171
  v_cvt_pk_bf16_f32 v246, v172, v173
  v_cvt_pk_bf16_f32 v247, v174, v175
  s_waitcnt lgkmcnt(12)
  v_mfma_f32_16x16x32_bf16 a[0:3], a[192:195], v[224:227], a[0:3]
  v_xor_b32 v6, 224, v5
  v_mfma_f32_16x16x32_bf16 a[64:67], a[192:195], v[232:235], a[64:67]
  ds_read_b64_tr_b16 a[220:221], v6 offset:0
  v_mfma_f32_16x16x32_bf16 a[128:131], a[192:195], v[240:243], a[128:131]
  ds_read_b64_tr_b16 a[222:223], v6 offset:8192
  s_waitcnt lgkmcnt(12)
  v_mfma_f32_16x16x32_bf16 a[4:7], a[196:199], v[224:227], a[4:7]
  v_xor_b32 v7, 0, v5
  v_mfma_f32_16x16x32_bf16 a[68:71], a[196:199], v[232:235], a[68:71]
  ds_read_b64_tr_b16 a[192:193], v7 offset:256
  v_mfma_f32_16x16x32_bf16 a[132:135], a[196:199], v[240:243], a[132:135]
  ds_read_b64_tr_b16 a[194:195], v7 offset:8448
  s_waitcnt lgkmcnt(12)
  v_mfma_f32_16x16x32_bf16 a[8:11], a[200:203], v[224:227], a[8:11]
  v_xor_b32 v8, 32, v5
  v_mfma_f32_16x16x32_bf16 a[72:75], a[200:203], v[232:235], a[72:75]
  ds_read_b64_tr_b16 a[196:197], v8 offset:256
  v_mfma_f32_16x16x32_bf16 a[136:139], a[200:203], v[240:243], a[136:139]
  ds_read_b64_tr_b16 a[198:199], v8 offset:8448
  s_waitcnt lgkmcnt(12)
  v_mfma_f32_16x16x32_bf16 a[12:15], a[204:207], v[224:227], a[12:15]
  v_xor_b32 v9, 64, v5
  v_mfma_f32_16x16x32_bf16 a[76:79], a[204:207], v[232:235], a[76:79]
  ds_read_b64_tr_b16 a[200:201], v9 offset:256
  v_mfma_f32_16x16x32_bf16 a[140:143], a[204:207], v[240:243], a[140:143]
  ds_read_b64_tr_b16 a[202:203], v9 offset:8448
  s_waitcnt lgkmcnt(12)
  v_mfma_f32_16x16x32_bf16 a[16:19], a[208:211], v[224:227], a[16:19]
  v_xor_b32 v6, 96, v5
  v_mfma_f32_16x16x32_bf16 a[80:83], a[208:211], v[232:235], a[80:83]
  ds_read_b64_tr_b16 a[204:205], v6 offset:256
  v_mfma_f32_16x16x32_bf16 a[144:147], a[208:211], v[240:243], a[144:147]
  ds_read_b64_tr_b16 a[206:207], v6 offset:8448
  s_waitcnt lgkmcnt(12)
  v_mfma_f32_16x16x32_bf16 a[20:23], a[212:215], v[224:227], a[20:23]
  v_xor_b32 v7, 128, v5
  v_mfma_f32_16x16x32_bf16 a[84:87], a[212:215], v[232:235], a[84:87]
  ds_read_b64_tr_b16 a[208:209], v7 offset:256
  v_mfma_f32_16x16x32_bf16 a[148:151], a[212:215], v[240:243], a[148:151]
  ds_read_b64_tr_b16 a[210:211], v7 offset:8448
  s_waitcnt lgkmcnt(12)
  v_mfma_f32_16x16x32_bf16 a[24:27], a[216:219], v[224:227], a[24:27]
  v_xor_b32 v8, 160, v5
  v_mfma_f32_16x16x32_bf16 a[88:91], a[216:219], v[232:235], a[88:91]
  ds_read_b64_tr_b16 a[212:213], v8 offset:256
  v_mfma_f32_16x16x32_bf16 a[152:155], a[216:219], v[240:243], a[152:155]
  ds_read_b64_tr_b16 a[214:215], v8 offset:8448
  s_waitcnt lgkmcnt(12)
  v_mfma_f32_16x16x32_bf16 a[28:31], a[220:223], v[224:227], a[28:31]
  v_xor_b32 v9, 192, v5
  v_mfma_f32_16x16x32_bf16 a[92:95], a[220:223], v[232:235], a[92:95]
  ds_read_b64_tr_b16 a[216:217], v9 offset:256
  v_mfma_f32_16x16x32_bf16 a[156:159], a[220:223], v[240:243], a[156:159]
  ds_read_b64_tr_b16 a[218:219], v9 offset:8448
  s_waitcnt lgkmcnt(12)
  v_mfma_f32_16x16x32_bf16 a[32:35], a[192:195], v[224:227], a[32:35]
  v_xor_b32 v6, 224, v5
  v_mfma_f32_16x16x32_bf16 a[96:99], a[192:195], v[232:235], a[96:99]
  ds_read_b64_tr_b16 a[220:221], v6 offset:256
  v_mfma_f32_16x16x32_bf16 a[160:163], a[192:195], v[240:243], a[160:163]
  ds_read_b64_tr_b16 a[222:223], v6 offset:8448
  s_waitcnt lgkmcnt(12)
  v_mfma_f32_16x16x32_bf16 a[36:39], a[196:199], v[224:227], a[36:39]
  s_waitcnt vmcnt(21)
  s_barrier
  s_add_u32 m0, s50, 49152
  s_mov_b32 s53, 212992
  buffer_load_dwordx4 v248, s[20:23], s53 offen nt lds
  v_mfma_f32_16x16x32_bf16 a[100:103], a[196:199], v[232:235], a[100:103]
  s_add_u32 m0, s50, 50176
  s_mov_b32 s53, 212992
  buffer_load_dwordx4 v249, s[20:23], s53 offen nt lds
  s_add_u32 m0, s50, 51200
  s_mov_b32 s53, 212992
  v_mfma_f32_16x16x32_bf16 a[164:167], a[196:199], v[240:243], a[164:167]
  buffer_load_dwordx4 v250, s[20:23], s53 offen nt lds
  v_add_u32 v5, 81920, v3
  v_xor_b32 v7, 0, v5
  ds_read_b64_tr_b16 a[192:193], v7 offset:0
  ds_read_b64_tr_b16 a[194:195], v7 offset:8192
  s_waitcnt lgkmcnt(12)
  v_mfma_f32_16x16x32_bf16 a[40:43], a[200:203], v[224:227], a[40:43]
  v_xor_b32 v8, 32, v5
  v_mfma_f32_16x16x32_bf16 a[104:107], a[200:203], v[232:235], a[104:107]
  ds_read_b64_tr_b16 a[196:197], v8 offset:0
  v_mfma_f32_16x16x32_bf16 a[168:171], a[200:203], v[240:243], a[168:171]
  ds_read_b64_tr_b16 a[198:199], v8 offset:8192
  s_waitcnt lgkmcnt(12)
  v_mfma_f32_16x16x32_bf16 a[44:47], a[204:207], v[224:227], a[44:47]
  v_xor_b32 v9, 64, v5
  v_mfma_f32_16x16x32_bf16 a[108:111], a[204:207], v[232:235], a[108:111]
  ds_read_b64_tr_b16 a[200:201], v9 offset:0
  v_mfma_f32_16x16x32_bf16 a[172:175], a[204:207], v[240:243], a[172:175]
  ds_read_b64_tr_b16 a[202:203], v9 offset:8192
  s_waitcnt lgkmcnt(12)
  v_mfma_f32_16x16x32_bf16 a[48:51], a[208:211], v[224:227], a[48:51]
  v_xor_b32 v6, 96, v5
  v_mfma_f32_16x16x32_bf16 a[112:115], a[208:211], v[232:235], a[112:115]
  ds_read_b64_tr_b16 a[204:205], v6 offset:0
  v_mfma_f32_16x16x32_bf16 a[176:179], a[208:211], v[240:243], a[176:179]
  ds_read_b64_tr_b16 a[206:207], v6 offset:8192
  s_waitcnt lgkmcnt(12)
  v_mfma_f32_16x16x32_bf16 a[52:55], a[212:215], v[224:227], a[52:55]
  v_xor_b32 v7, 128, v5
  v_mfma_f32_16x16x32_bf16 a[116:119], a[212:215], v[232:235], a[116:119]
  ds_read_b64_tr_b16 a[208:209], v7 offset:0
  v_mfma_f32_16x16x32_bf16 a[180:183], a[212:215], v[240:243], a[180:183]
  ds_read_b64_tr_b16 a[210:211], v7 offset:8192
  s_waitcnt lgkmcnt(12)
  v_mfma_f32_16x16x32_bf16 a[56:59], a[216:219], v[224:227], a[56:59]
  v_xor_b32 v8, 160, v5
  v_mfma_f32_16x16x32_bf16 a[120:123], a[216:219], v[232:235], a[120:123]
  ds_read_b64_tr_b16 a[212:213], v8 offset:0
  v_mfma_f32_16x16x32_bf16 a[184:187], a[216:219], v[240:243], a[184:187]
  ds_read_b64_tr_b16 a[214:215], v8 offset:8192
  s_waitcnt lgkmcnt(12)
  v_mfma_f32_16x16x32_bf16 a[60:63], a[220:223], v[224:227], a[60:63]
  v_xor_b32 v9, 192, v5
  v_mfma_f32_16x16x32_bf16 a[124:127], a[220:223], v[232:235], a[124:127]
  ds_read_b64_tr_b16 a[216:217], v9 offset:0
  v_mfma_f32_16x16x32_bf16 a[188:191], a[220:223], v[240:243], a[188:191]
  ds_read_b64_tr_b16 a[218:219], v9 offset:8192
  s_waitcnt lgkmcnt(12)
  v_mfma_f32_16x16x32_bf16 a[0:3], a[192:195], v[228:231], a[0:3]
  v_xor_b32 v6, 224, v5
  v_mfma_f32_16x16x32_bf16 a[64:67], a[192:195], v[236:239], a[64:67]
  ds_read_b64_tr_b16 a[220:221], v6 offset:0
  v_mfma_f32_16x16x32_bf16 a[128:131], a[192:195], v[244:247], a[128:131]
  ds_read_b64_tr_b16 a[222:223], v6 offset:8192
  s_waitcnt lgkmcnt(12)
  v_mfma_f32_16x16x32_bf16 a[4:7], a[196:199], v[228:231], a[4:7]
  v_xor_b32 v7, 0, v5
  v_mfma_f32_16x16x32_bf16 a[68:71], a[196:199], v[236:239], a[68:71]
  ds_read_b64_tr_b16 a[192:193], v7 offset:256
  v_mfma_f32_16x16x32_bf16 a[132:135], a[196:199], v[244:247], a[132:135]
  ds_read_b64_tr_b16 a[194:195], v7 offset:8448
  s_waitcnt lgkmcnt(12)
  v_mfma_f32_16x16x32_bf16 a[8:11], a[200:203], v[228:231], a[8:11]
  v_xor_b32 v8, 32, v5
  v_mfma_f32_16x16x32_bf16 a[72:75], a[200:203], v[236:239], a[72:75]
  ds_read_b64_tr_b16 a[196:197], v8 offset:256
  v_mfma_f32_16x16x32_bf16 a[136:139], a[200:203], v[244:247], a[136:139]
  ds_read_b64_tr_b16 a[198:199], v8 offset:8448
  s_waitcnt lgkmcnt(12)
  v_mfma_f32_16x16x32_bf16 a[12:15], a[204:207], v[228:231], a[12:15]
  v_xor_b32 v9, 64, v5
  v_mfma_f32_16x16x32_bf16 a[76:79], a[204:207], v[236:239], a[76:79]
  ds_read_b64_tr_b16 a[200:201], v9 offset:256
  v_mfma_f32_16x16x32_bf16 a[140:143], a[204:207], v[244:247], a[140:143]
  ds_read_b64_tr_b16 a[202:203], v9 offset:8448
  s_waitcnt lgkmcnt(12)
  v_mfma_f32_16x16x32_bf16 a[16:19], a[208:211], v[228:231], a[16:19]
  v_xor_b32 v6, 96, v5
  v_mfma_f32_16x16x32_bf16 a[80:83], a[208:211], v[236:239], a[80:83]
  ds_read_b64_tr_b16 a[204:205], v6 offset:256
  v_mfma_f32_16x16x32_bf16 a[144:147], a[208:211], v[244:247], a[144:147]
  ds_read_b64_tr_b16 a[206:207], v6 offset:8448
  s_waitcnt lgkmcnt(12)
  v_mfma_f32_16x16x32_bf16 a[20:23], a[212:215], v[228:231], a[20:23]
  v_xor_b32 v7, 128, v5
  v_mfma_f32_16x16x32_bf16 a[84:87], a[212:215], v[236:239], a[84:87]
  ds_read_b64_tr_b16 a[208:209], v7 offset:256
  v_mfma_f32_16x16x32_bf16 a[148:151], a[212:215], v[244:247], a[148:151]
  ds_read_b64_tr_b16 a[210:211], v7 offset:8448
  s_waitcnt lgkmcnt(12)
  v_mfma_f32_16x16x32_bf16 a[24:27], a[216:219], v[228:231], a[24:27]
  v_xor_b32 v8, 160, v5
  v_mfma_f32_16x16x32_bf16 a[88:91], a[216:219], v[236:239], a[88:91]
  ds_read_b64_tr_b16 a[212:213], v8 offset:256
  v_mfma_f32_16x16x32_bf16 a[152:155], a[216:219], v[244:247], a[152:155]
  ds_read_b64_tr_b16 a[214:215], v8 offset:8448
  s_waitcnt lgkmcnt(12)
  v_mfma_f32_16x16x32_bf16 a[28:31], a[220:223], v[228:231], a[28:31]
  v_xor_b32 v9, 192, v5
  v_mfma_f32_16x16x32_bf16 a[92:95], a[220:223], v[236:239], a[92:95]
  ds_read_b64_tr_b16 a[216:217], v9 offset:256
  v_mfma_f32_16x16x32_bf16 a[156:159], a[220:223], v[244:247], a[156:159]
  ds_read_b64_tr_b16 a[218:219], v9 offset:8448
  s_waitcnt lgkmcnt(12)
  v_mfma_f32_16x16x32_bf16 a[32:35], a[192:195], v[228:231], a[32:35]
  v_xor_b32 v6, 224, v5
  v_mfma_f32_16x16x32_bf16 a[96:99], a[192:195], v[236:239], a[96:99]
  ds_read_b64_tr_b16 a[220:221], v6 offset:256
  v_mfma_f32_16x16x32_bf16 a[160:163], a[192:195], v[244:247], a[160:163]
  ds_read_b64_tr_b16 a[222:223], v6 offset:8448
  s_waitcnt lgkmcnt(12)
  v_mfma_f32_16x16x32_bf16 a[36:39], a[196:199], v[228:231], a[36:39]
  s_waitcnt vmcnt(21)
  s_barrier
  s_add_u32 m0, s50, 65536
  s_mov_b32 s53, 229376
  v_mfma_f32_16x16x32_bf16 a[100:103], a[196:199], v[236:239], a[100:103]
  buffer_load_dwordx4 v248, s[20:23], s53 offen nt lds
  s_add_u32 m0, s50, 66560
  s_mov_b32 s53, 229376
  buffer_load_dwordx4 v249, s[20:23], s53 offen nt lds
  s_add_u32 m0, s50, 67584
  v_mfma_f32_16x16x32_bf16 a[164:167], a[196:199], v[244:247], a[164:167]
  s_mov_b32 s53, 229376
  buffer_load_dwordx4 v250, s[20:23], s53 offen nt lds
  v_add_u32 v5, 98304, v2
  v_xor_b32 v7, 0, v5
  ds_read_b128 a[192:195], v7 offset:0
  s_waitcnt lgkmcnt(11)
  v_mfma_f32_16x16x32_bf16 a[40:43], a[200:203], v[228:231], a[40:43]
  v_mfma_f32_16x16x32_bf16 a[104:107], a[200:203], v[236:239], a[104:107]
  v_mfma_f32_16x16x32_bf16 a[168:171], a[200:203], v[244:247], a[168:171]
  ds_read_b128 a[196:199], v7 offset:8192
  s_waitcnt lgkmcnt(10)
  v_mfma_f32_16x16x32_bf16 a[44:47], a[204:207], v[228:231], a[44:47]
  v_mfma_f32_16x16x32_bf16 a[108:111], a[204:207], v[236:239], a[108:111]
  v_xor_b32 v8, 64, v5
  v_mfma_f32_16x16x32_bf16 a[172:175], a[204:207], v[244:247], a[172:175]
  ds_read_b128 a[200:203], v8 offset:0
  s_waitcnt lgkmcnt(9)
  v_mfma_f32_16x16x32_bf16 a[48:51], a[208:211], v[228:231], a[48:51]
  v_mfma_f32_16x16x32_bf16 a[112:115], a[208:211], v[236:239], a[112:115]
  v_mfma_f32_16x16x32_bf16 a[176:179], a[208:211], v[244:247], a[176:179]
  ds_read_b128 a[204:207], v8 offset:8192
  s_waitcnt lgkmcnt(8)
  v_mfma_f32_16x16x32_bf16 a[52:55], a[212:215], v[228:231], a[52:55]
  v_mfma_f32_16x16x32_bf16 a[116:119], a[212:215], v[236:239], a[116:119]
  v_xor_b32 v9, 128, v5
  v_mfma_f32_16x16x32_bf16 a[180:183], a[212:215], v[244:247], a[180:183]
  ds_read_b128 a[208:211], v9 offset:0
  s_waitcnt lgkmcnt(7)
  v_mfma_f32_16x16x32_bf16 a[56:59], a[216:219], v[228:231], a[56:59]
  v_mfma_f32_16x16x32_bf16 a[120:123], a[216:219], v[236:239], a[120:123]
  v_mfma_f32_16x16x32_bf16 a[184:187], a[216:219], v[244:247], a[184:187]
  ds_read_b128 a[212:215], v9 offset:8192
  s_waitcnt lgkmcnt(6)
  v_mfma_f32_16x16x32_bf16 a[60:63], a[220:223], v[228:231], a[60:63]
  v_mfma_f32_16x16x32_bf16 a[124:127], a[220:223], v[236:239], a[124:127]
  v_xor_b32 v6, 192, v5
  v_mfma_f32_16x16x32_bf16 a[188:191], a[220:223], v[244:247], a[188:191]
  ds_read_b128 a[216:219], v6 offset:0
  s_waitcnt lgkmcnt(6)
  v_mfma_f32_16x16x32_bf16 v[128:131], a[192:195], v[32:35], 0
  v_mfma_f32_16x16x32_bf16 v[144:147], a[192:195], v[64:67], 0
  v_mfma_f32_16x16x32_bf16 v[160:163], a[192:195], v[96:99], 0
  ds_read_b128 a[220:223], v6 offset:8192
  s_waitcnt lgkmcnt(6)
  v_mfma_f32_16x16x32_bf16 v[132:135], a[196:199], v[32:35], 0
  v_max3_f32 v19, v176, v177, v178
  v_max3_f32 v20, v179, v180, v181
  v_mfma_f32_16x16x32_bf16 v[148:151], a[196:199], v[64:67], 0
  v_xor_b32 v7, 0, v5
  v_max3_f32 v21, v182, v183, v184
  v_max3_f32 v19, v19, v185, v186
  v_mfma_f32_16x16x32_bf16 v[164:167], a[196:199], v[96:99], 0
  ds_read_b128 a[192:195], v7 offset:256
  v_max3_f32 v20, v20, v187, v188
  v_max3_f32 v21, v21, v189, v190
  v_max3_f32 v19, v19, v20, v191
  s_waitcnt lgkmcnt(6)
  v_mfma_f32_16x16x32_bf16 v[128:131], a[200:203], v[36:39], v[128:131]
  v_max_f32 v16, v19, v21
  v_mov_b32 v19, v16
  v_mfma_f32_16x16x32_bf16 v[144:147], a[200:203], v[68:71], v[144:147]
  s_nop 1
  v_permlane32_swap_b32 v16, v19
  v_max_f32 v16, v16, v19
  v_mfma_f32_16x16x32_bf16 v[160:163], a[200:203], v[100:103], v[160:163]
  ds_read_b128 a[196:199], v7 offset:8448
  v_mov_b32 v19, v16
  s_nop 1
  s_waitcnt lgkmcnt(6)
  v_mfma_f32_16x16x32_bf16 v[132:135], a[204:207], v[36:39], v[132:135]
  v_permlane16_swap_b32 v16, v19
  v_max_f32 v16, v16, v19
  v_mul_f32 v16, s51, v16
  v_mfma_f32_16x16x32_bf16 v[148:151], a[204:207], v[68:71], v[148:151]
  v_xor_b32 v8, 64, v5
  v_max3_f32 v22, v192, v193, v194
  v_max3_f32 v23, v195, v196, v197
  v_mfma_f32_16x16x32_bf16 v[164:167], a[204:207], v[100:103], v[164:167]
  ds_read_b128 a[200:203], v8 offset:256
  v_max3_f32 v24, v198, v199, v200
  v_max3_f32 v22, v22, v201, v202
  v_max3_f32 v23, v23, v203, v204
  s_waitcnt lgkmcnt(6)
  v_mfma_f32_16x16x32_bf16 v[128:131], a[208:211], v[40:43], v[128:131]
  v_max3_f32 v24, v24, v205, v206
  v_max3_f32 v22, v22, v23, v207
  v_mfma_f32_16x16x32_bf16 v[144:147], a[208:211], v[72:75], v[144:147]
  v_max_f32 v17, v22, v24
  v_mov_b32 v22, v17
  s_nop 1
  v_mfma_f32_16x16x32_bf16 v[160:163], a[208:211], v[104:107], v[160:163]
  ds_read_b128 a[204:207], v8 offset:8448
  v_permlane32_swap_b32 v17, v22
  v_max_f32 v17, v17, v22
  s_waitcnt lgkmcnt(6)
  v_mfma_f32_16x16x32_bf16 v[132:135], a[212:215], v[40:43], v[132:135]
  v_mov_b32 v22, v17
  s_nop 1
  v_permlane16_swap_b32 v17, v22
  v_mfma_f32_16x16x32_bf16 v[148:151], a[212:215], v[72:75], v[148:151]
  v_xor_b32 v9, 128, v5
  v_max_f32 v17, v17, v22
  v_mul_f32 v17, s51, v17
  v_mfma_f32_16x16x32_bf16 v[164:167], a[212:215], v[104:107], v[164:167]
  ds_read_b128 a[208:211], v9 offset:256
  v_max3_f32 v25, v208, v209, v210
  v_max3_f32 v26, v211, v212, v213
  v_max3_f32 v27, v214, v215, v216
  s_waitcnt lgkmcnt(6)
  v_mfma_f32_16x16x32_bf16 v[128:131], a[216:219], v[44:47], v[128:131]
  v_max3_f32 v25, v25, v217, v218
  v_max3_f32 v26, v26, v219, v220
  v_mfma_f32_16x16x32_bf16 v[144:147], a[216:219], v[76:79], v[144:147]
  v_max3_f32 v27, v27, v221, v222
  v_max3_f32 v25, v25, v26, v223
  v_max_f32 v18, v25, v27
  v_mfma_f32_16x16x32_bf16 v[160:163], a[216:219], v[108:111], v[160:163]
  ds_read_b128 a[212:215], v9 offset:8448
  v_mov_b32 v25, v18
  s_nop 1
  s_waitcnt lgkmcnt(6)
  v_mfma_f32_16x16x32_bf16 v[132:135], a[220:223], v[44:47], v[132:135]
  v_permlane32_swap_b32 v18, v25
  v_max_f32 v18, v18, v25
  v_mov_b32 v25, v18
  v_mfma_f32_16x16x32_bf16 v[148:151], a[220:223], v[76:79], v[148:151]
  v_xor_b32 v6, 192, v5
  s_nop 1
  v_permlane16_swap_b32 v18, v25
  v_mfma_f32_16x16x32_bf16 v[164:167], a[220:223], v[108:111], v[164:167]
  ds_read_b128 a[216:219], v6 offset:256
  v_max_f32 v18, v18, v25
  v_mul_f32 v18, s51, v18
  v_sub_f32 v19, v16, v10
  s_waitcnt lgkmcnt(6)
  v_mfma_f32_16x16x32_bf16 v[128:131], a[192:195], v[48:51], v[128:131]
  v_sub_f32 v20, v17, v11
  v_sub_f32 v21, v18, v12
  v_mfma_f32_16x16x32_bf16 v[144:147], a[192:195], v[80:83], v[144:147]
  v_max3_f32 v19, v19, v20, v21
  v_cmp_lt_f32 vcc, s52, v19
  s_cbranch_vccnz Lrare_5
Lrare_5_ret:
  v_mfma_f32_16x16x32_bf16 v[160:163], a[192:195], v[112:115], v[160:163]
  ds_read_b128 a[220:223], v6 offset:8448
  v_fma_f32 v176, v176, s51, -v10
  v_fma_f32 v177, v177, s51, -v10
  s_waitcnt lgkmcnt(6)
  v_mfma_f32_16x16x32_bf16 v[132:135], a[196:199], v[48:51], v[132:135]
  s_waitcnt vmcnt(21)
  s_barrier
  s_add_u32 m0, s50, 81920
  s_mov_b32 s53, 245760
  v_fma_f32 v178, v178, s51, -v10
  v_fma_f32 v179, v179, s51, -v10
  v_fma_f32 v180, v180, s51, -v10
  v_mfma_f32_16x16x32_bf16 v[148:151], a[196:199], v[80:83], v[148:151]
  buffer_load_dwordx4 v248, s[20:23], s53 offen nt lds
  s_add_u32 m0, s50, 82944
  s_mov_b32 s53, 245760
  buffer_load_dwordx4 v249, s[20:23], s53 offen nt lds
  s_add_u32 m0, s50, 83968
  v_fma_f32 v181, v181, s51, -v10
  v_fma_f32 v182, v182, s51, -v10
  v_mfma_f32_16x16x32_bf16 v[164:167], a[196:199], v[112:115], v[164:167]
  s_mov_b32 s53, 245760
  buffer_load_dwordx4 v250, s[20:23], s53 offen nt lds
  v_add_u32 v5, 114688, v2
  v_xor_b32 v7, 0, v5
  ds_read_b128 a[192:195], v7 offset:0
  v_fma_f32 v183, v183, s51, -v10
  v_fma_f32 v184, v184, s51, -v10
  v_fma_f32 v185, v185, s51, -v10
  s_waitcnt lgkmcnt(6)
  v_mfma_f32_16x16x32_bf16 v[128:131], a[200:203], v[52:55], v[128:131]
  v_fma_f32 v186, v186, s51, -v10
  v_fma_f32 v187, v187, s51, -v10
  v_mfma_f32_16x16x32_bf16 v[144:147], a[200:203], v[84:87], v[144:147]
  v_fma_f32 v188, v188, s51, -v10
  v_fma_f32 v189, v189, s51, -v10
  v_fma_f32 v190, v190, s51, -v10
  v_mfma_f32_16x16x32_bf16 v[160:163], a[200:203], v[116:119], v[160:163]
  ds_read_b128 a[196:199], v7 offset:8192
  v_fma_f32 v191, v191, s51, -v10
  v_exp_f32 v176, v176
  s_waitcnt lgkmcnt(6)
  v_mfma_f32_16x16x32_bf16 v[132:135], a[204:207], v[52:55], v[132:135]
  v_exp_f32 v177, v177
  v_exp_f32 v178, v178
  v_exp_f32 v179, v179
  v_mfma_f32_16x16x32_bf16 v[148:151], a[204:207], v[84:87], v[148:151]
  v_xor_b32 v8, 64, v5
  v_exp_f32 v180, v180
  v_exp_f32 v181, v181
  v_mfma_f32_16x16x32_bf16 v[164:167], a[204:207], v[116:119], v[164:167]
  ds_read_b128 a[200:203], v8 offset:0
  v_exp_f32 v182, v182
  v_exp_f32 v183, v183
  v_exp_f32 v184, v184
  s_waitcnt lgkmcnt(6)
  v_mfma_f32_16x16x32_bf16 v[128:131], a[208:211], v[56:59], v[128:131]
  v_exp_f32 v185, v185
  v_exp_f32 v186, v186
  v_mfma_f32_16x16x32_bf16 v[144:147], a[208:211], v[88:91], v[144:147]
  v_exp_f32 v187, v187
  v_exp_f32 v188, v188
  v_exp_f32 v189, v189
  v_mfma_f32_16x16x32_bf16 v[160:163], a[208:211], v[120:123], v[160:163]
  ds_read_b128 a[204:207], v8 offset:8192
  v_exp_f32 v190, v190
  v_exp_f32 v191, v191
  s_waitcnt lgkmcnt(6)
  v_mfma_f32_16x16x32_bf16 v[132:135], a[212:215], v[56:59], v[132:135]
  v_fma_f32 v192, v192, s51, -v11
  v_fma_f32 v193, v193, s51, -v11
  v_fma_f32 v194, v194, s51, -v11
  v_mfma_f32_16x16x32_bf16 v[148:151], a[212:215], v[88:91], v[148:151]
  v_xor_b32 v9, 128, v5
  v_fma_f32 v195, v195, s51, -v11
  v_fma_f32 v196, v196, s51, -v11
  v_mfma_f32_16x16x32_bf16 v[164:167], a[212:215], v[120:123], v[164:167]
  ds_read_b128 a[208:211], v9 offset:0
  v_fma_f32 v197, v197, s51, -v11
  v_fma_f32 v198, v198, s51, -v11
  v_fma_f32 v199, v199, s51, -v11
  s_waitcnt lgkmcnt(6)
  v_mfma_f32_16x16x32_bf16 v[128:131], a[216:219], v[60:63], v[128:131]
  v_fma_f32 v200, v200, s51, -v11
  v_fma_f32 v201, v201, s51, -v11
  v_mfma_f32_16x16x32_bf16 v[144:147], a[216:219], v[92:95], v[144:147]
  v_fma_f32 v202, v202, s51, -v11
  v_fma_f32 v203, v203, s51, -v11
  v_fma_f32 v204, v204, s51, -v11
  v_mfma_f32_16x16x32_bf16 v[160:163], a[216:219], v[124:127], v[160:163]
  ds_read_b128 a[212:215], v9 offset:8192
  v_fma_f32 v205, v205, s51, -v11
  v_fma_f32 v206, v206, s51, -v11
  s_waitcnt lgkmcnt(6)
  v_mfma_f32_16x16x32_bf16 v[132:135], a[220:223], v[60:63], v[132:135]
  v_fma_f32 v207, v207, s51, -v11
  v_exp_f32 v192, v192
  v_exp_f32 v193, v193
  v_mfma_f32_16x16x32_bf16 v[148:151], a[220:223], v[92:95], v[148:151]
  v_xor_b32 v6, 192, v5
  v_exp_f32 v194, v194
  v_exp_f32 v195, v195
  v_mfma_f32_16x16x32_bf16 v[164:167], a[220:223], v[124:127], v[164:167]
  ds_read_b128 a[216:219], v6 offset:0
  v_exp_f32 v196, v196
  v_exp_f32 v197, v197
  v_exp_f32 v198, v198
  s_waitcnt lgkmcnt(6)
  v_mfma_f32_16x16x32_bf16 v[136:139], a[192:195], v[32:35], 0
  v_mfma_f32_16x16x32_bf16 v[152:155], a[192:195], v[64:67], 0
  v_mfma_f32_16x16x32_bf16 v[168:171], a[192:195], v[96:99], 0
  ds_read_b128 a[220:223], v6 offset:8192
  s_waitcnt lgkmcnt(6)
  v_mfma_f32_16x16x32_bf16 v[140:143], a[196:199], v[32:35], 0
  v_exp_f32 v199, v199
  v_exp_f32 v200, v200
  v_mfma_f32_16x16x32_bf16 v[156:159], a[196:199], v[64:67], 0
  v_xor_b32 v7, 0, v5
  v_exp_f32 v201, v201
  v_exp_f32 v202, v202
  v_exp_f32 v203, v203
  v_mfma_f32_16x16x32_bf16 v[172:175], a[196:199], v[96:99], 0
  ds_read_b128 a[192:195], v7 offset:256
  v_exp_f32 v204, v204
  v_exp_f32 v205, v205
  s_waitcnt lgkmcnt(6)
  v_mfma_f32_16x16x32_bf16 v[136:139], a[200:203], v[36:39], v[136:139]
  v_exp_f32 v206, v206
  v_exp_f32 v207, v207
  v_fma_f32 v208, v208, s51, -v12
  v_mfma_f32_16x16x32_bf16 v[152:155], a[200:203], v[68:71], v[152:155]
  v_fma_f32 v209, v209, s51, -v12
  v_fma_f32 v210, v210, s51, -v12
  v_mfma_f32_16x16x32_bf16 v[168:171], a[200:203], v[100:103], v[168:171]
  ds_read_b128 a[196:199], v7 offset:8448
  v_fma_f32 v211, v211, s51, -v12
  v_fma_f32 v212, v212, s51, -v12
  v_fma_f32 v213, v213, s51, -v12
  s_waitcnt lgkmcnt(6)
  v_mfma_f32_16x16x32_bf16 v[140:143], a[204:207], v[36:39], v[140:143]
  v_fma_f32 v214, v214, s51, -v12
  v_fma_f32 v215, v215, s51, -v12
  v_mfma_f32_16x16x32_bf16 v[156:159], a[204:207], v[68:71], v[156:159]
  v_xor_b32 v8, 64, v5
  v_fma_f32 v216, v216, s51, -v12
  v_fma_f32 v217, v217, s51, -v12
  v_fma_f32 v218, v218, s51, -v12
  v_mfma_f32_16x16x32_bf16 v[172:175], a[204:207], v[100:103], v[172:175]
  ds_read_b128 a[200:203], v8 offset:256
  v_fma_f32 v219, v219, s51, -v12
  v_fma_f32 v220, v220, s51, -v12
  s_waitcnt lgkmcnt(6)
  v_mfma_f32_16x16x32_bf16 v[136:139], a[208:211], v[40:43], v[136:139]
  v_fma_f32 v221, v221, s51, -v12
  v_fma_f32 v222, v222, s51, -v12
  v_fma_f32 v223, v223, s51, -v12
  v_mfma_f32_16x16x32_bf16 v[152:155], a[208:211], v[72:75], v[152:155]
  v_exp_f32 v208, v208
  v_exp_f32 v209, v209
  v_mfma_f32_16x16x32_bf16 v[168:171], a[208:211], v[104:107], v[168:171]
  ds_read_b128 a[204:207], v8 offset:8448
  v_exp_f32 v210, v210
  v_exp_f32 v211, v211
  v_exp_f32 v212, v212
  s_waitcnt lgkmcnt(6)
  v_mfma_f32_16x16x32_bf16 v[140:143], a[212:215], v[40:43], v[140:143]
  v_exp_f32 v213, v213
  v_exp_f32 v214, v214
  v_mfma_f32_16x16x32_bf16 v[156:159], a[212:215], v[72:75], v[156:159]
  v_xor_b32 v9, 128, v5
  v_exp_f32 v215, v215
  v_exp_f32 v216, v216
  v_exp_f32 v217, v217
  v_mfma_f32_16x16x32_bf16 v[172:175], a[212:215], v[104:107], v[172:175]
  ds_read_b128 a[208:211], v9 offset:256
  v_exp_f32 v218, v218
  v_exp_f32 v219, v219
  s_waitcnt lgkmcnt(6)
  v_mfma_f32_16x16x32_bf16 v[136:139], a[216:219], v[44:47], v[136:139]
  v_exp_f32 v220, v220
  v_exp_f32 v221, v221
  v_exp_f32 v222, v222
  v_mfma_f32_16x16x32_bf16 v[152:155], a[216:219], v[76:79], v[152:155]
  v_exp_f32 v223, v223
  v_add_f32 v19, v176, v177
  v_mfma_f32_16x16x32_bf16 v[168:171], a[216:219], v[108:111], v[168:171]
  ds_read_b128 a[212:215], v9 offset:8448
  v_add_f32 v20, v178, v179
  v_add_f32 v19, v19, v180
  v_add_f32 v20, v20, v181
  s_waitcnt lgkmcnt(6)
  v_mfma_f32_16x16x32_bf16 v[140:143], a[220:223], v[44:47], v[140:143]
  v_add_f32 v19, v19, v182
  v_add_f32 v20, v20, v183
  v_mfma_f32_16x16x32_bf16 v[156:159], a[220:223], v[76:79], v[156:159]
  v_xor_b32 v6, 192, v5
  v_add_f32 v19, v19, v184
  v_add_f32 v20, v20, v185
  v_add_f32 v19, v19, v186
  v_mfma_f32_16x16x32_bf16 v[172:175], a[220:223], v[108:111], v[172:175]
  ds_read_b128 a[216:219], v6 offset:256
  v_add_f32 v20, v20, v187
  v_add_f32 v19, v19, v188
  s_waitcnt lgkmcnt(6)
  v_mfma_f32_16x16x32_bf16 v[136:139], a[192:195], v[48:51], v[136:139]
  v_add_f32 v20, v20, v189
  v_add_f32 v19, v19, v190
  v_add_f32 v20, v20, v191
  v_mfma_f32_16x16x32_bf16 v[152:155], a[192:195], v[80:83], v[152:155]
  v_add_f32 v19, v19, v20
  v_add_f32 v13, v13, v19
  v_mfma_f32_16x16x32_bf16 v[168:171], a[192:195], v[112:115], v[168:171]
  ds_read_b128 a[220:223], v6 offset:8448
  v_add_f32 v22, v192, v193
  v_add_f32 v23, v194, v195
  v_add_f32 v22, v22, v196
  s_waitcnt lgkmcnt(6)
  v_mfma_f32_16x16x32_bf16 v[140:143], a[196:199], v[48:51], v[140:143]
  s_waitcnt vmcnt(21)
  s_barrier
  v_add_f32 v23, v23, v197
  v_add_f32 v22, v22, v198
  v_mfma_f32_16x16x32_bf16 v[156:159], a[196:199], v[80:83], v[156:159]
  v_add_u32 v5, 131072, v3
  v_xor_b32 v7, 0, v5
  v_add_f32 v23, v23, v199
  v_add_f32 v22, v22, v200
  v_add_f32 v23, v23, v201
  v_mfma_f32_16x16x32_bf16 v[172:175], a[196:199], v[112:115], v[172:175]
  ds_read_b64_tr_b16 a[192:193], v7 offset:0
  ds_read_b64_tr_b16 a[194:195], v7 offset:8192
  v_add_f32 v22, v22, v202
  v_add_f32 v23, v23, v203
  s_waitcnt lgkmcnt(7)
  v_mfma_f32_16x16x32_bf16 v[136:139], a[200:203], v[52:55], v[136:139]
  v_xor_b32 v8, 32, v5
  v_add_f32 v22, v22, v204
  v_add_f32 v23, v23, v205
  v_add_f32 v22, v22, v206
  v_mfma_f32_16x16x32_bf16 v[152:155], a[200:203], v[84:87], v[152:155]
  ds_read_b64_tr_b16 a[196:197], v8 offset:0
  v_add_f32 v23, v23, v207
  v_add_f32 v22, v22, v23
  v_mfma_f32_16x16x32_bf16 v[168:171], a[200:203], v[116:119], v[168:171]
  ds_read_b64_tr_b16 a[198:199], v8 offset:8192
  v_add_f32 v14, v14, v22
  v_add_f32 v25, v208, v209
  v_add_f32 v26, v210, v211
  s_waitcnt lgkmcnt(8)
  v_mfma_f32_16x16x32_bf16 v[140:143], a[204:207], v[52:55], v[140:143]
  v_xor_b32 v9, 64, v5
  v_add_f32 v25, v25, v212
  v_add_f32 v26, v26, v213
  v_mfma_f32_16x16x32_bf16 v[156:159], a[204:207], v[84:87], v[156:159]
  ds_read_b64_tr_b16 a[200:201], v9 offset:0
  v_add_f32 v25, v25, v214
  v_add_f32 v26, v26, v215
  v_add_f32 v25, v25, v216
  v_mfma_f32_16x16x32_bf16 v[172:175], a[204:207], v[116:119], v[172:175]
  ds_read_b64_tr_b16 a[202:203], v9 offset:8192
  v_add_f32 v26, v26, v217
  v_add_f32 v25, v25, v218
  s_waitcnt lgkmcnt(9)
  v_mfma_f32_16x16x32_bf16 v[136:139], a[208:211], v[56:59], v[136:139]
  v_xor_b32 v6, 96, v5
  v_add_f32 v26, v26, v219
  v_add_f32 v25, v25, v220
  v_add_f32 v26, v26, v221
  v_mfma_f32_16x16x32_bf16 v[152:155], a[208:211], v[88:91], v[152:155]
  ds_read_b64_tr_b16 a[204:205], v6 offset:0
  v_add_f32 v25, v25, v222
  v_add_f32 v26, v26, v223
  v_mfma_f32_16x16x32_bf16 v[168:171], a[208:211], v[120:123], v[168:171]
  ds_read_b64_tr_b16 a[206:207], v6 offset:8192
  v_add_f32 v25, v25, v26
  v_add_f32 v15, v15, v25
  v_cvt_pk_bf16_f32 v224, v176, v177
  s_waitcnt lgkmcnt(10)
  v_mfma_f32_16x16x32_bf16 v[140:143], a[212:215], v[56:59], v[140:143]
  v_xor_b32 v7, 128, v5
  v_cvt_pk_bf16_f32 v225, v178, v179
  v_cvt_pk_bf16_f32 v226, v180, v181
  v_mfma_f32_16x16x32_bf16 v[156:159], a[212:215], v[88:91], v[156:159]
  ds_read_b64_tr_b16 a[208:209], v7 offset:0
  v_cvt_pk_bf16_f32 v227, v182, v183
  v_cvt_pk_bf16_f32 v228, v184, v185
  v_cvt_pk_bf16_f32 v229, v186, v187
  v_mfma_f32_16x16x32_bf16 v[172:175], a[212:215], v[120:123], v[172:175]
  ds_read_b64_tr_b16 a[210:211], v7 offset:8192
  v_cvt_pk_bf16_f32 v230, v188, v189
  v_cvt_pk_bf16_f32 v231, v190, v191
  s_waitcnt lgkmcnt(11)
  v_mfma_f32_16x16x32_bf16 v[136:139], a[216:219], v[60:63], v[136:139]
  v_xor_b32 v8, 160, v5
  v_cvt_pk_bf16_f32 v232, v192, v193
  v_cvt_pk_bf16_f32 v233, v194, v195
  v_cvt_pk_bf16_f32 v234, v196, v197
  v_mfma_f32_16x16x32_bf16 v[152:155], a[216:219], v[92:95], v[152:155]
  ds_read_b64_tr_b16 a[212:213], v8 offset:0
  v_cvt_pk_bf16_f32 v235, v198, v199
  v_cvt_pk_bf16_f32 v236, v200, v201
  v_mfma_f32_16x16x32_bf16 v[168:171], a[216:219], v[124:127], v[168:171]
  ds_read_b64_tr_b16 a[214:215], v8 offset:8192
  v_cvt_pk_bf16_f32 v237, v202, v203
  v_cvt_pk_bf16_f32 v238, v204, v205
  v_cvt_pk_bf16_f32 v239, v206, v207
  s_waitcnt lgkmcnt(12)
  v_mfma_f32_16x16x32_bf16 v[140:143], a[220:223], v[60:63], v[140:143]
  v_xor_b32 v9, 192, v5
  v_cvt_pk_bf16_f32 v240, v208, v209
  v_cvt_pk_bf16_f32 v241, v210, v211
  v_mfma_f32_16x16x32_bf16 v[156:159], a[220:223], v[92:95], v[156:159]
  ds_read_b64_tr_b16 a[216:217], v9 offset:0
  v_cvt_pk_bf16_f32 v242, v212, v213
  v_cvt_pk_bf16_f32 v243, v214, v215
  v_cvt_pk_bf16_f32 v244, v216, v217
  v_mfma_f32_16x16x32_bf16 v[172:175], a[220:223], v[124:127], v[172:175]
  ds_read_b64_tr_b16 a[218:219], v9 offset:8192
  v_cvt_pk_bf16_f32 v245, v218, v219
  v_cvt_pk_bf16_f32 v246, v220, v221
  v_cvt_pk_bf16_f32 v247, v222, v223
  s_waitcnt lgkmcnt(12)
  v_mfma_f32_16x16x32_bf16 a[0:3], a[192:195], v[224:227], a[0:3]
  v_xor_b32 v6, 224, v5
  v_mfma_f32_16x16x32_bf16 a[64:67], a[192:195], v[232:235], a[64:67]
  ds_read_b64_tr_b16 a[220:221], v6 offset:0
  v_mfma_f32_16x16x32_bf16 a[128:131], a[192:195], v[240:243], a[128:131]
  ds_read_b64_tr_b16 a[222:223], v6 offset:8192
  s_waitcnt lgkmcnt(12)
  v_mfma_f32_16x16x32_bf16 a[4:7], a[196:199], v[224:227], a[4:7]
  v_xor_b32 v7, 0, v5
  v_mfma_f32_16x16x32_bf16 a[68:71], a[196:199], v[232:235], a[68:71]
  ds_read_b64_tr_b16 a[192:193], v7 offset:256
  v_mfma_f32_16x16x32_bf16 a[132:135], a[196:199], v[240:243], a[132:135]
  ds_read_b64_tr_b16 a[194:195], v7 offset:8448
  s_waitcnt lgkmcnt(12)
  v_mfma_f32_16x16x32_bf16 a[8:11], a[200:203], v[224:227], a[8:11]
  v_xor_b32 v8, 32, v5
  v_mfma_f32_16x16x32_bf16 a[72:75], a[200:203], v[232:235], a[72:75]
  ds_read_b64_tr_b16 a[196:197], v8 offset:256
  v_mfma_f32_16x16x32_bf16 a[136:139], a[200:203], v[240:243], a[136:139]
  ds_read_b64_tr_b16 a[198:199], v8 offset:8448
  s_waitcnt lgkmcnt(12)
  v_mfma_f32_16x16x32_bf16 a[12:15], a[204:207], v[224:227], a[12:15]
  v_xor_b32 v9, 64, v5
  v_mfma_f32_16x16x32_bf16 a[76:79], a[204:207], v[232:235], a[76:79]
  ds_read_b64_tr_b16 a[200:201], v9 offset:256
  v_mfma_f32_16x16x32_bf16 a[140:143], a[204:207], v[240:243], a[140:143]
  ds_read_b64_tr_b16 a[202:203], v9 offset:8448
  s_waitcnt lgkmcnt(12)
  v_mfma_f32_16x16x32_bf16 a[16:19], a[208:211], v[224:227], a[16:19]
  v_xor_b32 v6, 96, v5
  v_mfma_f32_16x16x32_bf16 a[80:83], a[208:211], v[232:235], a[80:83]
  ds_read_b64_tr_b16 a[204:205], v6 offset:256
  v_mfma_f32_16x16x32_bf16 a[144:147], a[208:211], v[240:243], a[144:147]
  ds_read_b64_tr_b16 a[206:207], v6 offset:8448
  s_waitcnt lgkmcnt(12)
  v_mfma_f32_16x16x32_bf16 a[20:23], a[212:215], v[224:227], a[20:23]
  v_xor_b32 v7, 128, v5
  v_mfma_f32_16x16x32_bf16 a[84:87], a[212:215], v[232:235], a[84:87]
  ds_read_b64_tr_b16 a[208:209], v7 offset:256
  v_mfma_f32_16x16x32_bf16 a[148:151], a[212:215], v[240:243], a[148:151]
  ds_read_b64_tr_b16 a[210:211], v7 offset:8448
  s_waitcnt lgkmcnt(12)
  v_mfma_f32_16x16x32_bf16 a[24:27], a[216:219], v[224:227], a[24:27]
  v_xor_b32 v8, 160, v5
  v_mfma_f32_16x16x32_bf16 a[88:91], a[216:219], v[232:235], a[88:91]
  ds_read_b64_tr_b16 a[212:213], v8 offset:256
  v_mfma_f32_16x16x32_bf16 a[152:155], a[216:219], v[240:243], a[152:155]
  ds_read_b64_tr_b16 a[214:215], v8 offset:8448
  s_waitcnt lgkmcnt(12)
  v_mfma_f32_16x16x32_bf16 a[28:31], a[220:223], v[224:227], a[28:31]
  v_xor_b32 v9, 192, v5
  v_mfma_f32_16x16x32_bf16 a[92:95], a[220:223], v[232:235], a[92:95]
  ds_read_b64_tr_b16 a[216:217], v9 offset:256
  v_mfma_f32_16x16x32_bf16 a[156:159], a[220:223], v[240:243], a[156:159]
  ds_read_b64_tr_b16 a[218:219], v9 offset:8448
  s_waitcnt lgkmcnt(12)
  v_mfma_f32_16x16x32_bf16 a[32:35], a[192:195], v[224:227], a[32:35]
  v_xor_b32 v6, 224, v5
  v_mfma_f32_16x16x32_bf16 a[96:99], a[192:195], v[232:235], a[96:99]
  ds_read_b64_tr_b16 a[220:221], v6 offset:256
  v_mfma_f32_16x16x32_bf16 a[160:163], a[192:195], v[240:243], a[160:163]
  ds_read_b64_tr_b16 a[222:223], v6 offset:8448
  s_waitcnt lgkmcnt(12)
  v_mfma_f32_16x16x32_bf16 a[36:39], a[196:199], v[224:227], a[36:39]
  s_waitcnt vmcnt(18)
  s_barrier
  v_mfma_f32_16x16x32_bf16 a[100:103], a[196:199], v[232:235], a[100:103]
  v_add_u32 v5, 147456, v3
  v_xor_b32 v7, 0, v5
  v_mfma_f32_16x16x32_bf16 a[164:167], a[196:199], v[240:243], a[164:167]
  ds_read_b64_tr_b16 a[192:193], v7 offset:0
  ds_read_b64_tr_b16 a[194:195], v7 offset:8192
  s_waitcnt lgkmcnt(12)
  v_mfma_f32_16x16x32_bf16 a[40:43], a[200:203], v[224:227], a[40:43]
  v_xor_b32 v8, 32, v5
  v_mfma_f32_16x16x32_bf16 a[104:107], a[200:203], v[232:235], a[104:107]
  ds_read_b64_tr_b16 a[196:197], v8 offset:0
  v_mfma_f32_16x16x32_bf16 a[168:171], a[200:203], v[240:243], a[168:171]
  ds_read_b64_tr_b16 a[198:199], v8 offset:8192
  s_waitcnt lgkmcnt(12)
  v_mfma_f32_16x16x32_bf16 a[44:47], a[204:207], v[224:227], a[44:47]
  v_xor_b32 v9, 64, v5
  v_mfma_f32_16x16x32_bf16 a[108:111], a[204:207], v[232:235], a[108:111]
  ds_read_b64_tr_b16 a[200:201], v9 offset:0
  v_mfma_f32_16x16x32_bf16 a[172:175], a[204:207], v[240:243], a[172:175]
  ds_read_b64_tr_b16 a[202:203], v9 offset:8192
  s_waitcnt lgkmcnt(12)
  v_mfma_f32_16x16x32_bf16 a[48:51], a[208:211], v[224:227], a[48:51]
  v_xor_b32 v6, 96, v5
  v_mfma_f32_16x16x32_bf16 a[112:115], a[208:211], v[232:235], a[112:115]
  ds_read_b64_tr_b16 a[204:205], v6 offset:0
  v_mfma_f32_16x16x32_bf16 a[176:179], a[208:211], v[240:243], a[176:179]
  ds_read_b64_tr_b16 a[206:207], v6 offset:8192
  s_waitcnt lgkmcnt(12)
  v_mfma_f32_16x16x32_bf16 a[52:55], a[212:215], v[224:227], a[52:55]
  v_xor_b32 v7, 128, v5
  v_mfma_f32_16x16x32_bf16 a[116:119], a[212:215], v[232:235], a[116:119]
  ds_read_b64_tr_b16 a[208:209], v7 offset:0
  v_mfma_f32_16x16x32_bf16 a[180:183], a[212:215], v[240:243], a[180:183]
  ds_read_b64_tr_b16 a[210:211], v7 offset:8192
  s_waitcnt lgkmcnt(12)
  v_mfma_f32_16x16x32_bf16 a[56:59], a[216:219], v[224:227], a[56:59]
  v_xor_b32 v8, 160, v5
  v_mfma_f32_16x16x32_bf16 a[120:123], a[216:219], v[232:235], a[120:123]
  ds_read_b64_tr_b16 a[212:213], v8 offset:0
  v_mfma_f32_16x16x32_bf16 a[184:187], a[216:219], v[240:243], a[184:187]
  ds_read_b64_tr_b16 a[214:215], v8 offset:8192
  s_waitcnt lgkmcnt(12)
  v_mfma_f32_16x16x32_bf16 a[60:63], a[220:223], v[224:227], a[60:63]
  v_xor_b32 v9, 192, v5
  v_mfma_f32_16x16x32_bf16 a[124:127], a[220:223], v[232:235], a[124:127]
  ds_read_b64_tr_b16 a[216:217], v9 offset:0
  v_mfma_f32_16x16x32_bf16 a[188:191], a[220:223], v[240:243], a[188:191]
  ds_read_b64_tr_b16 a[218:219], v9 offset:8192
  s_waitcnt lgkmcnt(12)
  v_mfma_f32_16x16x32_bf16 a[0:3], a[192:195], v[228:231], a[0:3]
  v_xor_b32 v6, 224, v5
  v_mfma_f32_16x16x32_bf16 a[64:67], a[192:195], v[236:239], a[64:67]
  ds_read_b64_tr_b16 a[220:221], v6 offset:0
  v_mfma_f32_16x16x32_bf16 a[128:131], a[192:195], v[244:247], a[128:131]
  ds_read_b64_tr_b16 a[222:223], v6 offset:8192
  s_waitcnt lgkmcnt(12)
  v_mfma_f32_16x16x32_bf16 a[4:7], a[196:199], v[228:231], a[4:7]
  v_xor_b32 v7, 0, v5
  v_mfma_f32_16x16x32_bf16 a[68:71], a[196:199], v[236:239], a[68:71]
  ds_read_b64_tr_b16 a[192:193], v7 offset:256
  v_mfma_f32_16x16x32_bf16 a[132:135], a[196:199], v[244:247], a[132:135]
  ds_read_b64_tr_b16 a[194:195], v7 offset:8448
  s_waitcnt lgkmcnt(12)
  v_mfma_f32_16x16x32_bf16 a[8:11], a[200:203], v[228:231], a[8:11]
  v_xor_b32 v8, 32, v5
  v_mfma_f32_16x16x32_bf16 a[72:75], a[200:203], v[236:239], a[72:75]
  ds_read_b64_tr_b16 a[196:197], v8 offset:256
  v_mfma_f32_16x16x32_bf16 a[136:139], a[200:203], v[244:247], a[136:139]
  ds_read_b64_tr_b16 a[198:199], v8 offset:8448
  s_waitcnt lgkmcnt(12)
  v_mfma_f32_16x16x32_bf16 a[12:15], a[204:207], v[228:231], a[12:15]
  v_xor_b32 v9, 64, v5
  v_mfma_f32_16x16x32_bf16 a[76:79], a[204:207], v[236:239], a[76:79]
  ds_read_b64_tr_b16 a[200:201], v9 offset:256
  v_mfma_f32_16x16x32_bf16 a[140:143], a[204:207], v[244:247], a[140:143]
  ds_read_b64_tr_b16 a[202:203], v9 offset:8448
  s_waitcnt lgkmcnt(12)
  v_mfma_f32_16x16x32_bf16 a[16:19], a[208:211], v[228:231], a[16:19]
  v_xor_b32 v6, 96, v5
  v_mfma_f32_16x16x32_bf16 a[80:83], a[208:211], v[236:239], a[80:83]
  ds_read_b64_tr_b16 a[204:205], v6 offset:256
  v_mfma_f32_16x16x32_bf16 a[144:147], a[208:211], v[244:247], a[144:147]
  ds_read_b64_tr_b16 a[206:207], v6 offset:8448
  s_waitcnt lgkmcnt(12)
  v_mfma_f32_16x16x32_bf16 a[20:23], a[212:215], v[228:231], a[20:23]
  v_xor_b32 v7, 128, v5
  v_mfma_f32_16x16x32_bf16 a[84:87], a[212:215], v[236:239], a[84:87]
  ds_read_b64_tr_b16 a[208:209], v7 offset:256
  v_mfma_f32_16x16x32_bf16 a[148:151], a[212:215], v[244:247], a[148:151]
  ds_read_b64_tr_b16 a[210:211], v7 offset:8448
  s_waitcnt lgkmcnt(12)
  v_mfma_f32_16x16x32_bf16 a[24:27], a[216:219], v[228:231], a[24:27]
  v_xor_b32 v8, 160, v5
  v_mfma_f32_16x16x32_bf16 a[88:91], a[216:219], v[236:239], a[88:91]
  ds_read_b64_tr_b16 a[212:213], v8 offset:256
  v_mfma_f32_16x16x32_bf16 a[152:155], a[216:219], v[244:247], a[152:155]
  ds_read_b64_tr_b16 a[214:215], v8 offset:8448
  s_waitcnt lgkmcnt(12)
  v_mfma_f32_16x16x32_bf16 a[28:31], a[220:223], v[228:231], a[28:31]
  v_xor_b32 v9, 192, v5
  v_mfma_f32_16x16x32_bf16 a[92:95], a[220:223], v[236:239], a[92:95]
  ds_read_b64_tr_b16 a[216:217], v9 offset:256
  v_mfma_f32_16x16x32_bf16 a[156:159], a[220:223], v[244:247], a[156:159]
  ds_read_b64_tr_b16 a[218:219], v9 offset:8448
  s_waitcnt lgkmcnt(12)
  v_mfma_f32_16x16x32_bf16 a[32:35], a[192:195], v[228:231], a[32:35]
  v_xor_b32 v6, 224, v5
  v_mfma_f32_16x16x32_bf16 a[96:99], a[192:195], v[236:239], a[96:99]
  ds_read_b64_tr_b16 a[220:221], v6 offset:256
  v_mfma_f32_16x16x32_bf16 a[160:163], a[192:195], v[244:247], a[160:163]
  ds_read_b64_tr_b16 a[222:223], v6 offset:8448
  s_waitcnt lgkmcnt(12)
  v_mfma_f32_16x16x32_bf16 a[36:39], a[196:199], v[228:231], a[36:39]
  s_waitcnt vmcnt(15)
  v_mfma_f32_16x16x32_bf16 a[100:103], a[196:199], v[236:239], a[100:103]
  s_barrier
  v_add_u32 v5, 0, v2
  v_mfma_f32_16x16x32_bf16 a[164:167], a[196:199], v[244:247], a[164:167]
  v_xor_b32 v7, 0, v5
  ds_read_b128 a[192:195], v7 offset:0
  s_waitcnt lgkmcnt(11)
  v_mfma_f32_16x16x32_bf16 a[40:43], a[200:203], v[228:231], a[40:43]
  v_mfma_f32_16x16x32_bf16 a[104:107], a[200:203], v[236:239], a[104:107]
  v_mfma_f32_16x16x32_bf16 a[168:171], a[200:203], v[244:247], a[168:171]
  ds_read_b128 a[196:199], v7 offset:8192
  s_waitcnt lgkmcnt(10)
  v_mfma_f32_16x16x32_bf16 a[44:47], a[204:207], v[228:231], a[44:47]
  v_mfma_f32_16x16x32_bf16 a[108:111], a[204:207], v[236:239], a[108:111]
  v_xor_b32 v8, 64, v5
  v_mfma_f32_16x16x32_bf16 a[172:175], a[204:207], v[244:247], a[172:175]
  ds_read_b128 a[200:203], v8 offset:0
  s_waitcnt lgkmcnt(9)
  v_mfma_f32_16x16x32_bf16 a[48:51], a[208:211], v[228:231], a[48:51]
  v_mfma_f32_16x16x32_bf16 a[112:115], a[208:211], v[236:239], a[112:115]
  v_mfma_f32_16x16x32_bf16 a[176:179], a[208:211], v[244:247], a[176:179]
  ds_read_b128 a[204:207], v8 offset:8192
  s_waitcnt lgkmcnt(8)
  v_mfma_f32_16x16x32_bf16 a[52:55], a[212:215], v[228:231], a[52:55]
  v_mfma_f32_16x16x32_bf16 a[116:119], a[212:215], v[236:239], a[116:119]
  v_xor_b32 v9, 128, v5
  v_mfma_f32_16x16x32_bf16 a[180:183], a[212:215], v[244:247], a[180:183]
  ds_read_b128 a[208:211], v9 offset:0
  s_waitcnt lgkmcnt(7)
  v_mfma_f32_16x16x32_bf16 a[56:59], a[216:219], v[228:231], a[56:59]
  v_mfma_f32_16x16x32_bf16 a[120:123], a[216:219], v[236:239], a[120:123]
  v_mfma_f32_16x16x32_bf16 a[184:187], a[216:219], v[244:247], a[184:187]
  ds_read_b128 a[212:215], v9 offset:8192
  s_waitcnt lgkmcnt(6)
  v_mfma_f32_16x16x32_bf16 a[60:63], a[220:223], v[228:231], a[60:63]
  v_mfma_f32_16x16x32_bf16 a[124:127], a[220:223], v[236:239], a[124:127]
  v_xor_b32 v6, 192, v5
  v_mfma_f32_16x16x32_bf16 a[188:191], a[220:223], v[244:247], a[188:191]
  ds_read_b128 a[216:219], v6 offset:0
  s_waitcnt lgkmcnt(6)
  v_mfma_f32_16x16x32_bf16 v[176:179], a[192:195], v[32:35], 0
  v_mfma_f32_16x16x32_bf16 v[192:195], a[192:195], v[64:67], 0
  v_mfma_f32_16x16x32_bf16 v[208:211], a[192:195], v[96:99], 0
  ds_read_b128 a[220:223], v6 offset:8192
  s_waitcnt lgkmcnt(6)
  v_mfma_f32_16x16x32_bf16 v[180:183], a[196:199], v[32:35], 0
  v_max3_f32 v19, v128, v129, v130
  v_max3_f32 v20, v131, v132, v133
  v_mfma_f32_16x16x32_bf16 v[196:199], a[196:199], v[64:67], 0
  v_xor_b32 v7, 0, v5
  v_max3_f32 v21, v134, v135, v136
  v_max3_f32 v19, v19, v137, v138
  v_mfma_f32_16x16x32_bf16 v[212:215], a[196:199], v[96:99], 0
  ds_read_b128 a[192:195], v7 offset:256
  v_max3_f32 v20, v20, v139, v140
  v_max3_f32 v21, v21, v141, v142
  v_max3_f32 v19, v19, v20, v143
  s_waitcnt lgkmcnt(6)
  v_mfma_f32_16x16x32_bf16 v[176:179], a[200:203], v[36:39], v[176:179]
  v_max_f32 v16, v19, v21
  v_mov_b32 v19, v16
  v_mfma_f32_16x16x32_bf16 v[192:195], a[200:203], v[68:71], v[192:195]
  s_nop 1
  v_permlane32_swap_b32 v16, v19
  v_max_f32 v16, v16, v19
  v_mfma_f32_16x16x32_bf16 v[208:211], a[200:203], v[100:103], v[208:211]
  ds_read_b128 a[196:199], v7 offset:8448
  v_mov_b32 v19, v16
  s_nop 1
  s_waitcnt lgkmcnt(6)
  v_mfma_f32_16x16x32_bf16 v[180:183], a[204:207], v[36:39], v[180:183]
  v_permlane16_swap_b32 v16, v19
  v_max_f32 v16, v16, v19
  v_mul_f32 v16, s51, v16
  v_mfma_f32_16x16x32_bf16 v[196:199], a[204:207], v[68:71], v[196:199]
  v_xor_b32 v8, 64, v5
  v_max3_f32 v22, v144, v145, v146
  v_max3_f32 v23, v147, v148, v149
  v_mfma_f32_16x16x32_bf16 v[212:215], a[204:207], v[100:103], v[212:215]
  ds_read_b128 a[200:203], v8 offset:256
  v_max3_f32 v24, v150, v151, v152
  v_max3_f32 v22, v22, v153, v154
  v_max3_f32 v23, v23, v155, v156
  s_waitcnt lgkmcnt(6)
  v_mfma_f32_16x16x32_bf16 v[176:179], a[208:211], v[40:43], v[176:179]
  v_max3_f32 v24, v24, v157, v158
  v_max3_f32 v22, v22, v23, v159
  v_mfma_f32_16x16x32_bf16 v[192:195], a[208:211], v[72:75], v[192:195]
  v_max_f32 v17, v22, v24
  v_mov_b32 v22, v17
  s_nop 1
  v_mfma_f32_16x16x32_bf16 v[208:211], a[208:211], v[104:107], v[208:211]
  ds_read_b128 a[204:207], v8 offset:8448
  v_permlane32_swap_b32 v17, v22
  v_max_f32 v17, v17, v22
  s_waitcnt lgkmcnt(6)
  v_mfma_f32_16x16x32_bf16 v[180:183], a[212:215], v[40:43], v[180:183]
  v_mov_b32 v22, v17
  s_nop 1
  v_permlane16_swap_b32 v17, v22
  v_mfma_f32_16x16x32_bf16 v[196:199], a[212:215], v[72:75], v[196:199]
  v_xor_b32 v9, 128, v5
  v_max_f32 v17, v17, v22
  v_mul_f32 v17, s51, v17
  v_mfma_f32_16x16x32_bf16 v[212:215], a[212:215], v[104:107], v[212:215]
  ds_read_b128 a[208:211], v9 offset:256
  v_max3_f32 v25, v160, v161, v162
  v_max3_f32 v26, v163, v164, v165
  v_max3_f32 v27, v166, v167, v168
  s_waitcnt lgkmcnt(6)
  v_mfma_f32_16x16x32_bf16 v[176:179], a[216:219], v[44:47], v[176:179]
  v_max3_f32 v25, v25, v169, v170
  v_max3_f32 v26, v26, v171, v172
  v_mfma_f32_16x16x32_bf16 v[192:195], a[216:219], v[76:79], v[192:195]
  v_max3_f32 v27, v27, v173, v174
  v_max3_f32 v25, v25, v26, v175
  v_max_f32 v18, v25, v27
  v_mfma_f32_16x16x32_bf16 v[208:211], a[216:219], v[108:111], v[208:211]
  ds_read_b128 a[212:215], v9 offset:8448
  v_mov_b32 v25, v18
  s_nop 1
  s_waitcnt lgkmcnt(6)
  v_mfma_f32_16x16x32_bf16 v[180:183], a[220:223], v[44:47], v[180:183]
  v_permlane32_swap_b32 v18, v25
  v_max_f32 v18, v18, v25
  v_mov_b32 v25, v18
  v_mfma_f32_16x16x32_bf16 v[196:199], a[220:223], v[76:79], v[196:199]
  v_xor_b32 v6, 192, v5
  s_nop 1
  v_permlane16_swap_b32 v18, v25
  v_mfma_f32_16x16x32_bf16 v[212:215], a[220:223], v[108:111], v[212:215]
  ds_read_b128 a[216:219], v6 offset:256
  v_max_f32 v18, v18, v25
  v_mul_f32 v18, s51, v18
  v_sub_f32 v19, v16, v10
  s_waitcnt lgkmcnt(6)
  v_mfma_f32_16x16x32_bf16 v[176:179], a[192:195], v[48:51], v[176:179]
  v_sub_f32 v20, v17, v11
  v_sub_f32 v21, v18, v12
  v_mfma_f32_16x16x32_bf16 v[192:195], a[192:195], v[80:83], v[192:195]
  v_max3_f32 v19, v19, v20, v21
  v_cmp_lt_f32 vcc, s52, v19
  s_cbranch_vccnz Lrare_6
Lrare_6_ret:
  v_mfma_f32_16x16x32_bf16 v[208:211], a[192:195], v[112:115], v[208:211]
  ds_read_b128 a[220:223], v6 offset:8448
  v_fma_f32 v128, v128, s51, -v10
  v_fma_f32 v129, v129, s51, -v10
  s_waitcnt lgkmcnt(6)
  v_mfma_f32_16x16x32_bf16 v[180:183], a[196:199], v[48:51], v[180:183]
  s_waitcnt vmcnt(12)
  v_fma_f32 v130, v130, s51, -v10
  v_fma_f32 v131, v131, s51, -v10
  v_fma_f32 v132, v132, s51, -v10
  v_mfma_f32_16x16x32_bf16 v[196:199], a[196:199], v[80:83], v[196:199]
  s_barrier
  v_add_u32 v5, 16384, v2
  v_fma_f32 v133, v133, s51, -v10
  v_fma_f32 v134, v134, s51, -v10
  v_mfma_f32_16x16x32_bf16 v[212:215], a[196:199], v[112:115], v[212:215]
  v_xor_b32 v7, 0, v5
  ds_read_b128 a[192:195], v7 offset:0
  v_fma_f32 v135, v135, s51, -v10
  v_fma_f32 v136, v136, s51, -v10
  v_fma_f32 v137, v137, s51, -v10
  s_waitcnt lgkmcnt(6)
  v_mfma_f32_16x16x32_bf16 v[176:179], a[200:203], v[52:55], v[176:179]
  v_fma_f32 v138, v138, s51, -v10
  v_fma_f32 v139, v139, s51, -v10
  v_mfma_f32_16x16x32_bf16 v[192:195], a[200:203], v[84:87], v[192:195]
  v_fma_f32 v140, v140, s51, -v10
  v_fma_f32 v141, v141, s51, -v10
  v_fma_f32 v142, v142, s51, -v10
  v_mfma_f32_16x16x32_bf16 v[208:211], a[200:203], v[116:119], v[208:211]
  ds_read_b128 a[196:199], v7 offset:8192
  v_fma_f32 v143, v143, s51, -v10
  v_exp_f32 v128, v128
  s_waitcnt lgkmcnt(6)
  v_mfma_f32_16x16x32_bf16 v[180:183], a[204:207], v[52:55], v[180:183]
  v_exp_f32 v129, v129
  v_exp_f32 v130, v130
  v_exp_f32 v131, v131
  v_mfma_f32_16x16x32_bf16 v[196:199], a[204:207], v[84:87], v[196:199]
  v_xor_b32 v8, 64, v5
  v_exp_f32 v132, v132
  v_exp_f32 v133, v133
  v_mfma_f32_16x16x32_bf16 v[212:215], a[204:207], v[116:119], v[212:215]
  ds_read_b128 a[200:203], v8 offset:0
  v_exp_f32 v134, v134
  v_exp_f32 v135, v135
  v_exp_f32 v136, v136
  s_waitcnt lgkmcnt(6)
  v_mfma_f32_16x16x32_bf16 v[176:179], a[208:211], v[56:59], v[176:179]
  v_exp_f32 v137, v137
  v_exp_f32 v138, v138
  v_mfma_f32_16x16x32_bf16 v[192:195], a[208:211], v[88:91], v[192:195]
  v_exp_f32 v139, v139
  v_exp_f32 v140, v140
  v_exp_f32 v141, v141
  v_mfma_f32_16x16x32_bf16 v[208:211], a[208:211], v[120:123], v[208:211]
  ds_read_b128 a[204:207], v8 offset:8192
  v_exp_f32 v142, v142
  v_exp_f32 v143, v143
  s_waitcnt lgkmcnt(6)
  v_mfma_f32_16x16x32_bf16 v[180:183], a[212:215], v[56:59], v[180:183]
  v_fma_f32 v144, v144, s51, -v11
  v_fma_f32 v145, v145, s51, -v11
  v_fma_f32 v146, v146, s51, -v11
  v_mfma_f32_16x16x32_bf16 v[196:199], a[212:215], v[88:91], v[196:199]
  v_xor_b32 v9, 128, v5
  v_fma_f32 v147, v147, s51, -v11
  v_fma_f32 v148, v148, s51, -v11
  v_mfma_f32_16x16x32_bf16 v[212:215], a[212:215], v[120:123], v[212:215]
  ds_read_b128 a[208:211], v9 offset:0
  v_fma_f32 v149, v149, s51, -v11
  v_fma_f32 v150, v150, s51, -v11
  v_fma_f32 v151, v151, s51, -v11
  s_waitcnt lgkmcnt(6)
  v_mfma_f32_16x16x32_bf16 v[176:179], a[216:219], v[60:63], v[176:179]
  v_fma_f32 v152, v152, s51, -v11
  v_fma_f32 v153, v153, s51, -v11
  v_mfma_f32_16x16x32_bf16 v[192:195], a[216:219], v[92:95], v[192:195]
  v_fma_f32 v154, v154, s51, -v11
  v_fma_f32 v155, v155, s51, -v11
  v_fma_f32 v156, v156, s51, -v11
  v_mfma_f32_16x16x32_bf16 v[208:211], a[216:219], v[124:127], v[208:211]
  ds_read_b128 a[212:215], v9 offset:8192
  v_fma_f32 v157, v157, s51, -v11
  v_fma_f32 v158, v158, s51, -v11
  s_waitcnt lgkmcnt(6)
  v_mfma_f32_16x16x32_bf16 v[180:183], a[220:223], v[60:63], v[180:183]
  v_fma_f32 v159, v159, s51, -v11
  v_exp_f32 v144, v144
  v_exp_f32 v145, v145
  v_mfma_f32_16x16x32_bf16 v[196:199], a[220:223], v[92:95], v[196:199]
  v_xor_b32 v6, 192, v5
  v_exp_f32 v146, v146
  v_exp_f32 v147, v147
  v_mfma_f32_16x16x32_bf16 v[212:215], a[220:223], v[124:127], v[212:215]
  ds_read_b128 a[216:219], v6 offset:0
  v_exp_f32 v148, v148
  v_exp_f32 v149, v149
  v_exp_f32 v150, v150
  s_waitcnt lgkmcnt(6)
  v_mfma_f32_16x16x32_bf16 v[184:187], a[192:195], v[32:35], 0
  v_mfma_f32_16x16x32_bf16 v[200:203], a[192:195], v[64:67], 0
  v_mfma_f32_16x16x32_bf16 v[216:219], a[192:195], v[96:99], 0
  ds_read_b128 a[220:223], v6 offset:8192
  s_waitcnt lgkmcnt(6)
  v_mfma_f32_16x16x32_bf16 v[188:191], a[196:199], v[32:35], 0
  v_exp_f32 v151, v151
  v_exp_f32 v152, v152
  v_mfma_f32_16x16x32_bf16 v[204:207], a[196:199], v[64:67], 0
  v_xor_b32 v7, 0, v5
  v_exp_f32 v153, v153
  v_exp_f32 v154, v154
  v_exp_f32 v155, v155
  v_mfma_f32_16x16x32_bf16 v[220:223], a[196:199], v[96:99], 0
  ds_read_b128 a[192:195], v7 offset:256
  v_exp_f32 v156, v156
  v_exp_f32 v157, v157
  s_waitcnt lgkmcnt(6)
  v_mfma_f32_16x16x32_bf16 v[184:187], a[200:203], v[36:39], v[184:187]
  v_exp_f32 v158, v158
  v_exp_f32 v159, v159
  v_fma_f32 v160, v160, s51, -v12
  v_mfma_f32_16x16x32_bf16 v[200:203], a[200:203], v[68:71], v[200:203]
  v_fma_f32 v161, v161, s51, -v12
  v_fma_f32 v162, v162, s51, -v12
  v_mfma_f32_16x16x32_bf16 v[216:219], a[200:203], v[100:103], v[216:219]
  ds_read_b128 a[196:199], v7 offset:8448
  v_fma_f32 v163, v163, s51, -v12
  v_fma_f32 v164, v164, s51, -v12
  v_fma_f32 v165, v165, s51, -v12
  s_waitcnt lgkmcnt(6)
  v_mfma_f32_16x16x32_bf16 v[188:191], a[204:207], v[36:39], v[188:191]
  v_fma_f32 v166, v166, s51, -v12
  v_fma_f32 v167, v167, s51, -v12
  v_mfma_f32_16x16x32_bf16 v[204:207], a[204:207], v[68:71], v[204:207]
  v_xor_b32 v8, 64, v5
  v_fma_f32 v168, v168, s51, -v12
  v_fma_f32 v169, v169, s51, -v12
  v_fma_f32 v170, v170, s51, -v12
  v_mfma_f32_16x16x32_bf16 v[220:223], a[204:207], v[100:103], v[220:223]
  ds_read_b128 a[200:203], v8 offset:256
  v_fma_f32 v171, v171, s51, -v12
  v_fma_f32 v172, v172, s51, -v12
  s_waitcnt lgkmcnt(6)
  v_mfma_f32_16x16x32_bf16 v[184:187], a[208:211], v[40:43], v[184:187]
  v_fma_f32 v173, v173, s51, -v12
  v_fma_f32 v174, v174, s51, -v12
  v_fma_f32 v175, v175, s51, -v12
  v_mfma_f32_16x16x32_bf16 v[200:203], a[208:211], v[72:75], v[200:203]
  v_exp_f32 v160, v160
  v_exp_f32 v161, v161
  v_mfma_f32_16x16x32_bf16 v[216:219], a[208:211], v[104:107], v[216:219]
  ds_read_b128 a[204:207], v8 offset:8448
  v_exp_f32 v162, v162
  v_exp_f32 v163, v163
  v_exp_f32 v164, v164
  s_waitcnt lgkmcnt(6)
  v_mfma_f32_16x16x32_bf16 v[188:191], a[212:215], v[40:43], v[188:191]
  v_exp_f32 v165, v165
  v_exp_f32 v166, v166
  v_mfma_f32_16x16x32_bf16 v[204:207], a[212:215], v[72:75], v[204:207]
  v_xor_b32 v9, 128, v5
  v_exp_f32 v167, v167
  v_exp_f32 v168, v168
  v_exp_f32 v169, v169
  v_mfma_f32_16x16x32_bf16 v[220:223], a[212:215], v[104:107], v[220:223]
  ds_read_b128 a[208:211], v9 offset:256
  v_exp_f32 v170, v170
  v_exp_f32 v171, v171
  s_waitcnt lgkmcnt(6)
  v_mfma_f32_16x16x32_bf16 v[184:187], a[216:219], v[44:47], v[184:187]
  v_exp_f32 v172, v172
  v_exp_f32 v173, v173
  v_exp_f32 v174, v174
  v_mfma_f32_16x16x32_bf16 v[200:203], a[216:219], v[76:79], v[200:203]
  v_exp_f32 v175, v175
  v_add_f32 v19, v128, v129
  v_mfma_f32_16x16x32_bf16 v[216:219], a[216:219], v[108:111], v[216:219]
  ds_read_b128 a[212:215], v9 offset:8448
  v_add_f32 v20, v130, v131
  v_add_f32 v19, v19, v132
  v_add_f32 v20, v20, v133
  s_waitcnt lgkmcnt(6)
  v_mfma_f32_16x16x32_bf16 v[188:191], a[220:223], v[44:47], v[188:191]
  v_add_f32 v19, v19, v134
  v_add_f32 v20, v20, v135
  v_mfma_f32_16x16x32_bf16 v[204:207], a[220:223], v[76:79], v[204:207]
  v_xor_b32 v6, 192, v5
  v_add_f32 v19, v19, v136
  v_add_f32 v20, v20, v137
  v_add_f32 v19, v19, v138
  v_mfma_f32_16x16x32_bf16 v[220:223], a[220:223], v[108:111], v[220:223]
  ds_read_b128 a[216:219], v6 offset:256
  v_add_f32 v20, v20, v139
  v_add_f32 v19, v19, v140
  s_waitcnt lgkmcnt(6)
  v_mfma_f32_16x16x32_bf16 v[184:187], a[192:195], v[48:51], v[184:187]
  v_add_f32 v20, v20, v141
  v_add_f32 v19, v19, v142
  v_add_f32 v20, v20, v143
  v_mfma_f32_16x16x32_bf16 v[200:203], a[192:195], v[80:83], v[200:203]
  v_add_f32 v19, v19, v20
  v_add_f32 v13, v13, v19
  v_mfma_f32_16x16x32_bf16 v[216:219], a[192:195], v[112:115], v[216:219]
  ds_read_b128 a[220:223], v6 offset:8448
  v_add_f32 v22, v144, v145
  v_add_f32 v23, v146, v147
  v_add_f32 v22, v22, v148
  s_waitcnt lgkmcnt(6)
  v_mfma_f32_16x16x32_bf16 v[188:191], a[196:199], v[48:51], v[188:191]
  s_waitcnt vmcnt(9)
  s_barrier
  v_add_f32 v23, v23, v149
  v_add_f32 v22, v22, v150
  v_mfma_f32_16x16x32_bf16 v[204:207], a[196:199], v[80:83], v[204:207]
  v_add_u32 v5, 32768, v3
  v_xor_b32 v7, 0, v5
  v_add_f32 v23, v23, v151
  v_add_f32 v22, v22, v152
  v_add_f32 v23, v23, v153
  v_mfma_f32_16x16x32_bf16 v[220:223], a[196:199], v[112:115], v[220:223]
  ds_read_b64_tr_b16 a[192:193], v7 offset:0
  ds_read_b64_tr_b16 a[194:195], v7 offset:8192
  v_add_f32 v22, v22, v154
  v_add_f32 v23, v23, v155
  s_waitcnt lgkmcnt(7)
  v_mfma_f32_16x16x32_bf16 v[184:187], a[200:203], v[52:55], v[184:187]
  v_xor_b32 v8, 32, v5
  v_add_f32 v22, v22, v156
  v_add_f32 v23, v23, v157
  v_add_f32 v22, v22, v158
  v_mfma_f32_16x16x32_bf16 v[200:203], a[200:203], v[84:87], v[200:203]
  ds_read_b64_tr_b16 a[196:197], v8 offset:0
  v_add_f32 v23, v23, v159
  v_add_f32 v22, v22, v23
  v_mfma_f32_16x16x32_bf16 v[216:219], a[200:203], v[116:119], v[216:219]
  ds_read_b64_tr_b16 a[198:199], v8 offset:8192
  v_add_f32 v14, v14, v22
  v_add_f32 v25, v160, v161
  v_add_f32 v26, v162, v163
  s_waitcnt lgkmcnt(8)
  v_mfma_f32_16x16x32_bf16 v[188:191], a[204:207], v[52:55], v[188:191]
  v_xor_b32 v9, 64, v5
  v_add_f32 v25, v25, v164
  v_add_f32 v26, v26, v165
  v_mfma_f32_16x16x32_bf16 v[204:207], a[204:207], v[84:87], v[204:207]
  ds_read_b64_tr_b16 a[200:201], v9 offset:0
  v_add_f32 v25, v25, v166
  v_add_f32 v26, v26, v167
  v_add_f32 v25, v25, v168
  v_mfma_f32_16x16x32_bf16 v[220:223], a[204:207], v[116:119], v[220:223]
  ds_read_b64_tr_b16 a[202:203], v9 offset:8192
  v_add_f32 v26, v26, v169
  v_add_f32 v25, v25, v170
  s_waitcnt lgkmcnt(9)
  v_mfma_f32_16x16x32_bf16 v[184:187], a[208:211], v[56:59], v[184:187]
  v_xor_b32 v6, 96, v5
  v_add_f32 v26, v26, v171
  v_add_f32 v25, v25, v172
  v_add_f32 v26, v26, v173
  v_mfma_f32_16x16x32_bf16 v[200:203], a[208:211], v[88:91], v[200:203]
  ds_read_b64_tr_b16 a[204:205], v6 offset:0
  v_add_f32 v25, v25, v174
  v_add_f32 v26, v26, v175
  v_mfma_f32_16x16x32_bf16 v[216:219], a[208:211], v[120:123], v[216:219]
  ds_read_b64_tr_b16 a[206:207], v6 offset:8192
  v_add_f32 v25, v25, v26
  v_add_f32 v15, v15, v25
  v_cvt_pk_bf16_f32 v224, v128, v129
  s_waitcnt lgkmcnt(10)
  v_mfma_f32_16x16x32_bf16 v[188:191], a[212:215], v[56:59], v[188:191]
  v_xor_b32 v7, 128, v5
  v_cvt_pk_bf16_f32 v225, v130, v131
  v_cvt_pk_bf16_f32 v226, v132, v133
  v_mfma_f32_16x16x32_bf16 v[204:207], a[212:215], v[88:91], v[204:207]
  ds_read_b64_tr_b16 a[208:209], v7 offset:0
  v_cvt_pk_bf16_f32 v227, v134, v135
  v_cvt_pk_bf16_f32 v228, v136, v137
  v_cvt_pk_bf16_f32 v229, v138, v139
  v_mfma_f32_16x16x32_bf16 v[220:223], a[212:215], v[120:123], v[220:223]
  ds_read_b64_tr_b16 a[210:211], v7 offset:8192
  v_cvt_pk_bf16_f32 v230, v140, v141
  v_cvt_pk_bf16_f32 v231, v142, v143
  s_waitcnt lgkmcnt(11)
  v_mfma_f32_16x16x32_bf16 v[184:187], a[216:219], v[60:63], v[184:187]
  v_xor_b32 v8, 160, v5
  v_cvt_pk_bf16_f32 v232, v144, v145
  v_cvt_pk_bf16_f32 v233, v146, v147
  v_cvt_pk_bf16_f32 v234, v148, v149
  v_mfma_f32_16x16x32_bf16 v[200:203], a[216:219], v[92:95], v[200:203]
  ds_read_b64_tr_b16 a[212:213], v8 offset:0
  v_cvt_pk_bf16_f32 v235, v150, v151
  v_cvt_pk_bf16_f32 v236, v152, v153
  v_mfma_f32_16x16x32_bf16 v[216:219], a[216:219], v[124:127], v[216:219]
  ds_read_b64_tr_b16 a[214:215], v8 offset:8192
  v_cvt_pk_bf16_f32 v237, v154, v155
  v_cvt_pk_bf16_f32 v238, v156, v157
  v_cvt_pk_bf16_f32 v239, v158, v159
  s_waitcnt lgkmcnt(12)
  v_mfma_f32_16x16x32_bf16 v[188:191], a[220:223], v[60:63], v[188:191]
  v_xor_b32 v9, 192, v5
  v_cvt_pk_bf16_f32 v240, v160, v161
  v_cvt_pk_bf16_f32 v241, v162, v163
  v_mfma_f32_16x16x32_bf16 v[204:207], a[220:223], v[92:95], v[204:207]
  ds_read_b64_tr_b16 a[216:217], v9 offset:0
  v_cvt_pk_bf16_f32 v242, v164, v165
  v_cvt_pk_bf16_f32 v243, v166, v167
  v_cvt_pk_bf16_f32 v244, v168, v169
  v_mfma_f32_16x16x32_bf16 v[220:223], a[220:223], v[124:127], v[220:223]
  ds_read_b64_tr_b16 a[218:219], v9 offset:8192
  v_cvt_pk_bf16_f32 v245, v170, v171
  v_cvt_pk_bf16_f32 v246, v172, v173
  v_cvt_pk_bf16_f32 v247, v174, v175
  s_waitcnt lgkmcnt(12)
  v_mfma_f32_16x16x32_bf16 a[0:3], a[192:195], v[224:227], a[0:3]
  v_xor_b32 v6, 224, v5
  v_mfma_f32_16x16x32_bf16 a[64:67], a[192:195], v[232:235], a[64:67]
  ds_read_b64_tr_b16 a[220:221], v6 offset:0
  v_mfma_f32_16x16x32_bf16 a[128:131], a[192:195], v[240:243], a[128:131]
  ds_read_b64_tr_b16 a[222:223], v6 offset:8192
  s_waitcnt lgkmcnt(12)
  v_mfma_f32_16x16x32_bf16 a[4:7], a[196:199], v[224:227], a[4:7]
  v_xor_b32 v7, 0, v5
  v_mfma_f32_16x16x32_bf16 a[68:71], a[196:199], v[232:235], a[68:71]
  ds_read_b64_tr_b16 a[192:193], v7 offset:256
  v_mfma_f32_16x16x32_bf16 a[132:135], a[196:199], v[240:243], a[132:135]
  ds_read_b64_tr_b16 a[194:195], v7 offset:8448
  s_waitcnt lgkmcnt(12)
  v_mfma_f32_16x16x32_bf16 a[8:11], a[200:203], v[224:227], a[8:11]
  v_xor_b32 v8, 32, v5
  v_mfma_f32_16x16x32_bf16 a[72:75], a[200:203], v[232:235], a[72:75]
  ds_read_b64_tr_b16 a[196:197], v8 offset:256
  v_mfma_f32_16x16x32_bf16 a[136:139], a[200:203], v[240:243], a[136:139]
  ds_read_b64_tr_b16 a[198:199], v8 offset:8448
  s_waitcnt lgkmcnt(12)
  v_mfma_f32_16x16x32_bf16 a[12:15], a[204:207], v[224:227], a[12:15]
  v_xor_b32 v9, 64, v5
  v_mfma_f32_16x16x32_bf16 a[76:79], a[204:207], v[232:235], a[76:79]
  ds_read_b64_tr_b16 a[200:201], v9 offset:256
  v_mfma_f32_16x16x32_bf16 a[140:143], a[204:207], v[240:243], a[140:143]
  ds_read_b64_tr_b16 a[202:203], v9 offset:8448
  s_waitcnt lgkmcnt(12)
  v_mfma_f32_16x16x32_bf16 a[16:19], a[208:211], v[224:227], a[16:19]
  v_xor_b32 v6, 96, v5
  v_mfma_f32_16x16x32_bf16 a[80:83], a[208:211], v[232:235], a[80:83]
  ds_read_b64_tr_b16 a[204:205], v6 offset:256
  v_mfma_f32_16x16x32_bf16 a[144:147], a[208:211], v[240:243], a[144:147]
  ds_read_b64_tr_b16 a[206:207], v6 offset:8448
  s_waitcnt lgkmcnt(12)
  v_mfma_f32_16x16x32_bf16 a[20:23], a[212:215], v[224:227], a[20:23]
  v_xor_b32 v7, 128, v5
  v_mfma_f32_16x16x32_bf16 a[84:87], a[212:215], v[232:235], a[84:87]
  ds_read_b64_tr_b16 a[208:209], v7 offset:256
  v_mfma_f32_16x16x32_bf16 a[148:151], a[212:215], v[240:243], a[148:151]
  ds_read_b64_tr_b16 a[210:211], v7 offset:8448
  s_waitcnt lgkmcnt(12)
  v_mfma_f32_16x16x32_bf16 a[24:27], a[216:219], v[224:227], a[24:27]
  v_xor_b32 v8, 160, v5
  v_mfma_f32_16x16x32_bf16 a[88:91], a[216:219], v[232:235], a[88:91]
  ds_read_b64_tr_b16 a[212:213], v8 offset:256
  v_mfma_f32_16x16x32_bf16 a[152:155], a[216:219], v[240:243], a[152:155]
  ds_read_b64_tr_b16 a[214:215], v8 offset:8448
  s_waitcnt lgkmcnt(12)
  v_mfma_f32_16x16x32_bf16 a[28:31], a[220:223], v[224:227], a[28:31]
  v_xor_b32 v9, 192, v5
  v_mfma_f32_16x16x32_bf16 a[92:95], a[220:223], v[232:235], a[92:95]
  ds_read_b64_tr_b16 a[216:217], v9 offset:256
  v_mfma_f32_16x16x32_bf16 a[156:159], a[220:223], v[240:243], a[156:159]
  ds_read_b64_tr_b16 a[218:219], v9 offset:8448
  s_waitcnt lgkmcnt(12)
  v_mfma_f32_16x16x32_bf16 a[32:35], a[192:195], v[224:227], a[32:35]
  v_xor_b32 v6, 224, v5
  v_mfma_f32_16x16x32_bf16 a[96:99], a[192:195], v[232:235], a[96:99]
  ds_read_b64_tr_b16 a[220:221], v6 offset:256
  v_mfma_f32_16x16x32_bf16 a[160:163], a[192:195], v[240:243], a[160:163]
  ds_read_b64_tr_b16 a[222:223], v6 offset:8448
  s_waitcnt lgkmcnt(12)
  v_mfma_f32_16x16x32_bf16 a[36:39], a[196:199], v[224:227], a[36:39]
  s_waitcnt vmcnt(6)
  s_barrier
  v_mfma_f32_16x16x32_bf16 a[100:103], a[196:199], v[232:235], a[100:103]
  v_add_u32 v5, 49152, v3
  v_xor_b32 v7, 0, v5
  v_mfma_f32_16x16x32_bf16 a[164:167], a[196:199], v[240:243], a[164:167]
  ds_read_b64_tr_b16 a[192:193], v7 offset:0
  ds_read_b64_tr_b16 a[194:195], v7 offset:8192
  s_waitcnt lgkmcnt(12)
  v_mfma_f32_16x16x32_bf16 a[40:43], a[200:203], v[224:227], a[40:43]
  v_xor_b32 v8, 32, v5
  v_mfma_f32_16x16x32_bf16 a[104:107], a[200:203], v[232:235], a[104:107]
  ds_read_b64_tr_b16 a[196:197], v8 offset:0
  v_mfma_f32_16x16x32_bf16 a[168:171], a[200:203], v[240:243], a[168:171]
  ds_read_b64_tr_b16 a[198:199], v8 offset:8192
  s_waitcnt lgkmcnt(12)
  v_mfma_f32_16x16x32_bf16 a[44:47], a[204:207], v[224:227], a[44:47]
  v_xor_b32 v9, 64, v5
  v_mfma_f32_16x16x32_bf16 a[108:111], a[204:207], v[232:235], a[108:111]
  ds_read_b64_tr_b16 a[200:201], v9 offset:0
  v_mfma_f32_16x16x32_bf16 a[172:175], a[204:207], v[240:243], a[172:175]
  ds_read_b64_tr_b16 a[202:203], v9 offset:8192
  s_waitcnt lgkmcnt(12)
  v_mfma_f32_16x16x32_bf16 a[48:51], a[208:211], v[224:227], a[48:51]
  v_xor_b32 v6, 96, v5
  v_mfma_f32_16x16x32_bf16 a[112:115], a[208:211], v[232:235], a[112:115]
  ds_read_b64_tr_b16 a[204:205], v6 offset:0
  v_mfma_f32_16x16x32_bf16 a[176:179], a[208:211], v[240:243], a[176:179]
  ds_read_b64_tr_b16 a[206:207], v6 offset:8192
  s_waitcnt lgkmcnt(12)
  v_mfma_f32_16x16x32_bf16 a[52:55], a[212:215], v[224:227], a[52:55]
  v_xor_b32 v7, 128, v5
  v_mfma_f32_16x16x32_bf16 a[116:119], a[212:215], v[232:235], a[116:119]
  ds_read_b64_tr_b16 a[208:209], v7 offset:0
  v_mfma_f32_16x16x32_bf16 a[180:183], a[212:215], v[240:243], a[180:183]
  ds_read_b64_tr_b16 a[210:211], v7 offset:8192
  s_waitcnt lgkmcnt(12)
  v_mfma_f32_16x16x32_bf16 a[56:59], a[216:219], v[224:227], a[56:59]
  v_xor_b32 v8, 160, v5
  v_mfma_f32_16x16x32_bf16 a[120:123], a[216:219], v[232:235], a[120:123]
  ds_read_b64_tr_b16 a[212:213], v8 offset:0
  v_mfma_f32_16x16x32_bf16 a[184:187], a[216:219], v[240:243], a[184:187]
  ds_read_b64_tr_b16 a[214:215], v8 offset:8192
  s_waitcnt lgkmcnt(12)
  v_mfma_f32_16x16x32_bf16 a[60:63], a[220:223], v[224:227], a[60:63]
  v_xor_b32 v9, 192, v5
  v_mfma_f32_16x16x32_bf16 a[124:127], a[220:223], v[232:235], a[124:127]
  ds_read_b64_tr_b16 a[216:217], v9 offset:0
  v_mfma_f32_16x16x32_bf16 a[188:191], a[220:223], v[240:243], a[188:191]
  ds_read_b64_tr_b16 a[218:219], v9 offset:8192
  s_waitcnt lgkmcnt(12)
  v_mfma_f32_16x16x32_bf16 a[0:3], a[192:195], v[228:231], a[0:3]
  v_xor_b32 v6, 224, v5
  v_mfma_f32_16x16x32_bf16 a[64:67], a[192:195], v[236:239], a[64:67]
  ds_read_b64_tr_b16 a[220:221], v6 offset:0
  v_mfma_f32_16x16x32_bf16 a[128:131], a[192:195], v[244:247], a[128:131]
  ds_read_b64_tr_b16 a[222:223], v6 offset:8192
  s_waitcnt lgkmcnt(12)
  v_mfma_f32_16x16x32_bf16 a[4:7], a[196:199], v[228:231], a[4:7]
  v_xor_b32 v7, 0, v5
  v_mfma_f32_16x16x32_bf16 a[68:71], a[196:199], v[236:239], a[68:71]
  ds_read_b64_tr_b16 a[192:193], v7 offset:256
  v_mfma_f32_16x16x32_bf16 a[132:135], a[196:199], v[244:247], a[132:135]
  ds_read_b64_tr_b16 a[194:195], v7 offset:8448
  s_waitcnt lgkmcnt(12)
  v_mfma_f32_16x16x32_bf16 a[8:11], a[200:203], v[228:231], a[8:11]
  v_xor_b32 v8, 32, v5
  v_mfma_f32_16x16x32_bf16 a[72:75], a[200:203], v[236:239], a[72:75]
  ds_read_b64_tr_b16 a[196:197], v8 offset:256
  v_mfma_f32_16x16x32_bf16 a[136:139], a[200:203], v[244:247], a[136:139]
  ds_read_b64_tr_b16 a[198:199], v8 offset:8448
  s_waitcnt lgkmcnt(12)
  v_mfma_f32_16x16x32_bf16 a[12:15], a[204:207], v[228:231], a[12:15]
  v_xor_b32 v9, 64, v5
  v_mfma_f32_16x16x32_bf16 a[76:79], a[204:207], v[236:239], a[76:79]
  ds_read_b64_tr_b16 a[200:201], v9 offset:256
  v_mfma_f32_16x16x32_bf16 a[140:143], a[204:207], v[244:247], a[140:143]
  ds_read_b64_tr_b16 a[202:203], v9 offset:8448
  s_waitcnt lgkmcnt(12)
  v_mfma_f32_16x16x32_bf16 a[16:19], a[208:211], v[228:231], a[16:19]
  v_xor_b32 v6, 96, v5
  v_mfma_f32_16x16x32_bf16 a[80:83], a[208:211], v[236:239], a[80:83]
  ds_read_b64_tr_b16 a[204:205], v6 offset:256
  v_mfma_f32_16x16x32_bf16 a[144:147], a[208:211], v[244:247], a[144:147]
  ds_read_b64_tr_b16 a[206:207], v6 offset:8448
  s_waitcnt lgkmcnt(12)
  v_mfma_f32_16x16x32_bf16 a[20:23], a[212:215], v[228:231], a[20:23]
  v_xor_b32 v7, 128, v5
  v_mfma_f32_16x16x32_bf16 a[84:87], a[212:215], v[236:239], a[84:87]
  ds_read_b64_tr_b16 a[208:209], v7 offset:256
  v_mfma_f32_16x16x32_bf16 a[148:151], a[212:215], v[244:247], a[148:151]
  ds_read_b64_tr_b16 a[210:211], v7 offset:8448
  s_waitcnt lgkmcnt(12)
  v_mfma_f32_16x16x32_bf16 a[24:27], a[216:219], v[228:231], a[24:27]
  v_xor_b32 v8, 160, v5
  v_mfma_f32_16x16x32_bf16 a[88:91], a[216:219], v[236:239], a[88:91]
  ds_read_b64_tr_b16 a[212:213], v8 offset:256
  v_mfma_f32_16x16x32_bf16 a[152:155], a[216:219], v[244:247], a[152:155]
  ds_read_b64_tr_b16 a[214:215], v8 offset:8448
  s_waitcnt lgkmcnt(12)
  v_mfma_f32_16x16x32_bf16 a[28:31], a[220:223], v[228:231], a[28:31]
  v_xor_b32 v9, 192, v5
  v_mfma_f32_16x16x32_bf16 a[92:95], a[220:223], v[236:239], a[92:95]
  ds_read_b64_tr_b16 a[216:217], v9 offset:256
  v_mfma_f32_16x16x32_bf16 a[156:159], a[220:223], v[244:247], a[156:159]
  ds_read_b64_tr_b16 a[218:219], v9 offset:8448
  s_waitcnt lgkmcnt(12)
  v_mfma_f32_16x16x32_bf16 a[32:35], a[192:195], v[228:231], a[32:35]
  v_xor_b32 v6, 224, v5
  v_mfma_f32_16x16x32_bf16 a[96:99], a[192:195], v[236:239], a[96:99]
  ds_read_b64_tr_b16 a[220:221], v6 offset:256
  v_mfma_f32_16x16x32_bf16 a[160:163], a[192:195], v[244:247], a[160:163]
  ds_read_b64_tr_b16 a[222:223], v6 offset:8448
  s_waitcnt lgkmcnt(12)
  v_mfma_f32_16x16x32_bf16 a[36:39], a[196:199], v[228:231], a[36:39]
  s_waitcnt vmcnt(3)
  s_barrier
  v_mfma_f32_16x16x32_bf16 a[100:103], a[196:199], v[236:239], a[100:103]
  v_add_u32 v5, 65536, v3
  v_xor_b32 v7, 0, v5
  v_mfma_f32_16x16x32_bf16 a[164:167], a[196:199], v[244:247], a[164:167]
  ds_read_b64_tr_b16 a[192:193], v7 offset:0
  ds_read_b64_tr_b16 a[194:195], v7 offset:8192
  s_waitcnt lgkmcnt(12)
  v_mfma_f32_16x16x32_bf16 a[40:43], a[200:203], v[228:231], a[40:43]
  v_xor_b32 v8, 32, v5
  v_mfma_f32_16x16x32_bf16 a[104:107], a[200:203], v[236:239], a[104:107]
  ds_read_b64_tr_b16 a[196:197], v8 offset:0
  v_mfma_f32_16x16x32_bf16 a[168:171], a[200:203], v[244:247], a[168:171]
  ds_read_b64_tr_b16 a[198:199], v8 offset:8192
  s_waitcnt lgkmcnt(12)
  v_mfma_f32_16x16x32_bf16 a[44:47], a[204:207], v[228:231], a[44:47]
  v_xor_b32 v9, 64, v5
  v_mfma_f32_16x16x32_bf16 a[108:111], a[204:207], v[236:239], a[108:111]
  ds_read_b64_tr_b16 a[200:201], v9 offset:0
  v_mfma_f32_16x16x32_bf16 a[172:175], a[204:207], v[244:247], a[172:175]
  ds_read_b64_tr_b16 a[202:203], v9 offset:8192
  s_waitcnt lgkmcnt(12)
  v_mfma_f32_16x16x32_bf16 a[48:51], a[208:211], v[228:231], a[48:51]
  v_xor_b32 v6, 96, v5
  v_mfma_f32_16x16x32_bf16 a[112:115], a[208:211], v[236:239], a[112:115]
  ds_read_b64_tr_b16 a[204:205], v6 offset:0
  v_mfma_f32_16x16x32_bf16 a[176:179], a[208:211], v[244:247], a[176:179]
  ds_read_b64_tr_b16 a[206:207], v6 offset:8192
  s_waitcnt lgkmcnt(12)
  v_mfma_f32_16x16x32_bf16 a[52:55], a[212:215], v[228:231], a[52:55]
  v_xor_b32 v7, 128, v5
  v_mfma_f32_16x16x32_bf16 a[116:119], a[212:215], v[236:239], a[116:119]
  ds_read_b64_tr_b16 a[208:209], v7 offset:0
  v_mfma_f32_16x16x32_bf16 a[180:183], a[212:215], v[244:247], a[180:183]
  ds_read_b64_tr_b16 a[210:211], v7 offset:8192
  s_waitcnt lgkmcnt(12)
  v_mfma_f32_16x16x32_bf16 a[56:59], a[216:219], v[228:231], a[56:59]
  v_xor_b32 v8, 160, v5
  v_mfma_f32_16x16x32_bf16 a[120:123], a[216:219], v[236:239], a[120:123]
  ds_read_b64_tr_b16 a[212:213], v8 offset:0
  v_mfma_f32_16x16x32_bf16 a[184:187], a[216:219], v[244:247], a[184:187]
  ds_read_b64_tr_b16 a[214:215], v8 offset:8192
  s_waitcnt lgkmcnt(12)
  v_mfma_f32_16x16x32_bf16 a[60:63], a[220:223], v[228:231], a[60:63]
  v_xor_b32 v9, 192, v5
  v_mfma_f32_16x16x32_bf16 a[124:127], a[220:223], v[236:239], a[124:127]
  ds_read_b64_tr_b16 a[216:217], v9 offset:0
  v_mfma_f32_16x16x32_bf16 a[188:191], a[220:223], v[244:247], a[188:191]
  ds_read_b64_tr_b16 a[218:219], v9 offset:8192
  s_nop 7
  v_max3_f32 v19, v176, v177, v178
  v_max3_f32 v20, v179, v180, v181
  v_max3_f32 v21, v182, v183, v184
  v_max3_f32 v19, v19, v185, v186
  v_max3_f32 v20, v20, v187, v188
  v_max3_f32 v21, v21, v189, v190
  v_max3_f32 v19, v19, v20, v191
  v_max_f32 v16, v19, v21
  v_mov_b32 v19, v16
  s_nop 1
  v_permlane32_swap_b32 v16, v19
  v_max_f32 v16, v16, v19
  v_mov_b32 v19, v16
  s_nop 1
  v_permlane16_swap_b32 v16, v19
  v_max_f32 v16, v16, v19
  v_mul_f32 v16, s51, v16
  v_max3_f32 v22, v192, v193, v194
  v_max3_f32 v23, v195, v196, v197
  v_max3_f32 v24, v198, v199, v200
  v_max3_f32 v22, v22, v201, v202
  v_max3_f32 v23, v23, v203, v204
  v_max3_f32 v24, v24, v205, v206
  v_max3_f32 v22, v22, v23, v207
  v_max_f32 v17, v22, v24
  v_mov_b32 v22, v17
  s_nop 1
  v_permlane32_swap_b32 v17, v22
  v_max_f32 v17, v17, v22
  v_mov_b32 v22, v17
  s_nop 1
  v_permlane16_swap_b32 v17, v22
  v_max_f32 v17, v17, v22
  v_mul_f32 v17, s51, v17
  v_max3_f32 v25, v208, v209, v210
  v_max3_f32 v26, v211, v212, v213
  v_max3_f32 v27, v214, v215, v216
  v_max3_f32 v25, v25, v217, v218
  v_max3_f32 v26, v26, v219, v220
  v_max3_f32 v27, v27, v221, v222
  v_max3_f32 v25, v25, v26, v223
  v_max_f32 v18, v25, v27
  v_mov_b32 v25, v18
  s_nop 1
  v_permlane32_swap_b32 v18, v25
  v_max_f32 v18, v18, v25
  v_mov_b32 v25, v18
  s_nop 1
  v_permlane16_swap_b32 v18, v25
  v_max_f32 v18, v18, v25
  v_mul_f32 v18, s51, v18
  v_sub_f32 v19, v16, v10
  v_sub_f32 v20, v17, v11
  v_sub_f32 v21, v18, v12
  v_max3_f32 v19, v19, v20, v21
  v_cmp_lt_f32 vcc, s52, v19
  s_cbranch_vccnz Lrare_7
Lrare_7_ret:
  v_fma_f32 v176, v176, s51, -v10
  v_fma_f32 v177, v177, s51, -v10
  v_fma_f32 v178, v178, s51, -v10
  v_fma_f32 v179, v179, s51, -v10
  v_fma_f32 v180, v180, s51, -v10
  v_fma_f32 v181, v181, s51, -v10
  v_fma_f32 v182, v182, s51, -v10
  v_fma_f32 v183, v183, s51, -v10
  v_fma_f32 v184, v184, s51, -v10
  v_fma_f32 v185, v185, s51, -v10
  v_fma_f32 v186, v186, s51, -v10
  v_fma_f32 v187, v187, s51, -v10
  v_fma_f32 v188, v188, s51, -v10
  v_fma_f32 v189, v189, s51, -v10
  v_fma_f32 v190, v190, s51, -v10
  v_fma_f32 v191, v191, s51, -v10
  v_exp_f32 v176, v176
  v_exp_f32 v177, v177
  v_exp_f32 v178, v178
  v_exp_f32 v179, v179
  v_exp_f32 v180, v180
  v_exp_f32 v181, v181
  v_exp_f32 v182, v182
  v_exp_f32 v183, v183
  v_exp_f32 v184, v184
  v_exp_f32 v185, v185
  v_exp_f32 v186, v186
  v_exp_f32 v187, v187
  v_exp_f32 v188, v188
  v_exp_f32 v189, v189
  v_exp_f32 v190, v190
  v_exp_f32 v191, v191
  v_fma_f32 v192, v192, s51, -v11
  v_fma_f32 v193, v193, s51, -v11
  v_fma_f32 v194, v194, s51, -v11
  v_fma_f32 v195, v195, s51, -v11
  v_fma_f32 v196, v196, s51, -v11
  v_fma_f32 v197, v197, s51, -v11
  v_fma_f32 v198, v198, s51, -v11
  v_fma_f32 v199, v199, s51, -v11
  v_fma_f32 v200, v200, s51, -v11
  v_fma_f32 v201, v201, s51, -v11
  v_fma_f32 v202, v202, s51, -v11
  v_fma_f32 v203, v203, s51, -v11
  v_fma_f32 v204, v204, s51, -v11
  v_fma_f32 v205, v205, s51, -v11
  v_fma_f32 v206, v206, s51, -v11
  v_fma_f32 v207, v207, s51, -v11
  v_exp_f32 v192, v192
  v_exp_f32 v193, v193
  v_exp_f32 v194, v194
  v_exp_f32 v195, v195
  v_exp_f32 v196, v196
  v_exp_f32 v197, v197
  v_exp_f32 v198, v198
  v_exp_f32 v199, v199
  v_exp_f32 v200, v200
  v_exp_f32 v201, v201
  v_exp_f32 v202, v202
  v_exp_f32 v203, v203
  v_exp_f32 v204, v204
  v_exp_f32 v205, v205
  v_exp_f32 v206, v206
  v_exp_f32 v207, v207
  v_fma_f32 v208, v208, s51, -v12
  v_fma_f32 v209, v209, s51, -v12
  v_fma_f32 v210, v210, s51, -v12
  v_fma_f32 v211, v211, s51, -v12
  v_fma_f32 v212, v212, s51, -v12
  v_fma_f32 v213, v213, s51, -v12
  v_fma_f32 v214, v214, s51, -v12
  v_fma_f32 v215, v215, s51, -v12
  v_fma_f32 v216, v216, s51, -v12
  v_fma_f32 v217, v217, s51, -v12
  v_fma_f32 v218, v218, s51, -v12
  v_fma_f32 v219, v219, s51, -v12
  v_fma_f32 v220, v220, s51, -v12
  v_fma_f32 v221, v221, s51, -v12
  v_fma_f32 v222, v222, s51, -v12
  v_fma_f32 v223, v223, s51, -v12
  v_exp_f32 v208, v208
  v_exp_f32 v209, v209
  v_exp_f32 v210, v210
  v_exp_f32 v211, v211
  v_exp_f32 v212, v212
  v_exp_f32 v213, v213
  v_exp_f32 v214, v214
  v_exp_f32 v215, v215
  v_exp_f32 v216, v216
  v_exp_f32 v217, v217
  v_exp_f32 v218, v218
  v_exp_f32 v219, v219
  v_exp_f32 v220, v220
  v_exp_f32 v221, v221
  v_exp_f32 v222, v222
  v_exp_f32 v223, v223
  v_add_f32 v19, v176, v177
  v_add_f32 v20, v178, v179
  v_add_f32 v19, v19, v180
  v_add_f32 v20, v20, v181
  v_add_f32 v19, v19, v182
  v_add_f32 v20, v20, v183
  v_add_f32 v19, v19, v184
  v_add_f32 v20, v20, v185
  v_add_f32 v19, v19, v186
  v_add_f32 v20, v20, v187
  v_add_f32 v19, v19, v188
  v_add_f32 v20, v20, v189
  v_add_f32 v19, v19, v190
  v_add_f32 v20, v20, v191
  v_add_f32 v19, v19, v20
  v_add_f32 v13, v13, v19
  v_add_f32 v22, v192, v193
  v_add_f32 v23, v194, v195
  v_add_f32 v22, v22, v196
  v_add_f32 v23, v23, v197
  v_add_f32 v22, v22, v198
  v_add_f32 v23, v23, v199
  v_add_f32 v22, v22, v200
  v_add_f32 v23, v23, v201
  v_add_f32 v22, v22, v202
  v_add_f32 v23, v23, v203
  v_add_f32 v22, v22, v204
  v_add_f32 v23, v23, v205
  v_add_f32 v22, v22, v206
  v_add_f32 v23, v23, v207
  v_add_f32 v22, v22, v23
  v_add_f32 v14, v14, v22
  v_add_f32 v25, v208, v209
  v_add_f32 v26, v210, v211
  v_add_f32 v25, v25, v212
  v_add_f32 v26, v26, v213
  v_add_f32 v25, v25, v214
  v_add_f32 v26, v26, v215
  v_add_f32 v25, v25, v216
  v_add_f32 v26, v26, v217
  v_add_f32 v25, v25, v218
  v_add_f32 v26, v26, v219
  v_add_f32 v25, v25, v220
  v_add_f32 v26, v26, v221
  v_add_f32 v25, v25, v222
  v_add_f32 v26, v26, v223
  v_add_f32 v25, v25, v26
  v_add_f32 v15, v15, v25
  v_cvt_pk_bf16_f32 v224, v176, v177
  v_cvt_pk_bf16_f32 v225, v178, v179
  v_cvt_pk_bf16_f32 v226, v180, v181
  v_cvt_pk_bf16_f32 v227, v182, v183
  v_cvt_pk_bf16_f32 v228, v184, v185
  v_cvt_pk_bf16_f32 v229, v186, v187
  v_cvt_pk_bf16_f32 v230, v188, v189
  v_cvt_pk_bf16_f32 v231, v190, v191
  v_cvt_pk_bf16_f32 v232, v192, v193
  v_cvt_pk_bf16_f32 v233, v194, v195
  v_cvt_pk_bf16_f32 v234, v196, v197
  v_cvt_pk_bf16_f32 v235, v198, v199
  v_cvt_pk_bf16_f32 v236, v200, v201
  v_cvt_pk_bf16_f32 v237, v202, v203
  v_cvt_pk_bf16_f32 v238, v204, v205
  v_cvt_pk_bf16_f32 v239, v206, v207
  v_cvt_pk_bf16_f32 v240, v208, v209
  v_cvt_pk_bf16_f32 v241, v210, v211
  v_cvt_pk_bf16_f32 v242, v212, v213
  v_cvt_pk_bf16_f32 v243, v214, v215
  v_cvt_pk_bf16_f32 v244, v216, v217
  v_cvt_pk_bf16_f32 v245, v218, v219
  v_cvt_pk_bf16_f32 v246, v220, v221
  v_cvt_pk_bf16_f32 v247, v222, v223
  s_nop 1
  s_waitcnt lgkmcnt(12)
  v_mfma_f32_16x16x32_bf16 a[0:3], a[192:195], v[224:227], a[0:3]
  v_xor_b32 v6, 224, v5
  v_mfma_f32_16x16x32_bf16 a[64:67], a[192:195], v[232:235], a[64:67]
  ds_read_b64_tr_b16 a[220:221], v6 offset:0
  v_mfma_f32_16x16x32_bf16 a[128:131], a[192:195], v[240:243], a[128:131]
  ds_read_b64_tr_b16 a[222:223], v6 offset:8192
  s_waitcnt lgkmcnt(12)
  v_mfma_f32_16x16x32_bf16 a[4:7], a[196:199], v[224:227], a[4:7]
  v_xor_b32 v7, 0, v5
  v_mfma_f32_16x16x32_bf16 a[68:71], a[196:199], v[232:235], a[68:71]
  ds_read_b64_tr_b16 a[192:193], v7 offset:256
  v_mov_b32 v19, v13
  v_mfma_f32_16x16x32_bf16 a[132:135], a[196:199], v[240:243], a[132:135]
  ds_read_b64_tr_b16 a[194:195], v7 offset:8448
  s_nop 1
  s_waitcnt lgkmcnt(12)
  v_mfma_f32_16x16x32_bf16 a[8:11], a[200:203], v[224:227], a[8:11]
  v_xor_b32 v8, 32, v5
  v_permlane32_swap_b32 v13, v19
  v_mfma_f32_16x16x32_bf16 a[72:75], a[200:203], v[232:235], a[72:75]
  ds_read_b64_tr_b16 a[196:197], v8 offset:256
  v_mfma_f32_16x16x32_bf16 a[136:139], a[200:203], v[240:243], a[136:139]
  ds_read_b64_tr_b16 a[198:199], v8 offset:8448
  v_add_f32 v13, v13, v19
  s_waitcnt lgkmcnt(12)
  v_mfma_f32_16x16x32_bf16 a[12:15], a[204:207], v[224:227], a[12:15]
  v_xor_b32 v9, 64, v5
  v_mov_b32 v19, v13
  v_mfma_f32_16x16x32_bf16 a[76:79], a[204:207], v[232:235], a[76:79]
  ds_read_b64_tr_b16 a[200:201], v9 offset:256
  s_nop 1
  v_mfma_f32_16x16x32_bf16 a[140:143], a[204:207], v[240:243], a[140:143]
  ds_read_b64_tr_b16 a[202:203], v9 offset:8448
  v_permlane16_swap_b32 v13, v19
  s_waitcnt lgkmcnt(12)
  v_mfma_f32_16x16x32_bf16 a[16:19], a[208:211], v[224:227], a[16:19]
  v_xor_b32 v6, 96, v5
  v_mfma_f32_16x16x32_bf16 a[80:83], a[208:211], v[232:235], a[80:83]
  ds_read_b64_tr_b16 a[204:205], v6 offset:256
  v_add_f32 v13, v13, v19
  v_mfma_f32_16x16x32_bf16 a[144:147], a[208:211], v[240:243], a[144:147]
  ds_read_b64_tr_b16 a[206:207], v6 offset:8448
  v_rcp_f32 v13, v13
  s_waitcnt lgkmcnt(12)
  v_mfma_f32_16x16x32_bf16 a[20:23], a[212:215], v[224:227], a[20:23]
  v_xor_b32 v7, 128, v5
  v_mov_b32 v22, v14
  v_mfma_f32_16x16x32_bf16 a[84:87], a[212:215], v[232:235], a[84:87]
  ds_read_b64_tr_b16 a[208:209], v7 offset:256
  v_mfma_f32_16x16x32_bf16 a[148:151], a[212:215], v[240:243], a[148:151]
  ds_read_b64_tr_b16 a[210:211], v7 offset:8448
  s_nop 1
  s_waitcnt lgkmcnt(12)
  v_mfma_f32_16x16x32_bf16 a[24:27], a[216:219], v[224:227], a[24:27]
  v_xor_b32 v8, 160, v5
  v_permlane32_swap_b32 v14, v22
  v_mfma_f32_16x16x32_bf16 a[88:91], a[216:219], v[232:235], a[88:91]
  ds_read_b64_tr_b16 a[212:213], v8 offset:256
  v_add_f32 v14, v14, v22
  v_mfma_f32_16x16x32_bf16 a[152:155], a[216:219], v[240:243], a[152:155]
  ds_read_b64_tr_b16 a[214:215], v8 offset:8448
  v_mov_b32 v22, v14
  s_waitcnt lgkmcnt(12)
  v_mfma_f32_16x16x32_bf16 a[28:31], a[220:223], v[224:227], a[28:31]
  v_xor_b32 v9, 192, v5
  v_mfma_f32_16x16x32_bf16 a[92:95], a[220:223], v[232:235], a[92:95]
  ds_read_b64_tr_b16 a[216:217], v9 offset:256
  s_nop 1
  v_mfma_f32_16x16x32_bf16 a[156:159], a[220:223], v[240:243], a[156:159]
  ds_read_b64_tr_b16 a[218:219], v9 offset:8448
  v_permlane16_swap_b32 v14, v22
  s_waitcnt lgkmcnt(12)
  v_mfma_f32_16x16x32_bf16 a[32:35], a[192:195], v[224:227], a[32:35]
  v_xor_b32 v6, 224, v5
  v_add_f32 v14, v14, v22
  v_mfma_f32_16x16x32_bf16 a[96:99], a[192:195], v[232:235], a[96:99]
  ds_read_b64_tr_b16 a[220:221], v6 offset:256
  v_mfma_f32_16x16x32_bf16 a[160:163], a[192:195], v[240:243], a[160:163]
  ds_read_b64_tr_b16 a[222:223], v6 offset:8448
  v_rcp_f32 v14, v14
  s_waitcnt lgkmcnt(12)
  v_mfma_f32_16x16x32_bf16 a[36:39], a[196:199], v[224:227], a[36:39]
  s_waitcnt vmcnt(0)
  s_barrier
  v_mov_b32 v25, v15
  v_mfma_f32_16x16x32_bf16 a[100:103], a[196:199], v[232:235], a[100:103]
  v_add_u32 v5, 81920, v3
  v_xor_b32 v7, 0, v5
  s_nop 1
  v_mfma_f32_16x16x32_bf16 a[164:167], a[196:199], v[240:243], a[164:167]
  ds_read_b64_tr_b16 a[192:193], v7 offset:0
  ds_read_b64_tr_b16 a[194:195], v7 offset:8192
  v_permlane32_swap_b32 v15, v25
  s_waitcnt lgkmcnt(12)
  v_mfma_f32_16x16x32_bf16 a[40:43], a[200:203], v[224:227], a[40:43]
  v_xor_b32 v8, 32, v5
  v_mfma_f32_16x16x32_bf16 a[104:107], a[200:203], v[232:235], a[104:107]
  ds_read_b64_tr_b16 a[196:197], v8 offset:0
  v_add_f32 v15, v15, v25
  v_mfma_f32_16x16x32_bf16 a[168:171], a[200:203], v[240:243], a[168:171]
  ds_read_b64_tr_b16 a[198:199], v8 offset:8192
  v_mov_b32 v25, v15
  s_waitcnt lgkmcnt(12)
  v_mfma_f32_16x16x32_bf16 a[44:47], a[204:207], v[224:227], a[44:47]
  v_xor_b32 v9, 64, v5
  s_nop 1
  v_mfma_f32_16x16x32_bf16 a[108:111], a[204:207], v[232:235], a[108:111]
  ds_read_b64_tr_b16 a[200:201], v9 offset:0
  v_mfma_f32_16x16x32_bf16 a[172:175], a[204:207], v[240:243], a[172:175]
  ds_read_b64_tr_b16 a[202:203], v9 offset:8192
  v_permlane16_swap_b32 v15, v25
  s_waitcnt lgkmcnt(12)
  v_mfma_f32_16x16x32_bf16 a[48:51], a[208:211], v[224:227], a[48:51]
  v_xor_b32 v6, 96, v5
  v_add_f32 v15, v15, v25
  v_mfma_f32_16x16x32_bf16 a[112:115], a[208:211], v[232:235], a[112:115]
  ds_read_b64_tr_b16 a[204:205], v6 offset:0
  v_rcp_f32 v15, v15
  v_mfma_f32_16x16x32_bf16 a[176:179], a[208:211], v[240:243], a[176:179]
  ds_read_b64_tr_b16 a[206:207], v6 offset:8192
  s_mul_i32 s4, s3, 25344
  s_waitcnt lgkmcnt(12)
  v_mfma_f32_16x16x32_bf16 a[52:55], a[212:215], v[224:227], a[52:55]
  v_xor_b32 v7, 128, v5
  v_mfma_f32_16x16x32_bf16 a[116:119], a[212:215], v[232:235], a[116:119]
  ds_read_b64_tr_b16 a[208:209], v7 offset:0
  s_add_u32 s4, s4, 98304
  v_mfma_f32_16x16x32_bf16 a[180:183], a[212:215], v[240:243], a[180:183]
  ds_read_b64_tr_b16 a[210:211], v7 offset:8192
  s_cmp_eq_u32 s3, 2
  s_cselect_b32 s4, 0, s4
  s_waitcnt lgkmcnt(12)
  v_mfma_f32_16x16x32_bf16 a[56:59], a[216:219], v[224:227], a[56:59]
  v_xor_b32 v8, 160, v5
  v_and_b32 v29, 15, v1
  v_mfma_f32_16x16x32_bf16 a[120:123], a[216:219], v[232:235], a[120:123]
  ds_read_b64_tr_b16 a[212:213], v8 offset:0
  v_mfma_f32_16x16x32_bf16 a[184:187], a[216:219], v[240:243], a[184:187]
  ds_read_b64_tr_b16 a[214:215], v8 offset:8192
  v_mul_u32_u24 v29, 528, v29
  s_waitcnt lgkmcnt(12)
  v_mfma_f32_16x16x32_bf16 a[60:63], a[220:223], v[224:227], a[60:63]
  v_xor_b32 v9, 192, v5
  v_lshrrev_b32 v30, 4, v1
  v_mfma_f32_16x16x32_bf16 a[124:127], a[220:223], v[232:235], a[124:127]
  ds_read_b64_tr_b16 a[216:217], v9 offset:0
  v_lshl_add_u32 v29, v30, 3, v29
  v_mfma_f32_16x16x32_bf16 a[188:191], a[220:223], v[240:243], a[188:191]
  ds_read_b64_tr_b16 a[218:219], v9 offset:8192
  v_add_u32 v29, s4, v29
  s_waitcnt lgkmcnt(12)
  v_mfma_f32_16x16x32_bf16 a[0:3], a[192:195], v[228:231], a[0:3]
  v_xor_b32 v6, 224, v5
  v_mfma_f32_16x16x32_bf16 a[64:67], a[192:195], v[236:239], a[64:67]
  ds_read_b64_tr_b16 a[220:221], v6 offset:0
  v_mfma_f32_16x16x32_bf16 a[128:131], a[192:195], v[244:247], a[128:131]
  ds_read_b64_tr_b16 a[222:223], v6 offset:8192
  s_waitcnt lgkmcnt(12)
  v_mfma_f32_16x16x32_bf16 a[4:7], a[196:199], v[228:231], a[4:7]
  v_xor_b32 v7, 0, v5
  v_mfma_f32_16x16x32_bf16 a[68:71], a[196:199], v[236:239], a[68:71]
  ds_read_b64_tr_b16 a[192:193], v7 offset:256
  v_mfma_f32_16x16x32_bf16 a[132:135], a[196:199], v[244:247], a[132:135]
  ds_read_b64_tr_b16 a[194:195], v7 offset:8448
  s_waitcnt lgkmcnt(12)
  v_mfma_f32_16x16x32_bf16 a[8:11], a[200:203], v[228:231], a[8:11]
  v_xor_b32 v8, 32, v5
  v_mfma_f32_16x16x32_bf16 a[72:75], a[200:203], v[236:239], a[72:75]
  ds_read_b64_tr_b16 a[196:197], v8 offset:256
  v_mfma_f32_16x16x32_bf16 a[136:139], a[200:203], v[244:247], a[136:139]
  ds_read_b64_tr_b16 a[198:199], v8 offset:8448
  s_waitcnt lgkmcnt(12)
  v_mfma_f32_16x16x32_bf16 a[12:15], a[204:207], v[228:231], a[12:15]
  v_xor_b32 v9, 64, v5
  v_mfma_f32_16x16x32_bf16 a[76:79], a[204:207], v[236:239], a[76:79]
  ds_read_b64_tr_b16 a[200:201], v9 offset:256
  v_mfma_f32_16x16x32_bf16 a[140:143], a[204:207], v[244:247], a[140:143]
  ds_read_b64_tr_b16 a[202:203], v9 offset:8448
  v_accvgpr_read_b32 v128, a0
  v_accvgpr_read_b32 v129, a1
  v_accvgpr_read_b32 v130, a2
  v_accvgpr_read_b32 v131, a3
  v_mul_f32 v128, v13, v128
  v_mul_f32 v129, v13, v129
  v_mul_f32 v130, v13, v130
  v_mul_f32 v131, v13, v131
  v_cvt_pk_bf16_f32 v132, v128, v129
  v_cvt_pk_bf16_f32 v133, v130, v131
  ds_write_b64 v29, v[132:133] offset:0
  v_accvgpr_read_b32 v136, a64
  v_accvgpr_read_b32 v137, a65
  v_accvgpr_read_b32 v138, a66
  v_accvgpr_read_b32 v139, a67
  v_mul_f32 v136, v14, v136
  v_mul_f32 v137, v14, v137
  v_mul_f32 v138, v14, v138
  v_mul_f32 v139, v14, v139
  v_cvt_pk_bf16_f32 v140, v136, v137
  v_cvt_pk_bf16_f32 v141, v138, v139
  ds_write_b64 v29, v[140:141] offset:8448
  v_accvgpr_read_b32 v144, a128
  v_accvgpr_read_b32 v145, a129
  v_accvgpr_read_b32 v146, a130
  v_accvgpr_read_b32 v147, a131
  v_mul_f32 v144, v15, v144
  v_mul_f32 v145, v15, v145
  v_mul_f32 v146, v15, v146
  v_mul_f32 v147, v15, v147
  v_cvt_pk_bf16_f32 v148, v144, v145
  v_cvt_pk_bf16_f32 v149, v146, v147
  ds_write_b64 v29, v[148:149] offset:16896
  s_waitcnt lgkmcnt(12)
  v_mfma_f32_16x16x32_bf16 a[16:19], a[208:211], v[228:231], a[16:19]
  v_xor_b32 v6, 96, v5
  v_mfma_f32_16x16x32_bf16 a[80:83], a[208:211], v[236:239], a[80:83]
  ds_read_b64_tr_b16 a[204:205], v6 offset:256
  v_mfma_f32_16x16x32_bf16 a[144:147], a[208:211], v[244:247], a[144:147]
  ds_read_b64_tr_b16 a[206:207], v6 offset:8448
  v_accvgpr_read_b32 v152, a4
  v_accvgpr_read_b32 v153, a5
  v_accvgpr_read_b32 v154, a6
  v_accvgpr_read_b32 v155, a7
  v_mul_f32 v152, v13, v152
  v_mul_f32 v153, v13, v153
  v_mul_f32 v154, v13, v154
  v_mul_f32 v155, v13, v155
  v_cvt_pk_bf16_f32 v156, v152, v153
  v_cvt_pk_bf16_f32 v157, v154, v155
  ds_write_b64 v29, v[156:157] offset:32
  v_accvgpr_read_b32 v160, a68
  v_accvgpr_read_b32 v161, a69
  v_accvgpr_read_b32 v162, a70
  v_accvgpr_read_b32 v163, a71
  v_mul_f32 v160, v14, v160
  v_mul_f32 v161, v14, v161
  v_mul_f32 v162, v14, v162
  v_mul_f32 v163, v14, v163
  v_cvt_pk_bf16_f32 v164, v160, v161
  v_cvt_pk_bf16_f32 v165, v162, v163
  ds_write_b64 v29, v[164:165] offset:8480
  v_accvgpr_read_b32 v168, a132
  v_accvgpr_read_b32 v169, a133
  v_accvgpr_read_b32 v170, a134
  v_accvgpr_read_b32 v171, a135
  v_mul_f32 v168, v15, v168
  v_mul_f32 v169, v15, v169
  v_mul_f32 v170, v15, v170
  v_mul_f32 v171, v15, v171
  v_cvt_pk_bf16_f32 v172, v168, v169
  v_cvt_pk_bf16_f32 v173, v170, v171
  ds_write_b64 v29, v[172:173] offset:16928
  s_waitcnt lgkmcnt(12)
  v_mfma_f32_16x16x32_bf16 a[20:23], a[212:215], v[228:231], a[20:23]
  v_xor_b32 v7, 128, v5
  v_mfma_f32_16x16x32_bf16 a[84:87], a[212:215], v[236:239], a[84:87]
  ds_read_b64_tr_b16 a[208:209], v7 offset:256
  v_mfma_f32_16x16x32_bf16 a[148:151], a[212:215], v[244:247], a[148:151]
  ds_read_b64_tr_b16 a[210:211], v7 offset:8448
  v_accvgpr_read_b32 v176, a8
  v_accvgpr_read_b32 v177, a9
  v_accvgpr_read_b32 v178, a10
  v_accvgpr_read_b32 v179, a11
  v_mul_f32 v176, v13, v176
  v_mul_f32 v177, v13, v177
  v_mul_f32 v178, v13, v178
  v_mul_f32 v179, v13, v179
  v_cvt_pk_bf16_f32 v180, v176, v177
  v_cvt_pk_bf16_f32 v181, v178, v179
  ds_write_b64 v29, v[180:181] offset:64
  v_accvgpr_read_b32 v184, a72
  v_accvgpr_read_b32 v185, a73
  v_accvgpr_read_b32 v186, a74
  v_accvgpr_read_b32 v187, a75
  v_mul_f32 v184, v14, v184
  v_mul_f32 v185, v14, v185
  v_mul_f32 v186, v14, v186
  v_mul_f32 v187, v14, v187
  v_cvt_pk_bf16_f32 v188, v184, v185
  v_cvt_pk_bf16_f32 v189, v186, v187
  ds_write_b64 v29, v[188:189] offset:8512
  v_accvgpr_read_b32 v128, a136
  v_accvgpr_read_b32 v129, a137
  v_accvgpr_read_b32 v130, a138
  v_accvgpr_read_b32 v131, a139
  v_mul_f32 v128, v15, v128
  v_mul_f32 v129, v15, v129
  v_mul_f32 v130, v15, v130
  v_mul_f32 v131, v15, v131
  v_cvt_pk_bf16_f32 v132, v128, v129
  v_cvt_pk_bf16_f32 v133, v130, v131
  ds_write_b64 v29, v[132:133] offset:16960
  s_waitcnt lgkmcnt(12)
  v_mfma_f32_16x16x32_bf16 a[24:27], a[216:219], v[228:231], a[24:27]
  v_xor_b32 v8, 160, v5
  v_mfma_f32_16x16x32_bf16 a[88:91], a[216:219], v[236:239], a[88:91]
  ds_read_b64_tr_b16 a[212:213], v8 offset:256
  v_mfma_f32_16x16x32_bf16 a[152:155], a[216:219], v[244:247], a[152:155]
  ds_read_b64_tr_b16 a[214:215], v8 offset:8448
  v_accvgpr_read_b32 v136, a12
  v_accvgpr_read_b32 v137, a13
  v_accvgpr_read_b32 v138, a14
  v_accvgpr_read_b32 v139, a15
  v_mul_f32 v136, v13, v136
  v_mul_f32 v137, v13, v137
  v_mul_f32 v138, v13, v138
  v_mul_f32 v139, v13, v139
  v_cvt_pk_bf16_f32 v140, v136, v137
  v_cvt_pk_bf16_f32 v141, v138, v139
  ds_write_b64 v29, v[140:141] offset:96
  v_accvgpr_read_b32 v144, a76
  v_accvgpr_read_b32 v145, a77
  v_accvgpr_read_b32 v146, a78
  v_accvgpr_read_b32 v147, a79
  v_mul_f32 v144, v14, v144
  v_mul_f32 v145, v14, v145
  v_mul_f32 v146, v14, v146
  v_mul_f32 v147, v14, v147
  v_cvt_pk_bf16_f32 v148, v144, v145
  v_cvt_pk_bf16_f32 v149, v146, v147
  ds_write_b64 v29, v[148:149] offset:8544
  v_accvgpr_read_b32 v152, a140
  v_accvgpr_read_b32 v153, a141
  v_accvgpr_read_b32 v154, a142
  v_accvgpr_read_b32 v155, a143
  v_mul_f32 v152, v15, v152
  v_mul_f32 v153, v15, v153
  v_mul_f32 v154, v15, v154
  v_mul_f32 v155, v15, v155
  v_cvt_pk_bf16_f32 v156, v152, v153
  v_cvt_pk_bf16_f32 v157, v154, v155
  ds_write_b64 v29, v[156:157] offset:16992
  s_waitcnt lgkmcnt(12)
  v_mfma_f32_16x16x32_bf16 a[28:31], a[220:223], v[228:231], a[28:31]
  v_xor_b32 v9, 192, v5
  v_mfma_f32_16x16x32_bf16 a[92:95], a[220:223], v[236:239], a[92:95]
  ds_read_b64_tr_b16 a[216:217], v9 offset:256
  v_mfma_f32_16x16x32_bf16 a[156:159], a[220:223], v[244:247], a[156:159]
  ds_read_b64_tr_b16 a[218:219], v9 offset:8448
  v_accvgpr_read_b32 v160, a16
  v_accvgpr_read_b32 v161, a17
  v_accvgpr_read_b32 v162, a18
  v_accvgpr_read_b32 v163, a19
  v_mul_f32 v160, v13, v160
  v_mul_f32 v161, v13, v161
  v_mul_f32 v162, v13, v162
  v_mul_f32 v163, v13, v163
  v_cvt_pk_bf16_f32 v164, v160, v161
  v_cvt_pk_bf16_f32 v165, v162, v163
  ds_write_b64 v29, v[164:165] offset:128
  v_accvgpr_read_b32 v168, a80
  v_accvgpr_read_b32 v169, a81
  v_accvgpr_read_b32 v170, a82
  v_accvgpr_read_b32 v171, a83
  v_mul_f32 v168, v14, v168
  v_mul_f32 v169, v14, v169
  v_mul_f32 v170, v14, v170
  v_mul_f32 v171, v14, v171
  v_cvt_pk_bf16_f32 v172, v168, v169
  v_cvt_pk_bf16_f32 v173, v170, v171
  ds_write_b64 v29, v[172:173] offset:8576
  v_accvgpr_read_b32 v176, a144
  v_accvgpr_read_b32 v177, a145
  v_accvgpr_read_b32 v178, a146
  v_accvgpr_read_b32 v179, a147
  v_mul_f32 v176, v15, v176
  v_mul_f32 v177, v15, v177
  v_mul_f32 v178, v15, v178
  v_mul_f32 v179, v15, v179
  v_cvt_pk_bf16_f32 v180, v176, v177
  v_cvt_pk_bf16_f32 v181, v178, v179
  ds_write_b64 v29, v[180:181] offset:17024
  s_waitcnt lgkmcnt(12)
  v_mfma_f32_16x16x32_bf16 a[32:35], a[192:195], v[228:231], a[32:35]
  v_xor_b32 v6, 224, v5
  v_mfma_f32_16x16x32_bf16 a[96:99], a[192:195], v[236:239], a[96:99]
  ds_read_b64_tr_b16 a[220:221], v6 offset:256
  v_mfma_f32_16x16x32_bf16 a[160:163], a[192:195], v[244:247], a[160:163]
  ds_read_b64_tr_b16 a[222:223], v6 offset:8448
  v_accvgpr_read_b32 v184, a20
  v_accvgpr_read_b32 v185, a21
  v_accvgpr_read_b32 v186, a22
  v_accvgpr_read_b32 v187, a23
  v_mul_f32 v184, v13, v184
  v_mul_f32 v185, v13, v185
  v_mul_f32 v186, v13, v186
  v_mul_f32 v187, v13, v187
  v_cvt_pk_bf16_f32 v188, v184, v185
  v_cvt_pk_bf16_f32 v189, v186, v187
  ds_write_b64 v29, v[188:189] offset:160
  v_accvgpr_read_b32 v128, a84
  v_accvgpr_read_b32 v129, a85
  v_accvgpr_read_b32 v130, a86
  v_accvgpr_read_b32 v131, a87
  v_mul_f32 v128, v14, v128
  v_mul_f32 v129, v14, v129
  v_mul_f32 v130, v14, v130
  v_mul_f32 v131, v14, v131
  v_cvt_pk_bf16_f32 v132, v128, v129
  v_cvt_pk_bf16_f32 v133, v130, v131
  ds_write_b64 v29, v[132:133] offset:8608
  v_accvgpr_read_b32 v136, a148
  v_accvgpr_read_b32 v137, a149
  v_accvgpr_read_b32 v138, a150
  v_accvgpr_read_b32 v139, a151
  v_mul_f32 v136, v15, v136
  v_mul_f32 v137, v15, v137
  v_mul_f32 v138, v15, v138
  v_mul_f32 v139, v15, v139
  v_cvt_pk_bf16_f32 v140, v136, v137
  v_cvt_pk_bf16_f32 v141, v138, v139
  ds_write_b64 v29, v[140:141] offset:17056
  s_waitcnt lgkmcnt(12)
  v_mfma_f32_16x16x32_bf16 a[36:39], a[196:199], v[228:231], a[36:39]
  v_mfma_f32_16x16x32_bf16 a[100:103], a[196:199], v[236:239], a[100:103]
  v_mfma_f32_16x16x32_bf16 a[164:167], a[196:199], v[244:247], a[164:167]
  v_accvgpr_read_b32 v144, a24
  v_accvgpr_read_b32 v145, a25
  v_accvgpr_read_b32 v146, a26
  v_accvgpr_read_b32 v147, a27
  v_mul_f32 v144, v13, v144
  v_mul_f32 v145, v13, v145
  v_mul_f32 v146, v13, v146
  v_mul_f32 v147, v13, v147
  v_cvt_pk_bf16_f32 v148, v144, v145
  v_cvt_pk_bf16_f32 v149, v146, v147
  ds_write_b64 v29, v[148:149] offset:192
  v_accvgpr_read_b32 v152, a88
  v_accvgpr_read_b32 v153, a89
  v_accvgpr_read_b32 v154, a90
  v_accvgpr_read_b32 v155, a91
  v_mul_f32 v152, v14, v152
  v_mul_f32 v153, v14, v153
  v_mul_f32 v154, v14, v154
  v_mul_f32 v155, v14, v155
  v_cvt_pk_bf16_f32 v156, v152, v153
  v_cvt_pk_bf16_f32 v157, v154, v155
  ds_write_b64 v29, v[156:157] offset:8640
  v_accvgpr_read_b32 v160, a152
  v_accvgpr_read_b32 v161, a153
  v_accvgpr_read_b32 v162, a154
  v_accvgpr_read_b32 v163, a155
  v_mul_f32 v160, v15, v160
  v_mul_f32 v161, v15, v161
  v_mul_f32 v162, v15, v162
  v_mul_f32 v163, v15, v163
  v_cvt_pk_bf16_f32 v164, v160, v161
  v_cvt_pk_bf16_f32 v165, v162, v163
  ds_write_b64 v29, v[164:165] offset:17088
  s_waitcnt lgkmcnt(10)
  v_mfma_f32_16x16x32_bf16 a[40:43], a[200:203], v[228:231], a[40:43]
  v_mfma_f32_16x16x32_bf16 a[104:107], a[200:203], v[236:239], a[104:107]
  v_mfma_f32_16x16x32_bf16 a[168:171], a[200:203], v[244:247], a[168:171]
  v_accvgpr_read_b32 v168, a28
  v_accvgpr_read_b32 v169, a29
  v_accvgpr_read_b32 v170, a30
  v_accvgpr_read_b32 v171, a31
  v_mul_f32 v168, v13, v168
  v_mul_f32 v169, v13, v169
  v_mul_f32 v170, v13, v170
  v_mul_f32 v171, v13, v171
  v_cvt_pk_bf16_f32 v172, v168, v169
  v_cvt_pk_bf16_f32 v173, v170, v171
  ds_write_b64 v29, v[172:173] offset:224
  v_accvgpr_read_b32 v176, a92
  v_accvgpr_read_b32 v177, a93
  v_accvgpr_read_b32 v178, a94
  v_accvgpr_read_b32 v179, a95
  v_mul_f32 v176, v14, v176
  v_mul_f32 v177, v14, v177
  v_mul_f32 v178, v14, v178
  v_mul_f32 v179, v14, v179
  v_cvt_pk_bf16_f32 v180, v176, v177
  v_cvt_pk_bf16_f32 v181, v178, v179
  ds_write_b64 v29, v[180:181] offset:8672
  v_accvgpr_read_b32 v184, a156
  v_accvgpr_read_b32 v185, a157
  v_accvgpr_read_b32 v186, a158
  v_accvgpr_read_b32 v187, a159
  v_mul_f32 v184, v15, v184
  v_mul_f32 v185, v15, v185
  v_mul_f32 v186, v15, v186
  v_mul_f32 v187, v15, v187
  v_cvt_pk_bf16_f32 v188, v184, v185
  v_cvt_pk_bf16_f32 v189, v186, v187
  ds_write_b64 v29, v[188:189] offset:17120
  s_waitcnt lgkmcnt(8)
  v_mfma_f32_16x16x32_bf16 a[44:47], a[204:207], v[228:231], a[44:47]
  v_mfma_f32_16x16x32_bf16 a[108:111], a[204:207], v[236:239], a[108:111]
  v_mfma_f32_16x16x32_bf16 a[172:175], a[204:207], v[244:247], a[172:175]
  v_accvgpr_read_b32 v128, a32
  v_accvgpr_read_b32 v129, a33
  v_accvgpr_read_b32 v130, a34
  v_accvgpr_read_b32 v131, a35
  v_mul_f32 v128, v13, v128
  v_mul_f32 v129, v13, v129
  v_mul_f32 v130, v13, v130
  v_mul_f32 v131, v13, v131
  v_cvt_pk_bf16_f32 v132, v128, v129
  v_cvt_pk_bf16_f32 v133, v130, v131
  ds_write_b64 v29, v[132:133] offset:256
  v_accvgpr_read_b32 v136, a96
  v_accvgpr_read_b32 v137, a97
  v_accvgpr_read_b32 v138, a98
  v_accvgpr_read_b32 v139, a99
  v_mul_f32 v136, v14, v136
  v_mul_f32 v137, v14, v137
  v_mul_f32 v138, v14, v138
  v_mul_f32 v139, v14, v139
  v_cvt_pk_bf16_f32 v140, v136, v137
  v_cvt_pk_bf16_f32 v141, v138, v139
  ds_write_b64 v29, v[140:141] offset:8704
  v_accvgpr_read_b32 v144, a160
  v_accvgpr_read_b32 v145, a161
  v_accvgpr_read_b32 v146, a162
  v_accvgpr_read_b32 v147, a163
  v_mul_f32 v144, v15, v144
  v_mul_f32 v145, v15, v145
  v_mul_f32 v146, v15, v146
  v_mul_f32 v147, v15, v147
  v_cvt_pk_bf16_f32 v148, v144, v145
  v_cvt_pk_bf16_f32 v149, v146, v147
  ds_write_b64 v29, v[148:149] offset:17152
  s_waitcnt lgkmcnt(6)
  v_mfma_f32_16x16x32_bf16 a[48:51], a[208:211], v[228:231], a[48:51]
  v_mfma_f32_16x16x32_bf16 a[112:115], a[208:211], v[236:239], a[112:115]
  v_mfma_f32_16x16x32_bf16 a[176:179], a[208:211], v[244:247], a[176:179]
  v_accvgpr_read_b32 v152, a36
  v_accvgpr_read_b32 v153, a37
  v_accvgpr_read_b32 v154, a38
  v_accvgpr_read_b32 v155, a39
  v_mul_f32 v152, v13, v152
  v_mul_f32 v153, v13, v153
  v_mul_f32 v154, v13, v154
  v_mul_f32 v155, v13, v155
  v_cvt_pk_bf16_f32 v156, v152, v153
  v_cvt_pk_bf16_f32 v157, v154, v155
  ds_write_b64 v29, v[156:157] offset:288
  v_accvgpr_read_b32 v160, a100
  v_accvgpr_read_b32 v161, a101
  v_accvgpr_read_b32 v162, a102
  v_accvgpr_read_b32 v163, a103
  v_mul_f32 v160, v14, v160
  v_mul_f32 v161, v14, v161
  v_mul_f32 v162, v14, v162
  v_mul_f32 v163, v14, v163
  v_cvt_pk_bf16_f32 v164, v160, v161
  v_cvt_pk_bf16_f32 v165, v162, v163
  ds_write_b64 v29, v[164:165] offset:8736
  v_accvgpr_read_b32 v168, a164
  v_accvgpr_read_b32 v169, a165
  v_accvgpr_read_b32 v170, a166
  v_accvgpr_read_b32 v171, a167
  v_mul_f32 v168, v15, v168
  v_mul_f32 v169, v15, v169
  v_mul_f32 v170, v15, v170
  v_mul_f32 v171, v15, v171
  v_cvt_pk_bf16_f32 v172, v168, v169
  v_cvt_pk_bf16_f32 v173, v170, v171
  ds_write_b64 v29, v[172:173] offset:17184
  s_waitcnt lgkmcnt(4)
  v_mfma_f32_16x16x32_bf16 a[52:55], a[212:215], v[228:231], a[52:55]
  v_mfma_f32_16x16x32_bf16 a[116:119], a[212:215], v[236:239], a[116:119]
  v_mfma_f32_16x16x32_bf16 a[180:183], a[212:215], v[244:247], a[180:183]
  v_accvgpr_read_b32 v176, a40
  v_accvgpr_read_b32 v177, a41
  v_accvgpr_read_b32 v178, a42
  v_accvgpr_read_b32 v179, a43
  v_mul_f32 v176, v13, v176
  v_mul_f32 v177, v13, v177
  v_mul_f32 v178, v13, v178
  v_mul_f32 v179, v13, v179
  v_cvt_pk_bf16_f32 v180, v176, v177
  v_cvt_pk_bf16_f32 v181, v178, v179
  ds_write_b64 v29, v[180:181] offset:320
  v_accvgpr_read_b32 v184, a104
  v_accvgpr_read_b32 v185, a105
  v_accvgpr_read_b32 v186, a106
  v_accvgpr_read_b32 v187, a107
  v_mul_f32 v184, v14, v184
  v_mul_f32 v185, v14, v185
  v_mul_f32 v186, v14, v186
  v_mul_f32 v187, v14, v187
  v_cvt_pk_bf16_f32 v188, v184, v185
  v_cvt_pk_bf16_f32 v189, v186, v187
  ds_write_b64 v29, v[188:189] offset:8768
  v_accvgpr_read_b32 v128, a168
  v_accvgpr_read_b32 v129, a169
  v_accvgpr_read_b32 v130, a170
  v_accvgpr_read_b32 v131, a171
  v_mul_f32 v128, v15, v128
  v_mul_f32 v129, v15, v129
  v_mul_f32 v130, v15, v130
  v_mul_f32 v131, v15, v131
  v_cvt_pk_bf16_f32 v132, v128, v129
  v_cvt_pk_bf16_f32 v133, v130, v131
  ds_write_b64 v29, v[132:133] offset:17216
  s_waitcnt lgkmcnt(2)
  v_mfma_f32_16x16x32_bf16 a[56:59], a[216:219], v[228:231], a[56:59]
  v_mfma_f32_16x16x32_bf16 a[120:123], a[216:219], v[236:239], a[120:123]
  v_mfma_f32_16x16x32_bf16 a[184:187], a[216:219], v[244:247], a[184:187]
  v_accvgpr_read_b32 v136, a44
  v_accvgpr_read_b32 v137, a45
  v_accvgpr_read_b32 v138, a46
  v_accvgpr_read_b32 v139, a47
  v_mul_f32 v136, v13, v136
  v_mul_f32 v137, v13, v137
  v_mul_f32 v138, v13, v138
  v_mul_f32 v139, v13, v139
  v_cvt_pk_bf16_f32 v140, v136, v137
  v_cvt_pk_bf16_f32 v141, v138, v139
  ds_write_b64 v29, v[140:141] offset:352
  v_accvgpr_read_b32 v144, a108
  v_accvgpr_read_b32 v145, a109
  v_accvgpr_read_b32 v146, a110
  v_accvgpr_read_b32 v147, a111
  v_mul_f32 v144, v14, v144
  v_mul_f32 v145, v14, v145
  v_mul_f32 v146, v14, v146
  v_mul_f32 v147, v14, v147
  v_cvt_pk_bf16_f32 v148, v144, v145
  v_cvt_pk_bf16_f32 v149, v146, v147
  ds_write_b64 v29, v[148:149] offset:8800
  v_accvgpr_read_b32 v152, a172
  v_accvgpr_read_b32 v153, a173
  v_accvgpr_read_b32 v154, a174
  v_accvgpr_read_b32 v155, a175
  v_mul_f32 v152, v15, v152
  v_mul_f32 v153, v15, v153
  v_mul_f32 v154, v15, v154
  v_mul_f32 v155, v15, v155
  v_cvt_pk_bf16_f32 v156, v152, v153
  v_cvt_pk_bf16_f32 v157, v154, v155
  ds_write_b64 v29, v[156:157] offset:17248
  s_waitcnt lgkmcnt(0)
  v_mfma_f32_16x16x32_bf16 a[60:63], a[220:223], v[228:231], a[60:63]
  v_mfma_f32_16x16x32_bf16 a[124:127], a[220:223], v[236:239], a[124:127]
  v_mfma_f32_16x16x32_bf16 a[188:191], a[220:223], v[244:247], a[188:191]
  v_accvgpr_read_b32 v160, a48
  v_accvgpr_read_b32 v161, a49
  v_accvgpr_read_b32 v162, a50
  v_accvgpr_read_b32 v163, a51
  v_mul_f32 v160, v13, v160
  v_mul_f32 v161, v13, v161
  v_mul_f32 v162, v13, v162
  v_mul_f32 v163, v13, v163
  v_cvt_pk_bf16_f32 v164, v160, v161
  v_cvt_pk_bf16_f32 v165, v162, v163
  ds_write_b64 v29, v[164:165] offset:384
  v_accvgpr_read_b32 v168, a112
  v_accvgpr_read_b32 v169, a113
  v_accvgpr_read_b32 v170, a114
  v_accvgpr_read_b32 v171, a115
  v_mul_f32 v168, v14, v168
  v_mul_f32 v169, v14, v169
  v_mul_f32 v170, v14, v170
  v_mul_f32 v171, v14, v171
  v_cvt_pk_bf16_f32 v172, v168, v169
  v_cvt_pk_bf16_f32 v173, v170, v171
  ds_write_b64 v29, v[172:173] offset:8832
  v_accvgpr_read_b32 v176, a176
  v_accvgpr_read_b32 v177, a177
  v_accvgpr_read_b32 v178, a178
  v_accvgpr_read_b32 v179, a179
  v_mul_f32 v176, v15, v176
  v_mul_f32 v177, v15, v177
  v_mul_f32 v178, v15, v178
  v_mul_f32 v179, v15, v179
  v_cvt_pk_bf16_f32 v180, v176, v177
  v_cvt_pk_bf16_f32 v181, v178, v179
  ds_write_b64 v29, v[180:181] offset:17280
  s_nop 7
  v_accvgpr_read_b32 v184, a52
  v_accvgpr_read_b32 v185, a53
  v_accvgpr_read_b32 v186, a54
  v_accvgpr_read_b32 v187, a55
  v_mul_f32 v184, v13, v184
  v_mul_f32 v185, v13, v185
  v_mul_f32 v186, v13, v186
  v_mul_f32 v187, v13, v187
  v_cvt_pk_bf16_f32 v188, v184, v185
  v_cvt_pk_bf16_f32 v189, v186, v187
  ds_write_b64 v29, v[188:189] offset:416
  v_accvgpr_read_b32 v128, a116
  v_accvgpr_read_b32 v129, a117
  v_accvgpr_read_b32 v130, a118
  v_accvgpr_read_b32 v131, a119
  v_mul_f32 v128, v14, v128
  v_mul_f32 v129, v14, v129
  v_mul_f32 v130, v14, v130
  v_mul_f32 v131, v14, v131
  v_cvt_pk_bf16_f32 v132, v128, v129
  v_cvt_pk_bf16_f32 v133, v130, v131
  ds_write_b64 v29, v[132:133] offset:8864
  v_accvgpr_read_b32 v136, a180
  v_accvgpr_read_b32 v137, a181
  v_accvgpr_read_b32 v138, a182
  v_accvgpr_read_b32 v139, a183
  v_mul_f32 v136, v15, v136
  v_mul_f32 v137, v15, v137
  v_mul_f32 v138, v15, v138
  v_mul_f32 v139, v15, v139
  v_cvt_pk_bf16_f32 v140, v136, v137
  v_cvt_pk_bf16_f32 v141, v138, v139
  ds_write_b64 v29, v[140:141] offset:17312
  v_accvgpr_read_b32 v144, a56
  v_accvgpr_read_b32 v145, a57
  v_accvgpr_read_b32 v146, a58
  v_accvgpr_read_b32 v147, a59
  v_mul_f32 v144, v13, v144
  v_mul_f32 v145, v13, v145
  v_mul_f32 v146, v13, v146
  v_mul_f32 v147, v13, v147
  v_cvt_pk_bf16_f32 v148, v144, v145
  v_cvt_pk_bf16_f32 v149, v146, v147
  ds_write_b64 v29, v[148:149] offset:448
  v_accvgpr_read_b32 v152, a120
  v_accvgpr_read_b32 v153, a121
  v_accvgpr_read_b32 v154, a122
  v_accvgpr_read_b32 v155, a123
  v_mul_f32 v152, v14, v152
  v_mul_f32 v153, v14, v153
  v_mul_f32 v154, v14, v154
  v_mul_f32 v155, v14, v155
  v_cvt_pk_bf16_f32 v156, v152, v153
  v_cvt_pk_bf16_f32 v157, v154, v155
  ds_write_b64 v29, v[156:157] offset:8896
  v_accvgpr_read_b32 v160, a184
  v_accvgpr_read_b32 v161, a185
  v_accvgpr_read_b32 v162, a186
  v_accvgpr_read_b32 v163, a187
  v_mul_f32 v160, v15, v160
  v_mul_f32 v161, v15, v161
  v_mul_f32 v162, v15, v162
  v_mul_f32 v163, v15, v163
  v_cvt_pk_bf16_f32 v164, v160, v161
  v_cvt_pk_bf16_f32 v165, v162, v163
  ds_write_b64 v29, v[164:165] offset:17344
  v_accvgpr_read_b32 v168, a60
  v_accvgpr_read_b32 v169, a61
  v_accvgpr_read_b32 v170, a62
  v_accvgpr_read_b32 v171, a63
  v_mul_f32 v168, v13, v168
  v_mul_f32 v169, v13, v169
  v_mul_f32 v170, v13, v170
  v_mul_f32 v171, v13, v171
  v_cvt_pk_bf16_f32 v172, v168, v169
  v_cvt_pk_bf16_f32 v173, v170, v171
  ds_write_b64 v29, v[172:173] offset:480
  v_accvgpr_read_b32 v176, a124
  v_accvgpr_read_b32 v177, a125
  v_accvgpr_read_b32 v178, a126
  v_accvgpr_read_b32 v179, a127
  v_mul_f32 v176, v14, v176
  v_mul_f32 v177, v14, v177
  v_mul_f32 v178, v14, v178
  v_mul_f32 v179, v14, v179
  v_cvt_pk_bf16_f32 v180, v176, v177
  v_cvt_pk_bf16_f32 v181, v178, v179
  ds_write_b64 v29, v[180:181] offset:8928
  v_accvgpr_read_b32 v184, a188
  v_accvgpr_read_b32 v185, a189
  v_accvgpr_read_b32 v186, a190
  v_accvgpr_read_b32 v187, a191
  v_mul_f32 v184, v15, v184
  v_mul_f32 v185, v15, v185
  v_mul_f32 v186, v15, v186
  v_mul_f32 v187, v15, v187
  v_cvt_pk_bf16_f32 v188, v184, v185
  v_cvt_pk_bf16_f32 v189, v186, v187
  ds_write_b64 v29, v[188:189] offset:17376
  v_lshrrev_b32 v8, 5, v1
  v_and_b32 v7, 31, v1
  v_mul_u32_u24 v9, 528, v8
  v_lshl_add_u32 v9, v7, 4, v9
  v_add_u32 v9, s4, v9
  s_lshl_b32 s4, s28, 4
  s_add_u32 s4, s4, s30
  s_mul_i32 s4, s4, 1152
  s_mul_i32 s5, s29, 144
  s_add_u32 s4, s4, s5
  s_mul_i32 s5, s3, 48
  s_add_u32 s4, s4, s5
  s_lshl_b32 s4, s4, 9
  v_lshlrev_b32 v8, 9, v8
  v_lshl_add_u32 v8, v7, 4, v8
  s_waitcnt lgkmcnt(0)
  ds_read_b128 v[32:35], v9 offset:0
  ds_read_b128 v[36:39], v9 offset:1056
  ds_read_b128 v[40:43], v9 offset:2112
  ds_read_b128 v[44:47], v9 offset:3168
  ds_read_b128 v[48:51], v9 offset:4224
  ds_read_b128 v[52:55], v9 offset:5280
  ds_read_b128 v[56:59], v9 offset:6336
  ds_read_b128 v[60:63], v9 offset:7392
  ds_read_b128 v[64:67], v9 offset:8448
  ds_read_b128 v[68:71], v9 offset:9504
  ds_read_b128 v[72:75], v9 offset:10560
  ds_read_b128 v[76:79], v9 offset:11616
  s_waitcnt lgkmcnt(11)
  s_add_u32 s5, s4, 0
  buffer_store_dwordx4 v[32:35], v8, s[24:27], s5 offen
  s_waitcnt lgkmcnt(10)
  s_add_u32 s5, s4, 1024
  buffer_store_dwordx4 v[36:39], v8, s[24:27], s5 offen
  s_waitcnt lgkmcnt(9)
  s_add_u32 s5, s4, 2048
  buffer_store_dwordx4 v[40:43], v8, s[24:27], s5 offen
  s_waitcnt lgkmcnt(8)
  s_add_u32 s5, s4, 3072
  buffer_store_dwordx4 v[44:47], v8, s[24:27], s5 offen
  s_waitcnt lgkmcnt(7)
  s_add_u32 s5, s4, 4096
  buffer_store_dwordx4 v[48:51], v8, s[24:27], s5 offen
  s_waitcnt lgkmcnt(6)
  s_add_u32 s5, s4, 5120
  buffer_store_dwordx4 v[52:55], v8, s[24:27], s5 offen
  s_waitcnt lgkmcnt(5)
  s_add_u32 s5, s4, 6144
  buffer_store_dwordx4 v[56:59], v8, s[24:27], s5 offen
  s_waitcnt lgkmcnt(4)
  s_add_u32 s5, s4, 7168
  buffer_store_dwordx4 v[60:63], v8, s[24:27], s5 offen
  s_waitcnt lgkmcnt(3)
  s_add_u32 s5, s4, 8192
  buffer_store_dwordx4 v[64:67], v8, s[24:27], s5 offen
  s_waitcnt lgkmcnt(2)
  s_add_u32 s5, s4, 9216
  buffer_store_dwordx4 v[68:71], v8, s[24:27], s5 offen
  s_waitcnt lgkmcnt(1)
  s_add_u32 s5, s4, 10240
  buffer_store_dwordx4 v[72:75], v8, s[24:27], s5 offen
  s_waitcnt lgkmcnt(0)
  s_add_u32 s5, s4, 11264
  buffer_store_dwordx4 v[76:79], v8, s[24:27], s5 offen
  ds_read_b128 v[80:83], v9 offset:12672
  ds_read_b128 v[84:87], v9 offset:13728
  ds_read_b128 v[88:91], v9 offset:14784
  ds_read_b128 v[92:95], v9 offset:15840
  ds_read_b128 v[96:99], v9 offset:16896
  ds_read_b128 v[100:103], v9 offset:17952
  ds_read_b128 v[104:107], v9 offset:19008
  ds_read_b128 v[108:111], v9 offset:20064
  ds_read_b128 v[112:115], v9 offset:21120
  ds_read_b128 v[116:119], v9 offset:22176
  ds_read_b128 v[120:123], v9 offset:23232
  ds_read_b128 v[124:127], v9 offset:24288
  s_waitcnt lgkmcnt(11)
  s_add_u32 s5, s4, 12288
  buffer_store_dwordx4 v[80:83], v8, s[24:27], s5 offen
  s_waitcnt lgkmcnt(10)
  s_add_u32 s5, s4, 13312
  buffer_store_dwordx4 v[84:87], v8, s[24:27], s5 offen
  s_waitcnt lgkmcnt(9)
  s_add_u32 s5, s4, 14336
  buffer_store_dwordx4 v[88:91], v8, s[24:27], s5 offen
  s_waitcnt lgkmcnt(8)
  s_add_u32 s5, s4, 15360
  buffer_store_dwordx4 v[92:95], v8, s[24:27], s5 offen
  s_waitcnt lgkmcnt(7)
  s_add_u32 s5, s4, 16384
  buffer_store_dwordx4 v[96:99], v8, s[24:27], s5 offen
  s_waitcnt lgkmcnt(6)
  s_add_u32 s5, s4, 17408
  buffer_store_dwordx4 v[100:103], v8, s[24:27], s5 offen
  s_waitcnt lgkmcnt(5)
  s_add_u32 s5, s4, 18432
  buffer_store_dwordx4 v[104:107], v8, s[24:27], s5 offen
  s_waitcnt lgkmcnt(4)
  s_add_u32 s5, s4, 19456
  buffer_store_dwordx4 v[108:111], v8, s[24:27], s5 offen
  s_waitcnt lgkmcnt(3)
  s_add_u32 s5, s4, 20480
  buffer_store_dwordx4 v[112:115], v8, s[24:27], s5 offen
  s_waitcnt lgkmcnt(2)
  s_add_u32 s5, s4, 21504
  buffer_store_dwordx4 v[116:119], v8, s[24:27], s5 offen
  s_waitcnt lgkmcnt(1)
  s_add_u32 s5, s4, 22528
  buffer_store_dwordx4 v[120:123], v8, s[24:27], s5 offen
  s_waitcnt lgkmcnt(0)
  s_add_u32 s5, s4, 23552
  buffer_store_dwordx4 v[124:127], v8, s[24:27], s5 offen
  s_endpgm
Lrare_1:
  v_max_f32 v19, v10, v16
  v_sub_f32 v20, v10, v19
  v_exp_f32 v20, v20
  v_mov_b32 v10, v19
  v_mul_f32 v13, v13, v20
  v_accvgpr_read_b32 v21, a0
  v_mul_f32 v21, v21, v20
  v_accvgpr_write_b32 a0, v21
  v_accvgpr_read_b32 v21, a1
  v_mul_f32 v21, v21, v20
  v_accvgpr_write_b32 a1, v21
  v_accvgpr_read_b32 v21, a2
  v_mul_f32 v21, v21, v20
  v_accvgpr_write_b32 a2, v21
  v_accvgpr_read_b32 v21, a3
  v_mul_f32 v21, v21, v20
  v_accvgpr_write_b32 a3, v21
  v_accvgpr_read_b32 v21, a4
  v_mul_f32 v21, v21, v20
  v_accvgpr_write_b32 a4, v21
  v_accvgpr_read_b32 v21, a5
  v_mul_f32 v21, v21, v20
  v_accvgpr_write_b32 a5, v21
  v_accvgpr_read_b32 v21, a6
  v_mul_f32 v21, v21, v20
  v_accvgpr_write_b32 a6, v21
  v_accvgpr_read_b32 v21, a7
  v_mul_f32 v21, v21, v20
  v_accvgpr_write_b32 a7, v21
  v_accvgpr_read_b32 v21, a8
  v_mul_f32 v21, v21, v20
  v_accvgpr_write_b32 a8, v21
  v_accvgpr_read_b32 v21, a9
  v_mul_f32 v21, v21, v20
  v_accvgpr_write_b32 a9, v21
  v_accvgpr_read_b32 v21, a10
  v_mul_f32 v21, v21, v20
  v_accvgpr_write_b32 a10, v21
  v_accvgpr_read_b32 v21, a11
  v_mul_f32 v21, v21, v20
  v_accvgpr_write_b32 a11, v21
  v_accvgpr_read_b32 v21, a12
  v_mul_f32 v21, v21, v20
  v_accvgpr_write_b32 a12, v21
  v_accvgpr_read_b32 v21, a13
  v_mul_f32 v21, v21, v20
  v_accvgpr_write_b32 a13, v21
  v_accvgpr_read_b32 v21, a14
  v_mul_f32 v21, v21, v20
  v_accvgpr_write_b32 a14, v21
  v_accvgpr_read_b32 v21, a15
  v_mul_f32 v21, v21, v20
  v_accvgpr_write_b32 a15, v21
  v_accvgpr_read_b32 v21, a16
  v_mul_f32 v21, v21, v20
  v_accvgpr_write_b32 a16, v21
  v_accvgpr_read_b32 v21, a17
  v_mul_f32 v21, v21, v20
  v_accvgpr_write_b32 a17, v21
  v_accvgpr_read_b32 v21, a18
  v_mul_f32 v21, v21, v20
  v_accvgpr_write_b32 a18, v21
  v_accvgpr_read_b32 v21, a19
  v_mul_f32 v21, v21, v20
  v_accvgpr_write_b32 a19, v21
  v_accvgpr_read_b32 v21, a20
  v_mul_f32 v21, v21, v20
  v_accvgpr_write_b32 a20, v21
  v_accvgpr_read_b32 v21, a21
  v_mul_f32 v21, v21, v20
  v_accvgpr_write_b32 a21, v21
  v_accvgpr_read_b32 v21, a22
  v_mul_f32 v21, v21, v20
  v_accvgpr_write_b32 a22, v21
  v_accvgpr_read_b32 v21, a23
  v_mul_f32 v21, v21, v20
  v_accvgpr_write_b32 a23, v21
  v_accvgpr_read_b32 v21, a24
  v_mul_f32 v21, v21, v20
  v_accvgpr_write_b32 a24, v21
  v_accvgpr_read_b32 v21, a25
  v_mul_f32 v21, v21, v20
  v_accvgpr_write_b32 a25, v21
  v_accvgpr_read_b32 v21, a26
  v_mul_f32 v21, v21, v20
  v_accvgpr_write_b32 a26, v21
  v_accvgpr_read_b32 v21, a27
  v_mul_f32 v21, v21, v20
  v_accvgpr_write_b32 a27, v21
  v_accvgpr_read_b32 v21, a28
  v_mul_f32 v21, v21, v20
  v_accvgpr_write_b32 a28, v21
  v_accvgpr_read_b32 v21, a29
  v_mul_f32 v21, v21, v20
  v_accvgpr_write_b32 a29, v21
  v_accvgpr_read_b32 v21, a30
  v_mul_f32 v21, v21, v20
  v_accvgpr_write_b32 a30, v21
  v_accvgpr_read_b32 v21, a31
  v_mul_f32 v21, v21, v20
  v_accvgpr_write_b32 a31, v21
  v_accvgpr_read_b32 v21, a32
  v_mul_f32 v21, v21, v20
  v_accvgpr_write_b32 a32, v21
  v_accvgpr_read_b32 v21, a33
  v_mul_f32 v21, v21, v20
  v_accvgpr_write_b32 a33, v21
  v_accvgpr_read_b32 v21, a34
  v_mul_f32 v21, v21, v20
  v_accvgpr_write_b32 a34, v21
  v_accvgpr_read_b32 v21, a35
  v_mul_f32 v21, v21, v20
  v_accvgpr_write_b32 a35, v21
  v_accvgpr_read_b32 v21, a36
  v_mul_f32 v21, v21, v20
  v_accvgpr_write_b32 a36, v21
  v_accvgpr_read_b32 v21, a37
  v_mul_f32 v21, v21, v20
  v_accvgpr_write_b32 a37, v21
  v_accvgpr_read_b32 v21, a38
  v_mul_f32 v21, v21, v20
  v_accvgpr_write_b32 a38, v21
  v_accvgpr_read_b32 v21, a39
  v_mul_f32 v21, v21, v20
  v_accvgpr_write_b32 a39, v21
  v_accvgpr_read_b32 v21, a40
  v_mul_f32 v21, v21, v20
  v_accvgpr_write_b32 a40, v21
  v_accvgpr_read_b32 v21, a41
  v_mul_f32 v21, v21, v20
  v_accvgpr_write_b32 a41, v21
  v_accvgpr_read_b32 v21, a42
  v_mul_f32 v21, v21, v20
  v_accvgpr_write_b32 a42, v21
  v_accvgpr_read_b32 v21, a43
  v_mul_f32 v21, v21, v20
  v_accvgpr_write_b32 a43, v21
  v_accvgpr_read_b32 v21, a44
  v_mul_f32 v21, v21, v20
  v_accvgpr_write_b32 a44, v21
  v_accvgpr_read_b32 v21, a45
  v_mul_f32 v21, v21, v20
  v_accvgpr_write_b32 a45, v21
  v_accvgpr_read_b32 v21, a46
  v_mul_f32 v21, v21, v20
  v_accvgpr_write_b32 a46, v21
  v_accvgpr_read_b32 v21, a47
  v_mul_f32 v21, v21, v20
  v_accvgpr_write_b32 a47, v21
  v_accvgpr_read_b32 v21, a48
  v_mul_f32 v21, v21, v20
  v_accvgpr_write_b32 a48, v21
  v_accvgpr_read_b32 v21, a49
  v_mul_f32 v21, v21, v20
  v_accvgpr_write_b32 a49, v21
  v_accvgpr_read_b32 v21, a50
  v_mul_f32 v21, v21, v20
  v_accvgpr_write_b32 a50, v21
  v_accvgpr_read_b32 v21, a51
  v_mul_f32 v21, v21, v20
  v_accvgpr_write_b32 a51, v21
  v_accvgpr_read_b32 v21, a52
  v_mul_f32 v21, v21, v20
  v_accvgpr_write_b32 a52, v21
  v_accvgpr_read_b32 v21, a53
  v_mul_f32 v21, v21, v20
  v_accvgpr_write_b32 a53, v21
  v_accvgpr_read_b32 v21, a54
  v_mul_f32 v21, v21, v20
  v_accvgpr_write_b32 a54, v21
  v_accvgpr_read_b32 v21, a55
  v_mul_f32 v21, v21, v20
  v_accvgpr_write_b32 a55, v21
  v_accvgpr_read_b32 v21, a56
  v_mul_f32 v21, v21, v20
  v_accvgpr_write_b32 a56, v21
  v_accvgpr_read_b32 v21, a57
  v_mul_f32 v21, v21, v20
  v_accvgpr_write_b32 a57, v21
  v_accvgpr_read_b32 v21, a58
  v_mul_f32 v21, v21, v20
  v_accvgpr_write_b32 a58, v21
  v_accvgpr_read_b32 v21, a59
  v_mul_f32 v21, v21, v20
  v_accvgpr_write_b32 a59, v21
  v_accvgpr_read_b32 v21, a60
  v_mul_f32 v21, v21, v20
  v_accvgpr_write_b32 a60, v21
  v_accvgpr_read_b32 v21, a61
  v_mul_f32 v21, v21, v20
  v_accvgpr_write_b32 a61, v21
  v_accvgpr_read_b32 v21, a62
  v_mul_f32 v21, v21, v20
  v_accvgpr_write_b32 a62, v21
  v_accvgpr_read_b32 v21, a63
  v_mul_f32 v21, v21, v20
  v_accvgpr_write_b32 a63, v21
  v_max_f32 v22, v11, v17
  v_sub_f32 v23, v11, v22
  v_exp_f32 v23, v23
  v_mov_b32 v11, v22
  v_mul_f32 v14, v14, v23
  v_accvgpr_read_b32 v24, a64
  v_mul_f32 v24, v24, v23
  v_accvgpr_write_b32 a64, v24
  v_accvgpr_read_b32 v24, a65
  v_mul_f32 v24, v24, v23
  v_accvgpr_write_b32 a65, v24
  v_accvgpr_read_b32 v24, a66
  v_mul_f32 v24, v24, v23
  v_accvgpr_write_b32 a66, v24
  v_accvgpr_read_b32 v24, a67
  v_mul_f32 v24, v24, v23
  v_accvgpr_write_b32 a67, v24
  v_accvgpr_read_b32 v24, a68
  v_mul_f32 v24, v24, v23
  v_accvgpr_write_b32 a68, v24
  v_accvgpr_read_b32 v24, a69
  v_mul_f32 v24, v24, v23
  v_accvgpr_write_b32 a69, v24
  v_accvgpr_read_b32 v24, a70
  v_mul_f32 v24, v24, v23
  v_accvgpr_write_b32 a70, v24
  v_accvgpr_read_b32 v24, a71
  v_mul_f32 v24, v24, v23
  v_accvgpr_write_b32 a71, v24
  v_accvgpr_read_b32 v24, a72
  v_mul_f32 v24, v24, v23
  v_accvgpr_write_b32 a72, v24
  v_accvgpr_read_b32 v24, a73
  v_mul_f32 v24, v24, v23
  v_accvgpr_write_b32 a73, v24
  v_accvgpr_read_b32 v24, a74
  v_mul_f32 v24, v24, v23
  v_accvgpr_write_b32 a74, v24
  v_accvgpr_read_b32 v24, a75
  v_mul_f32 v24, v24, v23
  v_accvgpr_write_b32 a75, v24
  v_accvgpr_read_b32 v24, a76
  v_mul_f32 v24, v24, v23
  v_accvgpr_write_b32 a76, v24
  v_accvgpr_read_b32 v24, a77
  v_mul_f32 v24, v24, v23
  v_accvgpr_write_b32 a77, v24
  v_accvgpr_read_b32 v24, a78
  v_mul_f32 v24, v24, v23
  v_accvgpr_write_b32 a78, v24
  v_accvgpr_read_b32 v24, a79
  v_mul_f32 v24, v24, v23
  v_accvgpr_write_b32 a79, v24
  v_accvgpr_read_b32 v24, a80
  v_mul_f32 v24, v24, v23
  v_accvgpr_write_b32 a80, v24
  v_accvgpr_read_b32 v24, a81
  v_mul_f32 v24, v24, v23
  v_accvgpr_write_b32 a81, v24
  v_accvgpr_read_b32 v24, a82
  v_mul_f32 v24, v24, v23
  v_accvgpr_write_b32 a82, v24
  v_accvgpr_read_b32 v24, a83
  v_mul_f32 v24, v24, v23
  v_accvgpr_write_b32 a83, v24
  v_accvgpr_read_b32 v24, a84
  v_mul_f32 v24, v24, v23
  v_accvgpr_write_b32 a84, v24
  v_accvgpr_read_b32 v24, a85
  v_mul_f32 v24, v24, v23
  v_accvgpr_write_b32 a85, v24
  v_accvgpr_read_b32 v24, a86
  v_mul_f32 v24, v24, v23
  v_accvgpr_write_b32 a86, v24
  v_accvgpr_read_b32 v24, a87
  v_mul_f32 v24, v24, v23
  v_accvgpr_write_b32 a87, v24
  v_accvgpr_read_b32 v24, a88
  v_mul_f32 v24, v24, v23
  v_accvgpr_write_b32 a88, v24
  v_accvgpr_read_b32 v24, a89
  v_mul_f32 v24, v24, v23
  v_accvgpr_write_b32 a89, v24
  v_accvgpr_read_b32 v24, a90
  v_mul_f32 v24, v24, v23
  v_accvgpr_write_b32 a90, v24
  v_accvgpr_read_b32 v24, a91
  v_mul_f32 v24, v24, v23
  v_accvgpr_write_b32 a91, v24
  v_accvgpr_read_b32 v24, a92
  v_mul_f32 v24, v24, v23
  v_accvgpr_write_b32 a92, v24
  v_accvgpr_read_b32 v24, a93
  v_mul_f32 v24, v24, v23
  v_accvgpr_write_b32 a93, v24
  v_accvgpr_read_b32 v24, a94
  v_mul_f32 v24, v24, v23
  v_accvgpr_write_b32 a94, v24
  v_accvgpr_read_b32 v24, a95
  v_mul_f32 v24, v24, v23
  v_accvgpr_write_b32 a95, v24
  v_accvgpr_read_b32 v24, a96
  v_mul_f32 v24, v24, v23
  v_accvgpr_write_b32 a96, v24
  v_accvgpr_read_b32 v24, a97
  v_mul_f32 v24, v24, v23
  v_accvgpr_write_b32 a97, v24
  v_accvgpr_read_b32 v24, a98
  v_mul_f32 v24, v24, v23
  v_accvgpr_write_b32 a98, v24
  v_accvgpr_read_b32 v24, a99
  v_mul_f32 v24, v24, v23
  v_accvgpr_write_b32 a99, v24
  v_accvgpr_read_b32 v24, a100
  v_mul_f32 v24, v24, v23
  v_accvgpr_write_b32 a100, v24
  v_accvgpr_read_b32 v24, a101
  v_mul_f32 v24, v24, v23
  v_accvgpr_write_b32 a101, v24
  v_accvgpr_read_b32 v24, a102
  v_mul_f32 v24, v24, v23
  v_accvgpr_write_b32 a102, v24
  v_accvgpr_read_b32 v24, a103
  v_mul_f32 v24, v24, v23
  v_accvgpr_write_b32 a103, v24
  v_accvgpr_read_b32 v24, a104
  v_mul_f32 v24, v24, v23
  v_accvgpr_write_b32 a104, v24
  v_accvgpr_read_b32 v24, a105
  v_mul_f32 v24, v24, v23
  v_accvgpr_write_b32 a105, v24
  v_accvgpr_read_b32 v24, a106
  v_mul_f32 v24, v24, v23
  v_accvgpr_write_b32 a106, v24
  v_accvgpr_read_b32 v24, a107
  v_mul_f32 v24, v24, v23
  v_accvgpr_write_b32 a107, v24
  v_accvgpr_read_b32 v24, a108
  v_mul_f32 v24, v24, v23
  v_accvgpr_write_b32 a108, v24
  v_accvgpr_read_b32 v24, a109
  v_mul_f32 v24, v24, v23
  v_accvgpr_write_b32 a109, v24
  v_accvgpr_read_b32 v24, a110
  v_mul_f32 v24, v24, v23
  v_accvgpr_write_b32 a110, v24
  v_accvgpr_read_b32 v24, a111
  v_mul_f32 v24, v24, v23
  v_accvgpr_write_b32 a111, v24
  v_accvgpr_read_b32 v24, a112
  v_mul_f32 v24, v24, v23
  v_accvgpr_write_b32 a112, v24
  v_accvgpr_read_b32 v24, a113
  v_mul_f32 v24, v24, v23
  v_accvgpr_write_b32 a113, v24
  v_accvgpr_read_b32 v24, a114
  v_mul_f32 v24, v24, v23
  v_accvgpr_write_b32 a114, v24
  v_accvgpr_read_b32 v24, a115
  v_mul_f32 v24, v24, v23
  v_accvgpr_write_b32 a115, v24
  v_accvgpr_read_b32 v24, a116
  v_mul_f32 v24, v24, v23
  v_accvgpr_write_b32 a116, v24
  v_accvgpr_read_b32 v24, a117
  v_mul_f32 v24, v24, v23
  v_accvgpr_write_b32 a117, v24
  v_accvgpr_read_b32 v24, a118
  v_mul_f32 v24, v24, v23
  v_accvgpr_write_b32 a118, v24
  v_accvgpr_read_b32 v24, a119
  v_mul_f32 v24, v24, v23
  v_accvgpr_write_b32 a119, v24
  v_accvgpr_read_b32 v24, a120
  v_mul_f32 v24, v24, v23
  v_accvgpr_write_b32 a120, v24
  v_accvgpr_read_b32 v24, a121
  v_mul_f32 v24, v24, v23
  v_accvgpr_write_b32 a121, v24
  v_accvgpr_read_b32 v24, a122
  v_mul_f32 v24, v24, v23
  v_accvgpr_write_b32 a122, v24
  v_accvgpr_read_b32 v24, a123
  v_mul_f32 v24, v24, v23
  v_accvgpr_write_b32 a123, v24
  v_accvgpr_read_b32 v24, a124
  v_mul_f32 v24, v24, v23
  v_accvgpr_write_b32 a124, v24
  v_accvgpr_read_b32 v24, a125
  v_mul_f32 v24, v24, v23
  v_accvgpr_write_b32 a125, v24
  v_accvgpr_read_b32 v24, a126
  v_mul_f32 v24, v24, v23
  v_accvgpr_write_b32 a126, v24
  v_accvgpr_read_b32 v24, a127
  v_mul_f32 v24, v24, v23
  v_accvgpr_write_b32 a127, v24
  v_max_f32 v25, v12, v18
  v_sub_f32 v26, v12, v25
  v_exp_f32 v26, v26
  v_mov_b32 v12, v25
  v_mul_f32 v15, v15, v26
  v_accvgpr_read_b32 v27, a128
  v_mul_f32 v27, v27, v26
  v_accvgpr_write_b32 a128, v27
  v_accvgpr_read_b32 v27, a129
  v_mul_f32 v27, v27, v26
  v_accvgpr_write_b32 a129, v27
  v_accvgpr_read_b32 v27, a130
  v_mul_f32 v27, v27, v26
  v_accvgpr_write_b32 a130, v27
  v_accvgpr_read_b32 v27, a131
  v_mul_f32 v27, v27, v26
  v_accvgpr_write_b32 a131, v27
  v_accvgpr_read_b32 v27, a132
  v_mul_f32 v27, v27, v26
  v_accvgpr_write_b32 a132, v27
  v_accvgpr_read_b32 v27, a133
  v_mul_f32 v27, v27, v26
  v_accvgpr_write_b32 a133, v27
  v_accvgpr_read_b32 v27, a134
  v_mul_f32 v27, v27, v26
  v_accvgpr_write_b32 a134, v27
  v_accvgpr_read_b32 v27, a135
  v_mul_f32 v27, v27, v26
  v_accvgpr_write_b32 a135, v27
  v_accvgpr_read_b32 v27, a136
  v_mul_f32 v27, v27, v26
  v_accvgpr_write_b32 a136, v27
  v_accvgpr_read_b32 v27, a137
  v_mul_f32 v27, v27, v26
  v_accvgpr_write_b32 a137, v27
  v_accvgpr_read_b32 v27, a138
  v_mul_f32 v27, v27, v26
  v_accvgpr_write_b32 a138, v27
  v_accvgpr_read_b32 v27, a139
  v_mul_f32 v27, v27, v26
  v_accvgpr_write_b32 a139, v27
  v_accvgpr_read_b32 v27, a140
  v_mul_f32 v27, v27, v26
  v_accvgpr_write_b32 a140, v27
  v_accvgpr_read_b32 v27, a141
  v_mul_f32 v27, v27, v26
  v_accvgpr_write_b32 a141, v27
  v_accvgpr_read_b32 v27, a142
  v_mul_f32 v27, v27, v26
  v_accvgpr_write_b32 a142, v27
  v_accvgpr_read_b32 v27, a143
  v_mul_f32 v27, v27, v26
  v_accvgpr_write_b32 a143, v27
  v_accvgpr_read_b32 v27, a144
  v_mul_f32 v27, v27, v26
  v_accvgpr_write_b32 a144, v27
  v_accvgpr_read_b32 v27, a145
  v_mul_f32 v27, v27, v26
  v_accvgpr_write_b32 a145, v27
  v_accvgpr_read_b32 v27, a146
  v_mul_f32 v27, v27, v26
  v_accvgpr_write_b32 a146, v27
  v_accvgpr_read_b32 v27, a147
  v_mul_f32 v27, v27, v26
  v_accvgpr_write_b32 a147, v27
  v_accvgpr_read_b32 v27, a148
  v_mul_f32 v27, v27, v26
  v_accvgpr_write_b32 a148, v27
  v_accvgpr_read_b32 v27, a149
  v_mul_f32 v27, v27, v26
  v_accvgpr_write_b32 a149, v27
  v_accvgpr_read_b32 v27, a150
  v_mul_f32 v27, v27, v26
  v_accvgpr_write_b32 a150, v27
  v_accvgpr_read_b32 v27, a151
  v_mul_f32 v27, v27, v26
  v_accvgpr_write_b32 a151, v27
  v_accvgpr_read_b32 v27, a152
  v_mul_f32 v27, v27, v26
  v_accvgpr_write_b32 a152, v27
  v_accvgpr_read_b32 v27, a153
  v_mul_f32 v27, v27, v26
  v_accvgpr_write_b32 a153, v27
  v_accvgpr_read_b32 v27, a154
  v_mul_f32 v27, v27, v26
  v_accvgpr_write_b32 a154, v27
  v_accvgpr_read_b32 v27, a155
  v_mul_f32 v27, v27, v26
  v_accvgpr_write_b32 a155, v27
  v_accvgpr_read_b32 v27, a156
  v_mul_f32 v27, v27, v26
  v_accvgpr_write_b32 a156, v27
  v_accvgpr_read_b32 v27, a157
  v_mul_f32 v27, v27, v26
  v_accvgpr_write_b32 a157, v27
  v_accvgpr_read_b32 v27, a158
  v_mul_f32 v27, v27, v26
  v_accvgpr_write_b32 a158, v27
  v_accvgpr_read_b32 v27, a159
  v_mul_f32 v27, v27, v26
  v_accvgpr_write_b32 a159, v27
  v_accvgpr_read_b32 v27, a160
  v_mul_f32 v27, v27, v26
  v_accvgpr_write_b32 a160, v27
  v_accvgpr_read_b32 v27, a161
  v_mul_f32 v27, v27, v26
  v_accvgpr_write_b32 a161, v27
  v_accvgpr_read_b32 v27, a162
  v_mul_f32 v27, v27, v26
  v_accvgpr_write_b32 a162, v27
  v_accvgpr_read_b32 v27, a163
  v_mul_f32 v27, v27, v26
  v_accvgpr_write_b32 a163, v27
  v_accvgpr_read_b32 v27, a164
  v_mul_f32 v27, v27, v26
  v_accvgpr_write_b32 a164, v27
  v_accvgpr_read_b32 v27, a165
  v_mul_f32 v27, v27, v26
  v_accvgpr_write_b32 a165, v27
  v_accvgpr_read_b32 v27, a166
  v_mul_f32 v27, v27, v26
  v_accvgpr_write_b32 a166, v27
  v_accvgpr_read_b32 v27, a167
  v_mul_f32 v27, v27, v26
  v_accvgpr_write_b32 a167, v27
  v_accvgpr_read_b32 v27, a168
  v_mul_f32 v27, v27, v26
  v_accvgpr_write_b32 a168, v27
  v_accvgpr_read_b32 v27, a169
  v_mul_f32 v27, v27, v26
  v_accvgpr_write_b32 a169, v27
  v_accvgpr_read_b32 v27, a170
  v_mul_f32 v27, v27, v26
  v_accvgpr_write_b32 a170, v27
  v_accvgpr_read_b32 v27, a171
  v_mul_f32 v27, v27, v26
  v_accvgpr_write_b32 a171, v27
  v_accvgpr_read_b32 v27, a172
  v_mul_f32 v27, v27, v26
  v_accvgpr_write_b32 a172, v27
  v_accvgpr_read_b32 v27, a173
  v_mul_f32 v27, v27, v26
  v_accvgpr_write_b32 a173, v27
  v_accvgpr_read_b32 v27, a174
  v_mul_f32 v27, v27, v26
  v_accvgpr_write_b32 a174, v27
  v_accvgpr_read_b32 v27, a175
  v_mul_f32 v27, v27, v26
  v_accvgpr_write_b32 a175, v27
  v_accvgpr_read_b32 v27, a176
  v_mul_f32 v27, v27, v26
  v_accvgpr_write_b32 a176, v27
  v_accvgpr_read_b32 v27, a177
  v_mul_f32 v27, v27, v26
  v_accvgpr_write_b32 a177, v27
  v_accvgpr_read_b32 v27, a178
  v_mul_f32 v27, v27, v26
  v_accvgpr_write_b32 a178, v27
  v_accvgpr_read_b32 v27, a179
  v_mul_f32 v27, v27, v26
  v_accvgpr_write_b32 a179, v27
  v_accvgpr_read_b32 v27, a180
  v_mul_f32 v27, v27, v26
  v_accvgpr_write_b32 a180, v27
  v_accvgpr_read_b32 v27, a181
  v_mul_f32 v27, v27, v26
  v_accvgpr_write_b32 a181, v27
  v_accvgpr_read_b32 v27, a182
  v_mul_f32 v27, v27, v26
  v_accvgpr_write_b32 a182, v27
  v_accvgpr_read_b32 v27, a183
  v_mul_f32 v27, v27, v26
  v_accvgpr_write_b32 a183, v27
  v_accvgpr_read_b32 v27, a184
  v_mul_f32 v27, v27, v26
  v_accvgpr_write_b32 a184, v27
  v_accvgpr_read_b32 v27, a185
  v_mul_f32 v27, v27, v26
  v_accvgpr_write_b32 a185, v27
  v_accvgpr_read_b32 v27, a186
  v_mul_f32 v27, v27, v26
  v_accvgpr_write_b32 a186, v27
  v_accvgpr_read_b32 v27, a187
  v_mul_f32 v27, v27, v26
  v_accvgpr_write_b32 a187, v27
  v_accvgpr_read_b32 v27, a188
  v_mul_f32 v27, v27, v26
  v_accvgpr_write_b32 a188, v27
  v_accvgpr_read_b32 v27, a189
  v_mul_f32 v27, v27, v26
  v_accvgpr_write_b32 a189, v27
  v_accvgpr_read_b32 v27, a190
  v_mul_f32 v27, v27, v26
  v_accvgpr_write_b32 a190, v27
  v_accvgpr_read_b32 v27, a191
  v_mul_f32 v27, v27, v26
  v_accvgpr_write_b32 a191, v27
  s_nop 1
  s_branch Lrare_1_ret
Lrare_2:
  v_max_f32 v19, v10, v16
  v_sub_f32 v20, v10, v19
  v_exp_f32 v20, v20
  v_mov_b32 v10, v19
  v_mul_f32 v13, v13, v20
  v_accvgpr_read_b32 v21, a0
  v_mul_f32 v21, v21, v20
  v_accvgpr_write_b32 a0, v21
  v_accvgpr_read_b32 v21, a1
  v_mul_f32 v21, v21, v20
  v_accvgpr_write_b32 a1, v21
  v_accvgpr_read_b32 v21, a2
  v_mul_f32 v21, v21, v20
  v_accvgpr_write_b32 a2, v21
  v_accvgpr_read_b32 v21, a3
  v_mul_f32 v21, v21, v20
  v_accvgpr_write_b32 a3, v21
  v_accvgpr_read_b32 v21, a4
  v_mul_f32 v21, v21, v20
  v_accvgpr_write_b32 a4, v21
  v_accvgpr_read_b32 v21, a5
  v_mul_f32 v21, v21, v20
  v_accvgpr_write_b32 a5, v21
  v_accvgpr_read_b32 v21, a6
  v_mul_f32 v21, v21, v20
  v_accvgpr_write_b32 a6, v21
  v_accvgpr_read_b32 v21, a7
  v_mul_f32 v21, v21, v20
  v_accvgpr_write_b32 a7, v21
  v_accvgpr_read_b32 v21, a8
  v_mul_f32 v21, v21, v20
  v_accvgpr_write_b32 a8, v21
  v_accvgpr_read_b32 v21, a9
  v_mul_f32 v21, v21, v20
  v_accvgpr_write_b32 a9, v21
  v_accvgpr_read_b32 v21, a10
  v_mul_f32 v21, v21, v20
  v_accvgpr_write_b32 a10, v21
  v_accvgpr_read_b32 v21, a11
  v_mul_f32 v21, v21, v20
  v_accvgpr_write_b32 a11, v21
  v_accvgpr_read_b32 v21, a12
  v_mul_f32 v21, v21, v20
  v_accvgpr_write_b32 a12, v21
  v_accvgpr_read_b32 v21, a13
  v_mul_f32 v21, v21, v20
  v_accvgpr_write_b32 a13, v21
  v_accvgpr_read_b32 v21, a14
  v_mul_f32 v21, v21, v20
  v_accvgpr_write_b32 a14, v21
  v_accvgpr_read_b32 v21, a15
  v_mul_f32 v21, v21, v20
  v_accvgpr_write_b32 a15, v21
  v_accvgpr_read_b32 v21, a16
  v_mul_f32 v21, v21, v20
  v_accvgpr_write_b32 a16, v21
  v_accvgpr_read_b32 v21, a17
  v_mul_f32 v21, v21, v20
  v_accvgpr_write_b32 a17, v21
  v_accvgpr_read_b32 v21, a18
  v_mul_f32 v21, v21, v20
  v_accvgpr_write_b32 a18, v21
  v_accvgpr_read_b32 v21, a19
  v_mul_f32 v21, v21, v20
  v_accvgpr_write_b32 a19, v21
  v_accvgpr_read_b32 v21, a20
  v_mul_f32 v21, v21, v20
  v_accvgpr_write_b32 a20, v21
  v_accvgpr_read_b32 v21, a21
  v_mul_f32 v21, v21, v20
  v_accvgpr_write_b32 a21, v21
  v_accvgpr_read_b32 v21, a22
  v_mul_f32 v21, v21, v20
  v_accvgpr_write_b32 a22, v21
  v_accvgpr_read_b32 v21, a23
  v_mul_f32 v21, v21, v20
  v_accvgpr_write_b32 a23, v21
  v_accvgpr_read_b32 v21, a24
  v_mul_f32 v21, v21, v20
  v_accvgpr_write_b32 a24, v21
  v_accvgpr_read_b32 v21, a25
  v_mul_f32 v21, v21, v20
  v_accvgpr_write_b32 a25, v21
  v_accvgpr_read_b32 v21, a26
  v_mul_f32 v21, v21, v20
  v_accvgpr_write_b32 a26, v21
  v_accvgpr_read_b32 v21, a27
  v_mul_f32 v21, v21, v20
  v_accvgpr_write_b32 a27, v21
  v_accvgpr_read_b32 v21, a28
  v_mul_f32 v21, v21, v20
  v_accvgpr_write_b32 a28, v21
  v_accvgpr_read_b32 v21, a29
  v_mul_f32 v21, v21, v20
  v_accvgpr_write_b32 a29, v21
  v_accvgpr_read_b32 v21, a30
  v_mul_f32 v21, v21, v20
  v_accvgpr_write_b32 a30, v21
  v_accvgpr_read_b32 v21, a31
  v_mul_f32 v21, v21, v20
  v_accvgpr_write_b32 a31, v21
  v_accvgpr_read_b32 v21, a32
  v_mul_f32 v21, v21, v20
  v_accvgpr_write_b32 a32, v21
  v_accvgpr_read_b32 v21, a33
  v_mul_f32 v21, v21, v20
  v_accvgpr_write_b32 a33, v21
  v_accvgpr_read_b32 v21, a34
  v_mul_f32 v21, v21, v20
  v_accvgpr_write_b32 a34, v21
  v_accvgpr_read_b32 v21, a35
  v_mul_f32 v21, v21, v20
  v_accvgpr_write_b32 a35, v21
  v_accvgpr_read_b32 v21, a36
  v_mul_f32 v21, v21, v20
  v_accvgpr_write_b32 a36, v21
  v_accvgpr_read_b32 v21, a37
  v_mul_f32 v21, v21, v20
  v_accvgpr_write_b32 a37, v21
  v_accvgpr_read_b32 v21, a38
  v_mul_f32 v21, v21, v20
  v_accvgpr_write_b32 a38, v21
  v_accvgpr_read_b32 v21, a39
  v_mul_f32 v21, v21, v20
  v_accvgpr_write_b32 a39, v21
  v_accvgpr_read_b32 v21, a40
  v_mul_f32 v21, v21, v20
  v_accvgpr_write_b32 a40, v21
  v_accvgpr_read_b32 v21, a41
  v_mul_f32 v21, v21, v20
  v_accvgpr_write_b32 a41, v21
  v_accvgpr_read_b32 v21, a42
  v_mul_f32 v21, v21, v20
  v_accvgpr_write_b32 a42, v21
  v_accvgpr_read_b32 v21, a43
  v_mul_f32 v21, v21, v20
  v_accvgpr_write_b32 a43, v21
  v_accvgpr_read_b32 v21, a44
  v_mul_f32 v21, v21, v20
  v_accvgpr_write_b32 a44, v21
  v_accvgpr_read_b32 v21, a45
  v_mul_f32 v21, v21, v20
  v_accvgpr_write_b32 a45, v21
  v_accvgpr_read_b32 v21, a46
  v_mul_f32 v21, v21, v20
  v_accvgpr_write_b32 a46, v21
  v_accvgpr_read_b32 v21, a47
  v_mul_f32 v21, v21, v20
  v_accvgpr_write_b32 a47, v21
  v_accvgpr_read_b32 v21, a48
  v_mul_f32 v21, v21, v20
  v_accvgpr_write_b32 a48, v21
  v_accvgpr_read_b32 v21, a49
  v_mul_f32 v21, v21, v20
  v_accvgpr_write_b32 a49, v21
  v_accvgpr_read_b32 v21, a50
  v_mul_f32 v21, v21, v20
  v_accvgpr_write_b32 a50, v21
  v_accvgpr_read_b32 v21, a51
  v_mul_f32 v21, v21, v20
  v_accvgpr_write_b32 a51, v21
  v_accvgpr_read_b32 v21, a52
  v_mul_f32 v21, v21, v20
  v_accvgpr_write_b32 a52, v21
  v_accvgpr_read_b32 v21, a53
  v_mul_f32 v21, v21, v20
  v_accvgpr_write_b32 a53, v21
  v_accvgpr_read_b32 v21, a54
  v_mul_f32 v21, v21, v20
  v_accvgpr_write_b32 a54, v21
  v_accvgpr_read_b32 v21, a55
  v_mul_f32 v21, v21, v20
  v_accvgpr_write_b32 a55, v21
  v_accvgpr_read_b32 v21, a56
  v_mul_f32 v21, v21, v20
  v_accvgpr_write_b32 a56, v21
  v_accvgpr_read_b32 v21, a57
  v_mul_f32 v21, v21, v20
  v_accvgpr_write_b32 a57, v21
  v_accvgpr_read_b32 v21, a58
  v_mul_f32 v21, v21, v20
  v_accvgpr_write_b32 a58, v21
  v_accvgpr_read_b32 v21, a59
  v_mul_f32 v21, v21, v20
  v_accvgpr_write_b32 a59, v21
  v_accvgpr_read_b32 v21, a60
  v_mul_f32 v21, v21, v20
  v_accvgpr_write_b32 a60, v21
  v_accvgpr_read_b32 v21, a61
  v_mul_f32 v21, v21, v20
  v_accvgpr_write_b32 a61, v21
  v_accvgpr_read_b32 v21, a62
  v_mul_f32 v21, v21, v20
  v_accvgpr_write_b32 a62, v21
  v_accvgpr_read_b32 v21, a63
  v_mul_f32 v21, v21, v20
  v_accvgpr_write_b32 a63, v21
  v_max_f32 v22, v11, v17
  v_sub_f32 v23, v11, v22
  v_exp_f32 v23, v23
  v_mov_b32 v11, v22
  v_mul_f32 v14, v14, v23
  v_accvgpr_read_b32 v24, a64
  v_mul_f32 v24, v24, v23
  v_accvgpr_write_b32 a64, v24
  v_accvgpr_read_b32 v24, a65
  v_mul_f32 v24, v24, v23
  v_accvgpr_write_b32 a65, v24
  v_accvgpr_read_b32 v24, a66
  v_mul_f32 v24, v24, v23
  v_accvgpr_write_b32 a66, v24
  v_accvgpr_read_b32 v24, a67
  v_mul_f32 v24, v24, v23
  v_accvgpr_write_b32 a67, v24
  v_accvgpr_read_b32 v24, a68
  v_mul_f32 v24, v24, v23
  v_accvgpr_write_b32 a68, v24
  v_accvgpr_read_b32 v24, a69
  v_mul_f32 v24, v24, v23
  v_accvgpr_write_b32 a69, v24
  v_accvgpr_read_b32 v24, a70
  v_mul_f32 v24, v24, v23
  v_accvgpr_write_b32 a70, v24
  v_accvgpr_read_b32 v24, a71
  v_mul_f32 v24, v24, v23
  v_accvgpr_write_b32 a71, v24
  v_accvgpr_read_b32 v24, a72
  v_mul_f32 v24, v24, v23
  v_accvgpr_write_b32 a72, v24
  v_accvgpr_read_b32 v24, a73
  v_mul_f32 v24, v24, v23
  v_accvgpr_write_b32 a73, v24
  v_accvgpr_read_b32 v24, a74
  v_mul_f32 v24, v24, v23
  v_accvgpr_write_b32 a74, v24
  v_accvgpr_read_b32 v24, a75
  v_mul_f32 v24, v24, v23
  v_accvgpr_write_b32 a75, v24
  v_accvgpr_read_b32 v24, a76
  v_mul_f32 v24, v24, v23
  v_accvgpr_write_b32 a76, v24
  v_accvgpr_read_b32 v24, a77
  v_mul_f32 v24, v24, v23
  v_accvgpr_write_b32 a77, v24
  v_accvgpr_read_b32 v24, a78
  v_mul_f32 v24, v24, v23
  v_accvgpr_write_b32 a78, v24
  v_accvgpr_read_b32 v24, a79
  v_mul_f32 v24, v24, v23
  v_accvgpr_write_b32 a79, v24
  v_accvgpr_read_b32 v24, a80
  v_mul_f32 v24, v24, v23
  v_accvgpr_write_b32 a80, v24
  v_accvgpr_read_b32 v24, a81
  v_mul_f32 v24, v24, v23
  v_accvgpr_write_b32 a81, v24
  v_accvgpr_read_b32 v24, a82
  v_mul_f32 v24, v24, v23
  v_accvgpr_write_b32 a82, v24
  v_accvgpr_read_b32 v24, a83
  v_mul_f32 v24, v24, v23
  v_accvgpr_write_b32 a83, v24
  v_accvgpr_read_b32 v24, a84
  v_mul_f32 v24, v24, v23
  v_accvgpr_write_b32 a84, v24
  v_accvgpr_read_b32 v24, a85
  v_mul_f32 v24, v24, v23
  v_accvgpr_write_b32 a85, v24
  v_accvgpr_read_b32 v24, a86
  v_mul_f32 v24, v24, v23
  v_accvgpr_write_b32 a86, v24
  v_accvgpr_read_b32 v24, a87
  v_mul_f32 v24, v24, v23
  v_accvgpr_write_b32 a87, v24
  v_accvgpr_read_b32 v24, a88
  v_mul_f32 v24, v24, v23
  v_accvgpr_write_b32 a88, v24
  v_accvgpr_read_b32 v24, a89
  v_mul_f32 v24, v24, v23
  v_accvgpr_write_b32 a89, v24
  v_accvgpr_read_b32 v24, a90
  v_mul_f32 v24, v24, v23
  v_accvgpr_write_b32 a90, v24
  v_accvgpr_read_b32 v24, a91
  v_mul_f32 v24, v24, v23
  v_accvgpr_write_b32 a91, v24
  v_accvgpr_read_b32 v24, a92
  v_mul_f32 v24, v24, v23
  v_accvgpr_write_b32 a92, v24
  v_accvgpr_read_b32 v24, a93
  v_mul_f32 v24, v24, v23
  v_accvgpr_write_b32 a93, v24
  v_accvgpr_read_b32 v24, a94
  v_mul_f32 v24, v24, v23
  v_accvgpr_write_b32 a94, v24
  v_accvgpr_read_b32 v24, a95
  v_mul_f32 v24, v24, v23
  v_accvgpr_write_b32 a95, v24
  v_accvgpr_read_b32 v24, a96
  v_mul_f32 v24, v24, v23
  v_accvgpr_write_b32 a96, v24
  v_accvgpr_read_b32 v24, a97
  v_mul_f32 v24, v24, v23
  v_accvgpr_write_b32 a97, v24
  v_accvgpr_read_b32 v24, a98
  v_mul_f32 v24, v24, v23
  v_accvgpr_write_b32 a98, v24
  v_accvgpr_read_b32 v24, a99
  v_mul_f32 v24, v24, v23
  v_accvgpr_write_b32 a99, v24
  v_accvgpr_read_b32 v24, a100
  v_mul_f32 v24, v24, v23
  v_accvgpr_write_b32 a100, v24
  v_accvgpr_read_b32 v24, a101
  v_mul_f32 v24, v24, v23
  v_accvgpr_write_b32 a101, v24
  v_accvgpr_read_b32 v24, a102
  v_mul_f32 v24, v24, v23
  v_accvgpr_write_b32 a102, v24
  v_accvgpr_read_b32 v24, a103
  v_mul_f32 v24, v24, v23
  v_accvgpr_write_b32 a103, v24
  v_accvgpr_read_b32 v24, a104
  v_mul_f32 v24, v24, v23
  v_accvgpr_write_b32 a104, v24
  v_accvgpr_read_b32 v24, a105
  v_mul_f32 v24, v24, v23
  v_accvgpr_write_b32 a105, v24
  v_accvgpr_read_b32 v24, a106
  v_mul_f32 v24, v24, v23
  v_accvgpr_write_b32 a106, v24
  v_accvgpr_read_b32 v24, a107
  v_mul_f32 v24, v24, v23
  v_accvgpr_write_b32 a107, v24
  v_accvgpr_read_b32 v24, a108
  v_mul_f32 v24, v24, v23
  v_accvgpr_write_b32 a108, v24
  v_accvgpr_read_b32 v24, a109
  v_mul_f32 v24, v24, v23
  v_accvgpr_write_b32 a109, v24
  v_accvgpr_read_b32 v24, a110
  v_mul_f32 v24, v24, v23
  v_accvgpr_write_b32 a110, v24
  v_accvgpr_read_b32 v24, a111
  v_mul_f32 v24, v24, v23
  v_accvgpr_write_b32 a111, v24
  v_accvgpr_read_b32 v24, a112
  v_mul_f32 v24, v24, v23
  v_accvgpr_write_b32 a112, v24
  v_accvgpr_read_b32 v24, a113
  v_mul_f32 v24, v24, v23
  v_accvgpr_write_b32 a113, v24
  v_accvgpr_read_b32 v24, a114
  v_mul_f32 v24, v24, v23
  v_accvgpr_write_b32 a114, v24
  v_accvgpr_read_b32 v24, a115
  v_mul_f32 v24, v24, v23
  v_accvgpr_write_b32 a115, v24
  v_accvgpr_read_b32 v24, a116
  v_mul_f32 v24, v24, v23
  v_accvgpr_write_b32 a116, v24
  v_accvgpr_read_b32 v24, a117
  v_mul_f32 v24, v24, v23
  v_accvgpr_write_b32 a117, v24
  v_accvgpr_read_b32 v24, a118
  v_mul_f32 v24, v24, v23
  v_accvgpr_write_b32 a118, v24
  v_accvgpr_read_b32 v24, a119
  v_mul_f32 v24, v24, v23
  v_accvgpr_write_b32 a119, v24
  v_accvgpr_read_b32 v24, a120
  v_mul_f32 v24, v24, v23
  v_accvgpr_write_b32 a120, v24
  v_accvgpr_read_b32 v24, a121
  v_mul_f32 v24, v24, v23
  v_accvgpr_write_b32 a121, v24
  v_accvgpr_read_b32 v24, a122
  v_mul_f32 v24, v24, v23
  v_accvgpr_write_b32 a122, v24
  v_accvgpr_read_b32 v24, a123
  v_mul_f32 v24, v24, v23
  v_accvgpr_write_b32 a123, v24
  v_accvgpr_read_b32 v24, a124
  v_mul_f32 v24, v24, v23
  v_accvgpr_write_b32 a124, v24
  v_accvgpr_read_b32 v24, a125
  v_mul_f32 v24, v24, v23
  v_accvgpr_write_b32 a125, v24
  v_accvgpr_read_b32 v24, a126
  v_mul_f32 v24, v24, v23
  v_accvgpr_write_b32 a126, v24
  v_accvgpr_read_b32 v24, a127
  v_mul_f32 v24, v24, v23
  v_accvgpr_write_b32 a127, v24
  v_max_f32 v25, v12, v18
  v_sub_f32 v26, v12, v25
  v_exp_f32 v26, v26
  v_mov_b32 v12, v25
  v_mul_f32 v15, v15, v26
  v_accvgpr_read_b32 v27, a128
  v_mul_f32 v27, v27, v26
  v_accvgpr_write_b32 a128, v27
  v_accvgpr_read_b32 v27, a129
  v_mul_f32 v27, v27, v26
  v_accvgpr_write_b32 a129, v27
  v_accvgpr_read_b32 v27, a130
  v_mul_f32 v27, v27, v26
  v_accvgpr_write_b32 a130, v27
  v_accvgpr_read_b32 v27, a131
  v_mul_f32 v27, v27, v26
  v_accvgpr_write_b32 a131, v27
  v_accvgpr_read_b32 v27, a132
  v_mul_f32 v27, v27, v26
  v_accvgpr_write_b32 a132, v27
  v_accvgpr_read_b32 v27, a133
  v_mul_f32 v27, v27, v26
  v_accvgpr_write_b32 a133, v27
  v_accvgpr_read_b32 v27, a134
  v_mul_f32 v27, v27, v26
  v_accvgpr_write_b32 a134, v27
  v_accvgpr_read_b32 v27, a135
  v_mul_f32 v27, v27, v26
  v_accvgpr_write_b32 a135, v27
  v_accvgpr_read_b32 v27, a136
  v_mul_f32 v27, v27, v26
  v_accvgpr_write_b32 a136, v27
  v_accvgpr_read_b32 v27, a137
  v_mul_f32 v27, v27, v26
  v_accvgpr_write_b32 a137, v27
  v_accvgpr_read_b32 v27, a138
  v_mul_f32 v27, v27, v26
  v_accvgpr_write_b32 a138, v27
  v_accvgpr_read_b32 v27, a139
  v_mul_f32 v27, v27, v26
  v_accvgpr_write_b32 a139, v27
  v_accvgpr_read_b32 v27, a140
  v_mul_f32 v27, v27, v26
  v_accvgpr_write_b32 a140, v27
  v_accvgpr_read_b32 v27, a141
  v_mul_f32 v27, v27, v26
  v_accvgpr_write_b32 a141, v27
  v_accvgpr_read_b32 v27, a142
  v_mul_f32 v27, v27, v26
  v_accvgpr_write_b32 a142, v27
  v_accvgpr_read_b32 v27, a143
  v_mul_f32 v27, v27, v26
  v_accvgpr_write_b32 a143, v27
  v_accvgpr_read_b32 v27, a144
  v_mul_f32 v27, v27, v26
  v_accvgpr_write_b32 a144, v27
  v_accvgpr_read_b32 v27, a145
  v_mul_f32 v27, v27, v26
  v_accvgpr_write_b32 a145, v27
  v_accvgpr_read_b32 v27, a146
  v_mul_f32 v27, v27, v26
  v_accvgpr_write_b32 a146, v27
  v_accvgpr_read_b32 v27, a147
  v_mul_f32 v27, v27, v26
  v_accvgpr_write_b32 a147, v27
  v_accvgpr_read_b32 v27, a148
  v_mul_f32 v27, v27, v26
  v_accvgpr_write_b32 a148, v27
  v_accvgpr_read_b32 v27, a149
  v_mul_f32 v27, v27, v26
  v_accvgpr_write_b32 a149, v27
  v_accvgpr_read_b32 v27, a150
  v_mul_f32 v27, v27, v26
  v_accvgpr_write_b32 a150, v27
  v_accvgpr_read_b32 v27, a151
  v_mul_f32 v27, v27, v26
  v_accvgpr_write_b32 a151, v27
  v_accvgpr_read_b32 v27, a152
  v_mul_f32 v27, v27, v26
  v_accvgpr_write_b32 a152, v27
  v_accvgpr_read_b32 v27, a153
  v_mul_f32 v27, v27, v26
  v_accvgpr_write_b32 a153, v27
  v_accvgpr_read_b32 v27, a154
  v_mul_f32 v27, v27, v26
  v_accvgpr_write_b32 a154, v27
  v_accvgpr_read_b32 v27, a155
  v_mul_f32 v27, v27, v26
  v_accvgpr_write_b32 a155, v27
  v_accvgpr_read_b32 v27, a156
  v_mul_f32 v27, v27, v26
  v_accvgpr_write_b32 a156, v27
  v_accvgpr_read_b32 v27, a157
  v_mul_f32 v27, v27, v26
  v_accvgpr_write_b32 a157, v27
  v_accvgpr_read_b32 v27, a158
  v_mul_f32 v27, v27, v26
  v_accvgpr_write_b32 a158, v27
  v_accvgpr_read_b32 v27, a159
  v_mul_f32 v27, v27, v26
  v_accvgpr_write_b32 a159, v27
  v_accvgpr_read_b32 v27, a160
  v_mul_f32 v27, v27, v26
  v_accvgpr_write_b32 a160, v27
  v_accvgpr_read_b32 v27, a161
  v_mul_f32 v27, v27, v26
  v_accvgpr_write_b32 a161, v27
  v_accvgpr_read_b32 v27, a162
  v_mul_f32 v27, v27, v26
  v_accvgpr_write_b32 a162, v27
  v_accvgpr_read_b32 v27, a163
  v_mul_f32 v27, v27, v26
  v_accvgpr_write_b32 a163, v27
  v_accvgpr_read_b32 v27, a164
  v_mul_f32 v27, v27, v26
  v_accvgpr_write_b32 a164, v27
  v_accvgpr_read_b32 v27, a165
  v_mul_f32 v27, v27, v26
  v_accvgpr_write_b32 a165, v27
  v_accvgpr_read_b32 v27, a166
  v_mul_f32 v27, v27, v26
  v_accvgpr_write_b32 a166, v27
  v_accvgpr_read_b32 v27, a167
  v_mul_f32 v27, v27, v26
  v_accvgpr_write_b32 a167, v27
  v_accvgpr_read_b32 v27, a168
  v_mul_f32 v27, v27, v26
  v_accvgpr_write_b32 a168, v27
  v_accvgpr_read_b32 v27, a169
  v_mul_f32 v27, v27, v26
  v_accvgpr_write_b32 a169, v27
  v_accvgpr_read_b32 v27, a170
  v_mul_f32 v27, v27, v26
  v_accvgpr_write_b32 a170, v27
  v_accvgpr_read_b32 v27, a171
  v_mul_f32 v27, v27, v26
  v_accvgpr_write_b32 a171, v27
  v_accvgpr_read_b32 v27, a172
  v_mul_f32 v27, v27, v26
  v_accvgpr_write_b32 a172, v27
  v_accvgpr_read_b32 v27, a173
  v_mul_f32 v27, v27, v26
  v_accvgpr_write_b32 a173, v27
  v_accvgpr_read_b32 v27, a174
  v_mul_f32 v27, v27, v26
  v_accvgpr_write_b32 a174, v27
  v_accvgpr_read_b32 v27, a175
  v_mul_f32 v27, v27, v26
  v_accvgpr_write_b32 a175, v27
  v_accvgpr_read_b32 v27, a176
  v_mul_f32 v27, v27, v26
  v_accvgpr_write_b32 a176, v27
  v_accvgpr_read_b32 v27, a177
  v_mul_f32 v27, v27, v26
  v_accvgpr_write_b32 a177, v27
  v_accvgpr_read_b32 v27, a178
  v_mul_f32 v27, v27, v26
  v_accvgpr_write_b32 a178, v27
  v_accvgpr_read_b32 v27, a179
  v_mul_f32 v27, v27, v26
  v_accvgpr_write_b32 a179, v27
  v_accvgpr_read_b32 v27, a180
  v_mul_f32 v27, v27, v26
  v_accvgpr_write_b32 a180, v27
  v_accvgpr_read_b32 v27, a181
  v_mul_f32 v27, v27, v26
  v_accvgpr_write_b32 a181, v27
  v_accvgpr_read_b32 v27, a182
  v_mul_f32 v27, v27, v26
  v_accvgpr_write_b32 a182, v27
  v_accvgpr_read_b32 v27, a183
  v_mul_f32 v27, v27, v26
  v_accvgpr_write_b32 a183, v27
  v_accvgpr_read_b32 v27, a184
  v_mul_f32 v27, v27, v26
  v_accvgpr_write_b32 a184, v27
  v_accvgpr_read_b32 v27, a185
  v_mul_f32 v27, v27, v26
  v_accvgpr_write_b32 a185, v27
  v_accvgpr_read_b32 v27, a186
  v_mul_f32 v27, v27, v26
  v_accvgpr_write_b32 a186, v27
  v_accvgpr_read_b32 v27, a187
  v_mul_f32 v27, v27, v26
  v_accvgpr_write_b32 a187, v27
  v_accvgpr_read_b32 v27, a188
  v_mul_f32 v27, v27, v26
  v_accvgpr_write_b32 a188, v27
  v_accvgpr_read_b32 v27, a189
  v_mul_f32 v27, v27, v26
  v_accvgpr_write_b32 a189, v27
  v_accvgpr_read_b32 v27, a190
  v_mul_f32 v27, v27, v26
  v_accvgpr_write_b32 a190, v27
  v_accvgpr_read_b32 v27, a191
  v_mul_f32 v27, v27, v26
  v_accvgpr_write_b32 a191, v27
  s_nop 1
  s_branch Lrare_2_ret
Lrare_3:
  v_max_f32 v19, v10, v16
  v_sub_f32 v20, v10, v19
  v_exp_f32 v20, v20
  v_mov_b32 v10, v19
  v_mul_f32 v13, v13, v20
  v_accvgpr_read_b32 v21, a0
  v_mul_f32 v21, v21, v20
  v_accvgpr_write_b32 a0, v21
  v_accvgpr_read_b32 v21, a1
  v_mul_f32 v21, v21, v20
  v_accvgpr_write_b32 a1, v21
  v_accvgpr_read_b32 v21, a2
  v_mul_f32 v21, v21, v20
  v_accvgpr_write_b32 a2, v21
  v_accvgpr_read_b32 v21, a3
  v_mul_f32 v21, v21, v20
  v_accvgpr_write_b32 a3, v21
  v_accvgpr_read_b32 v21, a4
  v_mul_f32 v21, v21, v20
  v_accvgpr_write_b32 a4, v21
  v_accvgpr_read_b32 v21, a5
  v_mul_f32 v21, v21, v20
  v_accvgpr_write_b32 a5, v21
  v_accvgpr_read_b32 v21, a6
  v_mul_f32 v21, v21, v20
  v_accvgpr_write_b32 a6, v21
  v_accvgpr_read_b32 v21, a7
  v_mul_f32 v21, v21, v20
  v_accvgpr_write_b32 a7, v21
  v_accvgpr_read_b32 v21, a8
  v_mul_f32 v21, v21, v20
  v_accvgpr_write_b32 a8, v21
  v_accvgpr_read_b32 v21, a9
  v_mul_f32 v21, v21, v20
  v_accvgpr_write_b32 a9, v21
  v_accvgpr_read_b32 v21, a10
  v_mul_f32 v21, v21, v20
  v_accvgpr_write_b32 a10, v21
  v_accvgpr_read_b32 v21, a11
  v_mul_f32 v21, v21, v20
  v_accvgpr_write_b32 a11, v21
  v_accvgpr_read_b32 v21, a12
  v_mul_f32 v21, v21, v20
  v_accvgpr_write_b32 a12, v21
  v_accvgpr_read_b32 v21, a13
  v_mul_f32 v21, v21, v20
  v_accvgpr_write_b32 a13, v21
  v_accvgpr_read_b32 v21, a14
  v_mul_f32 v21, v21, v20
  v_accvgpr_write_b32 a14, v21
  v_accvgpr_read_b32 v21, a15
  v_mul_f32 v21, v21, v20
  v_accvgpr_write_b32 a15, v21
  v_accvgpr_read_b32 v21, a16
  v_mul_f32 v21, v21, v20
  v_accvgpr_write_b32 a16, v21
  v_accvgpr_read_b32 v21, a17
  v_mul_f32 v21, v21, v20
  v_accvgpr_write_b32 a17, v21
  v_accvgpr_read_b32 v21, a18
  v_mul_f32 v21, v21, v20
  v_accvgpr_write_b32 a18, v21
  v_accvgpr_read_b32 v21, a19
  v_mul_f32 v21, v21, v20
  v_accvgpr_write_b32 a19, v21
  v_accvgpr_read_b32 v21, a20
  v_mul_f32 v21, v21, v20
  v_accvgpr_write_b32 a20, v21
  v_accvgpr_read_b32 v21, a21
  v_mul_f32 v21, v21, v20
  v_accvgpr_write_b32 a21, v21
  v_accvgpr_read_b32 v21, a22
  v_mul_f32 v21, v21, v20
  v_accvgpr_write_b32 a22, v21
  v_accvgpr_read_b32 v21, a23
  v_mul_f32 v21, v21, v20
  v_accvgpr_write_b32 a23, v21
  v_accvgpr_read_b32 v21, a24
  v_mul_f32 v21, v21, v20
  v_accvgpr_write_b32 a24, v21
  v_accvgpr_read_b32 v21, a25
  v_mul_f32 v21, v21, v20
  v_accvgpr_write_b32 a25, v21
  v_accvgpr_read_b32 v21, a26
  v_mul_f32 v21, v21, v20
  v_accvgpr_write_b32 a26, v21
  v_accvgpr_read_b32 v21, a27
  v_mul_f32 v21, v21, v20
  v_accvgpr_write_b32 a27, v21
  v_accvgpr_read_b32 v21, a28
  v_mul_f32 v21, v21, v20
  v_accvgpr_write_b32 a28, v21
  v_accvgpr_read_b32 v21, a29
  v_mul_f32 v21, v21, v20
  v_accvgpr_write_b32 a29, v21
  v_accvgpr_read_b32 v21, a30
  v_mul_f32 v21, v21, v20
  v_accvgpr_write_b32 a30, v21
  v_accvgpr_read_b32 v21, a31
  v_mul_f32 v21, v21, v20
  v_accvgpr_write_b32 a31, v21
  v_accvgpr_read_b32 v21, a32
  v_mul_f32 v21, v21, v20
  v_accvgpr_write_b32 a32, v21
  v_accvgpr_read_b32 v21, a33
  v_mul_f32 v21, v21, v20
  v_accvgpr_write_b32 a33, v21
  v_accvgpr_read_b32 v21, a34
  v_mul_f32 v21, v21, v20
  v_accvgpr_write_b32 a34, v21
  v_accvgpr_read_b32 v21, a35
  v_mul_f32 v21, v21, v20
  v_accvgpr_write_b32 a35, v21
  v_accvgpr_read_b32 v21, a36
  v_mul_f32 v21, v21, v20
  v_accvgpr_write_b32 a36, v21
  v_accvgpr_read_b32 v21, a37
  v_mul_f32 v21, v21, v20
  v_accvgpr_write_b32 a37, v21
  v_accvgpr_read_b32 v21, a38
  v_mul_f32 v21, v21, v20
  v_accvgpr_write_b32 a38, v21
  v_accvgpr_read_b32 v21, a39
  v_mul_f32 v21, v21, v20
  v_accvgpr_write_b32 a39, v21
  v_accvgpr_read_b32 v21, a40
  v_mul_f32 v21, v21, v20
  v_accvgpr_write_b32 a40, v21
  v_accvgpr_read_b32 v21, a41
  v_mul_f32 v21, v21, v20
  v_accvgpr_write_b32 a41, v21
  v_accvgpr_read_b32 v21, a42
  v_mul_f32 v21, v21, v20
  v_accvgpr_write_b32 a42, v21
  v_accvgpr_read_b32 v21, a43
  v_mul_f32 v21, v21, v20
  v_accvgpr_write_b32 a43, v21
  v_accvgpr_read_b32 v21, a44
  v_mul_f32 v21, v21, v20
  v_accvgpr_write_b32 a44, v21
  v_accvgpr_read_b32 v21, a45
  v_mul_f32 v21, v21, v20
  v_accvgpr_write_b32 a45, v21
  v_accvgpr_read_b32 v21, a46
  v_mul_f32 v21, v21, v20
  v_accvgpr_write_b32 a46, v21
  v_accvgpr_read_b32 v21, a47
  v_mul_f32 v21, v21, v20
  v_accvgpr_write_b32 a47, v21
  v_accvgpr_read_b32 v21, a48
  v_mul_f32 v21, v21, v20
  v_accvgpr_write_b32 a48, v21
  v_accvgpr_read_b32 v21, a49
  v_mul_f32 v21, v21, v20
  v_accvgpr_write_b32 a49, v21
  v_accvgpr_read_b32 v21, a50
  v_mul_f32 v21, v21, v20
  v_accvgpr_write_b32 a50, v21
  v_accvgpr_read_b32 v21, a51
  v_mul_f32 v21, v21, v20
  v_accvgpr_write_b32 a51, v21
  v_accvgpr_read_b32 v21, a52
  v_mul_f32 v21, v21, v20
  v_accvgpr_write_b32 a52, v21
  v_accvgpr_read_b32 v21, a53
  v_mul_f32 v21, v21, v20
  v_accvgpr_write_b32 a53, v21
  v_accvgpr_read_b32 v21, a54
  v_mul_f32 v21, v21, v20
  v_accvgpr_write_b32 a54, v21
  v_accvgpr_read_b32 v21, a55
  v_mul_f32 v21, v21, v20
  v_accvgpr_write_b32 a55, v21
  v_accvgpr_read_b32 v21, a56
  v_mul_f32 v21, v21, v20
  v_accvgpr_write_b32 a56, v21
  v_accvgpr_read_b32 v21, a57
  v_mul_f32 v21, v21, v20
  v_accvgpr_write_b32 a57, v21
  v_accvgpr_read_b32 v21, a58
  v_mul_f32 v21, v21, v20
  v_accvgpr_write_b32 a58, v21
  v_accvgpr_read_b32 v21, a59
  v_mul_f32 v21, v21, v20
  v_accvgpr_write_b32 a59, v21
  v_accvgpr_read_b32 v21, a60
  v_mul_f32 v21, v21, v20
  v_accvgpr_write_b32 a60, v21
  v_accvgpr_read_b32 v21, a61
  v_mul_f32 v21, v21, v20
  v_accvgpr_write_b32 a61, v21
  v_accvgpr_read_b32 v21, a62
  v_mul_f32 v21, v21, v20
  v_accvgpr_write_b32 a62, v21
  v_accvgpr_read_b32 v21, a63
  v_mul_f32 v21, v21, v20
  v_accvgpr_write_b32 a63, v21
  v_max_f32 v22, v11, v17
  v_sub_f32 v23, v11, v22
  v_exp_f32 v23, v23
  v_mov_b32 v11, v22
  v_mul_f32 v14, v14, v23
  v_accvgpr_read_b32 v24, a64
  v_mul_f32 v24, v24, v23
  v_accvgpr_write_b32 a64, v24
  v_accvgpr_read_b32 v24, a65
  v_mul_f32 v24, v24, v23
  v_accvgpr_write_b32 a65, v24
  v_accvgpr_read_b32 v24, a66
  v_mul_f32 v24, v24, v23
  v_accvgpr_write_b32 a66, v24
  v_accvgpr_read_b32 v24, a67
  v_mul_f32 v24, v24, v23
  v_accvgpr_write_b32 a67, v24
  v_accvgpr_read_b32 v24, a68
  v_mul_f32 v24, v24, v23
  v_accvgpr_write_b32 a68, v24
  v_accvgpr_read_b32 v24, a69
  v_mul_f32 v24, v24, v23
  v_accvgpr_write_b32 a69, v24
  v_accvgpr_read_b32 v24, a70
  v_mul_f32 v24, v24, v23
  v_accvgpr_write_b32 a70, v24
  v_accvgpr_read_b32 v24, a71
  v_mul_f32 v24, v24, v23
  v_accvgpr_write_b32 a71, v24
  v_accvgpr_read_b32 v24, a72
  v_mul_f32 v24, v24, v23
  v_accvgpr_write_b32 a72, v24
  v_accvgpr_read_b32 v24, a73
  v_mul_f32 v24, v24, v23
  v_accvgpr_write_b32 a73, v24
  v_accvgpr_read_b32 v24, a74
  v_mul_f32 v24, v24, v23
  v_accvgpr_write_b32 a74, v24
  v_accvgpr_read_b32 v24, a75
  v_mul_f32 v24, v24, v23
  v_accvgpr_write_b32 a75, v24
  v_accvgpr_read_b32 v24, a76
  v_mul_f32 v24, v24, v23
  v_accvgpr_write_b32 a76, v24
  v_accvgpr_read_b32 v24, a77
  v_mul_f32 v24, v24, v23
  v_accvgpr_write_b32 a77, v24
  v_accvgpr_read_b32 v24, a78
  v_mul_f32 v24, v24, v23
  v_accvgpr_write_b32 a78, v24
  v_accvgpr_read_b32 v24, a79
  v_mul_f32 v24, v24, v23
  v_accvgpr_write_b32 a79, v24
  v_accvgpr_read_b32 v24, a80
  v_mul_f32 v24, v24, v23
  v_accvgpr_write_b32 a80, v24
  v_accvgpr_read_b32 v24, a81
  v_mul_f32 v24, v24, v23
  v_accvgpr_write_b32 a81, v24
  v_accvgpr_read_b32 v24, a82
  v_mul_f32 v24, v24, v23
  v_accvgpr_write_b32 a82, v24
  v_accvgpr_read_b32 v24, a83
  v_mul_f32 v24, v24, v23
  v_accvgpr_write_b32 a83, v24
  v_accvgpr_read_b32 v24, a84
  v_mul_f32 v24, v24, v23
  v_accvgpr_write_b32 a84, v24
  v_accvgpr_read_b32 v24, a85
  v_mul_f32 v24, v24, v23
  v_accvgpr_write_b32 a85, v24
  v_accvgpr_read_b32 v24, a86
  v_mul_f32 v24, v24, v23
  v_accvgpr_write_b32 a86, v24
  v_accvgpr_read_b32 v24, a87
  v_mul_f32 v24, v24, v23
  v_accvgpr_write_b32 a87, v24
  v_accvgpr_read_b32 v24, a88
  v_mul_f32 v24, v24, v23
  v_accvgpr_write_b32 a88, v24
  v_accvgpr_read_b32 v24, a89
  v_mul_f32 v24, v24, v23
  v_accvgpr_write_b32 a89, v24
  v_accvgpr_read_b32 v24, a90
  v_mul_f32 v24, v24, v23
  v_accvgpr_write_b32 a90, v24
  v_accvgpr_read_b32 v24, a91
  v_mul_f32 v24, v24, v23
  v_accvgpr_write_b32 a91, v24
  v_accvgpr_read_b32 v24, a92
  v_mul_f32 v24, v24, v23
  v_accvgpr_write_b32 a92, v24
  v_accvgpr_read_b32 v24, a93
  v_mul_f32 v24, v24, v23
  v_accvgpr_write_b32 a93, v24
  v_accvgpr_read_b32 v24, a94
  v_mul_f32 v24, v24, v23
  v_accvgpr_write_b32 a94, v24
  v_accvgpr_read_b32 v24, a95
  v_mul_f32 v24, v24, v23
  v_accvgpr_write_b32 a95, v24
  v_accvgpr_read_b32 v24, a96
  v_mul_f32 v24, v24, v23
  v_accvgpr_write_b32 a96, v24
  v_accvgpr_read_b32 v24, a97
  v_mul_f32 v24, v24, v23
  v_accvgpr_write_b32 a97, v24
  v_accvgpr_read_b32 v24, a98
  v_mul_f32 v24, v24, v23
  v_accvgpr_write_b32 a98, v24
  v_accvgpr_read_b32 v24, a99
  v_mul_f32 v24, v24, v23
  v_accvgpr_write_b32 a99, v24
  v_accvgpr_read_b32 v24, a100
  v_mul_f32 v24, v24, v23
  v_accvgpr_write_b32 a100, v24
  v_accvgpr_read_b32 v24, a101
  v_mul_f32 v24, v24, v23
  v_accvgpr_write_b32 a101, v24
  v_accvgpr_read_b32 v24, a102
  v_mul_f32 v24, v24, v23
  v_accvgpr_write_b32 a102, v24
  v_accvgpr_read_b32 v24, a103
  v_mul_f32 v24, v24, v23
  v_accvgpr_write_b32 a103, v24
  v_accvgpr_read_b32 v24, a104
  v_mul_f32 v24, v24, v23
  v_accvgpr_write_b32 a104, v24
  v_accvgpr_read_b32 v24, a105
  v_mul_f32 v24, v24, v23
  v_accvgpr_write_b32 a105, v24
  v_accvgpr_read_b32 v24, a106
  v_mul_f32 v24, v24, v23
  v_accvgpr_write_b32 a106, v24
  v_accvgpr_read_b32 v24, a107
  v_mul_f32 v24, v24, v23
  v_accvgpr_write_b32 a107, v24
  v_accvgpr_read_b32 v24, a108
  v_mul_f32 v24, v24, v23
  v_accvgpr_write_b32 a108, v24
  v_accvgpr_read_b32 v24, a109
  v_mul_f32 v24, v24, v23
  v_accvgpr_write_b32 a109, v24
  v_accvgpr_read_b32 v24, a110
  v_mul_f32 v24, v24, v23
  v_accvgpr_write_b32 a110, v24
  v_accvgpr_read_b32 v24, a111
  v_mul_f32 v24, v24, v23
  v_accvgpr_write_b32 a111, v24
  v_accvgpr_read_b32 v24, a112
  v_mul_f32 v24, v24, v23
  v_accvgpr_write_b32 a112, v24
  v_accvgpr_read_b32 v24, a113
  v_mul_f32 v24, v24, v23
  v_accvgpr_write_b32 a113, v24
  v_accvgpr_read_b32 v24, a114
  v_mul_f32 v24, v24, v23
  v_accvgpr_write_b32 a114, v24
  v_accvgpr_read_b32 v24, a115
  v_mul_f32 v24, v24, v23
  v_accvgpr_write_b32 a115, v24
  v_accvgpr_read_b32 v24, a116
  v_mul_f32 v24, v24, v23
  v_accvgpr_write_b32 a116, v24
  v_accvgpr_read_b32 v24, a117
  v_mul_f32 v24, v24, v23
  v_accvgpr_write_b32 a117, v24
  v_accvgpr_read_b32 v24, a118
  v_mul_f32 v24, v24, v23
  v_accvgpr_write_b32 a118, v24
  v_accvgpr_read_b32 v24, a119
  v_mul_f32 v24, v24, v23
  v_accvgpr_write_b32 a119, v24
  v_accvgpr_read_b32 v24, a120
  v_mul_f32 v24, v24, v23
  v_accvgpr_write_b32 a120, v24
  v_accvgpr_read_b32 v24, a121
  v_mul_f32 v24, v24, v23
  v_accvgpr_write_b32 a121, v24
  v_accvgpr_read_b32 v24, a122
  v_mul_f32 v24, v24, v23
  v_accvgpr_write_b32 a122, v24
  v_accvgpr_read_b32 v24, a123
  v_mul_f32 v24, v24, v23
  v_accvgpr_write_b32 a123, v24
  v_accvgpr_read_b32 v24, a124
  v_mul_f32 v24, v24, v23
  v_accvgpr_write_b32 a124, v24
  v_accvgpr_read_b32 v24, a125
  v_mul_f32 v24, v24, v23
  v_accvgpr_write_b32 a125, v24
  v_accvgpr_read_b32 v24, a126
  v_mul_f32 v24, v24, v23
  v_accvgpr_write_b32 a126, v24
  v_accvgpr_read_b32 v24, a127
  v_mul_f32 v24, v24, v23
  v_accvgpr_write_b32 a127, v24
  v_max_f32 v25, v12, v18
  v_sub_f32 v26, v12, v25
  v_exp_f32 v26, v26
  v_mov_b32 v12, v25
  v_mul_f32 v15, v15, v26
  v_accvgpr_read_b32 v27, a128
  v_mul_f32 v27, v27, v26
  v_accvgpr_write_b32 a128, v27
  v_accvgpr_read_b32 v27, a129
  v_mul_f32 v27, v27, v26
  v_accvgpr_write_b32 a129, v27
  v_accvgpr_read_b32 v27, a130
  v_mul_f32 v27, v27, v26
  v_accvgpr_write_b32 a130, v27
  v_accvgpr_read_b32 v27, a131
  v_mul_f32 v27, v27, v26
  v_accvgpr_write_b32 a131, v27
  v_accvgpr_read_b32 v27, a132
  v_mul_f32 v27, v27, v26
  v_accvgpr_write_b32 a132, v27
  v_accvgpr_read_b32 v27, a133
  v_mul_f32 v27, v27, v26
  v_accvgpr_write_b32 a133, v27
  v_accvgpr_read_b32 v27, a134
  v_mul_f32 v27, v27, v26
  v_accvgpr_write_b32 a134, v27
  v_accvgpr_read_b32 v27, a135
  v_mul_f32 v27, v27, v26
  v_accvgpr_write_b32 a135, v27
  v_accvgpr_read_b32 v27, a136
  v_mul_f32 v27, v27, v26
  v_accvgpr_write_b32 a136, v27
  v_accvgpr_read_b32 v27, a137
  v_mul_f32 v27, v27, v26
  v_accvgpr_write_b32 a137, v27
  v_accvgpr_read_b32 v27, a138
  v_mul_f32 v27, v27, v26
  v_accvgpr_write_b32 a138, v27
  v_accvgpr_read_b32 v27, a139
  v_mul_f32 v27, v27, v26
  v_accvgpr_write_b32 a139, v27
  v_accvgpr_read_b32 v27, a140
  v_mul_f32 v27, v27, v26
  v_accvgpr_write_b32 a140, v27
  v_accvgpr_read_b32 v27, a141
  v_mul_f32 v27, v27, v26
  v_accvgpr_write_b32 a141, v27
  v_accvgpr_read_b32 v27, a142
  v_mul_f32 v27, v27, v26
  v_accvgpr_write_b32 a142, v27
  v_accvgpr_read_b32 v27, a143
  v_mul_f32 v27, v27, v26
  v_accvgpr_write_b32 a143, v27
  v_accvgpr_read_b32 v27, a144
  v_mul_f32 v27, v27, v26
  v_accvgpr_write_b32 a144, v27
  v_accvgpr_read_b32 v27, a145
  v_mul_f32 v27, v27, v26
  v_accvgpr_write_b32 a145, v27
  v_accvgpr_read_b32 v27, a146
  v_mul_f32 v27, v27, v26
  v_accvgpr_write_b32 a146, v27
  v_accvgpr_read_b32 v27, a147
  v_mul_f32 v27, v27, v26
  v_accvgpr_write_b32 a147, v27
  v_accvgpr_read_b32 v27, a148
  v_mul_f32 v27, v27, v26
  v_accvgpr_write_b32 a148, v27
  v_accvgpr_read_b32 v27, a149
  v_mul_f32 v27, v27, v26
  v_accvgpr_write_b32 a149, v27
  v_accvgpr_read_b32 v27, a150
  v_mul_f32 v27, v27, v26
  v_accvgpr_write_b32 a150, v27
  v_accvgpr_read_b32 v27, a151
  v_mul_f32 v27, v27, v26
  v_accvgpr_write_b32 a151, v27
  v_accvgpr_read_b32 v27, a152
  v_mul_f32 v27, v27, v26
  v_accvgpr_write_b32 a152, v27
  v_accvgpr_read_b32 v27, a153
  v_mul_f32 v27, v27, v26
  v_accvgpr_write_b32 a153, v27
  v_accvgpr_read_b32 v27, a154
  v_mul_f32 v27, v27, v26
  v_accvgpr_write_b32 a154, v27
  v_accvgpr_read_b32 v27, a155
  v_mul_f32 v27, v27, v26
  v_accvgpr_write_b32 a155, v27
  v_accvgpr_read_b32 v27, a156
  v_mul_f32 v27, v27, v26
  v_accvgpr_write_b32 a156, v27
  v_accvgpr_read_b32 v27, a157
  v_mul_f32 v27, v27, v26
  v_accvgpr_write_b32 a157, v27
  v_accvgpr_read_b32 v27, a158
  v_mul_f32 v27, v27, v26
  v_accvgpr_write_b32 a158, v27
  v_accvgpr_read_b32 v27, a159
  v_mul_f32 v27, v27, v26
  v_accvgpr_write_b32 a159, v27
  v_accvgpr_read_b32 v27, a160
  v_mul_f32 v27, v27, v26
  v_accvgpr_write_b32 a160, v27
  v_accvgpr_read_b32 v27, a161
  v_mul_f32 v27, v27, v26
  v_accvgpr_write_b32 a161, v27
  v_accvgpr_read_b32 v27, a162
  v_mul_f32 v27, v27, v26
  v_accvgpr_write_b32 a162, v27
  v_accvgpr_read_b32 v27, a163
  v_mul_f32 v27, v27, v26
  v_accvgpr_write_b32 a163, v27
  v_accvgpr_read_b32 v27, a164
  v_mul_f32 v27, v27, v26
  v_accvgpr_write_b32 a164, v27
  v_accvgpr_read_b32 v27, a165
  v_mul_f32 v27, v27, v26
  v_accvgpr_write_b32 a165, v27
  v_accvgpr_read_b32 v27, a166
  v_mul_f32 v27, v27, v26
  v_accvgpr_write_b32 a166, v27
  v_accvgpr_read_b32 v27, a167
  v_mul_f32 v27, v27, v26
  v_accvgpr_write_b32 a167, v27
  v_accvgpr_read_b32 v27, a168
  v_mul_f32 v27, v27, v26
  v_accvgpr_write_b32 a168, v27
  v_accvgpr_read_b32 v27, a169
  v_mul_f32 v27, v27, v26
  v_accvgpr_write_b32 a169, v27
  v_accvgpr_read_b32 v27, a170
  v_mul_f32 v27, v27, v26
  v_accvgpr_write_b32 a170, v27
  v_accvgpr_read_b32 v27, a171
  v_mul_f32 v27, v27, v26
  v_accvgpr_write_b32 a171, v27
  v_accvgpr_read_b32 v27, a172
  v_mul_f32 v27, v27, v26
  v_accvgpr_write_b32 a172, v27
  v_accvgpr_read_b32 v27, a173
  v_mul_f32 v27, v27, v26
  v_accvgpr_write_b32 a173, v27
  v_accvgpr_read_b32 v27, a174
  v_mul_f32 v27, v27, v26
  v_accvgpr_write_b32 a174, v27
  v_accvgpr_read_b32 v27, a175
  v_mul_f32 v27, v27, v26
  v_accvgpr_write_b32 a175, v27
  v_accvgpr_read_b32 v27, a176
  v_mul_f32 v27, v27, v26
  v_accvgpr_write_b32 a176, v27
  v_accvgpr_read_b32 v27, a177
  v_mul_f32 v27, v27, v26
  v_accvgpr_write_b32 a177, v27
  v_accvgpr_read_b32 v27, a178
  v_mul_f32 v27, v27, v26
  v_accvgpr_write_b32 a178, v27
  v_accvgpr_read_b32 v27, a179
  v_mul_f32 v27, v27, v26
  v_accvgpr_write_b32 a179, v27
  v_accvgpr_read_b32 v27, a180
  v_mul_f32 v27, v27, v26
  v_accvgpr_write_b32 a180, v27
  v_accvgpr_read_b32 v27, a181
  v_mul_f32 v27, v27, v26
  v_accvgpr_write_b32 a181, v27
  v_accvgpr_read_b32 v27, a182
  v_mul_f32 v27, v27, v26
  v_accvgpr_write_b32 a182, v27
  v_accvgpr_read_b32 v27, a183
  v_mul_f32 v27, v27, v26
  v_accvgpr_write_b32 a183, v27
  v_accvgpr_read_b32 v27, a184
  v_mul_f32 v27, v27, v26
  v_accvgpr_write_b32 a184, v27
  v_accvgpr_read_b32 v27, a185
  v_mul_f32 v27, v27, v26
  v_accvgpr_write_b32 a185, v27
  v_accvgpr_read_b32 v27, a186
  v_mul_f32 v27, v27, v26
  v_accvgpr_write_b32 a186, v27
  v_accvgpr_read_b32 v27, a187
  v_mul_f32 v27, v27, v26
  v_accvgpr_write_b32 a187, v27
  v_accvgpr_read_b32 v27, a188
  v_mul_f32 v27, v27, v26
  v_accvgpr_write_b32 a188, v27
  v_accvgpr_read_b32 v27, a189
  v_mul_f32 v27, v27, v26
  v_accvgpr_write_b32 a189, v27
  v_accvgpr_read_b32 v27, a190
  v_mul_f32 v27, v27, v26
  v_accvgpr_write_b32 a190, v27
  v_accvgpr_read_b32 v27, a191
  v_mul_f32 v27, v27, v26
  v_accvgpr_write_b32 a191, v27
  s_nop 1
  s_branch Lrare_3_ret
Lrare_4:
  v_max_f32 v19, v10, v16
  v_sub_f32 v20, v10, v19
  v_exp_f32 v20, v20
  v_mov_b32 v10, v19
  v_mul_f32 v13, v13, v20
  v_accvgpr_read_b32 v21, a0
  v_mul_f32 v21, v21, v20
  v_accvgpr_write_b32 a0, v21
  v_accvgpr_read_b32 v21, a1
  v_mul_f32 v21, v21, v20
  v_accvgpr_write_b32 a1, v21
  v_accvgpr_read_b32 v21, a2
  v_mul_f32 v21, v21, v20
  v_accvgpr_write_b32 a2, v21
  v_accvgpr_read_b32 v21, a3
  v_mul_f32 v21, v21, v20
  v_accvgpr_write_b32 a3, v21
  v_accvgpr_read_b32 v21, a4
  v_mul_f32 v21, v21, v20
  v_accvgpr_write_b32 a4, v21
  v_accvgpr_read_b32 v21, a5
  v_mul_f32 v21, v21, v20
  v_accvgpr_write_b32 a5, v21
  v_accvgpr_read_b32 v21, a6
  v_mul_f32 v21, v21, v20
  v_accvgpr_write_b32 a6, v21
  v_accvgpr_read_b32 v21, a7
  v_mul_f32 v21, v21, v20
  v_accvgpr_write_b32 a7, v21
  v_accvgpr_read_b32 v21, a8
  v_mul_f32 v21, v21, v20
  v_accvgpr_write_b32 a8, v21
  v_accvgpr_read_b32 v21, a9
  v_mul_f32 v21, v21, v20
  v_accvgpr_write_b32 a9, v21
  v_accvgpr_read_b32 v21, a10
  v_mul_f32 v21, v21, v20
  v_accvgpr_write_b32 a10, v21
  v_accvgpr_read_b32 v21, a11
  v_mul_f32 v21, v21, v20
  v_accvgpr_write_b32 a11, v21
  v_accvgpr_read_b32 v21, a12
  v_mul_f32 v21, v21, v20
  v_accvgpr_write_b32 a12, v21
  v_accvgpr_read_b32 v21, a13
  v_mul_f32 v21, v21, v20
  v_accvgpr_write_b32 a13, v21
  v_accvgpr_read_b32 v21, a14
  v_mul_f32 v21, v21, v20
  v_accvgpr_write_b32 a14, v21
  v_accvgpr_read_b32 v21, a15
  v_mul_f32 v21, v21, v20
  v_accvgpr_write_b32 a15, v21
  v_accvgpr_read_b32 v21, a16
  v_mul_f32 v21, v21, v20
  v_accvgpr_write_b32 a16, v21
  v_accvgpr_read_b32 v21, a17
  v_mul_f32 v21, v21, v20
  v_accvgpr_write_b32 a17, v21
  v_accvgpr_read_b32 v21, a18
  v_mul_f32 v21, v21, v20
  v_accvgpr_write_b32 a18, v21
  v_accvgpr_read_b32 v21, a19
  v_mul_f32 v21, v21, v20
  v_accvgpr_write_b32 a19, v21
  v_accvgpr_read_b32 v21, a20
  v_mul_f32 v21, v21, v20
  v_accvgpr_write_b32 a20, v21
  v_accvgpr_read_b32 v21, a21
  v_mul_f32 v21, v21, v20
  v_accvgpr_write_b32 a21, v21
  v_accvgpr_read_b32 v21, a22
  v_mul_f32 v21, v21, v20
  v_accvgpr_write_b32 a22, v21
  v_accvgpr_read_b32 v21, a23
  v_mul_f32 v21, v21, v20
  v_accvgpr_write_b32 a23, v21
  v_accvgpr_read_b32 v21, a24
  v_mul_f32 v21, v21, v20
  v_accvgpr_write_b32 a24, v21
  v_accvgpr_read_b32 v21, a25
  v_mul_f32 v21, v21, v20
  v_accvgpr_write_b32 a25, v21
  v_accvgpr_read_b32 v21, a26
  v_mul_f32 v21, v21, v20
  v_accvgpr_write_b32 a26, v21
  v_accvgpr_read_b32 v21, a27
  v_mul_f32 v21, v21, v20
  v_accvgpr_write_b32 a27, v21
  v_accvgpr_read_b32 v21, a28
  v_mul_f32 v21, v21, v20
  v_accvgpr_write_b32 a28, v21
  v_accvgpr_read_b32 v21, a29
  v_mul_f32 v21, v21, v20
  v_accvgpr_write_b32 a29, v21
  v_accvgpr_read_b32 v21, a30
  v_mul_f32 v21, v21, v20
  v_accvgpr_write_b32 a30, v21
  v_accvgpr_read_b32 v21, a31
  v_mul_f32 v21, v21, v20
  v_accvgpr_write_b32 a31, v21
  v_accvgpr_read_b32 v21, a32
  v_mul_f32 v21, v21, v20
  v_accvgpr_write_b32 a32, v21
  v_accvgpr_read_b32 v21, a33
  v_mul_f32 v21, v21, v20
  v_accvgpr_write_b32 a33, v21
  v_accvgpr_read_b32 v21, a34
  v_mul_f32 v21, v21, v20
  v_accvgpr_write_b32 a34, v21
  v_accvgpr_read_b32 v21, a35
  v_mul_f32 v21, v21, v20
  v_accvgpr_write_b32 a35, v21
  v_accvgpr_read_b32 v21, a36
  v_mul_f32 v21, v21, v20
  v_accvgpr_write_b32 a36, v21
  v_accvgpr_read_b32 v21, a37
  v_mul_f32 v21, v21, v20
  v_accvgpr_write_b32 a37, v21
  v_accvgpr_read_b32 v21, a38
  v_mul_f32 v21, v21, v20
  v_accvgpr_write_b32 a38, v21
  v_accvgpr_read_b32 v21, a39
  v_mul_f32 v21, v21, v20
  v_accvgpr_write_b32 a39, v21
  v_accvgpr_read_b32 v21, a40
  v_mul_f32 v21, v21, v20
  v_accvgpr_write_b32 a40, v21
  v_accvgpr_read_b32 v21, a41
  v_mul_f32 v21, v21, v20
  v_accvgpr_write_b32 a41, v21
  v_accvgpr_read_b32 v21, a42
  v_mul_f32 v21, v21, v20
  v_accvgpr_write_b32 a42, v21
  v_accvgpr_read_b32 v21, a43
  v_mul_f32 v21, v21, v20
  v_accvgpr_write_b32 a43, v21
  v_accvgpr_read_b32 v21, a44
  v_mul_f32 v21, v21, v20
  v_accvgpr_write_b32 a44, v21
  v_accvgpr_read_b32 v21, a45
  v_mul_f32 v21, v21, v20
  v_accvgpr_write_b32 a45, v21
  v_accvgpr_read_b32 v21, a46
  v_mul_f32 v21, v21, v20
  v_accvgpr_write_b32 a46, v21
  v_accvgpr_read_b32 v21, a47
  v_mul_f32 v21, v21, v20
  v_accvgpr_write_b32 a47, v21
  v_accvgpr_read_b32 v21, a48
  v_mul_f32 v21, v21, v20
  v_accvgpr_write_b32 a48, v21
  v_accvgpr_read_b32 v21, a49
  v_mul_f32 v21, v21, v20
  v_accvgpr_write_b32 a49, v21
  v_accvgpr_read_b32 v21, a50
  v_mul_f32 v21, v21, v20
  v_accvgpr_write_b32 a50, v21
  v_accvgpr_read_b32 v21, a51
  v_mul_f32 v21, v21, v20
  v_accvgpr_write_b32 a51, v21
  v_accvgpr_read_b32 v21, a52
  v_mul_f32 v21, v21, v20
  v_accvgpr_write_b32 a52, v21
  v_accvgpr_read_b32 v21, a53
  v_mul_f32 v21, v21, v20
  v_accvgpr_write_b32 a53, v21
  v_accvgpr_read_b32 v21, a54
  v_mul_f32 v21, v21, v20
  v_accvgpr_write_b32 a54, v21
  v_accvgpr_read_b32 v21, a55
  v_mul_f32 v21, v21, v20
  v_accvgpr_write_b32 a55, v21
  v_accvgpr_read_b32 v21, a56
  v_mul_f32 v21, v21, v20
  v_accvgpr_write_b32 a56, v21
  v_accvgpr_read_b32 v21, a57
  v_mul_f32 v21, v21, v20
  v_accvgpr_write_b32 a57, v21
  v_accvgpr_read_b32 v21, a58
  v_mul_f32 v21, v21, v20
  v_accvgpr_write_b32 a58, v21
  v_accvgpr_read_b32 v21, a59
  v_mul_f32 v21, v21, v20
  v_accvgpr_write_b32 a59, v21
  v_accvgpr_read_b32 v21, a60
  v_mul_f32 v21, v21, v20
  v_accvgpr_write_b32 a60, v21
  v_accvgpr_read_b32 v21, a61
  v_mul_f32 v21, v21, v20
  v_accvgpr_write_b32 a61, v21
  v_accvgpr_read_b32 v21, a62
  v_mul_f32 v21, v21, v20
  v_accvgpr_write_b32 a62, v21
  v_accvgpr_read_b32 v21, a63
  v_mul_f32 v21, v21, v20
  v_accvgpr_write_b32 a63, v21
  v_max_f32 v22, v11, v17
  v_sub_f32 v23, v11, v22
  v_exp_f32 v23, v23
  v_mov_b32 v11, v22
  v_mul_f32 v14, v14, v23
  v_accvgpr_read_b32 v24, a64
  v_mul_f32 v24, v24, v23
  v_accvgpr_write_b32 a64, v24
  v_accvgpr_read_b32 v24, a65
  v_mul_f32 v24, v24, v23
  v_accvgpr_write_b32 a65, v24
  v_accvgpr_read_b32 v24, a66
  v_mul_f32 v24, v24, v23
  v_accvgpr_write_b32 a66, v24
  v_accvgpr_read_b32 v24, a67
  v_mul_f32 v24, v24, v23
  v_accvgpr_write_b32 a67, v24
  v_accvgpr_read_b32 v24, a68
  v_mul_f32 v24, v24, v23
  v_accvgpr_write_b32 a68, v24
  v_accvgpr_read_b32 v24, a69
  v_mul_f32 v24, v24, v23
  v_accvgpr_write_b32 a69, v24
  v_accvgpr_read_b32 v24, a70
  v_mul_f32 v24, v24, v23
  v_accvgpr_write_b32 a70, v24
  v_accvgpr_read_b32 v24, a71
  v_mul_f32 v24, v24, v23
  v_accvgpr_write_b32 a71, v24
  v_accvgpr_read_b32 v24, a72
  v_mul_f32 v24, v24, v23
  v_accvgpr_write_b32 a72, v24
  v_accvgpr_read_b32 v24, a73
  v_mul_f32 v24, v24, v23
  v_accvgpr_write_b32 a73, v24
  v_accvgpr_read_b32 v24, a74
  v_mul_f32 v24, v24, v23
  v_accvgpr_write_b32 a74, v24
  v_accvgpr_read_b32 v24, a75
  v_mul_f32 v24, v24, v23
  v_accvgpr_write_b32 a75, v24
  v_accvgpr_read_b32 v24, a76
  v_mul_f32 v24, v24, v23
  v_accvgpr_write_b32 a76, v24
  v_accvgpr_read_b32 v24, a77
  v_mul_f32 v24, v24, v23
  v_accvgpr_write_b32 a77, v24
  v_accvgpr_read_b32 v24, a78
  v_mul_f32 v24, v24, v23
  v_accvgpr_write_b32 a78, v24
  v_accvgpr_read_b32 v24, a79
  v_mul_f32 v24, v24, v23
  v_accvgpr_write_b32 a79, v24
  v_accvgpr_read_b32 v24, a80
  v_mul_f32 v24, v24, v23
  v_accvgpr_write_b32 a80, v24
  v_accvgpr_read_b32 v24, a81
  v_mul_f32 v24, v24, v23
  v_accvgpr_write_b32 a81, v24
  v_accvgpr_read_b32 v24, a82
  v_mul_f32 v24, v24, v23
  v_accvgpr_write_b32 a82, v24
  v_accvgpr_read_b32 v24, a83
  v_mul_f32 v24, v24, v23
  v_accvgpr_write_b32 a83, v24
  v_accvgpr_read_b32 v24, a84
  v_mul_f32 v24, v24, v23
  v_accvgpr_write_b32 a84, v24
  v_accvgpr_read_b32 v24, a85
  v_mul_f32 v24, v24, v23
  v_accvgpr_write_b32 a85, v24
  v_accvgpr_read_b32 v24, a86
  v_mul_f32 v24, v24, v23
  v_accvgpr_write_b32 a86, v24
  v_accvgpr_read_b32 v24, a87
  v_mul_f32 v24, v24, v23
  v_accvgpr_write_b32 a87, v24
  v_accvgpr_read_b32 v24, a88
  v_mul_f32 v24, v24, v23
  v_accvgpr_write_b32 a88, v24
  v_accvgpr_read_b32 v24, a89
  v_mul_f32 v24, v24, v23
  v_accvgpr_write_b32 a89, v24
  v_accvgpr_read_b32 v24, a90
  v_mul_f32 v24, v24, v23
  v_accvgpr_write_b32 a90, v24
  v_accvgpr_read_b32 v24, a91
  v_mul_f32 v24, v24, v23
  v_accvgpr_write_b32 a91, v24
  v_accvgpr_read_b32 v24, a92
  v_mul_f32 v24, v24, v23
  v_accvgpr_write_b32 a92, v24
  v_accvgpr_read_b32 v24, a93
  v_mul_f32 v24, v24, v23
  v_accvgpr_write_b32 a93, v24
  v_accvgpr_read_b32 v24, a94
  v_mul_f32 v24, v24, v23
  v_accvgpr_write_b32 a94, v24
  v_accvgpr_read_b32 v24, a95
  v_mul_f32 v24, v24, v23
  v_accvgpr_write_b32 a95, v24
  v_accvgpr_read_b32 v24, a96
  v_mul_f32 v24, v24, v23
  v_accvgpr_write_b32 a96, v24
  v_accvgpr_read_b32 v24, a97
  v_mul_f32 v24, v24, v23
  v_accvgpr_write_b32 a97, v24
  v_accvgpr_read_b32 v24, a98
  v_mul_f32 v24, v24, v23
  v_accvgpr_write_b32 a98, v24
  v_accvgpr_read_b32 v24, a99
  v_mul_f32 v24, v24, v23
  v_accvgpr_write_b32 a99, v24
  v_accvgpr_read_b32 v24, a100
  v_mul_f32 v24, v24, v23
  v_accvgpr_write_b32 a100, v24
  v_accvgpr_read_b32 v24, a101
  v_mul_f32 v24, v24, v23
  v_accvgpr_write_b32 a101, v24
  v_accvgpr_read_b32 v24, a102
  v_mul_f32 v24, v24, v23
  v_accvgpr_write_b32 a102, v24
  v_accvgpr_read_b32 v24, a103
  v_mul_f32 v24, v24, v23
  v_accvgpr_write_b32 a103, v24
  v_accvgpr_read_b32 v24, a104
  v_mul_f32 v24, v24, v23
  v_accvgpr_write_b32 a104, v24
  v_accvgpr_read_b32 v24, a105
  v_mul_f32 v24, v24, v23
  v_accvgpr_write_b32 a105, v24
  v_accvgpr_read_b32 v24, a106
  v_mul_f32 v24, v24, v23
  v_accvgpr_write_b32 a106, v24
  v_accvgpr_read_b32 v24, a107
  v_mul_f32 v24, v24, v23
  v_accvgpr_write_b32 a107, v24
  v_accvgpr_read_b32 v24, a108
  v_mul_f32 v24, v24, v23
  v_accvgpr_write_b32 a108, v24
  v_accvgpr_read_b32 v24, a109
  v_mul_f32 v24, v24, v23
  v_accvgpr_write_b32 a109, v24
  v_accvgpr_read_b32 v24, a110
  v_mul_f32 v24, v24, v23
  v_accvgpr_write_b32 a110, v24
  v_accvgpr_read_b32 v24, a111
  v_mul_f32 v24, v24, v23
  v_accvgpr_write_b32 a111, v24
  v_accvgpr_read_b32 v24, a112
  v_mul_f32 v24, v24, v23
  v_accvgpr_write_b32 a112, v24
  v_accvgpr_read_b32 v24, a113
  v_mul_f32 v24, v24, v23
  v_accvgpr_write_b32 a113, v24
  v_accvgpr_read_b32 v24, a114
  v_mul_f32 v24, v24, v23
  v_accvgpr_write_b32 a114, v24
  v_accvgpr_read_b32 v24, a115
  v_mul_f32 v24, v24, v23
  v_accvgpr_write_b32 a115, v24
  v_accvgpr_read_b32 v24, a116
  v_mul_f32 v24, v24, v23
  v_accvgpr_write_b32 a116, v24
  v_accvgpr_read_b32 v24, a117
  v_mul_f32 v24, v24, v23
  v_accvgpr_write_b32 a117, v24
  v_accvgpr_read_b32 v24, a118
  v_mul_f32 v24, v24, v23
  v_accvgpr_write_b32 a118, v24
  v_accvgpr_read_b32 v24, a119
  v_mul_f32 v24, v24, v23
  v_accvgpr_write_b32 a119, v24
  v_accvgpr_read_b32 v24, a120
  v_mul_f32 v24, v24, v23
  v_accvgpr_write_b32 a120, v24
  v_accvgpr_read_b32 v24, a121
  v_mul_f32 v24, v24, v23
  v_accvgpr_write_b32 a121, v24
  v_accvgpr_read_b32 v24, a122
  v_mul_f32 v24, v24, v23
  v_accvgpr_write_b32 a122, v24
  v_accvgpr_read_b32 v24, a123
  v_mul_f32 v24, v24, v23
  v_accvgpr_write_b32 a123, v24
  v_accvgpr_read_b32 v24, a124
  v_mul_f32 v24, v24, v23
  v_accvgpr_write_b32 a124, v24
  v_accvgpr_read_b32 v24, a125
  v_mul_f32 v24, v24, v23
  v_accvgpr_write_b32 a125, v24
  v_accvgpr_read_b32 v24, a126
  v_mul_f32 v24, v24, v23
  v_accvgpr_write_b32 a126, v24
  v_accvgpr_read_b32 v24, a127
  v_mul_f32 v24, v24, v23
  v_accvgpr_write_b32 a127, v24
  v_max_f32 v25, v12, v18
  v_sub_f32 v26, v12, v25
  v_exp_f32 v26, v26
  v_mov_b32 v12, v25
  v_mul_f32 v15, v15, v26
  v_accvgpr_read_b32 v27, a128
  v_mul_f32 v27, v27, v26
  v_accvgpr_write_b32 a128, v27
  v_accvgpr_read_b32 v27, a129
  v_mul_f32 v27, v27, v26
  v_accvgpr_write_b32 a129, v27
  v_accvgpr_read_b32 v27, a130
  v_mul_f32 v27, v27, v26
  v_accvgpr_write_b32 a130, v27
  v_accvgpr_read_b32 v27, a131
  v_mul_f32 v27, v27, v26
  v_accvgpr_write_b32 a131, v27
  v_accvgpr_read_b32 v27, a132
  v_mul_f32 v27, v27, v26
  v_accvgpr_write_b32 a132, v27
  v_accvgpr_read_b32 v27, a133
  v_mul_f32 v27, v27, v26
  v_accvgpr_write_b32 a133, v27
  v_accvgpr_read_b32 v27, a134
  v_mul_f32 v27, v27, v26
  v_accvgpr_write_b32 a134, v27
  v_accvgpr_read_b32 v27, a135
  v_mul_f32 v27, v27, v26
  v_accvgpr_write_b32 a135, v27
  v_accvgpr_read_b32 v27, a136
  v_mul_f32 v27, v27, v26
  v_accvgpr_write_b32 a136, v27
  v_accvgpr_read_b32 v27, a137
  v_mul_f32 v27, v27, v26
  v_accvgpr_write_b32 a137, v27
  v_accvgpr_read_b32 v27, a138
  v_mul_f32 v27, v27, v26
  v_accvgpr_write_b32 a138, v27
  v_accvgpr_read_b32 v27, a139
  v_mul_f32 v27, v27, v26
  v_accvgpr_write_b32 a139, v27
  v_accvgpr_read_b32 v27, a140
  v_mul_f32 v27, v27, v26
  v_accvgpr_write_b32 a140, v27
  v_accvgpr_read_b32 v27, a141
  v_mul_f32 v27, v27, v26
  v_accvgpr_write_b32 a141, v27
  v_accvgpr_read_b32 v27, a142
  v_mul_f32 v27, v27, v26
  v_accvgpr_write_b32 a142, v27
  v_accvgpr_read_b32 v27, a143
  v_mul_f32 v27, v27, v26
  v_accvgpr_write_b32 a143, v27
  v_accvgpr_read_b32 v27, a144
  v_mul_f32 v27, v27, v26
  v_accvgpr_write_b32 a144, v27
  v_accvgpr_read_b32 v27, a145
  v_mul_f32 v27, v27, v26
  v_accvgpr_write_b32 a145, v27
  v_accvgpr_read_b32 v27, a146
  v_mul_f32 v27, v27, v26
  v_accvgpr_write_b32 a146, v27
  v_accvgpr_read_b32 v27, a147
  v_mul_f32 v27, v27, v26
  v_accvgpr_write_b32 a147, v27
  v_accvgpr_read_b32 v27, a148
  v_mul_f32 v27, v27, v26
  v_accvgpr_write_b32 a148, v27
  v_accvgpr_read_b32 v27, a149
  v_mul_f32 v27, v27, v26
  v_accvgpr_write_b32 a149, v27
  v_accvgpr_read_b32 v27, a150
  v_mul_f32 v27, v27, v26
  v_accvgpr_write_b32 a150, v27
  v_accvgpr_read_b32 v27, a151
  v_mul_f32 v27, v27, v26
  v_accvgpr_write_b32 a151, v27
  v_accvgpr_read_b32 v27, a152
  v_mul_f32 v27, v27, v26
  v_accvgpr_write_b32 a152, v27
  v_accvgpr_read_b32 v27, a153
  v_mul_f32 v27, v27, v26
  v_accvgpr_write_b32 a153, v27
  v_accvgpr_read_b32 v27, a154
  v_mul_f32 v27, v27, v26
  v_accvgpr_write_b32 a154, v27
  v_accvgpr_read_b32 v27, a155
  v_mul_f32 v27, v27, v26
  v_accvgpr_write_b32 a155, v27
  v_accvgpr_read_b32 v27, a156
  v_mul_f32 v27, v27, v26
  v_accvgpr_write_b32 a156, v27
  v_accvgpr_read_b32 v27, a157
  v_mul_f32 v27, v27, v26
  v_accvgpr_write_b32 a157, v27
  v_accvgpr_read_b32 v27, a158
  v_mul_f32 v27, v27, v26
  v_accvgpr_write_b32 a158, v27
  v_accvgpr_read_b32 v27, a159
  v_mul_f32 v27, v27, v26
  v_accvgpr_write_b32 a159, v27
  v_accvgpr_read_b32 v27, a160
  v_mul_f32 v27, v27, v26
  v_accvgpr_write_b32 a160, v27
  v_accvgpr_read_b32 v27, a161
  v_mul_f32 v27, v27, v26
  v_accvgpr_write_b32 a161, v27
  v_accvgpr_read_b32 v27, a162
  v_mul_f32 v27, v27, v26
  v_accvgpr_write_b32 a162, v27
  v_accvgpr_read_b32 v27, a163
  v_mul_f32 v27, v27, v26
  v_accvgpr_write_b32 a163, v27
  v_accvgpr_read_b32 v27, a164
  v_mul_f32 v27, v27, v26
  v_accvgpr_write_b32 a164, v27
  v_accvgpr_read_b32 v27, a165
  v_mul_f32 v27, v27, v26
  v_accvgpr_write_b32 a165, v27
  v_accvgpr_read_b32 v27, a166
  v_mul_f32 v27, v27, v26
  v_accvgpr_write_b32 a166, v27
  v_accvgpr_read_b32 v27, a167
  v_mul_f32 v27, v27, v26
  v_accvgpr_write_b32 a167, v27
  v_accvgpr_read_b32 v27, a168
  v_mul_f32 v27, v27, v26
  v_accvgpr_write_b32 a168, v27
  v_accvgpr_read_b32 v27, a169
  v_mul_f32 v27, v27, v26
  v_accvgpr_write_b32 a169, v27
  v_accvgpr_read_b32 v27, a170
  v_mul_f32 v27, v27, v26
  v_accvgpr_write_b32 a170, v27
  v_accvgpr_read_b32 v27, a171
  v_mul_f32 v27, v27, v26
  v_accvgpr_write_b32 a171, v27
  v_accvgpr_read_b32 v27, a172
  v_mul_f32 v27, v27, v26
  v_accvgpr_write_b32 a172, v27
  v_accvgpr_read_b32 v27, a173
  v_mul_f32 v27, v27, v26
  v_accvgpr_write_b32 a173, v27
  v_accvgpr_read_b32 v27, a174
  v_mul_f32 v27, v27, v26
  v_accvgpr_write_b32 a174, v27
  v_accvgpr_read_b32 v27, a175
  v_mul_f32 v27, v27, v26
  v_accvgpr_write_b32 a175, v27
  v_accvgpr_read_b32 v27, a176
  v_mul_f32 v27, v27, v26
  v_accvgpr_write_b32 a176, v27
  v_accvgpr_read_b32 v27, a177
  v_mul_f32 v27, v27, v26
  v_accvgpr_write_b32 a177, v27
  v_accvgpr_read_b32 v27, a178
  v_mul_f32 v27, v27, v26
  v_accvgpr_write_b32 a178, v27
  v_accvgpr_read_b32 v27, a179
  v_mul_f32 v27, v27, v26
  v_accvgpr_write_b32 a179, v27
  v_accvgpr_read_b32 v27, a180
  v_mul_f32 v27, v27, v26
  v_accvgpr_write_b32 a180, v27
  v_accvgpr_read_b32 v27, a181
  v_mul_f32 v27, v27, v26
  v_accvgpr_write_b32 a181, v27
  v_accvgpr_read_b32 v27, a182
  v_mul_f32 v27, v27, v26
  v_accvgpr_write_b32 a182, v27
  v_accvgpr_read_b32 v27, a183
  v_mul_f32 v27, v27, v26
  v_accvgpr_write_b32 a183, v27
  v_accvgpr_read_b32 v27, a184
  v_mul_f32 v27, v27, v26
  v_accvgpr_write_b32 a184, v27
  v_accvgpr_read_b32 v27, a185
  v_mul_f32 v27, v27, v26
  v_accvgpr_write_b32 a185, v27
  v_accvgpr_read_b32 v27, a186
  v_mul_f32 v27, v27, v26
  v_accvgpr_write_b32 a186, v27
  v_accvgpr_read_b32 v27, a187
  v_mul_f32 v27, v27, v26
  v_accvgpr_write_b32 a187, v27
  v_accvgpr_read_b32 v27, a188
  v_mul_f32 v27, v27, v26
  v_accvgpr_write_b32 a188, v27
  v_accvgpr_read_b32 v27, a189
  v_mul_f32 v27, v27, v26
  v_accvgpr_write_b32 a189, v27
  v_accvgpr_read_b32 v27, a190
  v_mul_f32 v27, v27, v26
  v_accvgpr_write_b32 a190, v27
  v_accvgpr_read_b32 v27, a191
  v_mul_f32 v27, v27, v26
  v_accvgpr_write_b32 a191, v27
  s_nop 1
  s_branch Lrare_4_ret
Lrare_5:
  v_max_f32 v19, v10, v16
  v_sub_f32 v20, v10, v19
  v_exp_f32 v20, v20
  v_mov_b32 v10, v19
  v_mul_f32 v13, v13, v20
  v_accvgpr_read_b32 v21, a0
  v_mul_f32 v21, v21, v20
  v_accvgpr_write_b32 a0, v21
  v_accvgpr_read_b32 v21, a1
  v_mul_f32 v21, v21, v20
  v_accvgpr_write_b32 a1, v21
  v_accvgpr_read_b32 v21, a2
  v_mul_f32 v21, v21, v20
  v_accvgpr_write_b32 a2, v21
  v_accvgpr_read_b32 v21, a3
  v_mul_f32 v21, v21, v20
  v_accvgpr_write_b32 a3, v21
  v_accvgpr_read_b32 v21, a4
  v_mul_f32 v21, v21, v20
  v_accvgpr_write_b32 a4, v21
  v_accvgpr_read_b32 v21, a5
  v_mul_f32 v21, v21, v20
  v_accvgpr_write_b32 a5, v21
  v_accvgpr_read_b32 v21, a6
  v_mul_f32 v21, v21, v20
  v_accvgpr_write_b32 a6, v21
  v_accvgpr_read_b32 v21, a7
  v_mul_f32 v21, v21, v20
  v_accvgpr_write_b32 a7, v21
  v_accvgpr_read_b32 v21, a8
  v_mul_f32 v21, v21, v20
  v_accvgpr_write_b32 a8, v21
  v_accvgpr_read_b32 v21, a9
  v_mul_f32 v21, v21, v20
  v_accvgpr_write_b32 a9, v21
  v_accvgpr_read_b32 v21, a10
  v_mul_f32 v21, v21, v20
  v_accvgpr_write_b32 a10, v21
  v_accvgpr_read_b32 v21, a11
  v_mul_f32 v21, v21, v20
  v_accvgpr_write_b32 a11, v21
  v_accvgpr_read_b32 v21, a12
  v_mul_f32 v21, v21, v20
  v_accvgpr_write_b32 a12, v21
  v_accvgpr_read_b32 v21, a13
  v_mul_f32 v21, v21, v20
  v_accvgpr_write_b32 a13, v21
  v_accvgpr_read_b32 v21, a14
  v_mul_f32 v21, v21, v20
  v_accvgpr_write_b32 a14, v21
  v_accvgpr_read_b32 v21, a15
  v_mul_f32 v21, v21, v20
  v_accvgpr_write_b32 a15, v21
  v_accvgpr_read_b32 v21, a16
  v_mul_f32 v21, v21, v20
  v_accvgpr_write_b32 a16, v21
  v_accvgpr_read_b32 v21, a17
  v_mul_f32 v21, v21, v20
  v_accvgpr_write_b32 a17, v21
  v_accvgpr_read_b32 v21, a18
  v_mul_f32 v21, v21, v20
  v_accvgpr_write_b32 a18, v21
  v_accvgpr_read_b32 v21, a19
  v_mul_f32 v21, v21, v20
  v_accvgpr_write_b32 a19, v21
  v_accvgpr_read_b32 v21, a20
  v_mul_f32 v21, v21, v20
  v_accvgpr_write_b32 a20, v21
  v_accvgpr_read_b32 v21, a21
  v_mul_f32 v21, v21, v20
  v_accvgpr_write_b32 a21, v21
  v_accvgpr_read_b32 v21, a22
  v_mul_f32 v21, v21, v20
  v_accvgpr_write_b32 a22, v21
  v_accvgpr_read_b32 v21, a23
  v_mul_f32 v21, v21, v20
  v_accvgpr_write_b32 a23, v21
  v_accvgpr_read_b32 v21, a24
  v_mul_f32 v21, v21, v20
  v_accvgpr_write_b32 a24, v21
  v_accvgpr_read_b32 v21, a25
  v_mul_f32 v21, v21, v20
  v_accvgpr_write_b32 a25, v21
  v_accvgpr_read_b32 v21, a26
  v_mul_f32 v21, v21, v20
  v_accvgpr_write_b32 a26, v21
  v_accvgpr_read_b32 v21, a27
  v_mul_f32 v21, v21, v20
  v_accvgpr_write_b32 a27, v21
  v_accvgpr_read_b32 v21, a28
  v_mul_f32 v21, v21, v20
  v_accvgpr_write_b32 a28, v21
  v_accvgpr_read_b32 v21, a29
  v_mul_f32 v21, v21, v20
  v_accvgpr_write_b32 a29, v21
  v_accvgpr_read_b32 v21, a30
  v_mul_f32 v21, v21, v20
  v_accvgpr_write_b32 a30, v21
  v_accvgpr_read_b32 v21, a31
  v_mul_f32 v21, v21, v20
  v_accvgpr_write_b32 a31, v21
  v_accvgpr_read_b32 v21, a32
  v_mul_f32 v21, v21, v20
  v_accvgpr_write_b32 a32, v21
  v_accvgpr_read_b32 v21, a33
  v_mul_f32 v21, v21, v20
  v_accvgpr_write_b32 a33, v21
  v_accvgpr_read_b32 v21, a34
  v_mul_f32 v21, v21, v20
  v_accvgpr_write_b32 a34, v21
  v_accvgpr_read_b32 v21, a35
  v_mul_f32 v21, v21, v20
  v_accvgpr_write_b32 a35, v21
  v_accvgpr_read_b32 v21, a36
  v_mul_f32 v21, v21, v20
  v_accvgpr_write_b32 a36, v21
  v_accvgpr_read_b32 v21, a37
  v_mul_f32 v21, v21, v20
  v_accvgpr_write_b32 a37, v21
  v_accvgpr_read_b32 v21, a38
  v_mul_f32 v21, v21, v20
  v_accvgpr_write_b32 a38, v21
  v_accvgpr_read_b32 v21, a39
  v_mul_f32 v21, v21, v20
  v_accvgpr_write_b32 a39, v21
  v_accvgpr_read_b32 v21, a40
  v_mul_f32 v21, v21, v20
  v_accvgpr_write_b32 a40, v21
  v_accvgpr_read_b32 v21, a41
  v_mul_f32 v21, v21, v20
  v_accvgpr_write_b32 a41, v21
  v_accvgpr_read_b32 v21, a42
  v_mul_f32 v21, v21, v20
  v_accvgpr_write_b32 a42, v21
  v_accvgpr_read_b32 v21, a43
  v_mul_f32 v21, v21, v20
  v_accvgpr_write_b32 a43, v21
  v_accvgpr_read_b32 v21, a44
  v_mul_f32 v21, v21, v20
  v_accvgpr_write_b32 a44, v21
  v_accvgpr_read_b32 v21, a45
  v_mul_f32 v21, v21, v20
  v_accvgpr_write_b32 a45, v21
  v_accvgpr_read_b32 v21, a46
  v_mul_f32 v21, v21, v20
  v_accvgpr_write_b32 a46, v21
  v_accvgpr_read_b32 v21, a47
  v_mul_f32 v21, v21, v20
  v_accvgpr_write_b32 a47, v21
  v_accvgpr_read_b32 v21, a48
  v_mul_f32 v21, v21, v20
  v_accvgpr_write_b32 a48, v21
  v_accvgpr_read_b32 v21, a49
  v_mul_f32 v21, v21, v20
  v_accvgpr_write_b32 a49, v21
  v_accvgpr_read_b32 v21, a50
  v_mul_f32 v21, v21, v20
  v_accvgpr_write_b32 a50, v21
  v_accvgpr_read_b32 v21, a51
  v_mul_f32 v21, v21, v20
  v_accvgpr_write_b32 a51, v21
  v_accvgpr_read_b32 v21, a52
  v_mul_f32 v21, v21, v20
  v_accvgpr_write_b32 a52, v21
  v_accvgpr_read_b32 v21, a53
  v_mul_f32 v21, v21, v20
  v_accvgpr_write_b32 a53, v21
  v_accvgpr_read_b32 v21, a54
  v_mul_f32 v21, v21, v20
  v_accvgpr_write_b32 a54, v21
  v_accvgpr_read_b32 v21, a55
  v_mul_f32 v21, v21, v20
  v_accvgpr_write_b32 a55, v21
  v_accvgpr_read_b32 v21, a56
  v_mul_f32 v21, v21, v20
  v_accvgpr_write_b32 a56, v21
  v_accvgpr_read_b32 v21, a57
  v_mul_f32 v21, v21, v20
  v_accvgpr_write_b32 a57, v21
  v_accvgpr_read_b32 v21, a58
  v_mul_f32 v21, v21, v20
  v_accvgpr_write_b32 a58, v21
  v_accvgpr_read_b32 v21, a59
  v_mul_f32 v21, v21, v20
  v_accvgpr_write_b32 a59, v21
  v_accvgpr_read_b32 v21, a60
  v_mul_f32 v21, v21, v20
  v_accvgpr_write_b32 a60, v21
  v_accvgpr_read_b32 v21, a61
  v_mul_f32 v21, v21, v20
  v_accvgpr_write_b32 a61, v21
  v_accvgpr_read_b32 v21, a62
  v_mul_f32 v21, v21, v20
  v_accvgpr_write_b32 a62, v21
  v_accvgpr_read_b32 v21, a63
  v_mul_f32 v21, v21, v20
  v_accvgpr_write_b32 a63, v21
  v_max_f32 v22, v11, v17
  v_sub_f32 v23, v11, v22
  v_exp_f32 v23, v23
  v_mov_b32 v11, v22
  v_mul_f32 v14, v14, v23
  v_accvgpr_read_b32 v24, a64
  v_mul_f32 v24, v24, v23
  v_accvgpr_write_b32 a64, v24
  v_accvgpr_read_b32 v24, a65
  v_mul_f32 v24, v24, v23
  v_accvgpr_write_b32 a65, v24
  v_accvgpr_read_b32 v24, a66
  v_mul_f32 v24, v24, v23
  v_accvgpr_write_b32 a66, v24
  v_accvgpr_read_b32 v24, a67
  v_mul_f32 v24, v24, v23
  v_accvgpr_write_b32 a67, v24
  v_accvgpr_read_b32 v24, a68
  v_mul_f32 v24, v24, v23
  v_accvgpr_write_b32 a68, v24
  v_accvgpr_read_b32 v24, a69
  v_mul_f32 v24, v24, v23
  v_accvgpr_write_b32 a69, v24
  v_accvgpr_read_b32 v24, a70
  v_mul_f32 v24, v24, v23
  v_accvgpr_write_b32 a70, v24
  v_accvgpr_read_b32 v24, a71
  v_mul_f32 v24, v24, v23
  v_accvgpr_write_b32 a71, v24
  v_accvgpr_read_b32 v24, a72
  v_mul_f32 v24, v24, v23
  v_accvgpr_write_b32 a72, v24
  v_accvgpr_read_b32 v24, a73
  v_mul_f32 v24, v24, v23
  v_accvgpr_write_b32 a73, v24
  v_accvgpr_read_b32 v24, a74
  v_mul_f32 v24, v24, v23
  v_accvgpr_write_b32 a74, v24
  v_accvgpr_read_b32 v24, a75
  v_mul_f32 v24, v24, v23
  v_accvgpr_write_b32 a75, v24
  v_accvgpr_read_b32 v24, a76
  v_mul_f32 v24, v24, v23
  v_accvgpr_write_b32 a76, v24
  v_accvgpr_read_b32 v24, a77
  v_mul_f32 v24, v24, v23
  v_accvgpr_write_b32 a77, v24
  v_accvgpr_read_b32 v24, a78
  v_mul_f32 v24, v24, v23
  v_accvgpr_write_b32 a78, v24
  v_accvgpr_read_b32 v24, a79
  v_mul_f32 v24, v24, v23
  v_accvgpr_write_b32 a79, v24
  v_accvgpr_read_b32 v24, a80
  v_mul_f32 v24, v24, v23
  v_accvgpr_write_b32 a80, v24
  v_accvgpr_read_b32 v24, a81
  v_mul_f32 v24, v24, v23
  v_accvgpr_write_b32 a81, v24
  v_accvgpr_read_b32 v24, a82
  v_mul_f32 v24, v24, v23
  v_accvgpr_write_b32 a82, v24
  v_accvgpr_read_b32 v24, a83
  v_mul_f32 v24, v24, v23
  v_accvgpr_write_b32 a83, v24
  v_accvgpr_read_b32 v24, a84
  v_mul_f32 v24, v24, v23
  v_accvgpr_write_b32 a84, v24
  v_accvgpr_read_b32 v24, a85
  v_mul_f32 v24, v24, v23
  v_accvgpr_write_b32 a85, v24
  v_accvgpr_read_b32 v24, a86
  v_mul_f32 v24, v24, v23
  v_accvgpr_write_b32 a86, v24
  v_accvgpr_read_b32 v24, a87
  v_mul_f32 v24, v24, v23
  v_accvgpr_write_b32 a87, v24
  v_accvgpr_read_b32 v24, a88
  v_mul_f32 v24, v24, v23
  v_accvgpr_write_b32 a88, v24
  v_accvgpr_read_b32 v24, a89
  v_mul_f32 v24, v24, v23
  v_accvgpr_write_b32 a89, v24
  v_accvgpr_read_b32 v24, a90
  v_mul_f32 v24, v24, v23
  v_accvgpr_write_b32 a90, v24
  v_accvgpr_read_b32 v24, a91
  v_mul_f32 v24, v24, v23
  v_accvgpr_write_b32 a91, v24
  v_accvgpr_read_b32 v24, a92
  v_mul_f32 v24, v24, v23
  v_accvgpr_write_b32 a92, v24
  v_accvgpr_read_b32 v24, a93
  v_mul_f32 v24, v24, v23
  v_accvgpr_write_b32 a93, v24
  v_accvgpr_read_b32 v24, a94
  v_mul_f32 v24, v24, v23
  v_accvgpr_write_b32 a94, v24
  v_accvgpr_read_b32 v24, a95
  v_mul_f32 v24, v24, v23
  v_accvgpr_write_b32 a95, v24
  v_accvgpr_read_b32 v24, a96
  v_mul_f32 v24, v24, v23
  v_accvgpr_write_b32 a96, v24
  v_accvgpr_read_b32 v24, a97
  v_mul_f32 v24, v24, v23
  v_accvgpr_write_b32 a97, v24
  v_accvgpr_read_b32 v24, a98
  v_mul_f32 v24, v24, v23
  v_accvgpr_write_b32 a98, v24
  v_accvgpr_read_b32 v24, a99
  v_mul_f32 v24, v24, v23
  v_accvgpr_write_b32 a99, v24
  v_accvgpr_read_b32 v24, a100
  v_mul_f32 v24, v24, v23
  v_accvgpr_write_b32 a100, v24
  v_accvgpr_read_b32 v24, a101
  v_mul_f32 v24, v24, v23
  v_accvgpr_write_b32 a101, v24
  v_accvgpr_read_b32 v24, a102
  v_mul_f32 v24, v24, v23
  v_accvgpr_write_b32 a102, v24
  v_accvgpr_read_b32 v24, a103
  v_mul_f32 v24, v24, v23
  v_accvgpr_write_b32 a103, v24
  v_accvgpr_read_b32 v24, a104
  v_mul_f32 v24, v24, v23
  v_accvgpr_write_b32 a104, v24
  v_accvgpr_read_b32 v24, a105
  v_mul_f32 v24, v24, v23
  v_accvgpr_write_b32 a105, v24
  v_accvgpr_read_b32 v24, a106
  v_mul_f32 v24, v24, v23
  v_accvgpr_write_b32 a106, v24
  v_accvgpr_read_b32 v24, a107
  v_mul_f32 v24, v24, v23
  v_accvgpr_write_b32 a107, v24
  v_accvgpr_read_b32 v24, a108
  v_mul_f32 v24, v24, v23
  v_accvgpr_write_b32 a108, v24
  v_accvgpr_read_b32 v24, a109
  v_mul_f32 v24, v24, v23
  v_accvgpr_write_b32 a109, v24
  v_accvgpr_read_b32 v24, a110
  v_mul_f32 v24, v24, v23
  v_accvgpr_write_b32 a110, v24
  v_accvgpr_read_b32 v24, a111
  v_mul_f32 v24, v24, v23
  v_accvgpr_write_b32 a111, v24
  v_accvgpr_read_b32 v24, a112
  v_mul_f32 v24, v24, v23
  v_accvgpr_write_b32 a112, v24
  v_accvgpr_read_b32 v24, a113
  v_mul_f32 v24, v24, v23
  v_accvgpr_write_b32 a113, v24
  v_accvgpr_read_b32 v24, a114
  v_mul_f32 v24, v24, v23
  v_accvgpr_write_b32 a114, v24
  v_accvgpr_read_b32 v24, a115
  v_mul_f32 v24, v24, v23
  v_accvgpr_write_b32 a115, v24
  v_accvgpr_read_b32 v24, a116
  v_mul_f32 v24, v24, v23
  v_accvgpr_write_b32 a116, v24
  v_accvgpr_read_b32 v24, a117
  v_mul_f32 v24, v24, v23
  v_accvgpr_write_b32 a117, v24
  v_accvgpr_read_b32 v24, a118
  v_mul_f32 v24, v24, v23
  v_accvgpr_write_b32 a118, v24
  v_accvgpr_read_b32 v24, a119
  v_mul_f32 v24, v24, v23
  v_accvgpr_write_b32 a119, v24
  v_accvgpr_read_b32 v24, a120
  v_mul_f32 v24, v24, v23
  v_accvgpr_write_b32 a120, v24
  v_accvgpr_read_b32 v24, a121
  v_mul_f32 v24, v24, v23
  v_accvgpr_write_b32 a121, v24
  v_accvgpr_read_b32 v24, a122
  v_mul_f32 v24, v24, v23
  v_accvgpr_write_b32 a122, v24
  v_accvgpr_read_b32 v24, a123
  v_mul_f32 v24, v24, v23
  v_accvgpr_write_b32 a123, v24
  v_accvgpr_read_b32 v24, a124
  v_mul_f32 v24, v24, v23
  v_accvgpr_write_b32 a124, v24
  v_accvgpr_read_b32 v24, a125
  v_mul_f32 v24, v24, v23
  v_accvgpr_write_b32 a125, v24
  v_accvgpr_read_b32 v24, a126
  v_mul_f32 v24, v24, v23
  v_accvgpr_write_b32 a126, v24
  v_accvgpr_read_b32 v24, a127
  v_mul_f32 v24, v24, v23
  v_accvgpr_write_b32 a127, v24
  v_max_f32 v25, v12, v18
  v_sub_f32 v26, v12, v25
  v_exp_f32 v26, v26
  v_mov_b32 v12, v25
  v_mul_f32 v15, v15, v26
  v_accvgpr_read_b32 v27, a128
  v_mul_f32 v27, v27, v26
  v_accvgpr_write_b32 a128, v27
  v_accvgpr_read_b32 v27, a129
  v_mul_f32 v27, v27, v26
  v_accvgpr_write_b32 a129, v27
  v_accvgpr_read_b32 v27, a130
  v_mul_f32 v27, v27, v26
  v_accvgpr_write_b32 a130, v27
  v_accvgpr_read_b32 v27, a131
  v_mul_f32 v27, v27, v26
  v_accvgpr_write_b32 a131, v27
  v_accvgpr_read_b32 v27, a132
  v_mul_f32 v27, v27, v26
  v_accvgpr_write_b32 a132, v27
  v_accvgpr_read_b32 v27, a133
  v_mul_f32 v27, v27, v26
  v_accvgpr_write_b32 a133, v27
  v_accvgpr_read_b32 v27, a134
  v_mul_f32 v27, v27, v26
  v_accvgpr_write_b32 a134, v27
  v_accvgpr_read_b32 v27, a135
  v_mul_f32 v27, v27, v26
  v_accvgpr_write_b32 a135, v27
  v_accvgpr_read_b32 v27, a136
  v_mul_f32 v27, v27, v26
  v_accvgpr_write_b32 a136, v27
  v_accvgpr_read_b32 v27, a137
  v_mul_f32 v27, v27, v26
  v_accvgpr_write_b32 a137, v27
  v_accvgpr_read_b32 v27, a138
  v_mul_f32 v27, v27, v26
  v_accvgpr_write_b32 a138, v27
  v_accvgpr_read_b32 v27, a139
  v_mul_f32 v27, v27, v26
  v_accvgpr_write_b32 a139, v27
  v_accvgpr_read_b32 v27, a140
  v_mul_f32 v27, v27, v26
  v_accvgpr_write_b32 a140, v27
  v_accvgpr_read_b32 v27, a141
  v_mul_f32 v27, v27, v26
  v_accvgpr_write_b32 a141, v27
  v_accvgpr_read_b32 v27, a142
  v_mul_f32 v27, v27, v26
  v_accvgpr_write_b32 a142, v27
  v_accvgpr_read_b32 v27, a143
  v_mul_f32 v27, v27, v26
  v_accvgpr_write_b32 a143, v27
  v_accvgpr_read_b32 v27, a144
  v_mul_f32 v27, v27, v26
  v_accvgpr_write_b32 a144, v27
  v_accvgpr_read_b32 v27, a145
  v_mul_f32 v27, v27, v26
  v_accvgpr_write_b32 a145, v27
  v_accvgpr_read_b32 v27, a146
  v_mul_f32 v27, v27, v26
  v_accvgpr_write_b32 a146, v27
  v_accvgpr_read_b32 v27, a147
  v_mul_f32 v27, v27, v26
  v_accvgpr_write_b32 a147, v27
  v_accvgpr_read_b32 v27, a148
  v_mul_f32 v27, v27, v26
  v_accvgpr_write_b32 a148, v27
  v_accvgpr_read_b32 v27, a149
  v_mul_f32 v27, v27, v26
  v_accvgpr_write_b32 a149, v27
  v_accvgpr_read_b32 v27, a150
  v_mul_f32 v27, v27, v26
  v_accvgpr_write_b32 a150, v27
  v_accvgpr_read_b32 v27, a151
  v_mul_f32 v27, v27, v26
  v_accvgpr_write_b32 a151, v27
  v_accvgpr_read_b32 v27, a152
  v_mul_f32 v27, v27, v26
  v_accvgpr_write_b32 a152, v27
  v_accvgpr_read_b32 v27, a153
  v_mul_f32 v27, v27, v26
  v_accvgpr_write_b32 a153, v27
  v_accvgpr_read_b32 v27, a154
  v_mul_f32 v27, v27, v26
  v_accvgpr_write_b32 a154, v27
  v_accvgpr_read_b32 v27, a155
  v_mul_f32 v27, v27, v26
  v_accvgpr_write_b32 a155, v27
  v_accvgpr_read_b32 v27, a156
  v_mul_f32 v27, v27, v26
  v_accvgpr_write_b32 a156, v27
  v_accvgpr_read_b32 v27, a157
  v_mul_f32 v27, v27, v26
  v_accvgpr_write_b32 a157, v27
  v_accvgpr_read_b32 v27, a158
  v_mul_f32 v27, v27, v26
  v_accvgpr_write_b32 a158, v27
  v_accvgpr_read_b32 v27, a159
  v_mul_f32 v27, v27, v26
  v_accvgpr_write_b32 a159, v27
  v_accvgpr_read_b32 v27, a160
  v_mul_f32 v27, v27, v26
  v_accvgpr_write_b32 a160, v27
  v_accvgpr_read_b32 v27, a161
  v_mul_f32 v27, v27, v26
  v_accvgpr_write_b32 a161, v27
  v_accvgpr_read_b32 v27, a162
  v_mul_f32 v27, v27, v26
  v_accvgpr_write_b32 a162, v27
  v_accvgpr_read_b32 v27, a163
  v_mul_f32 v27, v27, v26
  v_accvgpr_write_b32 a163, v27
  v_accvgpr_read_b32 v27, a164
  v_mul_f32 v27, v27, v26
  v_accvgpr_write_b32 a164, v27
  v_accvgpr_read_b32 v27, a165
  v_mul_f32 v27, v27, v26
  v_accvgpr_write_b32 a165, v27
  v_accvgpr_read_b32 v27, a166
  v_mul_f32 v27, v27, v26
  v_accvgpr_write_b32 a166, v27
  v_accvgpr_read_b32 v27, a167
  v_mul_f32 v27, v27, v26
  v_accvgpr_write_b32 a167, v27
  v_accvgpr_read_b32 v27, a168
  v_mul_f32 v27, v27, v26
  v_accvgpr_write_b32 a168, v27
  v_accvgpr_read_b32 v27, a169
  v_mul_f32 v27, v27, v26
  v_accvgpr_write_b32 a169, v27
  v_accvgpr_read_b32 v27, a170
  v_mul_f32 v27, v27, v26
  v_accvgpr_write_b32 a170, v27
  v_accvgpr_read_b32 v27, a171
  v_mul_f32 v27, v27, v26
  v_accvgpr_write_b32 a171, v27
  v_accvgpr_read_b32 v27, a172
  v_mul_f32 v27, v27, v26
  v_accvgpr_write_b32 a172, v27
  v_accvgpr_read_b32 v27, a173
  v_mul_f32 v27, v27, v26
  v_accvgpr_write_b32 a173, v27
  v_accvgpr_read_b32 v27, a174
  v_mul_f32 v27, v27, v26
  v_accvgpr_write_b32 a174, v27
  v_accvgpr_read_b32 v27, a175
  v_mul_f32 v27, v27, v26
  v_accvgpr_write_b32 a175, v27
  v_accvgpr_read_b32 v27, a176
  v_mul_f32 v27, v27, v26
  v_accvgpr_write_b32 a176, v27
  v_accvgpr_read_b32 v27, a177
  v_mul_f32 v27, v27, v26
  v_accvgpr_write_b32 a177, v27
  v_accvgpr_read_b32 v27, a178
  v_mul_f32 v27, v27, v26
  v_accvgpr_write_b32 a178, v27
  v_accvgpr_read_b32 v27, a179
  v_mul_f32 v27, v27, v26
  v_accvgpr_write_b32 a179, v27
  v_accvgpr_read_b32 v27, a180
  v_mul_f32 v27, v27, v26
  v_accvgpr_write_b32 a180, v27
  v_accvgpr_read_b32 v27, a181
  v_mul_f32 v27, v27, v26
  v_accvgpr_write_b32 a181, v27
  v_accvgpr_read_b32 v27, a182
  v_mul_f32 v27, v27, v26
  v_accvgpr_write_b32 a182, v27
  v_accvgpr_read_b32 v27, a183
  v_mul_f32 v27, v27, v26
  v_accvgpr_write_b32 a183, v27
  v_accvgpr_read_b32 v27, a184
  v_mul_f32 v27, v27, v26
  v_accvgpr_write_b32 a184, v27
  v_accvgpr_read_b32 v27, a185
  v_mul_f32 v27, v27, v26
  v_accvgpr_write_b32 a185, v27
  v_accvgpr_read_b32 v27, a186
  v_mul_f32 v27, v27, v26
  v_accvgpr_write_b32 a186, v27
  v_accvgpr_read_b32 v27, a187
  v_mul_f32 v27, v27, v26
  v_accvgpr_write_b32 a187, v27
  v_accvgpr_read_b32 v27, a188
  v_mul_f32 v27, v27, v26
  v_accvgpr_write_b32 a188, v27
  v_accvgpr_read_b32 v27, a189
  v_mul_f32 v27, v27, v26
  v_accvgpr_write_b32 a189, v27
  v_accvgpr_read_b32 v27, a190
  v_mul_f32 v27, v27, v26
  v_accvgpr_write_b32 a190, v27
  v_accvgpr_read_b32 v27, a191
  v_mul_f32 v27, v27, v26
  v_accvgpr_write_b32 a191, v27
  s_nop 1
  s_branch Lrare_5_ret
Lrare_6:
  v_max_f32 v19, v10, v16
  v_sub_f32 v20, v10, v19
  v_exp_f32 v20, v20
  v_mov_b32 v10, v19
  v_mul_f32 v13, v13, v20
  v_accvgpr_read_b32 v21, a0
  v_mul_f32 v21, v21, v20
  v_accvgpr_write_b32 a0, v21
  v_accvgpr_read_b32 v21, a1
  v_mul_f32 v21, v21, v20
  v_accvgpr_write_b32 a1, v21
  v_accvgpr_read_b32 v21, a2
  v_mul_f32 v21, v21, v20
  v_accvgpr_write_b32 a2, v21
  v_accvgpr_read_b32 v21, a3
  v_mul_f32 v21, v21, v20
  v_accvgpr_write_b32 a3, v21
  v_accvgpr_read_b32 v21, a4
  v_mul_f32 v21, v21, v20
  v_accvgpr_write_b32 a4, v21
  v_accvgpr_read_b32 v21, a5
  v_mul_f32 v21, v21, v20
  v_accvgpr_write_b32 a5, v21
  v_accvgpr_read_b32 v21, a6
  v_mul_f32 v21, v21, v20
  v_accvgpr_write_b32 a6, v21
  v_accvgpr_read_b32 v21, a7
  v_mul_f32 v21, v21, v20
  v_accvgpr_write_b32 a7, v21
  v_accvgpr_read_b32 v21, a8
  v_mul_f32 v21, v21, v20
  v_accvgpr_write_b32 a8, v21
  v_accvgpr_read_b32 v21, a9
  v_mul_f32 v21, v21, v20
  v_accvgpr_write_b32 a9, v21
  v_accvgpr_read_b32 v21, a10
  v_mul_f32 v21, v21, v20
  v_accvgpr_write_b32 a10, v21
  v_accvgpr_read_b32 v21, a11
  v_mul_f32 v21, v21, v20
  v_accvgpr_write_b32 a11, v21
  v_accvgpr_read_b32 v21, a12
  v_mul_f32 v21, v21, v20
  v_accvgpr_write_b32 a12, v21
  v_accvgpr_read_b32 v21, a13
  v_mul_f32 v21, v21, v20
  v_accvgpr_write_b32 a13, v21
  v_accvgpr_read_b32 v21, a14
  v_mul_f32 v21, v21, v20
  v_accvgpr_write_b32 a14, v21
  v_accvgpr_read_b32 v21, a15
  v_mul_f32 v21, v21, v20
  v_accvgpr_write_b32 a15, v21
  v_accvgpr_read_b32 v21, a16
  v_mul_f32 v21, v21, v20
  v_accvgpr_write_b32 a16, v21
  v_accvgpr_read_b32 v21, a17
  v_mul_f32 v21, v21, v20
  v_accvgpr_write_b32 a17, v21
  v_accvgpr_read_b32 v21, a18
  v_mul_f32 v21, v21, v20
  v_accvgpr_write_b32 a18, v21
  v_accvgpr_read_b32 v21, a19
  v_mul_f32 v21, v21, v20
  v_accvgpr_write_b32 a19, v21
  v_accvgpr_read_b32 v21, a20
  v_mul_f32 v21, v21, v20
  v_accvgpr_write_b32 a20, v21
  v_accvgpr_read_b32 v21, a21
  v_mul_f32 v21, v21, v20
  v_accvgpr_write_b32 a21, v21
  v_accvgpr_read_b32 v21, a22
  v_mul_f32 v21, v21, v20
  v_accvgpr_write_b32 a22, v21
  v_accvgpr_read_b32 v21, a23
  v_mul_f32 v21, v21, v20
  v_accvgpr_write_b32 a23, v21
  v_accvgpr_read_b32 v21, a24
  v_mul_f32 v21, v21, v20
  v_accvgpr_write_b32 a24, v21
  v_accvgpr_read_b32 v21, a25
  v_mul_f32 v21, v21, v20
  v_accvgpr_write_b32 a25, v21
  v_accvgpr_read_b32 v21, a26
  v_mul_f32 v21, v21, v20
  v_accvgpr_write_b32 a26, v21
  v_accvgpr_read_b32 v21, a27
  v_mul_f32 v21, v21, v20
  v_accvgpr_write_b32 a27, v21
  v_accvgpr_read_b32 v21, a28
  v_mul_f32 v21, v21, v20
  v_accvgpr_write_b32 a28, v21
  v_accvgpr_read_b32 v21, a29
  v_mul_f32 v21, v21, v20
  v_accvgpr_write_b32 a29, v21
  v_accvgpr_read_b32 v21, a30
  v_mul_f32 v21, v21, v20
  v_accvgpr_write_b32 a30, v21
  v_accvgpr_read_b32 v21, a31
  v_mul_f32 v21, v21, v20
  v_accvgpr_write_b32 a31, v21
  v_accvgpr_read_b32 v21, a32
  v_mul_f32 v21, v21, v20
  v_accvgpr_write_b32 a32, v21
  v_accvgpr_read_b32 v21, a33
  v_mul_f32 v21, v21, v20
  v_accvgpr_write_b32 a33, v21
  v_accvgpr_read_b32 v21, a34
  v_mul_f32 v21, v21, v20
  v_accvgpr_write_b32 a34, v21
  v_accvgpr_read_b32 v21, a35
  v_mul_f32 v21, v21, v20
  v_accvgpr_write_b32 a35, v21
  v_accvgpr_read_b32 v21, a36
  v_mul_f32 v21, v21, v20
  v_accvgpr_write_b32 a36, v21
  v_accvgpr_read_b32 v21, a37
  v_mul_f32 v21, v21, v20
  v_accvgpr_write_b32 a37, v21
  v_accvgpr_read_b32 v21, a38
  v_mul_f32 v21, v21, v20
  v_accvgpr_write_b32 a38, v21
  v_accvgpr_read_b32 v21, a39
  v_mul_f32 v21, v21, v20
  v_accvgpr_write_b32 a39, v21
  v_accvgpr_read_b32 v21, a40
  v_mul_f32 v21, v21, v20
  v_accvgpr_write_b32 a40, v21
  v_accvgpr_read_b32 v21, a41
  v_mul_f32 v21, v21, v20
  v_accvgpr_write_b32 a41, v21
  v_accvgpr_read_b32 v21, a42
  v_mul_f32 v21, v21, v20
  v_accvgpr_write_b32 a42, v21
  v_accvgpr_read_b32 v21, a43
  v_mul_f32 v21, v21, v20
  v_accvgpr_write_b32 a43, v21
  v_accvgpr_read_b32 v21, a44
  v_mul_f32 v21, v21, v20
  v_accvgpr_write_b32 a44, v21
  v_accvgpr_read_b32 v21, a45
  v_mul_f32 v21, v21, v20
  v_accvgpr_write_b32 a45, v21
  v_accvgpr_read_b32 v21, a46
  v_mul_f32 v21, v21, v20
  v_accvgpr_write_b32 a46, v21
  v_accvgpr_read_b32 v21, a47
  v_mul_f32 v21, v21, v20
  v_accvgpr_write_b32 a47, v21
  v_accvgpr_read_b32 v21, a48
  v_mul_f32 v21, v21, v20
  v_accvgpr_write_b32 a48, v21
  v_accvgpr_read_b32 v21, a49
  v_mul_f32 v21, v21, v20
  v_accvgpr_write_b32 a49, v21
  v_accvgpr_read_b32 v21, a50
  v_mul_f32 v21, v21, v20
  v_accvgpr_write_b32 a50, v21
  v_accvgpr_read_b32 v21, a51
  v_mul_f32 v21, v21, v20
  v_accvgpr_write_b32 a51, v21
  v_accvgpr_read_b32 v21, a52
  v_mul_f32 v21, v21, v20
  v_accvgpr_write_b32 a52, v21
  v_accvgpr_read_b32 v21, a53
  v_mul_f32 v21, v21, v20
  v_accvgpr_write_b32 a53, v21
  v_accvgpr_read_b32 v21, a54
  v_mul_f32 v21, v21, v20
  v_accvgpr_write_b32 a54, v21
  v_accvgpr_read_b32 v21, a55
  v_mul_f32 v21, v21, v20
  v_accvgpr_write_b32 a55, v21
  v_accvgpr_read_b32 v21, a56
  v_mul_f32 v21, v21, v20
  v_accvgpr_write_b32 a56, v21
  v_accvgpr_read_b32 v21, a57
  v_mul_f32 v21, v21, v20
  v_accvgpr_write_b32 a57, v21
  v_accvgpr_read_b32 v21, a58
  v_mul_f32 v21, v21, v20
  v_accvgpr_write_b32 a58, v21
  v_accvgpr_read_b32 v21, a59
  v_mul_f32 v21, v21, v20
  v_accvgpr_write_b32 a59, v21
  v_accvgpr_read_b32 v21, a60
  v_mul_f32 v21, v21, v20
  v_accvgpr_write_b32 a60, v21
  v_accvgpr_read_b32 v21, a61
  v_mul_f32 v21, v21, v20
  v_accvgpr_write_b32 a61, v21
  v_accvgpr_read_b32 v21, a62
  v_mul_f32 v21, v21, v20
  v_accvgpr_write_b32 a62, v21
  v_accvgpr_read_b32 v21, a63
  v_mul_f32 v21, v21, v20
  v_accvgpr_write_b32 a63, v21
  v_max_f32 v22, v11, v17
  v_sub_f32 v23, v11, v22
  v_exp_f32 v23, v23
  v_mov_b32 v11, v22
  v_mul_f32 v14, v14, v23
  v_accvgpr_read_b32 v24, a64
  v_mul_f32 v24, v24, v23
  v_accvgpr_write_b32 a64, v24
  v_accvgpr_read_b32 v24, a65
  v_mul_f32 v24, v24, v23
  v_accvgpr_write_b32 a65, v24
  v_accvgpr_read_b32 v24, a66
  v_mul_f32 v24, v24, v23
  v_accvgpr_write_b32 a66, v24
  v_accvgpr_read_b32 v24, a67
  v_mul_f32 v24, v24, v23
  v_accvgpr_write_b32 a67, v24
  v_accvgpr_read_b32 v24, a68
  v_mul_f32 v24, v24, v23
  v_accvgpr_write_b32 a68, v24
  v_accvgpr_read_b32 v24, a69
  v_mul_f32 v24, v24, v23
  v_accvgpr_write_b32 a69, v24
  v_accvgpr_read_b32 v24, a70
  v_mul_f32 v24, v24, v23
  v_accvgpr_write_b32 a70, v24
  v_accvgpr_read_b32 v24, a71
  v_mul_f32 v24, v24, v23
  v_accvgpr_write_b32 a71, v24
  v_accvgpr_read_b32 v24, a72
  v_mul_f32 v24, v24, v23
  v_accvgpr_write_b32 a72, v24
  v_accvgpr_read_b32 v24, a73
  v_mul_f32 v24, v24, v23
  v_accvgpr_write_b32 a73, v24
  v_accvgpr_read_b32 v24, a74
  v_mul_f32 v24, v24, v23
  v_accvgpr_write_b32 a74, v24
  v_accvgpr_read_b32 v24, a75
  v_mul_f32 v24, v24, v23
  v_accvgpr_write_b32 a75, v24
  v_accvgpr_read_b32 v24, a76
  v_mul_f32 v24, v24, v23
  v_accvgpr_write_b32 a76, v24
  v_accvgpr_read_b32 v24, a77
  v_mul_f32 v24, v24, v23
  v_accvgpr_write_b32 a77, v24
  v_accvgpr_read_b32 v24, a78
  v_mul_f32 v24, v24, v23
  v_accvgpr_write_b32 a78, v24
  v_accvgpr_read_b32 v24, a79
  v_mul_f32 v24, v24, v23
  v_accvgpr_write_b32 a79, v24
  v_accvgpr_read_b32 v24, a80
  v_mul_f32 v24, v24, v23
  v_accvgpr_write_b32 a80, v24
  v_accvgpr_read_b32 v24, a81
  v_mul_f32 v24, v24, v23
  v_accvgpr_write_b32 a81, v24
  v_accvgpr_read_b32 v24, a82
  v_mul_f32 v24, v24, v23
  v_accvgpr_write_b32 a82, v24
  v_accvgpr_read_b32 v24, a83
  v_mul_f32 v24, v24, v23
  v_accvgpr_write_b32 a83, v24
  v_accvgpr_read_b32 v24, a84
  v_mul_f32 v24, v24, v23
  v_accvgpr_write_b32 a84, v24
  v_accvgpr_read_b32 v24, a85
  v_mul_f32 v24, v24, v23
  v_accvgpr_write_b32 a85, v24
  v_accvgpr_read_b32 v24, a86
  v_mul_f32 v24, v24, v23
  v_accvgpr_write_b32 a86, v24
  v_accvgpr_read_b32 v24, a87
  v_mul_f32 v24, v24, v23
  v_accvgpr_write_b32 a87, v24
  v_accvgpr_read_b32 v24, a88
  v_mul_f32 v24, v24, v23
  v_accvgpr_write_b32 a88, v24
  v_accvgpr_read_b32 v24, a89
  v_mul_f32 v24, v24, v23
  v_accvgpr_write_b32 a89, v24
  v_accvgpr_read_b32 v24, a90
  v_mul_f32 v24, v24, v23
  v_accvgpr_write_b32 a90, v24
  v_accvgpr_read_b32 v24, a91
  v_mul_f32 v24, v24, v23
  v_accvgpr_write_b32 a91, v24
  v_accvgpr_read_b32 v24, a92
  v_mul_f32 v24, v24, v23
  v_accvgpr_write_b32 a92, v24
  v_accvgpr_read_b32 v24, a93
  v_mul_f32 v24, v24, v23
  v_accvgpr_write_b32 a93, v24
  v_accvgpr_read_b32 v24, a94
  v_mul_f32 v24, v24, v23
  v_accvgpr_write_b32 a94, v24
  v_accvgpr_read_b32 v24, a95
  v_mul_f32 v24, v24, v23
  v_accvgpr_write_b32 a95, v24
  v_accvgpr_read_b32 v24, a96
  v_mul_f32 v24, v24, v23
  v_accvgpr_write_b32 a96, v24
  v_accvgpr_read_b32 v24, a97
  v_mul_f32 v24, v24, v23
  v_accvgpr_write_b32 a97, v24
  v_accvgpr_read_b32 v24, a98
  v_mul_f32 v24, v24, v23
  v_accvgpr_write_b32 a98, v24
  v_accvgpr_read_b32 v24, a99
  v_mul_f32 v24, v24, v23
  v_accvgpr_write_b32 a99, v24
  v_accvgpr_read_b32 v24, a100
  v_mul_f32 v24, v24, v23
  v_accvgpr_write_b32 a100, v24
  v_accvgpr_read_b32 v24, a101
  v_mul_f32 v24, v24, v23
  v_accvgpr_write_b32 a101, v24
  v_accvgpr_read_b32 v24, a102
  v_mul_f32 v24, v24, v23
  v_accvgpr_write_b32 a102, v24
  v_accvgpr_read_b32 v24, a103
  v_mul_f32 v24, v24, v23
  v_accvgpr_write_b32 a103, v24
  v_accvgpr_read_b32 v24, a104
  v_mul_f32 v24, v24, v23
  v_accvgpr_write_b32 a104, v24
  v_accvgpr_read_b32 v24, a105
  v_mul_f32 v24, v24, v23
  v_accvgpr_write_b32 a105, v24
  v_accvgpr_read_b32 v24, a106
  v_mul_f32 v24, v24, v23
  v_accvgpr_write_b32 a106, v24
  v_accvgpr_read_b32 v24, a107
  v_mul_f32 v24, v24, v23
  v_accvgpr_write_b32 a107, v24
  v_accvgpr_read_b32 v24, a108
  v_mul_f32 v24, v24, v23
  v_accvgpr_write_b32 a108, v24
  v_accvgpr_read_b32 v24, a109
  v_mul_f32 v24, v24, v23
  v_accvgpr_write_b32 a109, v24
  v_accvgpr_read_b32 v24, a110
  v_mul_f32 v24, v24, v23
  v_accvgpr_write_b32 a110, v24
  v_accvgpr_read_b32 v24, a111
  v_mul_f32 v24, v24, v23
  v_accvgpr_write_b32 a111, v24
  v_accvgpr_read_b32 v24, a112
  v_mul_f32 v24, v24, v23
  v_accvgpr_write_b32 a112, v24
  v_accvgpr_read_b32 v24, a113
  v_mul_f32 v24, v24, v23
  v_accvgpr_write_b32 a113, v24
  v_accvgpr_read_b32 v24, a114
  v_mul_f32 v24, v24, v23
  v_accvgpr_write_b32 a114, v24
  v_accvgpr_read_b32 v24, a115
  v_mul_f32 v24, v24, v23
  v_accvgpr_write_b32 a115, v24
  v_accvgpr_read_b32 v24, a116
  v_mul_f32 v24, v24, v23
  v_accvgpr_write_b32 a116, v24
  v_accvgpr_read_b32 v24, a117
  v_mul_f32 v24, v24, v23
  v_accvgpr_write_b32 a117, v24
  v_accvgpr_read_b32 v24, a118
  v_mul_f32 v24, v24, v23
  v_accvgpr_write_b32 a118, v24
  v_accvgpr_read_b32 v24, a119
  v_mul_f32 v24, v24, v23
  v_accvgpr_write_b32 a119, v24
  v_accvgpr_read_b32 v24, a120
  v_mul_f32 v24, v24, v23
  v_accvgpr_write_b32 a120, v24
  v_accvgpr_read_b32 v24, a121
  v_mul_f32 v24, v24, v23
  v_accvgpr_write_b32 a121, v24
  v_accvgpr_read_b32 v24, a122
  v_mul_f32 v24, v24, v23
  v_accvgpr_write_b32 a122, v24
  v_accvgpr_read_b32 v24, a123
  v_mul_f32 v24, v24, v23
  v_accvgpr_write_b32 a123, v24
  v_accvgpr_read_b32 v24, a124
  v_mul_f32 v24, v24, v23
  v_accvgpr_write_b32 a124, v24
  v_accvgpr_read_b32 v24, a125
  v_mul_f32 v24, v24, v23
  v_accvgpr_write_b32 a125, v24
  v_accvgpr_read_b32 v24, a126
  v_mul_f32 v24, v24, v23
  v_accvgpr_write_b32 a126, v24
  v_accvgpr_read_b32 v24, a127
  v_mul_f32 v24, v24, v23
  v_accvgpr_write_b32 a127, v24
  v_max_f32 v25, v12, v18
  v_sub_f32 v26, v12, v25
  v_exp_f32 v26, v26
  v_mov_b32 v12, v25
  v_mul_f32 v15, v15, v26
  v_accvgpr_read_b32 v27, a128
  v_mul_f32 v27, v27, v26
  v_accvgpr_write_b32 a128, v27
  v_accvgpr_read_b32 v27, a129
  v_mul_f32 v27, v27, v26
  v_accvgpr_write_b32 a129, v27
  v_accvgpr_read_b32 v27, a130
  v_mul_f32 v27, v27, v26
  v_accvgpr_write_b32 a130, v27
  v_accvgpr_read_b32 v27, a131
  v_mul_f32 v27, v27, v26
  v_accvgpr_write_b32 a131, v27
  v_accvgpr_read_b32 v27, a132
  v_mul_f32 v27, v27, v26
  v_accvgpr_write_b32 a132, v27
  v_accvgpr_read_b32 v27, a133
  v_mul_f32 v27, v27, v26
  v_accvgpr_write_b32 a133, v27
  v_accvgpr_read_b32 v27, a134
  v_mul_f32 v27, v27, v26
  v_accvgpr_write_b32 a134, v27
  v_accvgpr_read_b32 v27, a135
  v_mul_f32 v27, v27, v26
  v_accvgpr_write_b32 a135, v27
  v_accvgpr_read_b32 v27, a136
  v_mul_f32 v27, v27, v26
  v_accvgpr_write_b32 a136, v27
  v_accvgpr_read_b32 v27, a137
  v_mul_f32 v27, v27, v26
  v_accvgpr_write_b32 a137, v27
  v_accvgpr_read_b32 v27, a138
  v_mul_f32 v27, v27, v26
  v_accvgpr_write_b32 a138, v27
  v_accvgpr_read_b32 v27, a139
  v_mul_f32 v27, v27, v26
  v_accvgpr_write_b32 a139, v27
  v_accvgpr_read_b32 v27, a140
  v_mul_f32 v27, v27, v26
  v_accvgpr_write_b32 a140, v27
  v_accvgpr_read_b32 v27, a141
  v_mul_f32 v27, v27, v26
  v_accvgpr_write_b32 a141, v27
  v_accvgpr_read_b32 v27, a142
  v_mul_f32 v27, v27, v26
  v_accvgpr_write_b32 a142, v27
  v_accvgpr_read_b32 v27, a143
  v_mul_f32 v27, v27, v26
  v_accvgpr_write_b32 a143, v27
  v_accvgpr_read_b32 v27, a144
  v_mul_f32 v27, v27, v26
  v_accvgpr_write_b32 a144, v27
  v_accvgpr_read_b32 v27, a145
  v_mul_f32 v27, v27, v26
  v_accvgpr_write_b32 a145, v27
  v_accvgpr_read_b32 v27, a146
  v_mul_f32 v27, v27, v26
  v_accvgpr_write_b32 a146, v27
  v_accvgpr_read_b32 v27, a147
  v_mul_f32 v27, v27, v26
  v_accvgpr_write_b32 a147, v27
  v_accvgpr_read_b32 v27, a148
  v_mul_f32 v27, v27, v26
  v_accvgpr_write_b32 a148, v27
  v_accvgpr_read_b32 v27, a149
  v_mul_f32 v27, v27, v26
  v_accvgpr_write_b32 a149, v27
  v_accvgpr_read_b32 v27, a150
  v_mul_f32 v27, v27, v26
  v_accvgpr_write_b32 a150, v27
  v_accvgpr_read_b32 v27, a151
  v_mul_f32 v27, v27, v26
  v_accvgpr_write_b32 a151, v27
  v_accvgpr_read_b32 v27, a152
  v_mul_f32 v27, v27, v26
  v_accvgpr_write_b32 a152, v27
  v_accvgpr_read_b32 v27, a153
  v_mul_f32 v27, v27, v26
  v_accvgpr_write_b32 a153, v27
  v_accvgpr_read_b32 v27, a154
  v_mul_f32 v27, v27, v26
  v_accvgpr_write_b32 a154, v27
  v_accvgpr_read_b32 v27, a155
  v_mul_f32 v27, v27, v26
  v_accvgpr_write_b32 a155, v27
  v_accvgpr_read_b32 v27, a156
  v_mul_f32 v27, v27, v26
  v_accvgpr_write_b32 a156, v27
  v_accvgpr_read_b32 v27, a157
  v_mul_f32 v27, v27, v26
  v_accvgpr_write_b32 a157, v27
  v_accvgpr_read_b32 v27, a158
  v_mul_f32 v27, v27, v26
  v_accvgpr_write_b32 a158, v27
  v_accvgpr_read_b32 v27, a159
  v_mul_f32 v27, v27, v26
  v_accvgpr_write_b32 a159, v27
  v_accvgpr_read_b32 v27, a160
  v_mul_f32 v27, v27, v26
  v_accvgpr_write_b32 a160, v27
  v_accvgpr_read_b32 v27, a161
  v_mul_f32 v27, v27, v26
  v_accvgpr_write_b32 a161, v27
  v_accvgpr_read_b32 v27, a162
  v_mul_f32 v27, v27, v26
  v_accvgpr_write_b32 a162, v27
  v_accvgpr_read_b32 v27, a163
  v_mul_f32 v27, v27, v26
  v_accvgpr_write_b32 a163, v27
  v_accvgpr_read_b32 v27, a164
  v_mul_f32 v27, v27, v26
  v_accvgpr_write_b32 a164, v27
  v_accvgpr_read_b32 v27, a165
  v_mul_f32 v27, v27, v26
  v_accvgpr_write_b32 a165, v27
  v_accvgpr_read_b32 v27, a166
  v_mul_f32 v27, v27, v26
  v_accvgpr_write_b32 a166, v27
  v_accvgpr_read_b32 v27, a167
  v_mul_f32 v27, v27, v26
  v_accvgpr_write_b32 a167, v27
  v_accvgpr_read_b32 v27, a168
  v_mul_f32 v27, v27, v26
  v_accvgpr_write_b32 a168, v27
  v_accvgpr_read_b32 v27, a169
  v_mul_f32 v27, v27, v26
  v_accvgpr_write_b32 a169, v27
  v_accvgpr_read_b32 v27, a170
  v_mul_f32 v27, v27, v26
  v_accvgpr_write_b32 a170, v27
  v_accvgpr_read_b32 v27, a171
  v_mul_f32 v27, v27, v26
  v_accvgpr_write_b32 a171, v27
  v_accvgpr_read_b32 v27, a172
  v_mul_f32 v27, v27, v26
  v_accvgpr_write_b32 a172, v27
  v_accvgpr_read_b32 v27, a173
  v_mul_f32 v27, v27, v26
  v_accvgpr_write_b32 a173, v27
  v_accvgpr_read_b32 v27, a174
  v_mul_f32 v27, v27, v26
  v_accvgpr_write_b32 a174, v27
  v_accvgpr_read_b32 v27, a175
  v_mul_f32 v27, v27, v26
  v_accvgpr_write_b32 a175, v27
  v_accvgpr_read_b32 v27, a176
  v_mul_f32 v27, v27, v26
  v_accvgpr_write_b32 a176, v27
  v_accvgpr_read_b32 v27, a177
  v_mul_f32 v27, v27, v26
  v_accvgpr_write_b32 a177, v27
  v_accvgpr_read_b32 v27, a178
  v_mul_f32 v27, v27, v26
  v_accvgpr_write_b32 a178, v27
  v_accvgpr_read_b32 v27, a179
  v_mul_f32 v27, v27, v26
  v_accvgpr_write_b32 a179, v27
  v_accvgpr_read_b32 v27, a180
  v_mul_f32 v27, v27, v26
  v_accvgpr_write_b32 a180, v27
  v_accvgpr_read_b32 v27, a181
  v_mul_f32 v27, v27, v26
  v_accvgpr_write_b32 a181, v27
  v_accvgpr_read_b32 v27, a182
  v_mul_f32 v27, v27, v26
  v_accvgpr_write_b32 a182, v27
  v_accvgpr_read_b32 v27, a183
  v_mul_f32 v27, v27, v26
  v_accvgpr_write_b32 a183, v27
  v_accvgpr_read_b32 v27, a184
  v_mul_f32 v27, v27, v26
  v_accvgpr_write_b32 a184, v27
  v_accvgpr_read_b32 v27, a185
  v_mul_f32 v27, v27, v26
  v_accvgpr_write_b32 a185, v27
  v_accvgpr_read_b32 v27, a186
  v_mul_f32 v27, v27, v26
  v_accvgpr_write_b32 a186, v27
  v_accvgpr_read_b32 v27, a187
  v_mul_f32 v27, v27, v26
  v_accvgpr_write_b32 a187, v27
  v_accvgpr_read_b32 v27, a188
  v_mul_f32 v27, v27, v26
  v_accvgpr_write_b32 a188, v27
  v_accvgpr_read_b32 v27, a189
  v_mul_f32 v27, v27, v26
  v_accvgpr_write_b32 a189, v27
  v_accvgpr_read_b32 v27, a190
  v_mul_f32 v27, v27, v26
  v_accvgpr_write_b32 a190, v27
  v_accvgpr_read_b32 v27, a191
  v_mul_f32 v27, v27, v26
  v_accvgpr_write_b32 a191, v27
  s_nop 1
  s_branch Lrare_6_ret
Lrare_7:
  v_max_f32 v19, v10, v16
  v_sub_f32 v20, v10, v19
  v_exp_f32 v20, v20
  v_mov_b32 v10, v19
  v_mul_f32 v13, v13, v20
  v_accvgpr_read_b32 v21, a0
  v_mul_f32 v21, v21, v20
  v_accvgpr_write_b32 a0, v21
  v_accvgpr_read_b32 v21, a1
  v_mul_f32 v21, v21, v20
  v_accvgpr_write_b32 a1, v21
  v_accvgpr_read_b32 v21, a2
  v_mul_f32 v21, v21, v20
  v_accvgpr_write_b32 a2, v21
  v_accvgpr_read_b32 v21, a3
  v_mul_f32 v21, v21, v20
  v_accvgpr_write_b32 a3, v21
  v_accvgpr_read_b32 v21, a4
  v_mul_f32 v21, v21, v20
  v_accvgpr_write_b32 a4, v21
  v_accvgpr_read_b32 v21, a5
  v_mul_f32 v21, v21, v20
  v_accvgpr_write_b32 a5, v21
  v_accvgpr_read_b32 v21, a6
  v_mul_f32 v21, v21, v20
  v_accvgpr_write_b32 a6, v21
  v_accvgpr_read_b32 v21, a7
  v_mul_f32 v21, v21, v20
  v_accvgpr_write_b32 a7, v21
  v_accvgpr_read_b32 v21, a8
  v_mul_f32 v21, v21, v20
  v_accvgpr_write_b32 a8, v21
  v_accvgpr_read_b32 v21, a9
  v_mul_f32 v21, v21, v20
  v_accvgpr_write_b32 a9, v21
  v_accvgpr_read_b32 v21, a10
  v_mul_f32 v21, v21, v20
  v_accvgpr_write_b32 a10, v21
  v_accvgpr_read_b32 v21, a11
  v_mul_f32 v21, v21, v20
  v_accvgpr_write_b32 a11, v21
  v_accvgpr_read_b32 v21, a12
  v_mul_f32 v21, v21, v20
  v_accvgpr_write_b32 a12, v21
  v_accvgpr_read_b32 v21, a13
  v_mul_f32 v21, v21, v20
  v_accvgpr_write_b32 a13, v21
  v_accvgpr_read_b32 v21, a14
  v_mul_f32 v21, v21, v20
  v_accvgpr_write_b32 a14, v21
  v_accvgpr_read_b32 v21, a15
  v_mul_f32 v21, v21, v20
  v_accvgpr_write_b32 a15, v21
  v_accvgpr_read_b32 v21, a16
  v_mul_f32 v21, v21, v20
  v_accvgpr_write_b32 a16, v21
  v_accvgpr_read_b32 v21, a17
  v_mul_f32 v21, v21, v20
  v_accvgpr_write_b32 a17, v21
  v_accvgpr_read_b32 v21, a18
  v_mul_f32 v21, v21, v20
  v_accvgpr_write_b32 a18, v21
  v_accvgpr_read_b32 v21, a19
  v_mul_f32 v21, v21, v20
  v_accvgpr_write_b32 a19, v21
  v_accvgpr_read_b32 v21, a20
  v_mul_f32 v21, v21, v20
  v_accvgpr_write_b32 a20, v21
  v_accvgpr_read_b32 v21, a21
  v_mul_f32 v21, v21, v20
  v_accvgpr_write_b32 a21, v21
  v_accvgpr_read_b32 v21, a22
  v_mul_f32 v21, v21, v20
  v_accvgpr_write_b32 a22, v21
  v_accvgpr_read_b32 v21, a23
  v_mul_f32 v21, v21, v20
  v_accvgpr_write_b32 a23, v21
  v_accvgpr_read_b32 v21, a24
  v_mul_f32 v21, v21, v20
  v_accvgpr_write_b32 a24, v21
  v_accvgpr_read_b32 v21, a25
  v_mul_f32 v21, v21, v20
  v_accvgpr_write_b32 a25, v21
  v_accvgpr_read_b32 v21, a26
  v_mul_f32 v21, v21, v20
  v_accvgpr_write_b32 a26, v21
  v_accvgpr_read_b32 v21, a27
  v_mul_f32 v21, v21, v20
  v_accvgpr_write_b32 a27, v21
  v_accvgpr_read_b32 v21, a28
  v_mul_f32 v21, v21, v20
  v_accvgpr_write_b32 a28, v21
  v_accvgpr_read_b32 v21, a29
  v_mul_f32 v21, v21, v20
  v_accvgpr_write_b32 a29, v21
  v_accvgpr_read_b32 v21, a30
  v_mul_f32 v21, v21, v20
  v_accvgpr_write_b32 a30, v21
  v_accvgpr_read_b32 v21, a31
  v_mul_f32 v21, v21, v20
  v_accvgpr_write_b32 a31, v21
  v_accvgpr_read_b32 v21, a32
  v_mul_f32 v21, v21, v20
  v_accvgpr_write_b32 a32, v21
  v_accvgpr_read_b32 v21, a33
  v_mul_f32 v21, v21, v20
  v_accvgpr_write_b32 a33, v21
  v_accvgpr_read_b32 v21, a34
  v_mul_f32 v21, v21, v20
  v_accvgpr_write_b32 a34, v21
  v_accvgpr_read_b32 v21, a35
  v_mul_f32 v21, v21, v20
  v_accvgpr_write_b32 a35, v21
  v_accvgpr_read_b32 v21, a36
  v_mul_f32 v21, v21, v20
  v_accvgpr_write_b32 a36, v21
  v_accvgpr_read_b32 v21, a37
  v_mul_f32 v21, v21, v20
  v_accvgpr_write_b32 a37, v21
  v_accvgpr_read_b32 v21, a38
  v_mul_f32 v21, v21, v20
  v_accvgpr_write_b32 a38, v21
  v_accvgpr_read_b32 v21, a39
  v_mul_f32 v21, v21, v20
  v_accvgpr_write_b32 a39, v21
  v_accvgpr_read_b32 v21, a40
  v_mul_f32 v21, v21, v20
  v_accvgpr_write_b32 a40, v21
  v_accvgpr_read_b32 v21, a41
  v_mul_f32 v21, v21, v20
  v_accvgpr_write_b32 a41, v21
  v_accvgpr_read_b32 v21, a42
  v_mul_f32 v21, v21, v20
  v_accvgpr_write_b32 a42, v21
  v_accvgpr_read_b32 v21, a43
  v_mul_f32 v21, v21, v20
  v_accvgpr_write_b32 a43, v21
  v_accvgpr_read_b32 v21, a44
  v_mul_f32 v21, v21, v20
  v_accvgpr_write_b32 a44, v21
  v_accvgpr_read_b32 v21, a45
  v_mul_f32 v21, v21, v20
  v_accvgpr_write_b32 a45, v21
  v_accvgpr_read_b32 v21, a46
  v_mul_f32 v21, v21, v20
  v_accvgpr_write_b32 a46, v21
  v_accvgpr_read_b32 v21, a47
  v_mul_f32 v21, v21, v20
  v_accvgpr_write_b32 a47, v21
  v_accvgpr_read_b32 v21, a48
  v_mul_f32 v21, v21, v20
  v_accvgpr_write_b32 a48, v21
  v_accvgpr_read_b32 v21, a49
  v_mul_f32 v21, v21, v20
  v_accvgpr_write_b32 a49, v21
  v_accvgpr_read_b32 v21, a50
  v_mul_f32 v21, v21, v20
  v_accvgpr_write_b32 a50, v21
  v_accvgpr_read_b32 v21, a51
  v_mul_f32 v21, v21, v20
  v_accvgpr_write_b32 a51, v21
  v_accvgpr_read_b32 v21, a52
  v_mul_f32 v21, v21, v20
  v_accvgpr_write_b32 a52, v21
  v_accvgpr_read_b32 v21, a53
  v_mul_f32 v21, v21, v20
  v_accvgpr_write_b32 a53, v21
  v_accvgpr_read_b32 v21, a54
  v_mul_f32 v21, v21, v20
  v_accvgpr_write_b32 a54, v21
  v_accvgpr_read_b32 v21, a55
  v_mul_f32 v21, v21, v20
  v_accvgpr_write_b32 a55, v21
  v_accvgpr_read_b32 v21, a56
  v_mul_f32 v21, v21, v20
  v_accvgpr_write_b32 a56, v21
  v_accvgpr_read_b32 v21, a57
  v_mul_f32 v21, v21, v20
  v_accvgpr_write_b32 a57, v21
  v_accvgpr_read_b32 v21, a58
  v_mul_f32 v21, v21, v20
  v_accvgpr_write_b32 a58, v21
  v_accvgpr_read_b32 v21, a59
  v_mul_f32 v21, v21, v20
  v_accvgpr_write_b32 a59, v21
  v_accvgpr_read_b32 v21, a60
  v_mul_f32 v21, v21, v20
  v_accvgpr_write_b32 a60, v21
  v_accvgpr_read_b32 v21, a61
  v_mul_f32 v21, v21, v20
  v_accvgpr_write_b32 a61, v21
  v_accvgpr_read_b32 v21, a62
  v_mul_f32 v21, v21, v20
  v_accvgpr_write_b32 a62, v21
  v_accvgpr_read_b32 v21, a63
  v_mul_f32 v21, v21, v20
  v_accvgpr_write_b32 a63, v21
  v_max_f32 v22, v11, v17
  v_sub_f32 v23, v11, v22
  v_exp_f32 v23, v23
  v_mov_b32 v11, v22
  v_mul_f32 v14, v14, v23
  v_accvgpr_read_b32 v24, a64
  v_mul_f32 v24, v24, v23
  v_accvgpr_write_b32 a64, v24
  v_accvgpr_read_b32 v24, a65
  v_mul_f32 v24, v24, v23
  v_accvgpr_write_b32 a65, v24
  v_accvgpr_read_b32 v24, a66
  v_mul_f32 v24, v24, v23
  v_accvgpr_write_b32 a66, v24
  v_accvgpr_read_b32 v24, a67
  v_mul_f32 v24, v24, v23
  v_accvgpr_write_b32 a67, v24
  v_accvgpr_read_b32 v24, a68
  v_mul_f32 v24, v24, v23
  v_accvgpr_write_b32 a68, v24
  v_accvgpr_read_b32 v24, a69
  v_mul_f32 v24, v24, v23
  v_accvgpr_write_b32 a69, v24
  v_accvgpr_read_b32 v24, a70
  v_mul_f32 v24, v24, v23
  v_accvgpr_write_b32 a70, v24
  v_accvgpr_read_b32 v24, a71
  v_mul_f32 v24, v24, v23
  v_accvgpr_write_b32 a71, v24
  v_accvgpr_read_b32 v24, a72
  v_mul_f32 v24, v24, v23
  v_accvgpr_write_b32 a72, v24
  v_accvgpr_read_b32 v24, a73
  v_mul_f32 v24, v24, v23
  v_accvgpr_write_b32 a73, v24
  v_accvgpr_read_b32 v24, a74
  v_mul_f32 v24, v24, v23
  v_accvgpr_write_b32 a74, v24
  v_accvgpr_read_b32 v24, a75
  v_mul_f32 v24, v24, v23
  v_accvgpr_write_b32 a75, v24
  v_accvgpr_read_b32 v24, a76
  v_mul_f32 v24, v24, v23
  v_accvgpr_write_b32 a76, v24
  v_accvgpr_read_b32 v24, a77
  v_mul_f32 v24, v24, v23
  v_accvgpr_write_b32 a77, v24
  v_accvgpr_read_b32 v24, a78
  v_mul_f32 v24, v24, v23
  v_accvgpr_write_b32 a78, v24
  v_accvgpr_read_b32 v24, a79
  v_mul_f32 v24, v24, v23
  v_accvgpr_write_b32 a79, v24
  v_accvgpr_read_b32 v24, a80
  v_mul_f32 v24, v24, v23
  v_accvgpr_write_b32 a80, v24
  v_accvgpr_read_b32 v24, a81
  v_mul_f32 v24, v24, v23
  v_accvgpr_write_b32 a81, v24
  v_accvgpr_read_b32 v24, a82
  v_mul_f32 v24, v24, v23
  v_accvgpr_write_b32 a82, v24
  v_accvgpr_read_b32 v24, a83
  v_mul_f32 v24, v24, v23
  v_accvgpr_write_b32 a83, v24
  v_accvgpr_read_b32 v24, a84
  v_mul_f32 v24, v24, v23
  v_accvgpr_write_b32 a84, v24
  v_accvgpr_read_b32 v24, a85
  v_mul_f32 v24, v24, v23
  v_accvgpr_write_b32 a85, v24
  v_accvgpr_read_b32 v24, a86
  v_mul_f32 v24, v24, v23
  v_accvgpr_write_b32 a86, v24
  v_accvgpr_read_b32 v24, a87
  v_mul_f32 v24, v24, v23
  v_accvgpr_write_b32 a87, v24
  v_accvgpr_read_b32 v24, a88
  v_mul_f32 v24, v24, v23
  v_accvgpr_write_b32 a88, v24
  v_accvgpr_read_b32 v24, a89
  v_mul_f32 v24, v24, v23
  v_accvgpr_write_b32 a89, v24
  v_accvgpr_read_b32 v24, a90
  v_mul_f32 v24, v24, v23
  v_accvgpr_write_b32 a90, v24
  v_accvgpr_read_b32 v24, a91
  v_mul_f32 v24, v24, v23
  v_accvgpr_write_b32 a91, v24
  v_accvgpr_read_b32 v24, a92
  v_mul_f32 v24, v24, v23
  v_accvgpr_write_b32 a92, v24
  v_accvgpr_read_b32 v24, a93
  v_mul_f32 v24, v24, v23
  v_accvgpr_write_b32 a93, v24
  v_accvgpr_read_b32 v24, a94
  v_mul_f32 v24, v24, v23
  v_accvgpr_write_b32 a94, v24
  v_accvgpr_read_b32 v24, a95
  v_mul_f32 v24, v24, v23
  v_accvgpr_write_b32 a95, v24
  v_accvgpr_read_b32 v24, a96
  v_mul_f32 v24, v24, v23
  v_accvgpr_write_b32 a96, v24
  v_accvgpr_read_b32 v24, a97
  v_mul_f32 v24, v24, v23
  v_accvgpr_write_b32 a97, v24
  v_accvgpr_read_b32 v24, a98
  v_mul_f32 v24, v24, v23
  v_accvgpr_write_b32 a98, v24
  v_accvgpr_read_b32 v24, a99
  v_mul_f32 v24, v24, v23
  v_accvgpr_write_b32 a99, v24
  v_accvgpr_read_b32 v24, a100
  v_mul_f32 v24, v24, v23
  v_accvgpr_write_b32 a100, v24
  v_accvgpr_read_b32 v24, a101
  v_mul_f32 v24, v24, v23
  v_accvgpr_write_b32 a101, v24
  v_accvgpr_read_b32 v24, a102
  v_mul_f32 v24, v24, v23
  v_accvgpr_write_b32 a102, v24
  v_accvgpr_read_b32 v24, a103
  v_mul_f32 v24, v24, v23
  v_accvgpr_write_b32 a103, v24
  v_accvgpr_read_b32 v24, a104
  v_mul_f32 v24, v24, v23
  v_accvgpr_write_b32 a104, v24
  v_accvgpr_read_b32 v24, a105
  v_mul_f32 v24, v24, v23
  v_accvgpr_write_b32 a105, v24
  v_accvgpr_read_b32 v24, a106
  v_mul_f32 v24, v24, v23
  v_accvgpr_write_b32 a106, v24
  v_accvgpr_read_b32 v24, a107
  v_mul_f32 v24, v24, v23
  v_accvgpr_write_b32 a107, v24
  v_accvgpr_read_b32 v24, a108
  v_mul_f32 v24, v24, v23
  v_accvgpr_write_b32 a108, v24
  v_accvgpr_read_b32 v24, a109
  v_mul_f32 v24, v24, v23
  v_accvgpr_write_b32 a109, v24
  v_accvgpr_read_b32 v24, a110
  v_mul_f32 v24, v24, v23
  v_accvgpr_write_b32 a110, v24
  v_accvgpr_read_b32 v24, a111
  v_mul_f32 v24, v24, v23
  v_accvgpr_write_b32 a111, v24
  v_accvgpr_read_b32 v24, a112
  v_mul_f32 v24, v24, v23
  v_accvgpr_write_b32 a112, v24
  v_accvgpr_read_b32 v24, a113
  v_mul_f32 v24, v24, v23
  v_accvgpr_write_b32 a113, v24
  v_accvgpr_read_b32 v24, a114
  v_mul_f32 v24, v24, v23
  v_accvgpr_write_b32 a114, v24
  v_accvgpr_read_b32 v24, a115
  v_mul_f32 v24, v24, v23
  v_accvgpr_write_b32 a115, v24
  v_accvgpr_read_b32 v24, a116
  v_mul_f32 v24, v24, v23
  v_accvgpr_write_b32 a116, v24
  v_accvgpr_read_b32 v24, a117
  v_mul_f32 v24, v24, v23
  v_accvgpr_write_b32 a117, v24
  v_accvgpr_read_b32 v24, a118
  v_mul_f32 v24, v24, v23
  v_accvgpr_write_b32 a118, v24
  v_accvgpr_read_b32 v24, a119
  v_mul_f32 v24, v24, v23
  v_accvgpr_write_b32 a119, v24
  v_accvgpr_read_b32 v24, a120
  v_mul_f32 v24, v24, v23
  v_accvgpr_write_b32 a120, v24
  v_accvgpr_read_b32 v24, a121
  v_mul_f32 v24, v24, v23
  v_accvgpr_write_b32 a121, v24
  v_accvgpr_read_b32 v24, a122
  v_mul_f32 v24, v24, v23
  v_accvgpr_write_b32 a122, v24
  v_accvgpr_read_b32 v24, a123
  v_mul_f32 v24, v24, v23
  v_accvgpr_write_b32 a123, v24
  v_accvgpr_read_b32 v24, a124
  v_mul_f32 v24, v24, v23
  v_accvgpr_write_b32 a124, v24
  v_accvgpr_read_b32 v24, a125
  v_mul_f32 v24, v24, v23
  v_accvgpr_write_b32 a125, v24
  v_accvgpr_read_b32 v24, a126
  v_mul_f32 v24, v24, v23
  v_accvgpr_write_b32 a126, v24
  v_accvgpr_read_b32 v24, a127
  v_mul_f32 v24, v24, v23
  v_accvgpr_write_b32 a127, v24
  v_max_f32 v25, v12, v18
  v_sub_f32 v26, v12, v25
  v_exp_f32 v26, v26
  v_mov_b32 v12, v25
  v_mul_f32 v15, v15, v26
  v_accvgpr_read_b32 v27, a128
  v_mul_f32 v27, v27, v26
  v_accvgpr_write_b32 a128, v27
  v_accvgpr_read_b32 v27, a129
  v_mul_f32 v27, v27, v26
  v_accvgpr_write_b32 a129, v27
  v_accvgpr_read_b32 v27, a130
  v_mul_f32 v27, v27, v26
  v_accvgpr_write_b32 a130, v27
  v_accvgpr_read_b32 v27, a131
  v_mul_f32 v27, v27, v26
  v_accvgpr_write_b32 a131, v27
  v_accvgpr_read_b32 v27, a132
  v_mul_f32 v27, v27, v26
  v_accvgpr_write_b32 a132, v27
  v_accvgpr_read_b32 v27, a133
  v_mul_f32 v27, v27, v26
  v_accvgpr_write_b32 a133, v27
  v_accvgpr_read_b32 v27, a134
  v_mul_f32 v27, v27, v26
  v_accvgpr_write_b32 a134, v27
  v_accvgpr_read_b32 v27, a135
  v_mul_f32 v27, v27, v26
  v_accvgpr_write_b32 a135, v27
  v_accvgpr_read_b32 v27, a136
  v_mul_f32 v27, v27, v26
  v_accvgpr_write_b32 a136, v27
  v_accvgpr_read_b32 v27, a137
  v_mul_f32 v27, v27, v26
  v_accvgpr_write_b32 a137, v27
  v_accvgpr_read_b32 v27, a138
  v_mul_f32 v27, v27, v26
  v_accvgpr_write_b32 a138, v27
  v_accvgpr_read_b32 v27, a139
  v_mul_f32 v27, v27, v26
  v_accvgpr_write_b32 a139, v27
  v_accvgpr_read_b32 v27, a140
  v_mul_f32 v27, v27, v26
  v_accvgpr_write_b32 a140, v27
  v_accvgpr_read_b32 v27, a141
  v_mul_f32 v27, v27, v26
  v_accvgpr_write_b32 a141, v27
  v_accvgpr_read_b32 v27, a142
  v_mul_f32 v27, v27, v26
  v_accvgpr_write_b32 a142, v27
  v_accvgpr_read_b32 v27, a143
  v_mul_f32 v27, v27, v26
  v_accvgpr_write_b32 a143, v27
  v_accvgpr_read_b32 v27, a144
  v_mul_f32 v27, v27, v26
  v_accvgpr_write_b32 a144, v27
  v_accvgpr_read_b32 v27, a145
  v_mul_f32 v27, v27, v26
  v_accvgpr_write_b32 a145, v27
  v_accvgpr_read_b32 v27, a146
  v_mul_f32 v27, v27, v26
  v_accvgpr_write_b32 a146, v27
  v_accvgpr_read_b32 v27, a147
  v_mul_f32 v27, v27, v26
  v_accvgpr_write_b32 a147, v27
  v_accvgpr_read_b32 v27, a148
  v_mul_f32 v27, v27, v26
  v_accvgpr_write_b32 a148, v27
  v_accvgpr_read_b32 v27, a149
  v_mul_f32 v27, v27, v26
  v_accvgpr_write_b32 a149, v27
  v_accvgpr_read_b32 v27, a150
  v_mul_f32 v27, v27, v26
  v_accvgpr_write_b32 a150, v27
  v_accvgpr_read_b32 v27, a151
  v_mul_f32 v27, v27, v26
  v_accvgpr_write_b32 a151, v27
  v_accvgpr_read_b32 v27, a152
  v_mul_f32 v27, v27, v26
  v_accvgpr_write_b32 a152, v27
  v_accvgpr_read_b32 v27, a153
  v_mul_f32 v27, v27, v26
  v_accvgpr_write_b32 a153, v27
  v_accvgpr_read_b32 v27, a154
  v_mul_f32 v27, v27, v26
  v_accvgpr_write_b32 a154, v27
  v_accvgpr_read_b32 v27, a155
  v_mul_f32 v27, v27, v26
  v_accvgpr_write_b32 a155, v27
  v_accvgpr_read_b32 v27, a156
  v_mul_f32 v27, v27, v26
  v_accvgpr_write_b32 a156, v27
  v_accvgpr_read_b32 v27, a157
  v_mul_f32 v27, v27, v26
  v_accvgpr_write_b32 a157, v27
  v_accvgpr_read_b32 v27, a158
  v_mul_f32 v27, v27, v26
  v_accvgpr_write_b32 a158, v27
  v_accvgpr_read_b32 v27, a159
  v_mul_f32 v27, v27, v26
  v_accvgpr_write_b32 a159, v27
  v_accvgpr_read_b32 v27, a160
  v_mul_f32 v27, v27, v26
  v_accvgpr_write_b32 a160, v27
  v_accvgpr_read_b32 v27, a161
  v_mul_f32 v27, v27, v26
  v_accvgpr_write_b32 a161, v27
  v_accvgpr_read_b32 v27, a162
  v_mul_f32 v27, v27, v26
  v_accvgpr_write_b32 a162, v27
  v_accvgpr_read_b32 v27, a163
  v_mul_f32 v27, v27, v26
  v_accvgpr_write_b32 a163, v27
  v_accvgpr_read_b32 v27, a164
  v_mul_f32 v27, v27, v26
  v_accvgpr_write_b32 a164, v27
  v_accvgpr_read_b32 v27, a165
  v_mul_f32 v27, v27, v26
  v_accvgpr_write_b32 a165, v27
  v_accvgpr_read_b32 v27, a166
  v_mul_f32 v27, v27, v26
  v_accvgpr_write_b32 a166, v27
  v_accvgpr_read_b32 v27, a167
  v_mul_f32 v27, v27, v26
  v_accvgpr_write_b32 a167, v27
  v_accvgpr_read_b32 v27, a168
  v_mul_f32 v27, v27, v26
  v_accvgpr_write_b32 a168, v27
  v_accvgpr_read_b32 v27, a169
  v_mul_f32 v27, v27, v26
  v_accvgpr_write_b32 a169, v27
  v_accvgpr_read_b32 v27, a170
  v_mul_f32 v27, v27, v26
  v_accvgpr_write_b32 a170, v27
  v_accvgpr_read_b32 v27, a171
  v_mul_f32 v27, v27, v26
  v_accvgpr_write_b32 a171, v27
  v_accvgpr_read_b32 v27, a172
  v_mul_f32 v27, v27, v26
  v_accvgpr_write_b32 a172, v27
  v_accvgpr_read_b32 v27, a173
  v_mul_f32 v27, v27, v26
  v_accvgpr_write_b32 a173, v27
  v_accvgpr_read_b32 v27, a174
  v_mul_f32 v27, v27, v26
  v_accvgpr_write_b32 a174, v27
  v_accvgpr_read_b32 v27, a175
  v_mul_f32 v27, v27, v26
  v_accvgpr_write_b32 a175, v27
  v_accvgpr_read_b32 v27, a176
  v_mul_f32 v27, v27, v26
  v_accvgpr_write_b32 a176, v27
  v_accvgpr_read_b32 v27, a177
  v_mul_f32 v27, v27, v26
  v_accvgpr_write_b32 a177, v27
  v_accvgpr_read_b32 v27, a178
  v_mul_f32 v27, v27, v26
  v_accvgpr_write_b32 a178, v27
  v_accvgpr_read_b32 v27, a179
  v_mul_f32 v27, v27, v26
  v_accvgpr_write_b32 a179, v27
  v_accvgpr_read_b32 v27, a180
  v_mul_f32 v27, v27, v26
  v_accvgpr_write_b32 a180, v27
  v_accvgpr_read_b32 v27, a181
  v_mul_f32 v27, v27, v26
  v_accvgpr_write_b32 a181, v27
  v_accvgpr_read_b32 v27, a182
  v_mul_f32 v27, v27, v26
  v_accvgpr_write_b32 a182, v27
  v_accvgpr_read_b32 v27, a183
  v_mul_f32 v27, v27, v26
  v_accvgpr_write_b32 a183, v27
  v_accvgpr_read_b32 v27, a184
  v_mul_f32 v27, v27, v26
  v_accvgpr_write_b32 a184, v27
  v_accvgpr_read_b32 v27, a185
  v_mul_f32 v27, v27, v26
  v_accvgpr_write_b32 a185, v27
  v_accvgpr_read_b32 v27, a186
  v_mul_f32 v27, v27, v26
  v_accvgpr_write_b32 a186, v27
  v_accvgpr_read_b32 v27, a187
  v_mul_f32 v27, v27, v26
  v_accvgpr_write_b32 a187, v27
  v_accvgpr_read_b32 v27, a188
  v_mul_f32 v27, v27, v26
  v_accvgpr_write_b32 a188, v27
  v_accvgpr_read_b32 v27, a189
  v_mul_f32 v27, v27, v26
  v_accvgpr_write_b32 a189, v27
  v_accvgpr_read_b32 v27, a190
  v_mul_f32 v27, v27, v26
  v_accvgpr_write_b32 a190, v27
  v_accvgpr_read_b32 v27, a191
  v_mul_f32 v27, v27, v26
  v_accvgpr_write_b32 a191, v27
  s_nop 1
  s_branch Lrare_7_ret
L_loader:
  v_lshrrev_b32 v10, 5, v1
  v_and_b32 v11, 31, v1
  v_add_u32 v12, 0, v10
  v_lshlrev_b32 v13, 1, v12
  v_xor_b32 v13, v13, v11
  v_lshlrev_b32 v13, 4, v13
  v_lshl_add_u32 v2, v12, 9, v13
  v_lshl_add_u32 v6, v12, 13, v13
  v_add_u32 v12, 2, v10
  v_lshlrev_b32 v13, 1, v12
  v_xor_b32 v13, v13, v11
  v_lshlrev_b32 v13, 4, v13
  v_lshl_add_u32 v3, v12, 9, v13
  v_lshl_add_u32 v7, v12, 13, v13
  v_add_u32 v12, 4, v10
  v_lshlrev_b32 v13, 1, v12
  v_xor_b32 v13, v13, v11
  v_lshlrev_b32 v13, 4, v13
  v_lshl_add_u32 v4, v12, 9, v13
  v_lshl_add_u32 v8, v12, 13, v13
  v_add_u32 v12, 6, v10
  v_lshlrev_b32 v13, 1, v12
  v_xor_b32 v13, v13, v11
  v_lshlrev_b32 v13, 4, v13
  v_lshl_add_u32 v5, v12, 9, v13
  v_lshl_add_u32 v9, v12, 13, v13
  v_lshlrev_b32 v28, 4, v1
  s_mul_i32 s5, s3, 904
  s_mul_i32 s6, s3, 896
  s_mov_b32 exec_lo, -1
  s_mov_b32 exec_hi, 0x00ffffff
  s_add_u32 m0, s5, 32768
  s_add_u32 s53, s6, 0
  buffer_load_dwordx4 v28, s[8:11], s53 offen lds
  s_add_u32 m0, s5, 36384
  s_add_u32 s53, s6, 3584
  buffer_load_dwordx4 v28, s[8:11], s53 offen lds
  s_add_u32 m0, s5, 40000
  s_add_u32 s53, s6, 7168
  buffer_load_dwordx4 v28, s[8:11], s53 offen lds
  s_add_u32 m0, s5, 43616
  s_add_u32 s53, s6, 10752
  buffer_load_dwordx4 v28, s[8:11], s53 offen lds
  s_add_u32 m0, s5, 47232
  s_add_u32 s53, s6, 14336
  buffer_load_dwordx4 v28, s[8:11], s53 offen lds
  s_add_u32 m0, s5, 50848
  s_add_u32 s53, s6, 17920
  buffer_load_dwordx4 v28, s[8:11], s53 offen lds
  s_add_u32 m0, s5, 54464
  s_add_u32 s53, s6, 21504
  buffer_load_dwordx4 v28, s[8:11], s53 offen lds
  s_add_u32 m0, s5, 58080
  s_add_u32 s53, s6, 25088
  buffer_load_dwordx4 v28, s[8:11], s53 offen lds
  s_add_u32 m0, s5, 61696
  s_add_u32 s53, s6, 28672
  buffer_load_dwordx4 v28, s[8:11], s53 offen lds
  s_add_u32 m0, s5, 65312
  s_add_u32 s53, s6, 32256
  buffer_load_dwordx4 v28, s[8:11], s53 offen lds
  s_add_u32 m0, s5, 68928
  s_add_u32 s53, s6, 35840
  buffer_load_dwordx4 v28, s[8:11], s53 offen lds
  s_add_u32 m0, s5, 72544
  s_add_u32 s53, s6, 39424
  buffer_load_dwordx4 v28, s[8:11], s53 offen lds
  s_add_u32 m0, s5, 76160
  s_add_u32 s53, s6, 43008
  buffer_load_dwordx4 v28, s[8:11], s53 offen lds
  s_add_u32 m0, s5, 79776
  s_add_u32 s53, s6, 46592
  buffer_load_dwordx4 v28, s[8:11], s53 offen lds
  s_add_u32 m0, s5, 83392
  s_add_u32 s53, s6, 50176
  buffer_load_dwordx4 v28, s[8:11], s53 offen lds
  s_add_u32 m0, s5, 87008
  s_add_u32 s53, s6, 53760
  buffer_load_dwordx4 v28, s[8:11], s53 offen lds
  s_add_u32 m0, s5, 90624
  s_add_u32 s53, s6, 57344
  buffer_load_dwordx4 v28, s[8:11], s53 offen lds
  s_add_u32 m0, s5, 94240
  s_add_u32 s53, s6, 60928
  buffer_load_dwordx4 v28, s[8:11], s53 offen lds
  s_add_u32 m0, s5, 97856
  s_add_u32 s53, s6, 64512
  buffer_load_dwordx4 v28, s[8:11], s53 offen lds
  s_add_u32 m0, s5, 101472
  s_add_u32 s53, s6, 68096
  buffer_load_dwordx4 v28, s[8:11], s53 offen lds
  s_add_u32 m0, s5, 105088
  s_add_u32 s53, s6, 71680
  buffer_load_dwordx4 v28, s[8:11], s53 offen lds
  s_add_u32 m0, s5, 108704
  s_add_u32 s53, s6, 75264
  buffer_load_dwordx4 v28, s[8:11], s53 offen lds
  s_add_u32 m0, s5, 112320
  s_add_u32 s53, s6, 78848
  buffer_load_dwordx4 v28, s[8:11], s53 offen lds
  s_add_u32 m0, s5, 115936
  s_add_u32 s53, s6, 82432
  buffer_load_dwordx4 v28, s[8:11], s53 offen lds
  s_add_u32 m0, s5, 119552
  s_add_u32 s53, s6, 86016
  buffer_load_dwordx4 v28, s[8:11], s53 offen lds
  s_add_u32 m0, s5, 123168
  s_add_u32 s53, s6, 89600
  buffer_load_dwordx4 v28, s[8:11], s53 offen lds
  s_add_u32 m0, s5, 126784
  s_add_u32 s53, s6, 93184
  buffer_load_dwordx4 v28, s[8:11], s53 offen lds
  s_add_u32 m0, s5, 130400
  s_add_u32 s53, s6, 96768
  buffer_load_dwordx4 v28, s[8:11], s53 offen lds
  s_add_u32 m0, s5, 134016
  s_add_u32 s53, s6, 100352
  buffer_load_dwordx4 v28, s[8:11], s53 offen lds
  s_add_u32 m0, s5, 137632
  s_add_u32 s53, s6, 103936
  buffer_load_dwordx4 v28, s[8:11], s53 offen lds
  s_add_u32 m0, s5, 141248
  s_add_u32 s53, s6, 107520
  buffer_load_dwordx4 v28, s[8:11], s53 offen lds
  s_add_u32 m0, s5, 144864
  s_add_u32 s53, s6, 111104
  buffer_load_dwordx4 v28, s[8:11], s53 offen lds
  s_add_u32 m0, s5, 148480
  s_add_u32 s53, s6, 114688
  buffer_load_dwordx4 v28, s[8:11], s53 offen lds
  s_add_u32 m0, s5, 152096
  s_add_u32 s53, s6, 118272
  buffer_load_dwordx4 v28, s[8:11], s53 offen lds
  s_add_u32 m0, s5, 155712
  s_add_u32 s53, s6, 121856
  buffer_load_dwordx4 v28, s[8:11], s53 offen lds
  s_add_u32 m0, s5, 159328
  s_add_u32 s53, s6, 125440
  buffer_load_dwordx4 v28, s[8:11], s53 offen lds
  s_mov_b64 exec, -1
  s_mov_b32 m0, 9216
  s_mov_b32 s53, 131072
  buffer_load_dwordx4 v7, s[12:15], s53 offen nt lds
  s_mov_b32 m0, 10240
  s_mov_b32 s53, 131072
  buffer_load_dwordx4 v8, s[12:15], s53 offen nt lds
  s_mov_b32 m0, 11264
  s_mov_b32 s53, 131072
  buffer_load_dwordx4 v9, s[12:15], s53 offen nt lds
  s_mov_b32 m0, 12288
  s_mov_b32 s53, 196608
  buffer_load_dwordx4 v6, s[12:15], s53 offen nt lds
  s_mov_b32 m0, 13312
  s_mov_b32 s53, 196608
  buffer_load_dwordx4 v7, s[12:15], s53 offen nt lds
  s_mov_b32 m0, 14336
  s_mov_b32 s53, 196608
  buffer_load_dwordx4 v8, s[12:15], s53 offen nt lds
  s_mov_b32 m0, 15360
  s_mov_b32 s53, 196608
  buffer_load_dwordx4 v9, s[12:15], s53 offen nt lds
  s_mov_b32 m0, 25600
  s_mov_b32 s53, 393216
  buffer_load_dwordx4 v7, s[12:15], s53 offen nt lds
  s_mov_b32 m0, 26624
  s_mov_b32 s53, 393216
  buffer_load_dwordx4 v8, s[12:15], s53 offen nt lds
  s_mov_b32 m0, 27648
  s_mov_b32 s53, 393216
  buffer_load_dwordx4 v9, s[12:15], s53 offen nt lds
  s_mov_b32 m0, 28672
  s_mov_b32 s53, 458752
  buffer_load_dwordx4 v6, s[12:15], s53 offen nt lds
  s_mov_b32 m0, 29696
  s_mov_b32 s53, 458752
  buffer_load_dwordx4 v7, s[12:15], s53 offen nt lds
  s_mov_b32 m0, 30720
  s_mov_b32 s53, 458752
  buffer_load_dwordx4 v8, s[12:15], s53 offen nt lds
  s_mov_b32 m0, 31744
  s_mov_b32 s53, 458752
  buffer_load_dwordx4 v9, s[12:15], s53 offen nt lds
  s_waitcnt vmcnt(14)
  s_barrier
  s_barrier
  s_mov_b32 m0, 41984
  s_mov_b32 s53, 655360
  buffer_load_dwordx4 v7, s[12:15], s53 offen nt lds
  s_mov_b32 m0, 43008
  s_mov_b32 s53, 655360
  buffer_load_dwordx4 v8, s[12:15], s53 offen nt lds
  s_mov_b32 m0, 44032
  s_mov_b32 s53, 655360
  buffer_load_dwordx4 v9, s[12:15], s53 offen nt lds
  s_mov_b32 m0, 45056
  s_mov_b32 s53, 720896
  buffer_load_dwordx4 v6, s[12:15], s53 offen nt lds
  s_mov_b32 m0, 46080
  s_mov_b32 s53, 720896
  buffer_load_dwordx4 v7, s[12:15], s53 offen nt lds
  s_mov_b32 m0, 47104
  s_mov_b32 s53, 720896
  buffer_load_dwordx4 v8, s[12:15], s53 offen nt lds
  s_mov_b32 m0, 48128
  s_mov_b32 s53, 720896
  buffer_load_dwordx4 v9, s[12:15], s53 offen nt lds
  s_mov_b32 m0, 58368
  s_mov_b32 s53, 917504
  buffer_load_dwordx4 v7, s[12:15], s53 offen nt lds
  s_mov_b32 m0, 59392
  s_mov_b32 s53, 917504
  buffer_load_dwordx4 v8, s[12:15], s53 offen nt lds
  s_mov_b32 m0, 60416
  s_mov_b32 s53, 917504
  buffer_load_dwordx4 v9, s[12:15], s53 offen nt lds
  s_mov_b32 m0, 61440
  s_mov_b32 s53, 983040
  buffer_load_dwordx4 v6, s[12:15], s53 offen nt lds
  s_mov_b32 m0, 62464
  s_mov_b32 s53, 983040
  buffer_load_dwordx4 v7, s[12:15], s53 offen nt lds
  s_mov_b32 m0, 63488
  s_mov_b32 s53, 983040
  buffer_load_dwordx4 v8, s[12:15], s53 offen nt lds
  s_mov_b32 m0, 64512
  s_mov_b32 s53, 983040
  buffer_load_dwordx4 v9, s[12:15], s53 offen nt lds
  s_mov_b32 m0, 74752
  s_mov_b32 s53, 1179648
  buffer_load_dwordx4 v7, s[12:15], s53 offen nt lds
  s_mov_b32 m0, 75776
  s_mov_b32 s53, 1179648
  buffer_load_dwordx4 v8, s[12:15], s53 offen nt lds
  s_mov_b32 m0, 76800
  s_mov_b32 s53, 1179648
  buffer_load_dwordx4 v9, s[12:15], s53 offen nt lds
  s_mov_b32 m0, 77824
  s_mov_b32 s53, 1245184
  buffer_load_dwordx4 v6, s[12:15], s53 offen nt lds
  s_mov_b32 m0, 78848
  s_mov_b32 s53, 1245184
  buffer_load_dwordx4 v7, s[12:15], s53 offen nt lds
  s_mov_b32 m0, 79872
  s_mov_b32 s53, 1245184
  buffer_load_dwordx4 v8, s[12:15], s53 offen nt lds
  s_mov_b32 m0, 80896
  s_mov_b32 s53, 1245184
  buffer_load_dwordx4 v9, s[12:15], s53 offen nt lds
  s_mov_b32 m0, 91136
  s_mov_b32 s53, 1441792
  buffer_load_dwordx4 v7, s[12:15], s53 offen nt lds
  s_mov_b32 m0, 92160
  s_mov_b32 s53, 1441792
  buffer_load_dwordx4 v8, s[12:15], s53 offen nt lds
  s_mov_b32 m0, 93184
  s_mov_b32 s53, 1441792
  buffer_load_dwordx4 v9, s[12:15], s53 offen nt lds
  s_mov_b32 m0, 94208
  s_mov_b32 s53, 1507328
  buffer_load_dwordx4 v6, s[12:15], s53 offen nt lds
  s_mov_b32 m0, 95232
  s_mov_b32 s53, 1507328
  buffer_load_dwordx4 v7, s[12:15], s53 offen nt lds
  s_mov_b32 m0, 96256
  s_mov_b32 s53, 1507328
  buffer_load_dwordx4 v8, s[12:15], s53 offen nt lds
  s_mov_b32 m0, 97280
  s_mov_b32 s53, 1507328
  buffer_load_dwordx4 v9, s[12:15], s53 offen nt lds
  s_mov_b32 m0, 107520
  s_mov_b32 s53, 1703936
  buffer_load_dwordx4 v7, s[12:15], s53 offen nt lds
  s_mov_b32 m0, 108544
  s_mov_b32 s53, 1703936
  buffer_load_dwordx4 v8, s[12:15], s53 offen nt lds
  s_mov_b32 m0, 109568
  s_mov_b32 s53, 1703936
  buffer_load_dwordx4 v9, s[12:15], s53 offen nt lds
  s_mov_b32 m0, 110592
  s_mov_b32 s53, 1769472
  buffer_load_dwordx4 v6, s[12:15], s53 offen nt lds
  s_mov_b32 m0, 111616
  s_mov_b32 s53, 1769472
  buffer_load_dwordx4 v7, s[12:15], s53 offen nt lds
  s_mov_b32 m0, 112640
  s_mov_b32 s53, 1769472
  buffer_load_dwordx4 v8, s[12:15], s53 offen nt lds
  s_mov_b32 m0, 113664
  s_mov_b32 s53, 1769472
  buffer_load_dwordx4 v9, s[12:15], s53 offen nt lds
  s_mov_b32 m0, 123904
  s_mov_b32 s53, 1966080
  buffer_load_dwordx4 v7, s[12:15], s53 offen nt lds
  s_mov_b32 m0, 124928
  s_mov_b32 s53, 1966080
  buffer_load_dwordx4 v8, s[12:15], s53 offen nt lds
  s_mov_b32 m0, 125952
  s_mov_b32 s53, 1966080
  buffer_load_dwordx4 v9, s[12:15], s53 offen nt lds
  s_mov_b32 m0, 126976
  s_mov_b32 s53, 2031616
  buffer_load_dwordx4 v6, s[12:15], s53 offen nt lds
  s_mov_b32 m0, 128000
  s_mov_b32 s53, 2031616
  buffer_load_dwordx4 v7, s[12:15], s53 offen nt lds
  s_mov_b32 m0, 129024
  s_mov_b32 s53, 2031616
  buffer_load_dwordx4 v8, s[12:15], s53 offen nt lds
  s_mov_b32 m0, 130048
  s_mov_b32 s53, 2031616
  buffer_load_dwordx4 v9, s[12:15], s53 offen nt lds
  v_lshlrev_b32 v15, 7, v1
  s_cmp_eq_u32 s28, 0
  s_cselect_b32 s56, s56, s58
  s_cselect_b32 s57, s57, s59
  s_mov_b32 s60, s56
  s_and_b32 s61, s57, 0xffff
  s_mov_b32 s62, 3670016
  s_mov_b32 s63, 0x00020000
  s_mov_b32 s26, 28311552
  s_lshl_b32 s4, s30, 8
  s_lshl_b32 s5, s29, 5
  s_add_u32 s4, s4, s5
  s_mul_i32 s54, s4, 896
  s_mul_i32 s55, s28, 7 * 4096
  s_add_u32 s55, s55, s4
  s_lshl_b32 s55, s55, 7
  s_add_u32 s55, s55, 20971520
  v_lshlrev_b32 v12, 4, v1
  v_lshrrev_b32 v13, 3, v1
  v_lshlrev_b32 v13, 19, v13
  v_and_b32 v14, 7, v1
  v_lshl_add_u32 v13, v14, 4, v13
  s_waitcnt vmcnt(49)
  s_barrier
  s_mov_b32 m0, 140288
  s_mov_b32 s53, 2228224
  buffer_load_dwordx4 v7, s[12:15], s53 offen nt lds
  s_mov_b32 m0, 141312
  s_mov_b32 s53, 2228224
  buffer_load_dwordx4 v8, s[12:15], s53 offen nt lds
  s_mov_b32 m0, 142336
  s_mov_b32 s53, 2228224
  buffer_load_dwordx4 v9, s[12:15], s53 offen nt lds
  s_mov_b32 m0, 143360
  s_mov_b32 s53, 2293760
  buffer_load_dwordx4 v6, s[12:15], s53 offen nt lds
  s_mov_b32 m0, 144384
  s_mov_b32 s53, 2293760
  buffer_load_dwordx4 v7, s[12:15], s53 offen nt lds
  s_mov_b32 m0, 145408
  s_mov_b32 s53, 2293760
  buffer_load_dwordx4 v8, s[12:15], s53 offen nt lds
  s_mov_b32 m0, 146432
  s_mov_b32 s53, 2293760
  buffer_load_dwordx4 v9, s[12:15], s53 offen nt lds
  s_waitcnt vmcnt(49)
  s_barrier
  s_mov_b32 m0, 156672
  s_mov_b32 s53, 2490368
  buffer_load_dwordx4 v7, s[12:15], s53 offen nt lds
  s_mov_b32 m0, 157696
  s_mov_b32 s53, 2490368
  buffer_load_dwordx4 v8, s[12:15], s53 offen nt lds
  s_mov_b32 m0, 158720
  s_mov_b32 s53, 2490368
  buffer_load_dwordx4 v9, s[12:15], s53 offen nt lds
  s_mov_b32 m0, 159744
  s_mov_b32 s53, 2555904
  buffer_load_dwordx4 v6, s[12:15], s53 offen nt lds
  s_mov_b32 m0, 160768
  s_mov_b32 s53, 2555904
  buffer_load_dwordx4 v7, s[12:15], s53 offen nt lds
  s_mov_b32 m0, 161792
  s_mov_b32 s53, 2555904
  buffer_load_dwordx4 v8, s[12:15], s53 offen nt lds
  s_mov_b32 m0, 162816
  s_mov_b32 s53, 2555904
  buffer_load_dwordx4 v9, s[12:15], s53 offen nt lds
  s_waitcnt vmcnt(49)
  s_barrier
  s_mov_b32 m0, 9216
  s_mov_b32 s53, 2752512
  buffer_load_dwordx4 v7, s[12:15], s53 offen nt lds
  s_mov_b32 m0, 10240
  s_mov_b32 s53, 2752512
  buffer_load_dwordx4 v8, s[12:15], s53 offen nt lds
  s_mov_b32 m0, 11264
  s_mov_b32 s53, 2752512
  buffer_load_dwordx4 v9, s[12:15], s53 offen nt lds
  s_mov_b32 m0, 12288
  s_mov_b32 s53, 2818048
  buffer_load_dwordx4 v6, s[12:15], s53 offen nt lds
  s_mov_b32 m0, 13312
  s_mov_b32 s53, 2818048
  buffer_load_dwordx4 v7, s[12:15], s53 offen nt lds
  s_mov_b32 m0, 14336
  s_mov_b32 s53, 2818048
  buffer_load_dwordx4 v8, s[12:15], s53 offen nt lds
  s_mov_b32 m0, 15360
  s_mov_b32 s53, 2818048
  buffer_load_dwordx4 v9, s[12:15], s53 offen nt lds
  s_waitcnt vmcnt(49)
  s_barrier
  s_mov_b32 m0, 25600
  s_mov_b32 s53, 3014656
  buffer_load_dwordx4 v7, s[12:15], s53 offen nt lds
  s_mov_b32 m0, 26624
  s_mov_b32 s53, 3014656
  buffer_load_dwordx4 v8, s[12:15], s53 offen nt lds
  s_mov_b32 m0, 27648
  s_mov_b32 s53, 3014656
  buffer_load_dwordx4 v9, s[12:15], s53 offen nt lds
  s_mov_b32 m0, 28672
  s_mov_b32 s53, 3080192
  buffer_load_dwordx4 v6, s[12:15], s53 offen nt lds
  s_mov_b32 m0, 29696
  s_mov_b32 s53, 3080192
  buffer_load_dwordx4 v7, s[12:15], s53 offen nt lds
  s_mov_b32 m0, 30720
  s_mov_b32 s53, 3080192
  buffer_load_dwordx4 v8, s[12:15], s53 offen nt lds
  s_mov_b32 m0, 31744
  s_mov_b32 s53, 3080192
  buffer_load_dwordx4 v9, s[12:15], s53 offen nt lds
  s_waitcnt vmcnt(49)
  s_barrier
  s_mov_b32 m0, 41984
  s_mov_b32 s53, 3276800
  buffer_load_dwordx4 v7, s[12:15], s53 offen nt lds
  s_mov_b32 m0, 43008
  s_mov_b32 s53, 3276800
  buffer_load_dwordx4 v8, s[12:15], s53 offen nt lds
  s_mov_b32 m0, 44032
  s_mov_b32 s53, 3276800
  buffer_load_dwordx4 v9, s[12:15], s53 offen nt lds
  s_mov_b32 m0, 45056
  s_mov_b32 s53, 3342336
  buffer_load_dwordx4 v6, s[12:15], s53 offen nt lds
  s_mov_b32 m0, 46080
  s_mov_b32 s53, 3342336
  buffer_load_dwordx4 v7, s[12:15], s53 offen nt lds
  s_mov_b32 m0, 47104
  s_mov_b32 s53, 3342336
  buffer_load_dwordx4 v8, s[12:15], s53 offen nt lds
  s_mov_b32 m0, 48128
  s_mov_b32 s53, 3342336
  buffer_load_dwordx4 v9, s[12:15], s53 offen nt lds
  s_waitcnt vmcnt(49)
  s_barrier
  s_mov_b32 m0, 58368
  s_mov_b32 s53, 3538944
  buffer_load_dwordx4 v7, s[12:15], s53 offen nt lds
  s_mov_b32 m0, 59392
  s_mov_b32 s53, 3538944
  buffer_load_dwordx4 v8, s[12:15], s53 offen nt lds
  s_mov_b32 m0, 60416
  s_mov_b32 s53, 3538944
  buffer_load_dwordx4 v9, s[12:15], s53 offen nt lds
  s_mov_b32 m0, 61440
  s_mov_b32 s53, 3604480
  buffer_load_dwordx4 v6, s[12:15], s53 offen nt lds
  s_mov_b32 m0, 62464
  s_mov_b32 s53, 3604480
  buffer_load_dwordx4 v7, s[12:15], s53 offen nt lds
  s_mov_b32 m0, 63488
  s_mov_b32 s53, 3604480
  buffer_load_dwordx4 v8, s[12:15], s53 offen nt lds
  s_mov_b32 m0, 64512
  s_mov_b32 s53, 3604480
  buffer_load_dwordx4 v9, s[12:15], s53 offen nt lds
  s_waitcnt vmcnt(49)
  s_barrier
  s_mov_b32 m0, 74752
  s_mov_b32 s53, 8192
  buffer_load_dwordx4 v3, s[16:19], s53 offen nt lds
  s_mov_b32 m0, 75776
  s_mov_b32 s53, 8192
  buffer_load_dwordx4 v4, s[16:19], s53 offen nt lds
  s_mov_b32 m0, 76800
  s_mov_b32 s53, 8192
  buffer_load_dwordx4 v5, s[16:19], s53 offen nt lds
  s_mov_b32 m0, 77824
  s_mov_b32 s53, 12288
  buffer_load_dwordx4 v2, s[16:19], s53 offen nt lds
  s_mov_b32 m0, 78848
  s_mov_b32 s53, 12288
  buffer_load_dwordx4 v3, s[16:19], s53 offen nt lds
  s_mov_b32 m0, 79872
  s_mov_b32 s53, 12288
  buffer_load_dwordx4 v4, s[16:19], s53 offen nt lds
  s_mov_b32 m0, 80896
  s_mov_b32 s53, 12288
  buffer_load_dwordx4 v5, s[16:19], s53 offen nt lds
  s_waitcnt vmcnt(49)
  s_barrier
  s_mov_b32 m0, 91136
  s_mov_b32 s53, 24576
  buffer_load_dwordx4 v3, s[16:19], s53 offen nt lds
  s_mov_b32 m0, 92160
  s_mov_b32 s53, 24576
  buffer_load_dwordx4 v4, s[16:19], s53 offen nt lds
  s_mov_b32 m0, 93184
  s_mov_b32 s53, 24576
  buffer_load_dwordx4 v5, s[16:19], s53 offen nt lds
  s_mov_b32 m0, 94208
  s_mov_b32 s53, 28672
  buffer_load_dwordx4 v2, s[16:19], s53 offen nt lds
  s_mov_b32 m0, 95232
  s_mov_b32 s53, 28672
  buffer_load_dwordx4 v3, s[16:19], s53 offen nt lds
  s_mov_b32 m0, 96256
  s_mov_b32 s53, 28672
  buffer_load_dwordx4 v4, s[16:19], s53 offen nt lds
  s_mov_b32 m0, 97280
  s_mov_b32 s53, 28672
  buffer_load_dwordx4 v5, s[16:19], s53 offen nt lds
  s_waitcnt vmcnt(49)
  s_barrier
  s_mov_b32 m0, 107520
  s_mov_b32 s53, 40960
  buffer_load_dwordx4 v3, s[16:19], s53 offen nt lds
  s_mov_b32 m0, 108544
  s_mov_b32 s53, 40960
  buffer_load_dwordx4 v4, s[16:19], s53 offen nt lds
  s_mov_b32 m0, 109568
  s_mov_b32 s53, 40960
  buffer_load_dwordx4 v5, s[16:19], s53 offen nt lds
  s_mov_b32 m0, 110592
  s_mov_b32 s53, 45056
  buffer_load_dwordx4 v2, s[16:19], s53 offen nt lds
  s_mov_b32 m0, 111616
  s_mov_b32 s53, 45056
  buffer_load_dwordx4 v3, s[16:19], s53 offen nt lds
  s_mov_b32 m0, 112640
  s_mov_b32 s53, 45056
  buffer_load_dwordx4 v4, s[16:19], s53 offen nt lds
  s_mov_b32 m0, 113664
  s_mov_b32 s53, 45056
  buffer_load_dwordx4 v5, s[16:19], s53 offen nt lds
  s_waitcnt vmcnt(49)
  s_barrier
  s_mov_b32 m0, 123904
  s_mov_b32 s53, 57344
  buffer_load_dwordx4 v3, s[16:19], s53 offen nt lds
  s_mov_b32 m0, 124928
  s_mov_b32 s53, 57344
  buffer_load_dwordx4 v4, s[16:19], s53 offen nt lds
  s_mov_b32 m0, 125952
  s_mov_b32 s53, 57344
  buffer_load_dwordx4 v5, s[16:19], s53 offen nt lds
  s_mov_b32 m0, 126976
  s_mov_b32 s53, 61440
  buffer_load_dwordx4 v2, s[16:19], s53 offen nt lds
  s_mov_b32 m0, 128000
  s_mov_b32 s53, 61440
  buffer_load_dwordx4 v3, s[16:19], s53 offen nt lds
  s_mov_b32 m0, 129024
  s_mov_b32 s53, 61440
  buffer_load_dwordx4 v4, s[16:19], s53 offen nt lds
  s_mov_b32 m0, 130048
  s_mov_b32 s53, 61440
  buffer_load_dwordx4 v5, s[16:19], s53 offen nt lds
  s_waitcnt vmcnt(49)
  s_barrier
  s_mov_b32 m0, 140288
  s_mov_b32 s53, 8192
  buffer_load_dwordx4 v3, s[20:23], s53 offen nt lds
  s_mov_b32 m0, 141312
  s_mov_b32 s53, 8192
  buffer_load_dwordx4 v4, s[20:23], s53 offen nt lds
  s_mov_b32 m0, 142336
  s_mov_b32 s53, 8192
  buffer_load_dwordx4 v5, s[20:23], s53 offen nt lds
  s_mov_b32 m0, 143360
  s_mov_b32 s53, 12288
  buffer_load_dwordx4 v2, s[20:23], s53 offen nt lds
  s_mov_b32 m0, 144384
  s_mov_b32 s53, 12288
  buffer_load_dwordx4 v3, s[20:23], s53 offen nt lds
  s_mov_b32 m0, 145408
  s_mov_b32 s53, 12288
  buffer_load_dwordx4 v4, s[20:23], s53 offen nt lds
  s_mov_b32 m0, 146432
  s_mov_b32 s53, 12288
  buffer_load_dwordx4 v5, s[20:23], s53 offen nt lds
  s_waitcnt vmcnt(49)
  s_barrier
  s_mov_b32 m0, 156672
  s_mov_b32 s53, 24576
  buffer_load_dwordx4 v3, s[20:23], s53 offen nt lds
  s_mov_b32 m0, 157696
  s_mov_b32 s53, 24576
  buffer_load_dwordx4 v4, s[20:23], s53 offen nt lds
  s_mov_b32 m0, 158720
  s_mov_b32 s53, 24576
  buffer_load_dwordx4 v5, s[20:23], s53 offen nt lds
  s_mov_b32 m0, 159744
  s_mov_b32 s53, 28672
  buffer_load_dwordx4 v2, s[20:23], s53 offen nt lds
  s_mov_b32 m0, 160768
  s_mov_b32 s53, 28672
  buffer_load_dwordx4 v3, s[20:23], s53 offen nt lds
  s_mov_b32 m0, 161792
  s_mov_b32 s53, 28672
  buffer_load_dwordx4 v4, s[20:23], s53 offen nt lds
  s_mov_b32 m0, 162816
  s_mov_b32 s53, 28672
  buffer_load_dwordx4 v5, s[20:23], s53 offen nt lds
  s_waitcnt vmcnt(49)
  s_barrier
  s_mov_b32 m0, 9216
  s_mov_b32 s53, 73728
  buffer_load_dwordx4 v3, s[16:19], s53 offen nt lds
  s_mov_b32 m0, 10240
  s_mov_b32 s53, 73728
  buffer_load_dwordx4 v4, s[16:19], s53 offen nt lds
  s_mov_b32 m0, 11264
  s_mov_b32 s53, 73728
  buffer_load_dwordx4 v5, s[16:19], s53 offen nt lds
  s_mov_b32 m0, 12288
  s_mov_b32 s53, 77824
  buffer_load_dwordx4 v2, s[16:19], s53 offen nt lds
  s_mov_b32 m0, 13312
  s_mov_b32 s53, 77824
  buffer_load_dwordx4 v3, s[16:19], s53 offen nt lds
  s_mov_b32 m0, 14336
  s_mov_b32 s53, 77824
  buffer_load_dwordx4 v4, s[16:19], s53 offen nt lds
  s_mov_b32 m0, 15360
  s_mov_b32 s53, 77824
  buffer_load_dwordx4 v5, s[16:19], s53 offen nt lds
  s_waitcnt vmcnt(49)
  s_barrier
  s_mov_b32 m0, 25600
  s_mov_b32 s53, 90112
  buffer_load_dwordx4 v3, s[16:19], s53 offen nt lds
  s_mov_b32 m0, 26624
  s_mov_b32 s53, 90112
  buffer_load_dwordx4 v4, s[16:19], s53 offen nt lds
  s_mov_b32 m0, 27648
  s_mov_b32 s53, 90112
  buffer_load_dwordx4 v5, s[16:19], s53 offen nt lds
  s_mov_b32 m0, 28672
  s_mov_b32 s53, 94208
  buffer_load_dwordx4 v2, s[16:19], s53 offen nt lds
  s_mov_b32 m0, 29696
  s_mov_b32 s53, 94208
  buffer_load_dwordx4 v3, s[16:19], s53 offen nt lds
  s_mov_b32 m0, 30720
  s_mov_b32 s53, 94208
  buffer_load_dwordx4 v4, s[16:19], s53 offen nt lds
  s_mov_b32 m0, 31744
  s_mov_b32 s53, 94208
  buffer_load_dwordx4 v5, s[16:19], s53 offen nt lds
  s_waitcnt vmcnt(49)
  s_barrier
  s_mov_b32 m0, 41984
  s_mov_b32 s53, 40960
  buffer_load_dwordx4 v3, s[20:23], s53 offen nt lds
  s_mov_b32 m0, 43008
  s_mov_b32 s53, 40960
  buffer_load_dwordx4 v4, s[20:23], s53 offen nt lds
  s_mov_b32 m0, 44032
  s_mov_b32 s53, 40960
  buffer_load_dwordx4 v5, s[20:23], s53 offen nt lds
  s_mov_b32 m0, 45056
  s_mov_b32 s53, 45056
  buffer_load_dwordx4 v2, s[20:23], s53 offen nt lds
  s_mov_b32 m0, 46080
  s_mov_b32 s53, 45056
  buffer_load_dwordx4 v3, s[20:23], s53 offen nt lds
  s_mov_b32 m0, 47104
  s_mov_b32 s53, 45056
  buffer_load_dwordx4 v4, s[20:23], s53 offen nt lds
  s_mov_b32 m0, 48128
  s_mov_b32 s53, 45056
  buffer_load_dwordx4 v5, s[20:23], s53 offen nt lds
  s_mov_b32 exec_lo, -1
  s_mov_b32 exec_hi, 0x00ffffff
  s_add_u32 s53, s54, 0
  buffer_load_dwordx4 v[16:19], v12, s[60:63], s53 offen nt
  s_add_u32 s53, s54, 896
  buffer_load_dwordx4 v[20:23], v12, s[60:63], s53 offen nt
  s_add_u32 s53, s54, 1792
  buffer_load_dwordx4 v[24:27], v12, s[60:63], s53 offen nt
  s_add_u32 s53, s54, 2688
  buffer_load_dwordx4 v[28:31], v12, s[60:63], s53 offen nt
  s_add_u32 s53, s54, 3584
  buffer_load_dwordx4 v[32:35], v12, s[60:63], s53 offen nt
  s_add_u32 s53, s54, 4480
  buffer_load_dwordx4 v[36:39], v12, s[60:63], s53 offen nt
  s_add_u32 s53, s54, 5376
  buffer_load_dwordx4 v[40:43], v12, s[60:63], s53 offen nt
  s_add_u32 s53, s54, 6272
  buffer_load_dwordx4 v[44:47], v12, s[60:63], s53 offen nt
  s_add_u32 s53, s54, 7168
  buffer_load_dwordx4 v[48:51], v12, s[60:63], s53 offen nt
  s_add_u32 s53, s54, 8064
  buffer_load_dwordx4 v[52:55], v12, s[60:63], s53 offen nt
  s_add_u32 s53, s54, 8960
  buffer_load_dwordx4 v[56:59], v12, s[60:63], s53 offen nt
  s_add_u32 s53, s54, 9856
  buffer_load_dwordx4 v[60:63], v12, s[60:63], s53 offen nt
  s_add_u32 s53, s54, 10752
  buffer_load_dwordx4 v[64:67], v12, s[60:63], s53 offen nt
  s_add_u32 s53, s54, 11648
  buffer_load_dwordx4 v[68:71], v12, s[60:63], s53 offen nt
  s_add_u32 s53, s54, 12544
  buffer_load_dwordx4 v[72:75], v12, s[60:63], s53 offen nt
  s_add_u32 s53, s54, 13440
  buffer_load_dwordx4 v[76:79], v12, s[60:63], s53 offen nt
  s_add_u32 s53, s54, 14336
  buffer_load_dwordx4 v[80:83], v12, s[60:63], s53 offen nt
  s_add_u32 s53, s54, 15232
  buffer_load_dwordx4 v[84:87], v12, s[60:63], s53 offen nt
  s_add_u32 s53, s54, 16128
  buffer_load_dwordx4 v[88:91], v12, s[60:63], s53 offen nt
  s_add_u32 s53, s54, 17024
  buffer_load_dwordx4 v[92:95], v12, s[60:63], s53 offen nt
  s_add_u32 s53, s54, 17920
  buffer_load_dwordx4 v[96:99], v12, s[60:63], s53 offen nt
  s_add_u32 s53, s54, 18816
  buffer_load_dwordx4 v[100:103], v12, s[60:63], s53 offen nt
  s_add_u32 s53, s54, 19712
  buffer_load_dwordx4 v[104:107], v12, s[60:63], s53 offen nt
  s_add_u32 s53, s54, 20608
  buffer_load_dwordx4 v[108:111], v12, s[60:63], s53 offen nt
  s_add_u32 s53, s54, 21504
  buffer_load_dwordx4 v[112:115], v12, s[60:63], s53 offen nt
  s_add_u32 s53, s54, 22400
  buffer_load_dwordx4 v[116:119], v12, s[60:63], s53 offen nt
  s_add_u32 s53, s54, 23296
  buffer_load_dwordx4 v[120:123], v12, s[60:63], s53 offen nt
  s_add_u32 s53, s54, 24192
  buffer_load_dwordx4 v[124:127], v12, s[60:63], s53 offen nt
  s_add_u32 s53, s54, 25088
  buffer_load_dwordx4 v[128:131], v12, s[60:63], s53 offen nt
  s_add_u32 s53, s54, 25984
  buffer_load_dwordx4 v[132:135], v12, s[60:63], s53 offen nt
  s_add_u32 s53, s54, 26880
  buffer_load_dwordx4 v[136:139], v12, s[60:63], s53 offen nt
  s_add_u32 s53, s54, 27776
  buffer_load_dwordx4 v[140:143], v12, s[60:63], s53 offen nt
  s_mov_b64 exec, -1
  s_waitcnt vmcnt(49)
  s_barrier
  s_mov_b32 m0, 58368
  s_mov_b32 s53, 57344
  buffer_load_dwordx4 v3, s[20:23], s53 offen nt lds
  s_mov_b32 m0, 59392
  s_mov_b32 s53, 57344
  buffer_load_dwordx4 v4, s[20:23], s53 offen nt lds
  s_mov_b32 m0, 60416
  s_mov_b32 s53, 57344
  buffer_load_dwordx4 v5, s[20:23], s53 offen nt lds
  s_mov_b32 m0, 61440
  s_mov_b32 s53, 61440
  buffer_load_dwordx4 v2, s[20:23], s53 offen nt lds
  s_mov_b32 m0, 62464
  s_mov_b32 s53, 61440
  buffer_load_dwordx4 v3, s[20:23], s53 offen nt lds
  s_mov_b32 m0, 63488
  s_mov_b32 s53, 61440
  buffer_load_dwordx4 v4, s[20:23], s53 offen nt lds
  s_mov_b32 m0, 64512
  s_mov_b32 s53, 61440
  buffer_load_dwordx4 v5, s[20:23], s53 offen nt lds
  s_waitcnt vmcnt(49)
  s_barrier
  s_mov_b32 m0, 74752
  s_mov_b32 s53, 106496
  buffer_load_dwordx4 v3, s[16:19], s53 offen nt lds
  s_mov_b32 m0, 75776
  s_mov_b32 s53, 106496
  buffer_load_dwordx4 v4, s[16:19], s53 offen nt lds
  s_mov_b32 m0, 76800
  s_mov_b32 s53, 106496
  buffer_load_dwordx4 v5, s[16:19], s53 offen nt lds
  s_mov_b32 m0, 77824
  s_mov_b32 s53, 110592
  buffer_load_dwordx4 v2, s[16:19], s53 offen nt lds
  s_mov_b32 m0, 78848
  s_mov_b32 s53, 110592
  buffer_load_dwordx4 v3, s[16:19], s53 offen nt lds
  s_mov_b32 m0, 79872
  s_mov_b32 s53, 110592
  buffer_load_dwordx4 v4, s[16:19], s53 offen nt lds
  s_mov_b32 m0, 80896
  s_mov_b32 s53, 110592
  buffer_load_dwordx4 v5, s[16:19], s53 offen nt lds
  s_waitcnt vmcnt(49)
  s_barrier
  s_mov_b32 m0, 91136
  s_mov_b32 s53, 122880
  buffer_load_dwordx4 v3, s[16:19], s53 offen nt lds
  s_mov_b32 m0, 92160
  s_mov_b32 s53, 122880
  buffer_load_dwordx4 v4, s[16:19], s53 offen nt lds
  s_mov_b32 m0, 93184
  s_mov_b32 s53, 122880
  buffer_load_dwordx4 v5, s[16:19], s53 offen nt lds
  s_mov_b32 m0, 94208
  s_mov_b32 s53, 126976
  buffer_load_dwordx4 v2, s[16:19], s53 offen nt lds
  s_mov_b32 m0, 95232
  s_mov_b32 s53, 126976
  buffer_load_dwordx4 v3, s[16:19], s53 offen nt lds
  s_mov_b32 m0, 96256
  s_mov_b32 s53, 126976
  buffer_load_dwordx4 v4, s[16:19], s53 offen nt lds
  s_mov_b32 m0, 97280
  s_mov_b32 s53, 126976
  buffer_load_dwordx4 v5, s[16:19], s53 offen nt lds
  s_waitcnt vmcnt(49)
  s_barrier
  s_mov_b32 m0, 107520
  s_mov_b32 s53, 73728
  buffer_load_dwordx4 v3, s[20:23], s53 offen nt lds
  s_mov_b32 m0, 108544
  s_mov_b32 s53, 73728
  buffer_load_dwordx4 v4, s[20:23], s53 offen nt lds
  s_mov_b32 m0, 109568
  s_mov_b32 s53, 73728
  buffer_load_dwordx4 v5, s[20:23], s53 offen nt lds
  s_mov_b32 m0, 110592
  s_mov_b32 s53, 77824
  buffer_load_dwordx4 v2, s[20:23], s53 offen nt lds
  s_mov_b32 m0, 111616
  s_mov_b32 s53, 77824
  buffer_load_dwordx4 v3, s[20:23], s53 offen nt lds
  s_mov_b32 m0, 112640
  s_mov_b32 s53, 77824
  buffer_load_dwordx4 v4, s[20:23], s53 offen nt lds
  s_mov_b32 m0, 113664
  s_mov_b32 s53, 77824
  buffer_load_dwordx4 v5, s[20:23], s53 offen nt lds
  s_waitcnt vmcnt(49)
  s_barrier
  s_mov_b32 m0, 123904
  s_mov_b32 s53, 90112
  buffer_load_dwordx4 v3, s[20:23], s53 offen nt lds
  s_mov_b32 m0, 124928
  s_mov_b32 s53, 90112
  buffer_load_dwordx4 v4, s[20:23], s53 offen nt lds
  s_mov_b32 m0, 125952
  s_mov_b32 s53, 90112
  buffer_load_dwordx4 v5, s[20:23], s53 offen nt lds
  s_mov_b32 m0, 126976
  s_mov_b32 s53, 94208
  buffer_load_dwordx4 v2, s[20:23], s53 offen nt lds
  s_mov_b32 m0, 128000
  s_mov_b32 s53, 94208
  buffer_load_dwordx4 v3, s[20:23], s53 offen nt lds
  s_mov_b32 m0, 129024
  s_mov_b32 s53, 94208
  buffer_load_dwordx4 v4, s[20:23], s53 offen nt lds
  s_mov_b32 m0, 130048
  s_mov_b32 s53, 94208
  buffer_load_dwordx4 v5, s[20:23], s53 offen nt lds
  s_waitcnt vmcnt(49)
  s_barrier
  s_mov_b32 m0, 140288
  s_mov_b32 s53, 139264
  buffer_load_dwordx4 v3, s[16:19], s53 offen nt lds
  s_mov_b32 m0, 141312
  s_mov_b32 s53, 139264
  buffer_load_dwordx4 v4, s[16:19], s53 offen nt lds
  s_mov_b32 m0, 142336
  s_mov_b32 s53, 139264
  buffer_load_dwordx4 v5, s[16:19], s53 offen nt lds
  s_mov_b32 m0, 143360
  s_mov_b32 s53, 143360
  buffer_load_dwordx4 v2, s[16:19], s53 offen nt lds
  s_mov_b32 m0, 144384
  s_mov_b32 s53, 143360
  buffer_load_dwordx4 v3, s[16:19], s53 offen nt lds
  s_mov_b32 m0, 145408
  s_mov_b32 s53, 143360
  buffer_load_dwordx4 v4, s[16:19], s53 offen nt lds
  s_mov_b32 m0, 146432
  s_mov_b32 s53, 143360
  buffer_load_dwordx4 v5, s[16:19], s53 offen nt lds
  s_waitcnt vmcnt(49)
  s_barrier
  s_mov_b32 m0, 156672
  s_mov_b32 s53, 155648
  buffer_load_dwordx4 v3, s[16:19], s53 offen nt lds
  s_mov_b32 m0, 157696
  s_mov_b32 s53, 155648
  buffer_load_dwordx4 v4, s[16:19], s53 offen nt lds
  s_mov_b32 m0, 158720
  s_mov_b32 s53, 155648
  buffer_load_dwordx4 v5, s[16:19], s53 offen nt lds
  s_mov_b32 m0, 159744
  s_mov_b32 s53, 159744
  buffer_load_dwordx4 v2, s[16:19], s53 offen nt lds
  s_mov_b32 m0, 160768
  s_mov_b32 s53, 159744
  buffer_load_dwordx4 v3, s[16:19], s53 offen nt lds
  s_mov_b32 m0, 161792
  s_mov_b32 s53, 159744
  buffer_load_dwordx4 v4, s[16:19], s53 offen nt lds
  s_mov_b32 m0, 162816
  s_mov_b32 s53, 159744
  buffer_load_dwordx4 v5, s[16:19], s53 offen nt lds
  s_waitcnt vmcnt(49)
  s_barrier
  s_mov_b32 m0, 9216
  s_mov_b32 s53, 106496
  buffer_load_dwordx4 v3, s[20:23], s53 offen nt lds
  s_mov_b32 m0, 10240
  s_mov_b32 s53, 106496
  buffer_load_dwordx4 v4, s[20:23], s53 offen nt lds
  s_mov_b32 m0, 11264
  s_mov_b32 s53, 106496
  buffer_load_dwordx4 v5, s[20:23], s53 offen nt lds
  s_mov_b32 m0, 12288
  s_mov_b32 s53, 110592
  buffer_load_dwordx4 v2, s[20:23], s53 offen nt lds
  s_mov_b32 m0, 13312
  s_mov_b32 s53, 110592
  buffer_load_dwordx4 v3, s[20:23], s53 offen nt lds
  s_mov_b32 m0, 14336
  s_mov_b32 s53, 110592
  buffer_load_dwordx4 v4, s[20:23], s53 offen nt lds
  s_mov_b32 m0, 15360
  s_mov_b32 s53, 110592
  buffer_load_dwordx4 v5, s[20:23], s53 offen nt lds
  s_waitcnt vmcnt(49)
  s_barrier
  s_mov_b32 m0, 25600
  s_mov_b32 s53, 122880
  buffer_load_dwordx4 v3, s[20:23], s53 offen nt lds
  s_mov_b32 m0, 26624
  s_mov_b32 s53, 122880
  buffer_load_dwordx4 v4, s[20:23], s53 offen nt lds
  s_mov_b32 m0, 27648
  s_mov_b32 s53, 122880
  buffer_load_dwordx4 v5, s[20:23], s53 offen nt lds
  s_mov_b32 m0, 28672
  s_mov_b32 s53, 126976
  buffer_load_dwordx4 v2, s[20:23], s53 offen nt lds
  s_mov_b32 m0, 29696
  s_mov_b32 s53, 126976
  buffer_load_dwordx4 v3, s[20:23], s53 offen nt lds
  s_mov_b32 m0, 30720
  s_mov_b32 s53, 126976
  buffer_load_dwordx4 v4, s[20:23], s53 offen nt lds
  s_mov_b32 m0, 31744
  s_mov_b32 s53, 126976
  buffer_load_dwordx4 v5, s[20:23], s53 offen nt lds
  s_waitcnt vmcnt(49)
  s_barrier
  s_mov_b32 m0, 41984
  s_mov_b32 s53, 172032
  buffer_load_dwordx4 v3, s[16:19], s53 offen nt lds
  s_mov_b32 m0, 43008
  s_mov_b32 s53, 172032
  buffer_load_dwordx4 v4, s[16:19], s53 offen nt lds
  s_mov_b32 m0, 44032
  s_mov_b32 s53, 172032
  buffer_load_dwordx4 v5, s[16:19], s53 offen nt lds
  s_mov_b32 m0, 45056
  s_mov_b32 s53, 176128
  buffer_load_dwordx4 v2, s[16:19], s53 offen nt lds
  s_mov_b32 m0, 46080
  s_mov_b32 s53, 176128
  buffer_load_dwordx4 v3, s[16:19], s53 offen nt lds
  s_mov_b32 m0, 47104
  s_mov_b32 s53, 176128
  buffer_load_dwordx4 v4, s[16:19], s53 offen nt lds
  s_mov_b32 m0, 48128
  s_mov_b32 s53, 176128
  buffer_load_dwordx4 v5, s[16:19], s53 offen nt lds
  s_mov_b32 exec_lo, -1
  s_mov_b32 exec_hi, 0x00ffffff
  s_add_u32 s53, s55, 0
  buffer_store_dwordx4 v[16:19], v13, s[24:27], s53 offen
  s_add_u32 s53, s55, 128
  buffer_store_dwordx4 v[20:23], v13, s[24:27], s53 offen
  s_add_u32 s53, s55, 256
  buffer_store_dwordx4 v[24:27], v13, s[24:27], s53 offen
  s_add_u32 s53, s55, 384
  buffer_store_dwordx4 v[28:31], v13, s[24:27], s53 offen
  s_add_u32 s53, s55, 512
  buffer_store_dwordx4 v[32:35], v13, s[24:27], s53 offen
  s_add_u32 s53, s55, 640
  buffer_store_dwordx4 v[36:39], v13, s[24:27], s53 offen
  s_add_u32 s53, s55, 768
  buffer_store_dwordx4 v[40:43], v13, s[24:27], s53 offen
  s_add_u32 s53, s55, 896
  buffer_store_dwordx4 v[44:47], v13, s[24:27], s53 offen
  s_add_u32 s53, s55, 1024
  buffer_store_dwordx4 v[48:51], v13, s[24:27], s53 offen
  s_add_u32 s53, s55, 1152
  buffer_store_dwordx4 v[52:55], v13, s[24:27], s53 offen
  s_add_u32 s53, s55, 1280
  buffer_store_dwordx4 v[56:59], v13, s[24:27], s53 offen
  s_add_u32 s53, s55, 1408
  buffer_store_dwordx4 v[60:63], v13, s[24:27], s53 offen
  s_add_u32 s53, s55, 1536
  buffer_store_dwordx4 v[64:67], v13, s[24:27], s53 offen
  s_add_u32 s53, s55, 1664
  buffer_store_dwordx4 v[68:71], v13, s[24:27], s53 offen
  s_add_u32 s53, s55, 1792
  buffer_store_dwordx4 v[72:75], v13, s[24:27], s53 offen
  s_add_u32 s53, s55, 1920
  buffer_store_dwordx4 v[76:79], v13, s[24:27], s53 offen
  s_add_u32 s53, s55, 2048
  buffer_store_dwordx4 v[80:83], v13, s[24:27], s53 offen
  s_add_u32 s53, s55, 2176
  buffer_store_dwordx4 v[84:87], v13, s[24:27], s53 offen
  s_add_u32 s53, s55, 2304
  buffer_store_dwordx4 v[88:91], v13, s[24:27], s53 offen
  s_add_u32 s53, s55, 2432
  buffer_store_dwordx4 v[92:95], v13, s[24:27], s53 offen
  s_add_u32 s53, s55, 2560
  buffer_store_dwordx4 v[96:99], v13, s[24:27], s53 offen
  s_add_u32 s53, s55, 2688
  buffer_store_dwordx4 v[100:103], v13, s[24:27], s53 offen
  s_add_u32 s53, s55, 2816
  buffer_store_dwordx4 v[104:107], v13, s[24:27], s53 offen
  s_add_u32 s53, s55, 2944
  buffer_store_dwordx4 v[108:111], v13, s[24:27], s53 offen
  s_add_u32 s53, s55, 3072
  buffer_store_dwordx4 v[112:115], v13, s[24:27], s53 offen
  s_add_u32 s53, s55, 3200
  buffer_store_dwordx4 v[116:119], v13, s[24:27], s53 offen
  s_add_u32 s53, s55, 3328
  buffer_store_dwordx4 v[120:123], v13, s[24:27], s53 offen
  s_add_u32 s53, s55, 3456
  buffer_store_dwordx4 v[124:127], v13, s[24:27], s53 offen
  s_add_u32 s53, s55, 3584
  buffer_store_dwordx4 v[128:131], v13, s[24:27], s53 offen
  s_add_u32 s53, s55, 3712
  buffer_store_dwordx4 v[132:135], v13, s[24:27], s53 offen
  s_add_u32 s53, s55, 3840
  buffer_store_dwordx4 v[136:139], v13, s[24:27], s53 offen
  s_add_u32 s53, s55, 3968
  buffer_store_dwordx4 v[140:143], v13, s[24:27], s53 offen
  s_mov_b64 exec, -1
  s_waitcnt vmcnt(49)
  s_barrier
  s_mov_b32 m0, 58368
  s_mov_b32 s53, 188416
  buffer_load_dwordx4 v3, s[16:19], s53 offen nt lds
  s_mov_b32 m0, 59392
  s_mov_b32 s53, 188416
  buffer_load_dwordx4 v4, s[16:19], s53 offen nt lds
  s_mov_b32 m0, 60416
  s_mov_b32 s53, 188416
  buffer_load_dwordx4 v5, s[16:19], s53 offen nt lds
  s_mov_b32 m0, 61440
  s_mov_b32 s53, 192512
  buffer_load_dwordx4 v2, s[16:19], s53 offen nt lds
  s_mov_b32 m0, 62464
  s_mov_b32 s53, 192512
  buffer_load_dwordx4 v3, s[16:19], s53 offen nt lds
  s_mov_b32 m0, 63488
  s_mov_b32 s53, 192512
  buffer_load_dwordx4 v4, s[16:19], s53 offen nt lds
  s_mov_b32 m0, 64512
  s_mov_b32 s53, 192512
  buffer_load_dwordx4 v5, s[16:19], s53 offen nt lds
  s_waitcnt vmcnt(49)
  s_barrier
  s_mov_b32 m0, 74752
  s_mov_b32 s53, 139264
  buffer_load_dwordx4 v3, s[20:23], s53 offen nt lds
  s_mov_b32 m0, 75776
  s_mov_b32 s53, 139264
  buffer_load_dwordx4 v4, s[20:23], s53 offen nt lds
  s_mov_b32 m0, 76800
  s_mov_b32 s53, 139264
  buffer_load_dwordx4 v5, s[20:23], s53 offen nt lds
  s_mov_b32 m0, 77824
  s_mov_b32 s53, 143360
  buffer_load_dwordx4 v2, s[20:23], s53 offen nt lds
  s_mov_b32 m0, 78848
  s_mov_b32 s53, 143360
  buffer_load_dwordx4 v3, s[20:23], s53 offen nt lds
  s_mov_b32 m0, 79872
  s_mov_b32 s53, 143360
  buffer_load_dwordx4 v4, s[20:23], s53 offen nt lds
  s_mov_b32 m0, 80896
  s_mov_b32 s53, 143360
  buffer_load_dwordx4 v5, s[20:23], s53 offen nt lds
  s_waitcnt vmcnt(49)
  s_barrier
  s_mov_b32 m0, 91136
  s_mov_b32 s53, 155648
  buffer_load_dwordx4 v3, s[20:23], s53 offen nt lds
  s_mov_b32 m0, 92160
  s_mov_b32 s53, 155648
  buffer_load_dwordx4 v4, s[20:23], s53 offen nt lds
  s_mov_b32 m0, 93184
  s_mov_b32 s53, 155648
  buffer_load_dwordx4 v5, s[20:23], s53 offen nt lds
  s_mov_b32 m0, 94208
  s_mov_b32 s53, 159744
  buffer_load_dwordx4 v2, s[20:23], s53 offen nt lds
  s_mov_b32 m0, 95232
  s_mov_b32 s53, 159744
  buffer_load_dwordx4 v3, s[20:23], s53 offen nt lds
  s_mov_b32 m0, 96256
  s_mov_b32 s53, 159744
  buffer_load_dwordx4 v4, s[20:23], s53 offen nt lds
  s_mov_b32 m0, 97280
  s_mov_b32 s53, 159744
  buffer_load_dwordx4 v5, s[20:23], s53 offen nt lds
  s_waitcnt vmcnt(49)
  s_barrier
  s_mov_b32 m0, 107520
  s_mov_b32 s53, 204800
  buffer_load_dwordx4 v3, s[16:19], s53 offen nt lds
  s_mov_b32 m0, 108544
  s_mov_b32 s53, 204800
  buffer_load_dwordx4 v4, s[16:19], s53 offen nt lds
  s_mov_b32 m0, 109568
  s_mov_b32 s53, 204800
  buffer_load_dwordx4 v5, s[16:19], s53 offen nt lds
  s_mov_b32 m0, 110592
  s_mov_b32 s53, 208896
  buffer_load_dwordx4 v2, s[16:19], s53 offen nt lds
  s_mov_b32 m0, 111616
  s_mov_b32 s53, 208896
  buffer_load_dwordx4 v3, s[16:19], s53 offen nt lds
  s_mov_b32 m0, 112640
  s_mov_b32 s53, 208896
  buffer_load_dwordx4 v4, s[16:19], s53 offen nt lds
  s_mov_b32 m0, 113664
  s_mov_b32 s53, 208896
  buffer_load_dwordx4 v5, s[16:19], s53 offen nt lds
  s_waitcnt vmcnt(49)
  s_barrier
  s_mov_b32 m0, 123904
  s_mov_b32 s53, 221184
  buffer_load_dwordx4 v3, s[16:19], s53 offen nt lds
  s_mov_b32 m0, 124928
  s_mov_b32 s53, 221184
  buffer_load_dwordx4 v4, s[16:19], s53 offen nt lds
  s_mov_b32 m0, 125952
  s_mov_b32 s53, 221184
  buffer_load_dwordx4 v5, s[16:19], s53 offen nt lds
  s_mov_b32 m0, 126976
  s_mov_b32 s53, 225280
  buffer_load_dwordx4 v2, s[16:19], s53 offen nt lds
  s_mov_b32 m0, 128000
  s_mov_b32 s53, 225280
  buffer_load_dwordx4 v3, s[16:19], s53 offen nt lds
  s_mov_b32 m0, 129024
  s_mov_b32 s53, 225280
  buffer_load_dwordx4 v4, s[16:19], s53 offen nt lds
  s_mov_b32 m0, 130048
  s_mov_b32 s53, 225280
  buffer_load_dwordx4 v5, s[16:19], s53 offen nt lds
  s_waitcnt vmcnt(49)
  s_barrier
  s_mov_b32 m0, 140288
  s_mov_b32 s53, 172032
  buffer_load_dwordx4 v3, s[20:23], s53 offen nt lds
  s_mov_b32 m0, 141312
  s_mov_b32 s53, 172032
  buffer_load_dwordx4 v4, s[20:23], s53 offen nt lds
  s_mov_b32 m0, 142336
  s_mov_b32 s53, 172032
  buffer_load_dwordx4 v5, s[20:23], s53 offen nt lds
  s_mov_b32 m0, 143360
  s_mov_b32 s53, 176128
  buffer_load_dwordx4 v2, s[20:23], s53 offen nt lds
  s_mov_b32 m0, 144384
  s_mov_b32 s53, 176128
  buffer_load_dwordx4 v3, s[20:23], s53 offen nt lds
  s_mov_b32 m0, 145408
  s_mov_b32 s53, 176128
  buffer_load_dwordx4 v4, s[20:23], s53 offen nt lds
  s_mov_b32 m0, 146432
  s_mov_b32 s53, 176128
  buffer_load_dwordx4 v5, s[20:23], s53 offen nt lds
  s_waitcnt vmcnt(49)
  s_barrier
  s_mov_b32 m0, 156672
  s_mov_b32 s53, 188416
  buffer_load_dwordx4 v3, s[20:23], s53 offen nt lds
  s_mov_b32 m0, 157696
  s_mov_b32 s53, 188416
  buffer_load_dwordx4 v4, s[20:23], s53 offen nt lds
  s_mov_b32 m0, 158720
  s_mov_b32 s53, 188416
  buffer_load_dwordx4 v5, s[20:23], s53 offen nt lds
  s_mov_b32 m0, 159744
  s_mov_b32 s53, 192512
  buffer_load_dwordx4 v2, s[20:23], s53 offen nt lds
  s_mov_b32 m0, 160768
  s_mov_b32 s53, 192512
  buffer_load_dwordx4 v3, s[20:23], s53 offen nt lds
  s_mov_b32 m0, 161792
  s_mov_b32 s53, 192512
  buffer_load_dwordx4 v4, s[20:23], s53 offen nt lds
  s_mov_b32 m0, 162816
  s_mov_b32 s53, 192512
  buffer_load_dwordx4 v5, s[20:23], s53 offen nt lds
  s_waitcnt vmcnt(49)
  s_barrier
  s_mov_b32 m0, 9216
  s_mov_b32 s53, 237568
  buffer_load_dwordx4 v3, s[16:19], s53 offen nt lds
  s_mov_b32 m0, 10240
  s_mov_b32 s53, 237568
  buffer_load_dwordx4 v4, s[16:19], s53 offen nt lds
  s_mov_b32 m0, 11264
  s_mov_b32 s53, 237568
  buffer_load_dwordx4 v5, s[16:19], s53 offen nt lds
  s_mov_b32 m0, 12288
  s_mov_b32 s53, 241664
  buffer_load_dwordx4 v2, s[16:19], s53 offen nt lds
  s_mov_b32 m0, 13312
  s_mov_b32 s53, 241664
  buffer_load_dwordx4 v3, s[16:19], s53 offen nt lds
  s_mov_b32 m0, 14336
  s_mov_b32 s53, 241664
  buffer_load_dwordx4 v4, s[16:19], s53 offen nt lds
  s_mov_b32 m0, 15360
  s_mov_b32 s53, 241664
  buffer_load_dwordx4 v5, s[16:19], s53 offen nt lds
  s_waitcnt vmcnt(49)
  s_barrier
  s_mov_b32 m0, 25600
  s_mov_b32 s53, 253952
  buffer_load_dwordx4 v3, s[16:19], s53 offen nt lds
  s_mov_b32 m0, 26624
  s_mov_b32 s53, 253952
  buffer_load_dwordx4 v4, s[16:19], s53 offen nt lds
  s_mov_b32 m0, 27648
  s_mov_b32 s53, 253952
  buffer_load_dwordx4 v5, s[16:19], s53 offen nt lds
  s_mov_b32 m0, 28672
  s_mov_b32 s53, 258048
  buffer_load_dwordx4 v2, s[16:19], s53 offen nt lds
  s_mov_b32 m0, 29696
  s_mov_b32 s53, 258048
  buffer_load_dwordx4 v3, s[16:19], s53 offen nt lds
  s_mov_b32 m0, 30720
  s_mov_b32 s53, 258048
  buffer_load_dwordx4 v4, s[16:19], s53 offen nt lds
  s_mov_b32 m0, 31744
  s_mov_b32 s53, 258048
  buffer_load_dwordx4 v5, s[16:19], s53 offen nt lds
  s_waitcnt vmcnt(49)
  s_barrier
  s_mov_b32 m0, 41984
  s_mov_b32 s53, 204800
  buffer_load_dwordx4 v3, s[20:23], s53 offen nt lds
  s_mov_b32 m0, 43008
  s_mov_b32 s53, 204800
  buffer_load_dwordx4 v4, s[20:23], s53 offen nt lds
  s_mov_b32 m0, 44032
  s_mov_b32 s53, 204800
  buffer_load_dwordx4 v5, s[20:23], s53 offen nt lds
  s_mov_b32 m0, 45056
  s_mov_b32 s53, 208896
  buffer_load_dwordx4 v2, s[20:23], s53 offen nt lds
  s_mov_b32 m0, 46080
  s_mov_b32 s53, 208896
  buffer_load_dwordx4 v3, s[20:23], s53 offen nt lds
  s_mov_b32 m0, 47104
  s_mov_b32 s53, 208896
  buffer_load_dwordx4 v4, s[20:23], s53 offen nt lds
  s_mov_b32 m0, 48128
  s_mov_b32 s53, 208896
  buffer_load_dwordx4 v5, s[20:23], s53 offen nt lds
  s_waitcnt vmcnt(49)
  s_barrier
  s_mov_b32 m0, 58368
  s_mov_b32 s53, 221184
  buffer_load_dwordx4 v3, s[20:23], s53 offen nt lds
  s_mov_b32 m0, 59392
  s_mov_b32 s53, 221184
  buffer_load_dwordx4 v4, s[20:23], s53 offen nt lds
  s_mov_b32 m0, 60416
  s_mov_b32 s53, 221184
  buffer_load_dwordx4 v5, s[20:23], s53 offen nt lds
  s_mov_b32 m0, 61440
  s_mov_b32 s53, 225280
  buffer_load_dwordx4 v2, s[20:23], s53 offen nt lds
  s_mov_b32 m0, 62464
  s_mov_b32 s53, 225280
  buffer_load_dwordx4 v3, s[20:23], s53 offen nt lds
  s_mov_b32 m0, 63488
  s_mov_b32 s53, 225280
  buffer_load_dwordx4 v4, s[20:23], s53 offen nt lds
  s_mov_b32 m0, 64512
  s_mov_b32 s53, 225280
  buffer_load_dwordx4 v5, s[20:23], s53 offen nt lds
  s_waitcnt vmcnt(49)
  s_barrier
  s_mov_b32 m0, 74752
  s_mov_b32 s53, 237568
  buffer_load_dwordx4 v3, s[20:23], s53 offen nt lds
  s_mov_b32 m0, 75776
  s_mov_b32 s53, 237568
  buffer_load_dwordx4 v4, s[20:23], s53 offen nt lds
  s_mov_b32 m0, 76800
  s_mov_b32 s53, 237568
  buffer_load_dwordx4 v5, s[20:23], s53 offen nt lds
  s_mov_b32 m0, 77824
  s_mov_b32 s53, 241664
  buffer_load_dwordx4 v2, s[20:23], s53 offen nt lds
  s_mov_b32 m0, 78848
  s_mov_b32 s53, 241664
  buffer_load_dwordx4 v3, s[20:23], s53 offen nt lds
  s_mov_b32 m0, 79872
  s_mov_b32 s53, 241664
  buffer_load_dwordx4 v4, s[20:23], s53 offen nt lds
  s_mov_b32 m0, 80896
  s_mov_b32 s53, 241664
  buffer_load_dwordx4 v5, s[20:23], s53 offen nt lds
  s_waitcnt vmcnt(49)
  s_barrier
  s_mov_b32 m0, 91136
  s_mov_b32 s53, 253952
  buffer_load_dwordx4 v3, s[20:23], s53 offen nt lds
  s_mov_b32 m0, 92160
  s_mov_b32 s53, 253952
  buffer_load_dwordx4 v4, s[20:23], s53 offen nt lds
  s_mov_b32 m0, 93184
  s_mov_b32 s53, 253952
  buffer_load_dwordx4 v5, s[20:23], s53 offen nt lds
  s_mov_b32 m0, 94208
  s_mov_b32 s53, 258048
  buffer_load_dwordx4 v2, s[20:23], s53 offen nt lds
  s_mov_b32 m0, 95232
  s_mov_b32 s53, 258048
  buffer_load_dwordx4 v3, s[20:23], s53 offen nt lds
  s_mov_b32 m0, 96256
  s_mov_b32 s53, 258048
  buffer_load_dwordx4 v4, s[20:23], s53 offen nt lds
  s_mov_b32 m0, 97280
  s_mov_b32 s53, 258048
  buffer_load_dwordx4 v5, s[20:23], s53 offen nt lds
  s_waitcnt vmcnt(49)
  s_barrier
  s_waitcnt vmcnt(42)
  s_barrier
  s_waitcnt vmcnt(35)
  s_barrier
  s_waitcnt vmcnt(28)
  s_barrier
  s_waitcnt vmcnt(21)
  s_barrier
  s_waitcnt vmcnt(14)
  s_barrier
  s_waitcnt vmcnt(7)
  s_barrier
  s_waitcnt vmcnt(0)
  s_barrier
L_k1_end:
  s_endpgm
.globl oproj_kernel
.type oproj_kernel,@function
.p2align 8
oproj_kernel:
  s_cmp_ge_u32 s2, 252
  s_cbranch_scc1 L_k2_end
  s_load_dwordx2 s[32:33], s[0:1], 32
  s_load_dwordx2 s[34:35], s[0:1], 72
  s_load_dwordx2 s[36:37], s[0:1], 80
  s_load_dwordx2 s[38:39], s[0:1], 96
  s_and_b32 s4, s2, 7
  s_lshr_b32 s5, s2, 3
  s_lshl_b32 s6, s4, 5
  s_mul_i32 s7, s4, 31
  s_add_u32 s7, s7, 4
  s_cmp_lt_u32 s4, 4
  s_cselect_b32 s6, s6, s7
  s_add_u32 s6, s6, s5
  s_cmp_ge_u32 s6, 126
  s_cselect_b32 s28, 1, 0
  s_mul_i32 s4, s28, 126
  s_sub_u32 s4, s6, s4
  s_mul_i32 s29, s4, 9363
  s_lshr_b32 s29, s29, 16
  s_mul_i32 s5, s29, 7
  s_sub_u32 s30, s4, s5
  v_lshrrev_b32 v1, 6, v0
  s_nop 0
  v_readfirstlane_b32 s3, v1
  v_and_b32 v1, 63, v0
  s_waitcnt lgkmcnt(0)
  s_cmp_eq_u32 s28, 0
  s_cselect_b32 s32, s32, s34
  s_cselect_b32 s33, s33, s35
  s_mov_b32 s12, s38
  s_and_b32 s13, s39, 0xffff
  s_mov_b32 s14, 28311552
  s_mov_b32 s15, 0x00020000
  s_mov_b32 s16, s36
  s_and_b32 s17, s37, 0xffff
  s_mov_b32 s18, 2064384
  s_mov_b32 s19, 0x00020000
  s_lshl_b32 s50, s3, 11
  s_and_b32 s40, s3, 3
  s_lshr_b32 s41, s3, 2
  v_and_b32 v9, 15, v1
  v_lshrrev_b32 v10, 4, v1
  v_lshrrev_b32 v11, 3, v1
  v_bfe_u32 v12, v11, 1, 1
  v_lshlrev_b32 v12, 1, v12
  v_and_b32 v13, 7, v1
  v_xor_b32 v12, v12, v13
  v_lshlrev_b32 v12, 4, v12
  s_lshl_b32 s5, s3, 4
  v_add_u32 v11, s5, v11
  v_lshlrev_b32 v11, 7, v11
  v_add_u32 v2, v11, v12
  s_mul_i32 s5, s28, 7
  s_add_u32 s5, s5, s30
  s_lshl_b32 s5, s5, 19
  s_add_u32 s5, s5, 20971520
  v_add_u32 v2, s5, v2
  v_xor_b32 v3, 64, v2
  v_add_u32 v3, 1024, v3
  v_lshlrev_b32 v12, 1, v10
  v_xor_b32 v12, v12, v9
  v_lshlrev_b32 v12, 4, v12
  s_lshl_b32 s4, s28, 4
  s_mul_i32 s4, s4, 1152
  s_lshl_b32 s5, s29, 6
  s_add_u32 s4, s4, s5
  s_lshl_b32 s5, s3, 3
  s_add_u32 s4, s4, s5
  v_add_u32 v11, s4, v10
  v_lshlrev_b32 v11, 9, v11
  v_add_u32 v4, v11, v12
  v_xor_b32 v5, 128, v4
  v_add_u32 v5, 2048, v5
  v_bfe_u32 v11, v1, 2, 2
  v_lshl_add_u32 v11, v10, 3, v11
  s_lshl_b32 s5, s40, 5
  v_add_u32 v11, s5, v11
  v_bfe_u32 v12, v1, 3, 1
  v_bfe_u32 v13, v1, 4, 1
  v_lshl_add_u32 v12, v13, 1, v12
  v_lshlrev_b32 v12, 1, v12
  v_bfe_u32 v13, v1, 1, 1
  v_or_b32 v12, v12, v13
  v_lshlrev_b32 v12, 4, v12
  v_lshl_add_u32 v6, v11, 7, v12
  v_and_b32 v13, 1, v1
  v_lshl_add_u32 v6, v13, 3, v6
  s_lshl_b32 s5, s40, 2
  v_add_u32 v12, s5, v10
  v_and_b32 v13, 7, v9
  v_lshlrev_b32 v13, 1, v13
  v_xor_b32 v12, v12, v13
  v_lshlrev_b32 v12, 4, v12
  s_lshl_b32 s5, s41, 5
  v_add_u32 v11, s5, v9
  v_lshl_add_u32 v7, v11, 8, v12
  v_add_u32 v7, 16384, v7
  s_add_u32 m0, s50, 0
  s_mov_b32 s53, 0
  buffer_load_dwordx4 v2, s[12:15], s53 offen lds
  s_add_u32 m0, s50, 1024
  s_mov_b32 s53, 0
  buffer_load_dwordx4 v3, s[12:15], s53 offen lds
  s_add_u32 m0, s50, 16384
  s_mov_b32 s53, 0
  buffer_load_dwordx4 v4, s[12:15], s53 offen lds
  s_add_u32 m0, s50, 17408
  s_mov_b32 s53, 0
  buffer_load_dwordx4 v5, s[12:15], s53 offen lds
  s_add_u32 m0, s50, 32768
  s_mov_b32 s53, 16384
  buffer_load_dwordx4 v2, s[12:15], s53 offen lds
  s_add_u32 m0, s50, 33792
  s_mov_b32 s53, 16384
  buffer_load_dwordx4 v3, s[12:15], s53 offen lds
  s_add_u32 m0, s50, 49152
  s_mov_b32 s53, 256
  buffer_load_dwordx4 v4, s[12:15], s53 offen lds
  s_add_u32 m0, s50, 50176
  s_mov_b32 s53, 256
  buffer_load_dwordx4 v5, s[12:15], s53 offen lds
  s_add_u32 m0, s50, 65536
  s_mov_b32 s53, 32768
  buffer_load_dwordx4 v2, s[12:15], s53 offen lds
  s_add_u32 m0, s50, 66560
  s_mov_b32 s53, 32768
  buffer_load_dwordx4 v3, s[12:15], s53 offen lds
  s_add_u32 m0, s50, 81920
  s_mov_b32 s53, 589824
  buffer_load_dwordx4 v4, s[12:15], s53 offen lds
  s_add_u32 m0, s50, 82944
  s_mov_b32 s53, 589824
  buffer_load_dwordx4 v5, s[12:15], s53 offen lds
  s_add_u32 m0, s50, 98304
  s_mov_b32 s53, 49152
  buffer_load_dwordx4 v2, s[12:15], s53 offen lds
  s_add_u32 m0, s50, 99328
  s_mov_b32 s53, 49152
  buffer_load_dwordx4 v3, s[12:15], s53 offen lds
  s_add_u32 m0, s50, 114688
  s_mov_b32 s53, 590080
  buffer_load_dwordx4 v4, s[12:15], s53 offen lds
  s_add_u32 m0, s50, 115712
  s_mov_b32 s53, 590080
  buffer_load_dwordx4 v5, s[12:15], s53 offen lds
  s_waitcnt vmcnt(12)
  s_barrier
  v_add_u32 v8, 0, v6
  v_add_u32 v11, 0, v7
  ds_read_b128 v[32:35], v11 offset:0
  ds_read_b128 v[36:39], v11 offset:4096
  v_xor_b32 v12, 0, v8
  ds_read_b64_tr_b16 v[16:17], v12
  ds_read_b64_tr_b16 v[18:19], v12 offset:512
  v_xor_b32 v13, 32, v8
  ds_read_b64_tr_b16 v[20:21], v13
  ds_read_b64_tr_b16 v[22:23], v13 offset:512
  v_xor_b32 v14, 64, v8
  ds_read_b64_tr_b16 v[24:25], v14
  ds_read_b64_tr_b16 v[26:27], v14 offset:512
  v_xor_b32 v15, 96, v8
  ds_read_b64_tr_b16 v[28:29], v15
  ds_read_b64_tr_b16 v[30:31], v15 offset:512
  s_add_u32 m0, s50, 131072
  s_mov_b32 s53, 65536
  buffer_load_dwordx4 v2, s[12:15], s53 offen lds
  s_add_u32 m0, s50, 132096
  s_mov_b32 s53, 65536
  buffer_load_dwordx4 v3, s[12:15], s53 offen lds
  s_add_u32 m0, s50, 147456
  s_mov_b32 s53, 1179648
  buffer_load_dwordx4 v4, s[12:15], s53 offen lds
  s_add_u32 m0, s50, 148480
  s_mov_b32 s53, 1179648
  buffer_load_dwordx4 v5, s[12:15], s53 offen lds
  s_waitcnt lgkmcnt(6)
  v_mfma_f32_16x16x32_bf16 v[64:67], v[16:19], v[32:35], 0
  v_mfma_f32_16x16x32_bf16 v[68:71], v[16:19], v[36:39], 0
  s_waitcnt lgkmcnt(4)
  v_mfma_f32_16x16x32_bf16 v[72:75], v[20:23], v[32:35], 0
  v_mfma_f32_16x16x32_bf16 v[76:79], v[20:23], v[36:39], 0
  s_waitcnt lgkmcnt(2)
  v_mfma_f32_16x16x32_bf16 v[80:83], v[24:27], v[32:35], 0
  v_mfma_f32_16x16x32_bf16 v[84:87], v[24:27], v[36:39], 0
  s_waitcnt lgkmcnt(0)
  v_mfma_f32_16x16x32_bf16 v[88:91], v[28:31], v[32:35], 0
  v_mfma_f32_16x16x32_bf16 v[92:95], v[28:31], v[36:39], 0
  s_waitcnt vmcnt(12)
  s_barrier
  v_add_u32 v8, 32768, v6
  v_add_u32 v11, 32768, v7
  ds_read_b128 v[32:35], v11 offset:0
  ds_read_b128 v[36:39], v11 offset:4096
  v_xor_b32 v12, 0, v8
  ds_read_b64_tr_b16 v[16:17], v12
  ds_read_b64_tr_b16 v[18:19], v12 offset:512
  v_xor_b32 v13, 32, v8
  ds_read_b64_tr_b16 v[20:21], v13
  ds_read_b64_tr_b16 v[22:23], v13 offset:512
  v_xor_b32 v14, 64, v8
  ds_read_b64_tr_b16 v[24:25], v14
  ds_read_b64_tr_b16 v[26:27], v14 offset:512
  v_xor_b32 v15, 96, v8
  ds_read_b64_tr_b16 v[28:29], v15
  ds_read_b64_tr_b16 v[30:31], v15 offset:512
  s_add_u32 m0, s50, 0
  s_mov_b32 s53, 81920
  buffer_load_dwordx4 v2, s[12:15], s53 offen lds
  s_add_u32 m0, s50, 1024
  s_mov_b32 s53, 81920
  buffer_load_dwordx4 v3, s[12:15], s53 offen lds
  s_add_u32 m0, s50, 16384
  s_mov_b32 s53, 1179904
  buffer_load_dwordx4 v4, s[12:15], s53 offen lds
  s_add_u32 m0, s50, 17408
  s_mov_b32 s53, 1179904
  buffer_load_dwordx4 v5, s[12:15], s53 offen lds
  s_waitcnt lgkmcnt(6)
  v_mfma_f32_16x16x32_bf16 v[64:67], v[16:19], v[32:35], v[64:67]
  v_mfma_f32_16x16x32_bf16 v[68:71], v[16:19], v[36:39], v[68:71]
  s_waitcnt lgkmcnt(4)
  v_mfma_f32_16x16x32_bf16 v[72:75], v[20:23], v[32:35], v[72:75]
  v_mfma_f32_16x16x32_bf16 v[76:79], v[20:23], v[36:39], v[76:79]
  s_waitcnt lgkmcnt(2)
  v_mfma_f32_16x16x32_bf16 v[80:83], v[24:27], v[32:35], v[80:83]
  v_mfma_f32_16x16x32_bf16 v[84:87], v[24:27], v[36:39], v[84:87]
  s_waitcnt lgkmcnt(0)
  v_mfma_f32_16x16x32_bf16 v[88:91], v[28:31], v[32:35], v[88:91]
  v_mfma_f32_16x16x32_bf16 v[92:95], v[28:31], v[36:39], v[92:95]
  s_waitcnt vmcnt(12)
  s_barrier
  v_add_u32 v8, 65536, v6
  v_add_u32 v11, 65536, v7
  ds_read_b128 v[32:35], v11 offset:0
  ds_read_b128 v[36:39], v11 offset:4096
  v_xor_b32 v12, 0, v8
  ds_read_b64_tr_b16 v[16:17], v12
  ds_read_b64_tr_b16 v[18:19], v12 offset:512
  v_xor_b32 v13, 32, v8
  ds_read_b64_tr_b16 v[20:21], v13
  ds_read_b64_tr_b16 v[22:23], v13 offset:512
  v_xor_b32 v14, 64, v8
  ds_read_b64_tr_b16 v[24:25], v14
  ds_read_b64_tr_b16 v[26:27], v14 offset:512
  v_xor_b32 v15, 96, v8
  ds_read_b64_tr_b16 v[28:29], v15
  ds_read_b64_tr_b16 v[30:31], v15 offset:512
  s_add_u32 m0, s50, 32768
  s_mov_b32 s53, 98304
  buffer_load_dwordx4 v2, s[12:15], s53 offen lds
  s_add_u32 m0, s50, 33792
  s_mov_b32 s53, 98304
  buffer_load_dwordx4 v3, s[12:15], s53 offen lds
  s_add_u32 m0, s50, 49152
  s_mov_b32 s53, 1769472
  buffer_load_dwordx4 v4, s[12:15], s53 offen lds
  s_add_u32 m0, s50, 50176
  s_mov_b32 s53, 1769472
  buffer_load_dwordx4 v5, s[12:15], s53 offen lds
  s_waitcnt lgkmcnt(6)
  v_mfma_f32_16x16x32_bf16 v[64:67], v[16:19], v[32:35], v[64:67]
  v_mfma_f32_16x16x32_bf16 v[68:71], v[16:19], v[36:39], v[68:71]
  s_waitcnt lgkmcnt(4)
  v_mfma_f32_16x16x32_bf16 v[72:75], v[20:23], v[32:35], v[72:75]
  v_mfma_f32_16x16x32_bf16 v[76:79], v[20:23], v[36:39], v[76:79]
  s_waitcnt lgkmcnt(2)
  v_mfma_f32_16x16x32_bf16 v[80:83], v[24:27], v[32:35], v[80:83]
  v_mfma_f32_16x16x32_bf16 v[84:87], v[24:27], v[36:39], v[84:87]
  s_waitcnt lgkmcnt(0)
  v_mfma_f32_16x16x32_bf16 v[88:91], v[28:31], v[32:35], v[88:91]
  v_mfma_f32_16x16x32_bf16 v[92:95], v[28:31], v[36:39], v[92:95]
  s_waitcnt vmcnt(12)
  s_barrier
  v_add_u32 v8, 98304, v6
  v_add_u32 v11, 98304, v7
  ds_read_b128 v[32:35], v11 offset:0
  ds_read_b128 v[36:39], v11 offset:4096
  v_xor_b32 v12, 0, v8
  ds_read_b64_tr_b16 v[16:17], v12
  ds_read_b64_tr_b16 v[18:19], v12 offset:512
  v_xor_b32 v13, 32, v8
  ds_read_b64_tr_b16 v[20:21], v13
  ds_read_b64_tr_b16 v[22:23], v13 offset:512
  v_xor_b32 v14, 64, v8
  ds_read_b64_tr_b16 v[24:25], v14
  ds_read_b64_tr_b16 v[26:27], v14 offset:512
  v_xor_b32 v15, 96, v8
  ds_read_b64_tr_b16 v[28:29], v15
  ds_read_b64_tr_b16 v[30:31], v15 offset:512
  s_add_u32 m0, s50, 65536
  s_mov_b32 s53, 114688
  buffer_load_dwordx4 v2, s[12:15], s53 offen lds
  s_add_u32 m0, s50, 66560
  s_mov_b32 s53, 114688
  buffer_load_dwordx4 v3, s[12:15], s53 offen lds
  s_add_u32 m0, s50, 81920
  s_mov_b32 s53, 1769728
  buffer_load_dwordx4 v4, s[12:15], s53 offen lds
  s_add_u32 m0, s50, 82944
  s_mov_b32 s53, 1769728
  buffer_load_dwordx4 v5, s[12:15], s53 offen lds
  s_waitcnt lgkmcnt(6)
  v_mfma_f32_16x16x32_bf16 v[64:67], v[16:19], v[32:35], v[64:67]
  v_mfma_f32_16x16x32_bf16 v[68:71], v[16:19], v[36:39], v[68:71]
  s_waitcnt lgkmcnt(4)
  v_mfma_f32_16x16x32_bf16 v[72:75], v[20:23], v[32:35], v[72:75]
  v_mfma_f32_16x16x32_bf16 v[76:79], v[20:23], v[36:39], v[76:79]
  s_waitcnt lgkmcnt(2)
  v_mfma_f32_16x16x32_bf16 v[80:83], v[24:27], v[32:35], v[80:83]
  v_mfma_f32_16x16x32_bf16 v[84:87], v[24:27], v[36:39], v[84:87]
  s_waitcnt lgkmcnt(0)
  v_mfma_f32_16x16x32_bf16 v[88:91], v[28:31], v[32:35], v[88:91]
  v_mfma_f32_16x16x32_bf16 v[92:95], v[28:31], v[36:39], v[92:95]
  s_waitcnt vmcnt(12)
  s_barrier
  v_add_u32 v8, 131072, v6
  v_add_u32 v11, 131072, v7
  ds_read_b128 v[32:35], v11 offset:0
  ds_read_b128 v[36:39], v11 offset:4096
  v_xor_b32 v12, 0, v8
  ds_read_b64_tr_b16 v[16:17], v12
  ds_read_b64_tr_b16 v[18:19], v12 offset:512
  v_xor_b32 v13, 32, v8
  ds_read_b64_tr_b16 v[20:21], v13
  ds_read_b64_tr_b16 v[22:23], v13 offset:512
  v_xor_b32 v14, 64, v8
  ds_read_b64_tr_b16 v[24:25], v14
  ds_read_b64_tr_b16 v[26:27], v14 offset:512
  v_xor_b32 v15, 96, v8
  ds_read_b64_tr_b16 v[28:29], v15
  ds_read_b64_tr_b16 v[30:31], v15 offset:512
  s_add_u32 m0, s50, 98304
  s_mov_b32 s53, 131072
  buffer_load_dwordx4 v2, s[12:15], s53 offen lds
  s_add_u32 m0, s50, 99328
  s_mov_b32 s53, 131072
  buffer_load_dwordx4 v3, s[12:15], s53 offen lds
  s_add_u32 m0, s50, 114688
  s_mov_b32 s53, 2359296
  buffer_load_dwordx4 v4, s[12:15], s53 offen lds
  s_add_u32 m0, s50, 115712
  s_mov_b32 s53, 2359296
  buffer_load_dwordx4 v5, s[12:15], s53 offen lds
  s_waitcnt lgkmcnt(6)
  v_mfma_f32_16x16x32_bf16 v[64:67], v[16:19], v[32:35], v[64:67]
  v_mfma_f32_16x16x32_bf16 v[68:71], v[16:19], v[36:39], v[68:71]
  s_waitcnt lgkmcnt(4)
  v_mfma_f32_16x16x32_bf16 v[72:75], v[20:23], v[32:35], v[72:75]
  v_mfma_f32_16x16x32_bf16 v[76:79], v[20:23], v[36:39], v[76:79]
  s_waitcnt lgkmcnt(2)
  v_mfma_f32_16x16x32_bf16 v[80:83], v[24:27], v[32:35], v[80:83]
  v_mfma_f32_16x16x32_bf16 v[84:87], v[24:27], v[36:39], v[84:87]
  s_waitcnt lgkmcnt(0)
  v_mfma_f32_16x16x32_bf16 v[88:91], v[28:31], v[32:35], v[88:91]
  v_mfma_f32_16x16x32_bf16 v[92:95], v[28:31], v[36:39], v[92:95]
  s_waitcnt vmcnt(12)
  s_barrier
  v_add_u32 v8, 0, v6
  v_add_u32 v11, 0, v7
  ds_read_b128 v[32:35], v11 offset:0
  ds_read_b128 v[36:39], v11 offset:4096
  v_xor_b32 v12, 0, v8
  ds_read_b64_tr_b16 v[16:17], v12
  ds_read_b64_tr_b16 v[18:19], v12 offset:512
  v_xor_b32 v13, 32, v8
  ds_read_b64_tr_b16 v[20:21], v13
  ds_read_b64_tr_b16 v[22:23], v13 offset:512
  v_xor_b32 v14, 64, v8
  ds_read_b64_tr_b16 v[24:25], v14
  ds_read_b64_tr_b16 v[26:27], v14 offset:512
  v_xor_b32 v15, 96, v8
  ds_read_b64_tr_b16 v[28:29], v15
  ds_read_b64_tr_b16 v[30:31], v15 offset:512
  s_add_u32 m0, s50, 131072
  s_mov_b32 s53, 147456
  buffer_load_dwordx4 v2, s[12:15], s53 offen lds
  s_add_u32 m0, s50, 132096
  s_mov_b32 s53, 147456
  buffer_load_dwordx4 v3, s[12:15], s53 offen lds
  s_add_u32 m0, s50, 147456
  s_mov_b32 s53, 2359552
  buffer_load_dwordx4 v4, s[12:15], s53 offen lds
  s_add_u32 m0, s50, 148480
  s_mov_b32 s53, 2359552
  buffer_load_dwordx4 v5, s[12:15], s53 offen lds
  s_waitcnt lgkmcnt(6)
  v_mfma_f32_16x16x32_bf16 v[64:67], v[16:19], v[32:35], v[64:67]
  v_mfma_f32_16x16x32_bf16 v[68:71], v[16:19], v[36:39], v[68:71]
  s_waitcnt lgkmcnt(4)
  v_mfma_f32_16x16x32_bf16 v[72:75], v[20:23], v[32:35], v[72:75]
  v_mfma_f32_16x16x32_bf16 v[76:79], v[20:23], v[36:39], v[76:79]
  s_waitcnt lgkmcnt(2)
  v_mfma_f32_16x16x32_bf16 v[80:83], v[24:27], v[32:35], v[80:83]
  v_mfma_f32_16x16x32_bf16 v[84:87], v[24:27], v[36:39], v[84:87]
  s_waitcnt lgkmcnt(0)
  v_mfma_f32_16x16x32_bf16 v[88:91], v[28:31], v[32:35], v[88:91]
  v_mfma_f32_16x16x32_bf16 v[92:95], v[28:31], v[36:39], v[92:95]
  s_waitcnt vmcnt(12)
  s_barrier
  v_add_u32 v8, 32768, v6
  v_add_u32 v11, 32768, v7
  ds_read_b128 v[32:35], v11 offset:0
  ds_read_b128 v[36:39], v11 offset:4096
  v_xor_b32 v12, 0, v8
  ds_read_b64_tr_b16 v[16:17], v12
  ds_read_b64_tr_b16 v[18:19], v12 offset:512
  v_xor_b32 v13, 32, v8
  ds_read_b64_tr_b16 v[20:21], v13
  ds_read_b64_tr_b16 v[22:23], v13 offset:512
  v_xor_b32 v14, 64, v8
  ds_read_b64_tr_b16 v[24:25], v14
  ds_read_b64_tr_b16 v[26:27], v14 offset:512
  v_xor_b32 v15, 96, v8
  ds_read_b64_tr_b16 v[28:29], v15
  ds_read_b64_tr_b16 v[30:31], v15 offset:512
  s_add_u32 m0, s50, 0
  s_mov_b32 s53, 163840
  buffer_load_dwordx4 v2, s[12:15], s53 offen lds
  s_add_u32 m0, s50, 1024
  s_mov_b32 s53, 163840
  buffer_load_dwordx4 v3, s[12:15], s53 offen lds
  s_add_u32 m0, s50, 16384
  s_mov_b32 s53, 2949120
  buffer_load_dwordx4 v4, s[12:15], s53 offen lds
  s_add_u32 m0, s50, 17408
  s_mov_b32 s53, 2949120
  buffer_load_dwordx4 v5, s[12:15], s53 offen lds
  s_waitcnt lgkmcnt(6)
  v_mfma_f32_16x16x32_bf16 v[64:67], v[16:19], v[32:35], v[64:67]
  v_mfma_f32_16x16x32_bf16 v[68:71], v[16:19], v[36:39], v[68:71]
  s_waitcnt lgkmcnt(4)
  v_mfma_f32_16x16x32_bf16 v[72:75], v[20:23], v[32:35], v[72:75]
  v_mfma_f32_16x16x32_bf16 v[76:79], v[20:23], v[36:39], v[76:79]
  s_waitcnt lgkmcnt(2)
  v_mfma_f32_16x16x32_bf16 v[80:83], v[24:27], v[32:35], v[80:83]
  v_mfma_f32_16x16x32_bf16 v[84:87], v[24:27], v[36:39], v[84:87]
  s_waitcnt lgkmcnt(0)
  v_mfma_f32_16x16x32_bf16 v[88:91], v[28:31], v[32:35], v[88:91]
  v_mfma_f32_16x16x32_bf16 v[92:95], v[28:31], v[36:39], v[92:95]
  s_waitcnt vmcnt(12)
  s_barrier
  v_add_u32 v8, 65536, v6
  v_add_u32 v11, 65536, v7
  ds_read_b128 v[32:35], v11 offset:0
  ds_read_b128 v[36:39], v11 offset:4096
  v_xor_b32 v12, 0, v8
  ds_read_b64_tr_b16 v[16:17], v12
  ds_read_b64_tr_b16 v[18:19], v12 offset:512
  v_xor_b32 v13, 32, v8
  ds_read_b64_tr_b16 v[20:21], v13
  ds_read_b64_tr_b16 v[22:23], v13 offset:512
  v_xor_b32 v14, 64, v8
  ds_read_b64_tr_b16 v[24:25], v14
  ds_read_b64_tr_b16 v[26:27], v14 offset:512
  v_xor_b32 v15, 96, v8
  ds_read_b64_tr_b16 v[28:29], v15
  ds_read_b64_tr_b16 v[30:31], v15 offset:512
  s_add_u32 m0, s50, 32768
  s_mov_b32 s53, 180224
  buffer_load_dwordx4 v2, s[12:15], s53 offen lds
  s_add_u32 m0, s50, 33792
  s_mov_b32 s53, 180224
  buffer_load_dwordx4 v3, s[12:15], s53 offen lds
  s_add_u32 m0, s50, 49152
  s_mov_b32 s53, 2949376
  buffer_load_dwordx4 v4, s[12:15], s53 offen lds
  s_add_u32 m0, s50, 50176
  s_mov_b32 s53, 2949376
  buffer_load_dwordx4 v5, s[12:15], s53 offen lds
  s_waitcnt lgkmcnt(6)
  v_mfma_f32_16x16x32_bf16 v[64:67], v[16:19], v[32:35], v[64:67]
  v_mfma_f32_16x16x32_bf16 v[68:71], v[16:19], v[36:39], v[68:71]
  s_waitcnt lgkmcnt(4)
  v_mfma_f32_16x16x32_bf16 v[72:75], v[20:23], v[32:35], v[72:75]
  v_mfma_f32_16x16x32_bf16 v[76:79], v[20:23], v[36:39], v[76:79]
  s_waitcnt lgkmcnt(2)
  v_mfma_f32_16x16x32_bf16 v[80:83], v[24:27], v[32:35], v[80:83]
  v_mfma_f32_16x16x32_bf16 v[84:87], v[24:27], v[36:39], v[84:87]
  s_waitcnt lgkmcnt(0)
  v_mfma_f32_16x16x32_bf16 v[88:91], v[28:31], v[32:35], v[88:91]
  v_mfma_f32_16x16x32_bf16 v[92:95], v[28:31], v[36:39], v[92:95]
  s_waitcnt vmcnt(12)
  s_barrier
  v_add_u32 v8, 98304, v6
  v_add_u32 v11, 98304, v7
  ds_read_b128 v[32:35], v11 offset:0
  ds_read_b128 v[36:39], v11 offset:4096
  v_xor_b32 v12, 0, v8
  ds_read_b64_tr_b16 v[16:17], v12
  ds_read_b64_tr_b16 v[18:19], v12 offset:512
  v_xor_b32 v13, 32, v8
  ds_read_b64_tr_b16 v[20:21], v13
  ds_read_b64_tr_b16 v[22:23], v13 offset:512
  v_xor_b32 v14, 64, v8
  ds_read_b64_tr_b16 v[24:25], v14
  ds_read_b64_tr_b16 v[26:27], v14 offset:512
  v_xor_b32 v15, 96, v8
  ds_read_b64_tr_b16 v[28:29], v15
  ds_read_b64_tr_b16 v[30:31], v15 offset:512
  s_add_u32 m0, s50, 65536
  s_mov_b32 s53, 196608
  buffer_load_dwordx4 v2, s[12:15], s53 offen lds
  s_add_u32 m0, s50, 66560
  s_mov_b32 s53, 196608
  buffer_load_dwordx4 v3, s[12:15], s53 offen lds
  s_add_u32 m0, s50, 81920
  s_mov_b32 s53, 3538944
  buffer_load_dwordx4 v4, s[12:15], s53 offen lds
  s_add_u32 m0, s50, 82944
  s_mov_b32 s53, 3538944
  buffer_load_dwordx4 v5, s[12:15], s53 offen lds
  s_waitcnt lgkmcnt(6)
  v_mfma_f32_16x16x32_bf16 v[64:67], v[16:19], v[32:35], v[64:67]
  v_mfma_f32_16x16x32_bf16 v[68:71], v[16:19], v[36:39], v[68:71]
  s_waitcnt lgkmcnt(4)
  v_mfma_f32_16x16x32_bf16 v[72:75], v[20:23], v[32:35], v[72:75]
  v_mfma_f32_16x16x32_bf16 v[76:79], v[20:23], v[36:39], v[76:79]
  s_waitcnt lgkmcnt(2)
  v_mfma_f32_16x16x32_bf16 v[80:83], v[24:27], v[32:35], v[80:83]
  v_mfma_f32_16x16x32_bf16 v[84:87], v[24:27], v[36:39], v[84:87]
  s_waitcnt lgkmcnt(0)
  v_mfma_f32_16x16x32_bf16 v[88:91], v[28:31], v[32:35], v[88:91]
  v_mfma_f32_16x16x32_bf16 v[92:95], v[28:31], v[36:39], v[92:95]
  s_waitcnt vmcnt(12)
  s_barrier
  v_add_u32 v8, 131072, v6
  v_add_u32 v11, 131072, v7
  ds_read_b128 v[32:35], v11 offset:0
  ds_read_b128 v[36:39], v11 offset:4096
  v_xor_b32 v12, 0, v8
  ds_read_b64_tr_b16 v[16:17], v12
  ds_read_b64_tr_b16 v[18:19], v12 offset:512
  v_xor_b32 v13, 32, v8
  ds_read_b64_tr_b16 v[20:21], v13
  ds_read_b64_tr_b16 v[22:23], v13 offset:512
  v_xor_b32 v14, 64, v8
  ds_read_b64_tr_b16 v[24:25], v14
  ds_read_b64_tr_b16 v[26:27], v14 offset:512
  v_xor_b32 v15, 96, v8
  ds_read_b64_tr_b16 v[28:29], v15
  ds_read_b64_tr_b16 v[30:31], v15 offset:512
  s_add_u32 m0, s50, 98304
  s_mov_b32 s53, 212992
  buffer_load_dwordx4 v2, s[12:15], s53 offen lds
  s_add_u32 m0, s50, 99328
  s_mov_b32 s53, 212992
  buffer_load_dwordx4 v3, s[12:15], s53 offen lds
  s_add_u32 m0, s50, 114688
  s_mov_b32 s53, 3539200
  buffer_load_dwordx4 v4, s[12:15], s53 offen lds
  s_add_u32 m0, s50, 115712
  s_mov_b32 s53, 3539200
  buffer_load_dwordx4 v5, s[12:15], s53 offen lds
  s_waitcnt lgkmcnt(6)
  v_mfma_f32_16x16x32_bf16 v[64:67], v[16:19], v[32:35], v[64:67]
  v_mfma_f32_16x16x32_bf16 v[68:71], v[16:19], v[36:39], v[68:71]
  s_waitcnt lgkmcnt(4)
  v_mfma_f32_16x16x32_bf16 v[72:75], v[20:23], v[32:35], v[72:75]
  v_mfma_f32_16x16x32_bf16 v[76:79], v[20:23], v[36:39], v[76:79]
  s_waitcnt lgkmcnt(2)
  v_mfma_f32_16x16x32_bf16 v[80:83], v[24:27], v[32:35], v[80:83]
  v_mfma_f32_16x16x32_bf16 v[84:87], v[24:27], v[36:39], v[84:87]
  s_waitcnt lgkmcnt(0)
  v_mfma_f32_16x16x32_bf16 v[88:91], v[28:31], v[32:35], v[88:91]
  v_mfma_f32_16x16x32_bf16 v[92:95], v[28:31], v[36:39], v[92:95]
  s_waitcnt vmcnt(12)
  s_barrier
  v_add_u32 v8, 0, v6
  v_add_u32 v11, 0, v7
  ds_read_b128 v[32:35], v11 offset:0
  ds_read_b128 v[36:39], v11 offset:4096
  v_xor_b32 v12, 0, v8
  ds_read_b64_tr_b16 v[16:17], v12
  ds_read_b64_tr_b16 v[18:19], v12 offset:512
  v_xor_b32 v13, 32, v8
  ds_read_b64_tr_b16 v[20:21], v13
  ds_read_b64_tr_b16 v[22:23], v13 offset:512
  v_xor_b32 v14, 64, v8
  ds_read_b64_tr_b16 v[24:25], v14
  ds_read_b64_tr_b16 v[26:27], v14 offset:512
  v_xor_b32 v15, 96, v8
  ds_read_b64_tr_b16 v[28:29], v15
  ds_read_b64_tr_b16 v[30:31], v15 offset:512
  s_add_u32 m0, s50, 131072
  s_mov_b32 s53, 229376
  buffer_load_dwordx4 v2, s[12:15], s53 offen lds
  s_add_u32 m0, s50, 132096
  s_mov_b32 s53, 229376
  buffer_load_dwordx4 v3, s[12:15], s53 offen lds
  s_add_u32 m0, s50, 147456
  s_mov_b32 s53, 4128768
  buffer_load_dwordx4 v4, s[12:15], s53 offen lds
  s_add_u32 m0, s50, 148480
  s_mov_b32 s53, 4128768
  buffer_load_dwordx4 v5, s[12:15], s53 offen lds
  s_waitcnt lgkmcnt(6)
  v_mfma_f32_16x16x32_bf16 v[64:67], v[16:19], v[32:35], v[64:67]
  v_mfma_f32_16x16x32_bf16 v[68:71], v[16:19], v[36:39], v[68:71]
  s_waitcnt lgkmcnt(4)
  v_mfma_f32_16x16x32_bf16 v[72:75], v[20:23], v[32:35], v[72:75]
  v_mfma_f32_16x16x32_bf16 v[76:79], v[20:23], v[36:39], v[76:79]
  s_waitcnt lgkmcnt(2)
  v_mfma_f32_16x16x32_bf16 v[80:83], v[24:27], v[32:35], v[80:83]
  v_mfma_f32_16x16x32_bf16 v[84:87], v[24:27], v[36:39], v[84:87]
  s_waitcnt lgkmcnt(0)
  v_mfma_f32_16x16x32_bf16 v[88:91], v[28:31], v[32:35], v[88:91]
  v_mfma_f32_16x16x32_bf16 v[92:95], v[28:31], v[36:39], v[92:95]
  s_waitcnt vmcnt(12)
  s_barrier
  v_add_u32 v8, 32768, v6
  v_add_u32 v11, 32768, v7
  ds_read_b128 v[32:35], v11 offset:0
  ds_read_b128 v[36:39], v11 offset:4096
  v_xor_b32 v12, 0, v8
  ds_read_b64_tr_b16 v[16:17], v12
  ds_read_b64_tr_b16 v[18:19], v12 offset:512
  v_xor_b32 v13, 32, v8
  ds_read_b64_tr_b16 v[20:21], v13
  ds_read_b64_tr_b16 v[22:23], v13 offset:512
  v_xor_b32 v14, 64, v8
  ds_read_b64_tr_b16 v[24:25], v14
  ds_read_b64_tr_b16 v[26:27], v14 offset:512
  v_xor_b32 v15, 96, v8
  ds_read_b64_tr_b16 v[28:29], v15
  ds_read_b64_tr_b16 v[30:31], v15 offset:512
  s_add_u32 m0, s50, 0
  s_mov_b32 s53, 245760
  buffer_load_dwordx4 v2, s[12:15], s53 offen lds
  s_add_u32 m0, s50, 1024
  s_mov_b32 s53, 245760
  buffer_load_dwordx4 v3, s[12:15], s53 offen lds
  s_add_u32 m0, s50, 16384
  s_mov_b32 s53, 4129024
  buffer_load_dwordx4 v4, s[12:15], s53 offen lds
  s_add_u32 m0, s50, 17408
  s_mov_b32 s53, 4129024
  buffer_load_dwordx4 v5, s[12:15], s53 offen lds
  s_waitcnt lgkmcnt(6)
  v_mfma_f32_16x16x32_bf16 v[64:67], v[16:19], v[32:35], v[64:67]
  v_mfma_f32_16x16x32_bf16 v[68:71], v[16:19], v[36:39], v[68:71]
  s_waitcnt lgkmcnt(4)
  v_mfma_f32_16x16x32_bf16 v[72:75], v[20:23], v[32:35], v[72:75]
  v_mfma_f32_16x16x32_bf16 v[76:79], v[20:23], v[36:39], v[76:79]
  s_waitcnt lgkmcnt(2)
  v_mfma_f32_16x16x32_bf16 v[80:83], v[24:27], v[32:35], v[80:83]
  v_mfma_f32_16x16x32_bf16 v[84:87], v[24:27], v[36:39], v[84:87]
  s_waitcnt lgkmcnt(0)
  v_mfma_f32_16x16x32_bf16 v[88:91], v[28:31], v[32:35], v[88:91]
  v_mfma_f32_16x16x32_bf16 v[92:95], v[28:31], v[36:39], v[92:95]
  s_waitcnt vmcnt(12)
  s_barrier
  v_add_u32 v8, 65536, v6
  v_add_u32 v11, 65536, v7
  ds_read_b128 v[32:35], v11 offset:0
  ds_read_b128 v[36:39], v11 offset:4096
  v_xor_b32 v12, 0, v8
  ds_read_b64_tr_b16 v[16:17], v12
  ds_read_b64_tr_b16 v[18:19], v12 offset:512
  v_xor_b32 v13, 32, v8
  ds_read_b64_tr_b16 v[20:21], v13
  ds_read_b64_tr_b16 v[22:23], v13 offset:512
  v_xor_b32 v14, 64, v8
  ds_read_b64_tr_b16 v[24:25], v14
  ds_read_b64_tr_b16 v[26:27], v14 offset:512
  v_xor_b32 v15, 96, v8
  ds_read_b64_tr_b16 v[28:29], v15
  ds_read_b64_tr_b16 v[30:31], v15 offset:512
  s_add_u32 m0, s50, 32768
  s_mov_b32 s53, 262144
  buffer_load_dwordx4 v2, s[12:15], s53 offen lds
  s_add_u32 m0, s50, 33792
  s_mov_b32 s53, 262144
  buffer_load_dwordx4 v3, s[12:15], s53 offen lds
  s_add_u32 m0, s50, 49152
  s_mov_b32 s53, 4718592
  buffer_load_dwordx4 v4, s[12:15], s53 offen lds
  s_add_u32 m0, s50, 50176
  s_mov_b32 s53, 4718592
  buffer_load_dwordx4 v5, s[12:15], s53 offen lds
  s_waitcnt lgkmcnt(6)
  v_mfma_f32_16x16x32_bf16 v[64:67], v[16:19], v[32:35], v[64:67]
  v_mfma_f32_16x16x32_bf16 v[68:71], v[16:19], v[36:39], v[68:71]
  s_waitcnt lgkmcnt(4)
  v_mfma_f32_16x16x32_bf16 v[72:75], v[20:23], v[32:35], v[72:75]
  v_mfma_f32_16x16x32_bf16 v[76:79], v[20:23], v[36:39], v[76:79]
  s_waitcnt lgkmcnt(2)
  v_mfma_f32_16x16x32_bf16 v[80:83], v[24:27], v[32:35], v[80:83]
  v_mfma_f32_16x16x32_bf16 v[84:87], v[24:27], v[36:39], v[84:87]
  s_waitcnt lgkmcnt(0)
  v_mfma_f32_16x16x32_bf16 v[88:91], v[28:31], v[32:35], v[88:91]
  v_mfma_f32_16x16x32_bf16 v[92:95], v[28:31], v[36:39], v[92:95]
  s_waitcnt vmcnt(12)
  s_barrier
  v_add_u32 v8, 98304, v6
  v_add_u32 v11, 98304, v7
  ds_read_b128 v[32:35], v11 offset:0
  ds_read_b128 v[36:39], v11 offset:4096
  v_xor_b32 v12, 0, v8
  ds_read_b64_tr_b16 v[16:17], v12
  ds_read_b64_tr_b16 v[18:19], v12 offset:512
  v_xor_b32 v13, 32, v8
  ds_read_b64_tr_b16 v[20:21], v13
  ds_read_b64_tr_b16 v[22:23], v13 offset:512
  v_xor_b32 v14, 64, v8
  ds_read_b64_tr_b16 v[24:25], v14
  ds_read_b64_tr_b16 v[26:27], v14 offset:512
  v_xor_b32 v15, 96, v8
  ds_read_b64_tr_b16 v[28:29], v15
  ds_read_b64_tr_b16 v[30:31], v15 offset:512
  s_add_u32 m0, s50, 65536
  s_mov_b32 s53, 278528
  buffer_load_dwordx4 v2, s[12:15], s53 offen lds
  s_add_u32 m0, s50, 66560
  s_mov_b32 s53, 278528
  buffer_load_dwordx4 v3, s[12:15], s53 offen lds
  s_add_u32 m0, s50, 81920
  s_mov_b32 s53, 4718848
  buffer_load_dwordx4 v4, s[12:15], s53 offen lds
  s_add_u32 m0, s50, 82944
  s_mov_b32 s53, 4718848
  buffer_load_dwordx4 v5, s[12:15], s53 offen lds
  s_waitcnt lgkmcnt(6)
  v_mfma_f32_16x16x32_bf16 v[64:67], v[16:19], v[32:35], v[64:67]
  v_mfma_f32_16x16x32_bf16 v[68:71], v[16:19], v[36:39], v[68:71]
  s_waitcnt lgkmcnt(4)
  v_mfma_f32_16x16x32_bf16 v[72:75], v[20:23], v[32:35], v[72:75]
  v_mfma_f32_16x16x32_bf16 v[76:79], v[20:23], v[36:39], v[76:79]
  s_waitcnt lgkmcnt(2)
  v_mfma_f32_16x16x32_bf16 v[80:83], v[24:27], v[32:35], v[80:83]
  v_mfma_f32_16x16x32_bf16 v[84:87], v[24:27], v[36:39], v[84:87]
  s_waitcnt lgkmcnt(0)
  v_mfma_f32_16x16x32_bf16 v[88:91], v[28:31], v[32:35], v[88:91]
  v_mfma_f32_16x16x32_bf16 v[92:95], v[28:31], v[36:39], v[92:95]
  s_waitcnt vmcnt(12)
  s_barrier
  v_add_u32 v8, 131072, v6
  v_add_u32 v11, 131072, v7
  ds_read_b128 v[32:35], v11 offset:0
  ds_read_b128 v[36:39], v11 offset:4096
  v_xor_b32 v12, 0, v8
  ds_read_b64_tr_b16 v[16:17], v12
  ds_read_b64_tr_b16 v[18:19], v12 offset:512
  v_xor_b32 v13, 32, v8
  ds_read_b64_tr_b16 v[20:21], v13
  ds_read_b64_tr_b16 v[22:23], v13 offset:512
  v_xor_b32 v14, 64, v8
  ds_read_b64_tr_b16 v[24:25], v14
  ds_read_b64_tr_b16 v[26:27], v14 offset:512
  v_xor_b32 v15, 96, v8
  ds_read_b64_tr_b16 v[28:29], v15
  ds_read_b64_tr_b16 v[30:31], v15 offset:512
  s_add_u32 m0, s50, 98304
  s_mov_b32 s53, 294912
  buffer_load_dwordx4 v2, s[12:15], s53 offen lds
  s_add_u32 m0, s50, 99328
  s_mov_b32 s53, 294912
  buffer_load_dwordx4 v3, s[12:15], s53 offen lds
  s_add_u32 m0, s50, 114688
  s_mov_b32 s53, 5308416
  buffer_load_dwordx4 v4, s[12:15], s53 offen lds
  s_add_u32 m0, s50, 115712
  s_mov_b32 s53, 5308416
  buffer_load_dwordx4 v5, s[12:15], s53 offen lds
  s_waitcnt lgkmcnt(6)
  v_mfma_f32_16x16x32_bf16 v[64:67], v[16:19], v[32:35], v[64:67]
  v_mfma_f32_16x16x32_bf16 v[68:71], v[16:19], v[36:39], v[68:71]
  s_waitcnt lgkmcnt(4)
  v_mfma_f32_16x16x32_bf16 v[72:75], v[20:23], v[32:35], v[72:75]
  v_mfma_f32_16x16x32_bf16 v[76:79], v[20:23], v[36:39], v[76:79]
  s_waitcnt lgkmcnt(2)
  v_mfma_f32_16x16x32_bf16 v[80:83], v[24:27], v[32:35], v[80:83]
  v_mfma_f32_16x16x32_bf16 v[84:87], v[24:27], v[36:39], v[84:87]
  s_waitcnt lgkmcnt(0)
  v_mfma_f32_16x16x32_bf16 v[88:91], v[28:31], v[32:35], v[88:91]
  v_mfma_f32_16x16x32_bf16 v[92:95], v[28:31], v[36:39], v[92:95]
  s_waitcnt vmcnt(12)
  s_barrier
  v_add_u32 v8, 0, v6
  v_add_u32 v11, 0, v7
  ds_read_b128 v[32:35], v11 offset:0
  ds_read_b128 v[36:39], v11 offset:4096
  v_xor_b32 v12, 0, v8
  ds_read_b64_tr_b16 v[16:17], v12
  ds_read_b64_tr_b16 v[18:19], v12 offset:512
  v_xor_b32 v13, 32, v8
  ds_read_b64_tr_b16 v[20:21], v13
  ds_read_b64_tr_b16 v[22:23], v13 offset:512
  v_xor_b32 v14, 64, v8
  ds_read_b64_tr_b16 v[24:25], v14
  ds_read_b64_tr_b16 v[26:27], v14 offset:512
  v_xor_b32 v15, 96, v8
  ds_read_b64_tr_b16 v[28:29], v15
  ds_read_b64_tr_b16 v[30:31], v15 offset:512
  s_add_u32 m0, s50, 131072
  s_mov_b32 s53, 311296
  buffer_load_dwordx4 v2, s[12:15], s53 offen lds
  s_add_u32 m0, s50, 132096
  s_mov_b32 s53, 311296
  buffer_load_dwordx4 v3, s[12:15], s53 offen lds
  s_add_u32 m0, s50, 147456
  s_mov_b32 s53, 5308672
  buffer_load_dwordx4 v4, s[12:15], s53 offen lds
  s_add_u32 m0, s50, 148480
  s_mov_b32 s53, 5308672
  buffer_load_dwordx4 v5, s[12:15], s53 offen lds
  s_waitcnt lgkmcnt(6)
  v_mfma_f32_16x16x32_bf16 v[64:67], v[16:19], v[32:35], v[64:67]
  v_mfma_f32_16x16x32_bf16 v[68:71], v[16:19], v[36:39], v[68:71]
  s_waitcnt lgkmcnt(4)
  v_mfma_f32_16x16x32_bf16 v[72:75], v[20:23], v[32:35], v[72:75]
  v_mfma_f32_16x16x32_bf16 v[76:79], v[20:23], v[36:39], v[76:79]
  s_waitcnt lgkmcnt(2)
  v_mfma_f32_16x16x32_bf16 v[80:83], v[24:27], v[32:35], v[80:83]
  v_mfma_f32_16x16x32_bf16 v[84:87], v[24:27], v[36:39], v[84:87]
  s_waitcnt lgkmcnt(0)
  v_mfma_f32_16x16x32_bf16 v[88:91], v[28:31], v[32:35], v[88:91]
  v_mfma_f32_16x16x32_bf16 v[92:95], v[28:31], v[36:39], v[92:95]
  s_waitcnt vmcnt(12)
  s_barrier
  v_add_u32 v8, 32768, v6
  v_add_u32 v11, 32768, v7
  ds_read_b128 v[32:35], v11 offset:0
  ds_read_b128 v[36:39], v11 offset:4096
  v_xor_b32 v12, 0, v8
  ds_read_b64_tr_b16 v[16:17], v12
  ds_read_b64_tr_b16 v[18:19], v12 offset:512
  v_xor_b32 v13, 32, v8
  ds_read_b64_tr_b16 v[20:21], v13
  ds_read_b64_tr_b16 v[22:23], v13 offset:512
  v_xor_b32 v14, 64, v8
  ds_read_b64_tr_b16 v[24:25], v14
  ds_read_b64_tr_b16 v[26:27], v14 offset:512
  v_xor_b32 v15, 96, v8
  ds_read_b64_tr_b16 v[28:29], v15
  ds_read_b64_tr_b16 v[30:31], v15 offset:512
  s_add_u32 m0, s50, 0
  s_mov_b32 s53, 327680
  buffer_load_dwordx4 v2, s[12:15], s53 offen lds
  s_add_u32 m0, s50, 1024
  s_mov_b32 s53, 327680
  buffer_load_dwordx4 v3, s[12:15], s53 offen lds
  s_add_u32 m0, s50, 16384
  s_mov_b32 s53, 5898240
  buffer_load_dwordx4 v4, s[12:15], s53 offen lds
  s_add_u32 m0, s50, 17408
  s_mov_b32 s53, 5898240
  buffer_load_dwordx4 v5, s[12:15], s53 offen lds
  s_waitcnt lgkmcnt(6)
  v_mfma_f32_16x16x32_bf16 v[64:67], v[16:19], v[32:35], v[64:67]
  v_mfma_f32_16x16x32_bf16 v[68:71], v[16:19], v[36:39], v[68:71]
  s_waitcnt lgkmcnt(4)
  v_mfma_f32_16x16x32_bf16 v[72:75], v[20:23], v[32:35], v[72:75]
  v_mfma_f32_16x16x32_bf16 v[76:79], v[20:23], v[36:39], v[76:79]
  s_waitcnt lgkmcnt(2)
  v_mfma_f32_16x16x32_bf16 v[80:83], v[24:27], v[32:35], v[80:83]
  v_mfma_f32_16x16x32_bf16 v[84:87], v[24:27], v[36:39], v[84:87]
  s_waitcnt lgkmcnt(0)
  v_mfma_f32_16x16x32_bf16 v[88:91], v[28:31], v[32:35], v[88:91]
  v_mfma_f32_16x16x32_bf16 v[92:95], v[28:31], v[36:39], v[92:95]
  s_waitcnt vmcnt(12)
  s_barrier
  v_add_u32 v8, 65536, v6
  v_add_u32 v11, 65536, v7
  ds_read_b128 v[32:35], v11 offset:0
  ds_read_b128 v[36:39], v11 offset:4096
  v_xor_b32 v12, 0, v8
  ds_read_b64_tr_b16 v[16:17], v12
  ds_read_b64_tr_b16 v[18:19], v12 offset:512
  v_xor_b32 v13, 32, v8
  ds_read_b64_tr_b16 v[20:21], v13
  ds_read_b64_tr_b16 v[22:23], v13 offset:512
  v_xor_b32 v14, 64, v8
  ds_read_b64_tr_b16 v[24:25], v14
  ds_read_b64_tr_b16 v[26:27], v14 offset:512
  v_xor_b32 v15, 96, v8
  ds_read_b64_tr_b16 v[28:29], v15
  ds_read_b64_tr_b16 v[30:31], v15 offset:512
  s_add_u32 m0, s50, 32768
  s_mov_b32 s53, 344064
  buffer_load_dwordx4 v2, s[12:15], s53 offen lds
  s_add_u32 m0, s50, 33792
  s_mov_b32 s53, 344064
  buffer_load_dwordx4 v3, s[12:15], s53 offen lds
  s_add_u32 m0, s50, 49152
  s_mov_b32 s53, 5898496
  buffer_load_dwordx4 v4, s[12:15], s53 offen lds
  s_add_u32 m0, s50, 50176
  s_mov_b32 s53, 5898496
  buffer_load_dwordx4 v5, s[12:15], s53 offen lds
  s_waitcnt lgkmcnt(6)
  v_mfma_f32_16x16x32_bf16 v[64:67], v[16:19], v[32:35], v[64:67]
  v_mfma_f32_16x16x32_bf16 v[68:71], v[16:19], v[36:39], v[68:71]
  s_waitcnt lgkmcnt(4)
  v_mfma_f32_16x16x32_bf16 v[72:75], v[20:23], v[32:35], v[72:75]
  v_mfma_f32_16x16x32_bf16 v[76:79], v[20:23], v[36:39], v[76:79]
  s_waitcnt lgkmcnt(2)
  v_mfma_f32_16x16x32_bf16 v[80:83], v[24:27], v[32:35], v[80:83]
  v_mfma_f32_16x16x32_bf16 v[84:87], v[24:27], v[36:39], v[84:87]
  s_waitcnt lgkmcnt(0)
  v_mfma_f32_16x16x32_bf16 v[88:91], v[28:31], v[32:35], v[88:91]
  v_mfma_f32_16x16x32_bf16 v[92:95], v[28:31], v[36:39], v[92:95]
  s_waitcnt vmcnt(12)
  s_barrier
  v_add_u32 v8, 98304, v6
  v_add_u32 v11, 98304, v7
  ds_read_b128 v[32:35], v11 offset:0
  ds_read_b128 v[36:39], v11 offset:4096
  v_xor_b32 v12, 0, v8
  ds_read_b64_tr_b16 v[16:17], v12
  ds_read_b64_tr_b16 v[18:19], v12 offset:512
  v_xor_b32 v13, 32, v8
  ds_read_b64_tr_b16 v[20:21], v13
  ds_read_b64_tr_b16 v[22:23], v13 offset:512
  v_xor_b32 v14, 64, v8
  ds_read_b64_tr_b16 v[24:25], v14
  ds_read_b64_tr_b16 v[26:27], v14 offset:512
  v_xor_b32 v15, 96, v8
  ds_read_b64_tr_b16 v[28:29], v15
  ds_read_b64_tr_b16 v[30:31], v15 offset:512
  s_add_u32 m0, s50, 65536
  s_mov_b32 s53, 360448
  buffer_load_dwordx4 v2, s[12:15], s53 offen lds
  s_add_u32 m0, s50, 66560
  s_mov_b32 s53, 360448
  buffer_load_dwordx4 v3, s[12:15], s53 offen lds
  s_add_u32 m0, s50, 81920
  s_mov_b32 s53, 6488064
  buffer_load_dwordx4 v4, s[12:15], s53 offen lds
  s_add_u32 m0, s50, 82944
  s_mov_b32 s53, 6488064
  buffer_load_dwordx4 v5, s[12:15], s53 offen lds
  s_waitcnt lgkmcnt(6)
  v_mfma_f32_16x16x32_bf16 v[64:67], v[16:19], v[32:35], v[64:67]
  v_mfma_f32_16x16x32_bf16 v[68:71], v[16:19], v[36:39], v[68:71]
  s_waitcnt lgkmcnt(4)
  v_mfma_f32_16x16x32_bf16 v[72:75], v[20:23], v[32:35], v[72:75]
  v_mfma_f32_16x16x32_bf16 v[76:79], v[20:23], v[36:39], v[76:79]
  s_waitcnt lgkmcnt(2)
  v_mfma_f32_16x16x32_bf16 v[80:83], v[24:27], v[32:35], v[80:83]
  v_mfma_f32_16x16x32_bf16 v[84:87], v[24:27], v[36:39], v[84:87]
  s_waitcnt lgkmcnt(0)
  v_mfma_f32_16x16x32_bf16 v[88:91], v[28:31], v[32:35], v[88:91]
  v_mfma_f32_16x16x32_bf16 v[92:95], v[28:31], v[36:39], v[92:95]
  s_waitcnt vmcnt(12)
  s_barrier
  v_add_u32 v8, 131072, v6
  v_add_u32 v11, 131072, v7
  ds_read_b128 v[32:35], v11 offset:0
  ds_read_b128 v[36:39], v11 offset:4096
  v_xor_b32 v12, 0, v8
  ds_read_b64_tr_b16 v[16:17], v12
  ds_read_b64_tr_b16 v[18:19], v12 offset:512
  v_xor_b32 v13, 32, v8
  ds_read_b64_tr_b16 v[20:21], v13
  ds_read_b64_tr_b16 v[22:23], v13 offset:512
  v_xor_b32 v14, 64, v8
  ds_read_b64_tr_b16 v[24:25], v14
  ds_read_b64_tr_b16 v[26:27], v14 offset:512
  v_xor_b32 v15, 96, v8
  ds_read_b64_tr_b16 v[28:29], v15
  ds_read_b64_tr_b16 v[30:31], v15 offset:512
  s_add_u32 m0, s50, 98304
  s_mov_b32 s53, 376832
  buffer_load_dwordx4 v2, s[12:15], s53 offen lds
  s_add_u32 m0, s50, 99328
  s_mov_b32 s53, 376832
  buffer_load_dwordx4 v3, s[12:15], s53 offen lds
  s_add_u32 m0, s50, 114688
  s_mov_b32 s53, 6488320
  buffer_load_dwordx4 v4, s[12:15], s53 offen lds
  s_add_u32 m0, s50, 115712
  s_mov_b32 s53, 6488320
  buffer_load_dwordx4 v5, s[12:15], s53 offen lds
  s_waitcnt lgkmcnt(6)
  v_mfma_f32_16x16x32_bf16 v[64:67], v[16:19], v[32:35], v[64:67]
  v_mfma_f32_16x16x32_bf16 v[68:71], v[16:19], v[36:39], v[68:71]
  s_waitcnt lgkmcnt(4)
  v_mfma_f32_16x16x32_bf16 v[72:75], v[20:23], v[32:35], v[72:75]
  v_mfma_f32_16x16x32_bf16 v[76:79], v[20:23], v[36:39], v[76:79]
  s_waitcnt lgkmcnt(2)
  v_mfma_f32_16x16x32_bf16 v[80:83], v[24:27], v[32:35], v[80:83]
  v_mfma_f32_16x16x32_bf16 v[84:87], v[24:27], v[36:39], v[84:87]
  s_waitcnt lgkmcnt(0)
  v_mfma_f32_16x16x32_bf16 v[88:91], v[28:31], v[32:35], v[88:91]
  v_mfma_f32_16x16x32_bf16 v[92:95], v[28:31], v[36:39], v[92:95]
  s_waitcnt vmcnt(12)
  s_barrier
  v_add_u32 v8, 0, v6
  v_add_u32 v11, 0, v7
  ds_read_b128 v[32:35], v11 offset:0
  ds_read_b128 v[36:39], v11 offset:4096
  v_xor_b32 v12, 0, v8
  ds_read_b64_tr_b16 v[16:17], v12
  ds_read_b64_tr_b16 v[18:19], v12 offset:512
  v_xor_b32 v13, 32, v8
  ds_read_b64_tr_b16 v[20:21], v13
  ds_read_b64_tr_b16 v[22:23], v13 offset:512
  v_xor_b32 v14, 64, v8
  ds_read_b64_tr_b16 v[24:25], v14
  ds_read_b64_tr_b16 v[26:27], v14 offset:512
  v_xor_b32 v15, 96, v8
  ds_read_b64_tr_b16 v[28:29], v15
  ds_read_b64_tr_b16 v[30:31], v15 offset:512
  s_add_u32 m0, s50, 131072
  s_mov_b32 s53, 393216
  buffer_load_dwordx4 v2, s[12:15], s53 offen lds
  s_add_u32 m0, s50, 132096
  s_mov_b32 s53, 393216
  buffer_load_dwordx4 v3, s[12:15], s53 offen lds
  s_add_u32 m0, s50, 147456
  s_mov_b32 s53, 7077888
  buffer_load_dwordx4 v4, s[12:15], s53 offen lds
  s_add_u32 m0, s50, 148480
  s_mov_b32 s53, 7077888
  buffer_load_dwordx4 v5, s[12:15], s53 offen lds
  s_waitcnt lgkmcnt(6)
  v_mfma_f32_16x16x32_bf16 v[64:67], v[16:19], v[32:35], v[64:67]
  v_mfma_f32_16x16x32_bf16 v[68:71], v[16:19], v[36:39], v[68:71]
  s_waitcnt lgkmcnt(4)
  v_mfma_f32_16x16x32_bf16 v[72:75], v[20:23], v[32:35], v[72:75]
  v_mfma_f32_16x16x32_bf16 v[76:79], v[20:23], v[36:39], v[76:79]
  s_waitcnt lgkmcnt(2)
  v_mfma_f32_16x16x32_bf16 v[80:83], v[24:27], v[32:35], v[80:83]
  v_mfma_f32_16x16x32_bf16 v[84:87], v[24:27], v[36:39], v[84:87]
  s_waitcnt lgkmcnt(0)
  v_mfma_f32_16x16x32_bf16 v[88:91], v[28:31], v[32:35], v[88:91]
  v_mfma_f32_16x16x32_bf16 v[92:95], v[28:31], v[36:39], v[92:95]
  s_waitcnt vmcnt(12)
  s_barrier
  v_add_u32 v8, 32768, v6
  v_add_u32 v11, 32768, v7
  ds_read_b128 v[32:35], v11 offset:0
  ds_read_b128 v[36:39], v11 offset:4096
  v_xor_b32 v12, 0, v8
  ds_read_b64_tr_b16 v[16:17], v12
  ds_read_b64_tr_b16 v[18:19], v12 offset:512
  v_xor_b32 v13, 32, v8
  ds_read_b64_tr_b16 v[20:21], v13
  ds_read_b64_tr_b16 v[22:23], v13 offset:512
  v_xor_b32 v14, 64, v8
  ds_read_b64_tr_b16 v[24:25], v14
  ds_read_b64_tr_b16 v[26:27], v14 offset:512
  v_xor_b32 v15, 96, v8
  ds_read_b64_tr_b16 v[28:29], v15
  ds_read_b64_tr_b16 v[30:31], v15 offset:512
  s_add_u32 m0, s50, 0
  s_mov_b32 s53, 409600
  buffer_load_dwordx4 v2, s[12:15], s53 offen lds
  s_add_u32 m0, s50, 1024
  s_mov_b32 s53, 409600
  buffer_load_dwordx4 v3, s[12:15], s53 offen lds
  s_add_u32 m0, s50, 16384
  s_mov_b32 s53, 7078144
  buffer_load_dwordx4 v4, s[12:15], s53 offen lds
  s_add_u32 m0, s50, 17408
  s_mov_b32 s53, 7078144
  buffer_load_dwordx4 v5, s[12:15], s53 offen lds
  s_waitcnt lgkmcnt(6)
  v_mfma_f32_16x16x32_bf16 v[64:67], v[16:19], v[32:35], v[64:67]
  v_mfma_f32_16x16x32_bf16 v[68:71], v[16:19], v[36:39], v[68:71]
  s_waitcnt lgkmcnt(4)
  v_mfma_f32_16x16x32_bf16 v[72:75], v[20:23], v[32:35], v[72:75]
  v_mfma_f32_16x16x32_bf16 v[76:79], v[20:23], v[36:39], v[76:79]
  s_waitcnt lgkmcnt(2)
  v_mfma_f32_16x16x32_bf16 v[80:83], v[24:27], v[32:35], v[80:83]
  v_mfma_f32_16x16x32_bf16 v[84:87], v[24:27], v[36:39], v[84:87]
  s_waitcnt lgkmcnt(0)
  v_mfma_f32_16x16x32_bf16 v[88:91], v[28:31], v[32:35], v[88:91]
  v_mfma_f32_16x16x32_bf16 v[92:95], v[28:31], v[36:39], v[92:95]
  s_waitcnt vmcnt(12)
  s_barrier
  v_add_u32 v8, 65536, v6
  v_add_u32 v11, 65536, v7
  ds_read_b128 v[32:35], v11 offset:0
  ds_read_b128 v[36:39], v11 offset:4096
  v_xor_b32 v12, 0, v8
  ds_read_b64_tr_b16 v[16:17], v12
  ds_read_b64_tr_b16 v[18:19], v12 offset:512
  v_xor_b32 v13, 32, v8
  ds_read_b64_tr_b16 v[20:21], v13
  ds_read_b64_tr_b16 v[22:23], v13 offset:512
  v_xor_b32 v14, 64, v8
  ds_read_b64_tr_b16 v[24:25], v14
  ds_read_b64_tr_b16 v[26:27], v14 offset:512
  v_xor_b32 v15, 96, v8
  ds_read_b64_tr_b16 v[28:29], v15
  ds_read_b64_tr_b16 v[30:31], v15 offset:512
  s_add_u32 m0, s50, 32768
  s_mov_b32 s53, 425984
  buffer_load_dwordx4 v2, s[12:15], s53 offen lds
  s_add_u32 m0, s50, 33792
  s_mov_b32 s53, 425984
  buffer_load_dwordx4 v3, s[12:15], s53 offen lds
  s_add_u32 m0, s50, 49152
  s_mov_b32 s53, 7667712
  buffer_load_dwordx4 v4, s[12:15], s53 offen lds
  s_add_u32 m0, s50, 50176
  s_mov_b32 s53, 7667712
  buffer_load_dwordx4 v5, s[12:15], s53 offen lds
  s_waitcnt lgkmcnt(6)
  v_mfma_f32_16x16x32_bf16 v[64:67], v[16:19], v[32:35], v[64:67]
  v_mfma_f32_16x16x32_bf16 v[68:71], v[16:19], v[36:39], v[68:71]
  s_waitcnt lgkmcnt(4)
  v_mfma_f32_16x16x32_bf16 v[72:75], v[20:23], v[32:35], v[72:75]
  v_mfma_f32_16x16x32_bf16 v[76:79], v[20:23], v[36:39], v[76:79]
  s_waitcnt lgkmcnt(2)
  v_mfma_f32_16x16x32_bf16 v[80:83], v[24:27], v[32:35], v[80:83]
  v_mfma_f32_16x16x32_bf16 v[84:87], v[24:27], v[36:39], v[84:87]
  s_waitcnt lgkmcnt(0)
  v_mfma_f32_16x16x32_bf16 v[88:91], v[28:31], v[32:35], v[88:91]
  v_mfma_f32_16x16x32_bf16 v[92:95], v[28:31], v[36:39], v[92:95]
  s_waitcnt vmcnt(12)
  s_barrier
  v_add_u32 v8, 98304, v6
  v_add_u32 v11, 98304, v7
  ds_read_b128 v[32:35], v11 offset:0
  ds_read_b128 v[36:39], v11 offset:4096
  v_xor_b32 v12, 0, v8
  ds_read_b64_tr_b16 v[16:17], v12
  ds_read_b64_tr_b16 v[18:19], v12 offset:512
  v_xor_b32 v13, 32, v8
  ds_read_b64_tr_b16 v[20:21], v13
  ds_read_b64_tr_b16 v[22:23], v13 offset:512
  v_xor_b32 v14, 64, v8
  ds_read_b64_tr_b16 v[24:25], v14
  ds_read_b64_tr_b16 v[26:27], v14 offset:512
  v_xor_b32 v15, 96, v8
  ds_read_b64_tr_b16 v[28:29], v15
  ds_read_b64_tr_b16 v[30:31], v15 offset:512
  s_add_u32 m0, s50, 65536
  s_mov_b32 s53, 442368
  buffer_load_dwordx4 v2, s[12:15], s53 offen lds
  s_add_u32 m0, s50, 66560
  s_mov_b32 s53, 442368
  buffer_load_dwordx4 v3, s[12:15], s53 offen lds
  s_add_u32 m0, s50, 81920
  s_mov_b32 s53, 7667968
  buffer_load_dwordx4 v4, s[12:15], s53 offen lds
  s_add_u32 m0, s50, 82944
  s_mov_b32 s53, 7667968
  buffer_load_dwordx4 v5, s[12:15], s53 offen lds
  s_waitcnt lgkmcnt(6)
  v_mfma_f32_16x16x32_bf16 v[64:67], v[16:19], v[32:35], v[64:67]
  v_mfma_f32_16x16x32_bf16 v[68:71], v[16:19], v[36:39], v[68:71]
  s_waitcnt lgkmcnt(4)
  v_mfma_f32_16x16x32_bf16 v[72:75], v[20:23], v[32:35], v[72:75]
  v_mfma_f32_16x16x32_bf16 v[76:79], v[20:23], v[36:39], v[76:79]
  s_waitcnt lgkmcnt(2)
  v_mfma_f32_16x16x32_bf16 v[80:83], v[24:27], v[32:35], v[80:83]
  v_mfma_f32_16x16x32_bf16 v[84:87], v[24:27], v[36:39], v[84:87]
  s_waitcnt lgkmcnt(0)
  v_mfma_f32_16x16x32_bf16 v[88:91], v[28:31], v[32:35], v[88:91]
  v_mfma_f32_16x16x32_bf16 v[92:95], v[28:31], v[36:39], v[92:95]
  s_waitcnt vmcnt(12)
  s_barrier
  v_add_u32 v8, 131072, v6
  v_add_u32 v11, 131072, v7
  ds_read_b128 v[32:35], v11 offset:0
  ds_read_b128 v[36:39], v11 offset:4096
  v_xor_b32 v12, 0, v8
  ds_read_b64_tr_b16 v[16:17], v12
  ds_read_b64_tr_b16 v[18:19], v12 offset:512
  v_xor_b32 v13, 32, v8
  ds_read_b64_tr_b16 v[20:21], v13
  ds_read_b64_tr_b16 v[22:23], v13 offset:512
  v_xor_b32 v14, 64, v8
  ds_read_b64_tr_b16 v[24:25], v14
  ds_read_b64_tr_b16 v[26:27], v14 offset:512
  v_xor_b32 v15, 96, v8
  ds_read_b64_tr_b16 v[28:29], v15
  ds_read_b64_tr_b16 v[30:31], v15 offset:512
  s_add_u32 m0, s50, 98304
  s_mov_b32 s53, 458752
  buffer_load_dwordx4 v2, s[12:15], s53 offen lds
  s_add_u32 m0, s50, 99328
  s_mov_b32 s53, 458752
  buffer_load_dwordx4 v3, s[12:15], s53 offen lds
  s_add_u32 m0, s50, 114688
  s_mov_b32 s53, 8257536
  buffer_load_dwordx4 v4, s[12:15], s53 offen lds
  s_add_u32 m0, s50, 115712
  s_mov_b32 s53, 8257536
  buffer_load_dwordx4 v5, s[12:15], s53 offen lds
  s_waitcnt lgkmcnt(6)
  v_mfma_f32_16x16x32_bf16 v[64:67], v[16:19], v[32:35], v[64:67]
  v_mfma_f32_16x16x32_bf16 v[68:71], v[16:19], v[36:39], v[68:71]
  s_waitcnt lgkmcnt(4)
  v_mfma_f32_16x16x32_bf16 v[72:75], v[20:23], v[32:35], v[72:75]
  v_mfma_f32_16x16x32_bf16 v[76:79], v[20:23], v[36:39], v[76:79]
  s_waitcnt lgkmcnt(2)
  v_mfma_f32_16x16x32_bf16 v[80:83], v[24:27], v[32:35], v[80:83]
  v_mfma_f32_16x16x32_bf16 v[84:87], v[24:27], v[36:39], v[84:87]
  s_waitcnt lgkmcnt(0)
  v_mfma_f32_16x16x32_bf16 v[88:91], v[28:31], v[32:35], v[88:91]
  v_mfma_f32_16x16x32_bf16 v[92:95], v[28:31], v[36:39], v[92:95]
  s_waitcnt vmcnt(12)
  s_barrier
  v_add_u32 v8, 0, v6
  v_add_u32 v11, 0, v7
  ds_read_b128 v[32:35], v11 offset:0
  ds_read_b128 v[36:39], v11 offset:4096
  v_xor_b32 v12, 0, v8
  ds_read_b64_tr_b16 v[16:17], v12
  ds_read_b64_tr_b16 v[18:19], v12 offset:512
  v_xor_b32 v13, 32, v8
  ds_read_b64_tr_b16 v[20:21], v13
  ds_read_b64_tr_b16 v[22:23], v13 offset:512
  v_xor_b32 v14, 64, v8
  ds_read_b64_tr_b16 v[24:25], v14
  ds_read_b64_tr_b16 v[26:27], v14 offset:512
  v_xor_b32 v15, 96, v8
  ds_read_b64_tr_b16 v[28:29], v15
  ds_read_b64_tr_b16 v[30:31], v15 offset:512
  s_add_u32 m0, s50, 131072
  s_mov_b32 s53, 475136
  buffer_load_dwordx4 v2, s[12:15], s53 offen lds
  s_add_u32 m0, s50, 132096
  s_mov_b32 s53, 475136
  buffer_load_dwordx4 v3, s[12:15], s53 offen lds
  s_add_u32 m0, s50, 147456
  s_mov_b32 s53, 8257792
  buffer_load_dwordx4 v4, s[12:15], s53 offen lds
  s_add_u32 m0, s50, 148480
  s_mov_b32 s53, 8257792
  buffer_load_dwordx4 v5, s[12:15], s53 offen lds
  s_waitcnt lgkmcnt(6)
  v_mfma_f32_16x16x32_bf16 v[64:67], v[16:19], v[32:35], v[64:67]
  v_mfma_f32_16x16x32_bf16 v[68:71], v[16:19], v[36:39], v[68:71]
  s_waitcnt lgkmcnt(4)
  v_mfma_f32_16x16x32_bf16 v[72:75], v[20:23], v[32:35], v[72:75]
  v_mfma_f32_16x16x32_bf16 v[76:79], v[20:23], v[36:39], v[76:79]
  s_waitcnt lgkmcnt(2)
  v_mfma_f32_16x16x32_bf16 v[80:83], v[24:27], v[32:35], v[80:83]
  v_mfma_f32_16x16x32_bf16 v[84:87], v[24:27], v[36:39], v[84:87]
  s_waitcnt lgkmcnt(0)
  v_mfma_f32_16x16x32_bf16 v[88:91], v[28:31], v[32:35], v[88:91]
  v_mfma_f32_16x16x32_bf16 v[92:95], v[28:31], v[36:39], v[92:95]
  s_waitcnt vmcnt(12)
  s_barrier
  v_add_u32 v8, 32768, v6
  v_add_u32 v11, 32768, v7
  ds_read_b128 v[32:35], v11 offset:0
  ds_read_b128 v[36:39], v11 offset:4096
  v_xor_b32 v12, 0, v8
  ds_read_b64_tr_b16 v[16:17], v12
  ds_read_b64_tr_b16 v[18:19], v12 offset:512
  v_xor_b32 v13, 32, v8
  ds_read_b64_tr_b16 v[20:21], v13
  ds_read_b64_tr_b16 v[22:23], v13 offset:512
  v_xor_b32 v14, 64, v8
  ds_read_b64_tr_b16 v[24:25], v14
  ds_read_b64_tr_b16 v[26:27], v14 offset:512
  v_xor_b32 v15, 96, v8
  ds_read_b64_tr_b16 v[28:29], v15
  ds_read_b64_tr_b16 v[30:31], v15 offset:512
  s_add_u32 m0, s50, 0
  s_mov_b32 s53, 491520
  buffer_load_dwordx4 v2, s[12:15], s53 offen lds
  s_add_u32 m0, s50, 1024
  s_mov_b32 s53, 491520
  buffer_load_dwordx4 v3, s[12:15], s53 offen lds
  s_add_u32 m0, s50, 16384
  s_mov_b32 s53, 8847360
  buffer_load_dwordx4 v4, s[12:15], s53 offen lds
  s_add_u32 m0, s50, 17408
  s_mov_b32 s53, 8847360
  buffer_load_dwordx4 v5, s[12:15], s53 offen lds
  s_waitcnt lgkmcnt(6)
  v_mfma_f32_16x16x32_bf16 v[64:67], v[16:19], v[32:35], v[64:67]
  v_mfma_f32_16x16x32_bf16 v[68:71], v[16:19], v[36:39], v[68:71]
  s_waitcnt lgkmcnt(4)
  v_mfma_f32_16x16x32_bf16 v[72:75], v[20:23], v[32:35], v[72:75]
  v_mfma_f32_16x16x32_bf16 v[76:79], v[20:23], v[36:39], v[76:79]
  s_waitcnt lgkmcnt(2)
  v_mfma_f32_16x16x32_bf16 v[80:83], v[24:27], v[32:35], v[80:83]
  v_mfma_f32_16x16x32_bf16 v[84:87], v[24:27], v[36:39], v[84:87]
  s_waitcnt lgkmcnt(0)
  v_mfma_f32_16x16x32_bf16 v[88:91], v[28:31], v[32:35], v[88:91]
  v_mfma_f32_16x16x32_bf16 v[92:95], v[28:31], v[36:39], v[92:95]
  s_waitcnt vmcnt(12)
  s_barrier
  v_add_u32 v8, 65536, v6
  v_add_u32 v11, 65536, v7
  ds_read_b128 v[32:35], v11 offset:0
  ds_read_b128 v[36:39], v11 offset:4096
  v_xor_b32 v12, 0, v8
  ds_read_b64_tr_b16 v[16:17], v12
  ds_read_b64_tr_b16 v[18:19], v12 offset:512
  v_xor_b32 v13, 32, v8
  ds_read_b64_tr_b16 v[20:21], v13
  ds_read_b64_tr_b16 v[22:23], v13 offset:512
  v_xor_b32 v14, 64, v8
  ds_read_b64_tr_b16 v[24:25], v14
  ds_read_b64_tr_b16 v[26:27], v14 offset:512
  v_xor_b32 v15, 96, v8
  ds_read_b64_tr_b16 v[28:29], v15
  ds_read_b64_tr_b16 v[30:31], v15 offset:512
  s_add_u32 m0, s50, 32768
  s_mov_b32 s53, 507904
  buffer_load_dwordx4 v2, s[12:15], s53 offen lds
  s_add_u32 m0, s50, 33792
  s_mov_b32 s53, 507904
  buffer_load_dwordx4 v3, s[12:15], s53 offen lds
  s_add_u32 m0, s50, 49152
  s_mov_b32 s53, 8847616
  buffer_load_dwordx4 v4, s[12:15], s53 offen lds
  s_add_u32 m0, s50, 50176
  s_mov_b32 s53, 8847616
  buffer_load_dwordx4 v5, s[12:15], s53 offen lds
  s_waitcnt lgkmcnt(6)
  v_mfma_f32_16x16x32_bf16 v[64:67], v[16:19], v[32:35], v[64:67]
  v_mfma_f32_16x16x32_bf16 v[68:71], v[16:19], v[36:39], v[68:71]
  s_waitcnt lgkmcnt(4)
  v_mfma_f32_16x16x32_bf16 v[72:75], v[20:23], v[32:35], v[72:75]
  v_mfma_f32_16x16x32_bf16 v[76:79], v[20:23], v[36:39], v[76:79]
  s_waitcnt lgkmcnt(2)
  v_mfma_f32_16x16x32_bf16 v[80:83], v[24:27], v[32:35], v[80:83]
  v_mfma_f32_16x16x32_bf16 v[84:87], v[24:27], v[36:39], v[84:87]
  s_waitcnt lgkmcnt(0)
  v_mfma_f32_16x16x32_bf16 v[88:91], v[28:31], v[32:35], v[88:91]
  v_mfma_f32_16x16x32_bf16 v[92:95], v[28:31], v[36:39], v[92:95]
  s_waitcnt vmcnt(12)
  s_barrier
  v_add_u32 v8, 98304, v6
  v_add_u32 v11, 98304, v7
  ds_read_b128 v[32:35], v11 offset:0
  ds_read_b128 v[36:39], v11 offset:4096
  v_xor_b32 v12, 0, v8
  ds_read_b64_tr_b16 v[16:17], v12
  ds_read_b64_tr_b16 v[18:19], v12 offset:512
  v_xor_b32 v13, 32, v8
  ds_read_b64_tr_b16 v[20:21], v13
  ds_read_b64_tr_b16 v[22:23], v13 offset:512
  v_xor_b32 v14, 64, v8
  ds_read_b64_tr_b16 v[24:25], v14
  ds_read_b64_tr_b16 v[26:27], v14 offset:512
  v_xor_b32 v15, 96, v8
  ds_read_b64_tr_b16 v[28:29], v15
  ds_read_b64_tr_b16 v[30:31], v15 offset:512
  s_waitcnt lgkmcnt(6)
  v_mfma_f32_16x16x32_bf16 v[64:67], v[16:19], v[32:35], v[64:67]
  v_mfma_f32_16x16x32_bf16 v[68:71], v[16:19], v[36:39], v[68:71]
  s_waitcnt lgkmcnt(4)
  v_mfma_f32_16x16x32_bf16 v[72:75], v[20:23], v[32:35], v[72:75]
  v_mfma_f32_16x16x32_bf16 v[76:79], v[20:23], v[36:39], v[76:79]
  s_waitcnt lgkmcnt(2)
  v_mfma_f32_16x16x32_bf16 v[80:83], v[24:27], v[32:35], v[80:83]
  v_mfma_f32_16x16x32_bf16 v[84:87], v[24:27], v[36:39], v[84:87]
  s_waitcnt lgkmcnt(0)
  v_mfma_f32_16x16x32_bf16 v[88:91], v[28:31], v[32:35], v[88:91]
  v_mfma_f32_16x16x32_bf16 v[92:95], v[28:31], v[36:39], v[92:95]
  s_waitcnt vmcnt(8)
  s_barrier
  v_add_u32 v8, 131072, v6
  v_add_u32 v11, 131072, v7
  ds_read_b128 v[32:35], v11 offset:0
  ds_read_b128 v[36:39], v11 offset:4096
  v_xor_b32 v12, 0, v8
  ds_read_b64_tr_b16 v[16:17], v12
  ds_read_b64_tr_b16 v[18:19], v12 offset:512
  v_xor_b32 v13, 32, v8
  ds_read_b64_tr_b16 v[20:21], v13
  ds_read_b64_tr_b16 v[22:23], v13 offset:512
  v_xor_b32 v14, 64, v8
  ds_read_b64_tr_b16 v[24:25], v14
  ds_read_b64_tr_b16 v[26:27], v14 offset:512
  v_xor_b32 v15, 96, v8
  ds_read_b64_tr_b16 v[28:29], v15
  ds_read_b64_tr_b16 v[30:31], v15 offset:512
  s_waitcnt lgkmcnt(6)
  v_mfma_f32_16x16x32_bf16 v[64:67], v[16:19], v[32:35], v[64:67]
  v_mfma_f32_16x16x32_bf16 v[68:71], v[16:19], v[36:39], v[68:71]
  s_waitcnt lgkmcnt(4)
  v_mfma_f32_16x16x32_bf16 v[72:75], v[20:23], v[32:35], v[72:75]
  v_mfma_f32_16x16x32_bf16 v[76:79], v[20:23], v[36:39], v[76:79]
  s_waitcnt lgkmcnt(2)
  v_mfma_f32_16x16x32_bf16 v[80:83], v[24:27], v[32:35], v[80:83]
  v_mfma_f32_16x16x32_bf16 v[84:87], v[24:27], v[36:39], v[84:87]
  s_waitcnt lgkmcnt(0)
  v_mfma_f32_16x16x32_bf16 v[88:91], v[28:31], v[32:35], v[88:91]
  v_mfma_f32_16x16x32_bf16 v[92:95], v[28:31], v[36:39], v[92:95]
  s_waitcnt vmcnt(4)
  s_barrier
  v_add_u32 v8, 0, v6
  v_add_u32 v11, 0, v7
  ds_read_b128 v[32:35], v11 offset:0
  ds_read_b128 v[36:39], v11 offset:4096
  v_xor_b32 v12, 0, v8
  ds_read_b64_tr_b16 v[16:17], v12
  ds_read_b64_tr_b16 v[18:19], v12 offset:512
  v_xor_b32 v13, 32, v8
  ds_read_b64_tr_b16 v[20:21], v13
  ds_read_b64_tr_b16 v[22:23], v13 offset:512
  v_xor_b32 v14, 64, v8
  ds_read_b64_tr_b16 v[24:25], v14
  ds_read_b64_tr_b16 v[26:27], v14 offset:512
  v_xor_b32 v15, 96, v8
  ds_read_b64_tr_b16 v[28:29], v15
  ds_read_b64_tr_b16 v[30:31], v15 offset:512
  s_waitcnt lgkmcnt(6)
  v_mfma_f32_16x16x32_bf16 v[64:67], v[16:19], v[32:35], v[64:67]
  v_mfma_f32_16x16x32_bf16 v[68:71], v[16:19], v[36:39], v[68:71]
  s_waitcnt lgkmcnt(4)
  v_mfma_f32_16x16x32_bf16 v[72:75], v[20:23], v[32:35], v[72:75]
  v_mfma_f32_16x16x32_bf16 v[76:79], v[20:23], v[36:39], v[76:79]
  s_waitcnt lgkmcnt(2)
  v_mfma_f32_16x16x32_bf16 v[80:83], v[24:27], v[32:35], v[80:83]
  v_mfma_f32_16x16x32_bf16 v[84:87], v[24:27], v[36:39], v[84:87]
  s_waitcnt lgkmcnt(0)
  v_mfma_f32_16x16x32_bf16 v[88:91], v[28:31], v[32:35], v[88:91]
  v_mfma_f32_16x16x32_bf16 v[92:95], v[28:31], v[36:39], v[92:95]
  s_waitcnt vmcnt(0)
  s_barrier
  v_add_u32 v8, 32768, v6
  v_add_u32 v11, 32768, v7
  ds_read_b128 v[32:35], v11 offset:0
  ds_read_b128 v[36:39], v11 offset:4096
  v_xor_b32 v12, 0, v8
  ds_read_b64_tr_b16 v[16:17], v12
  ds_read_b64_tr_b16 v[18:19], v12 offset:512
  v_xor_b32 v13, 32, v8
  ds_read_b64_tr_b16 v[20:21], v13
  ds_read_b64_tr_b16 v[22:23], v13 offset:512
  v_xor_b32 v14, 64, v8
  ds_read_b64_tr_b16 v[24:25], v14
  ds_read_b64_tr_b16 v[26:27], v14 offset:512
  v_xor_b32 v15, 96, v8
  ds_read_b64_tr_b16 v[28:29], v15
  ds_read_b64_tr_b16 v[30:31], v15 offset:512
  s_waitcnt lgkmcnt(6)
  v_mfma_f32_16x16x32_bf16 v[64:67], v[16:19], v[32:35], v[64:67]
  v_mfma_f32_16x16x32_bf16 v[68:71], v[16:19], v[36:39], v[68:71]
  s_waitcnt lgkmcnt(4)
  v_mfma_f32_16x16x32_bf16 v[72:75], v[20:23], v[32:35], v[72:75]
  v_mfma_f32_16x16x32_bf16 v[76:79], v[20:23], v[36:39], v[76:79]
  s_waitcnt lgkmcnt(2)
  v_mfma_f32_16x16x32_bf16 v[80:83], v[24:27], v[32:35], v[80:83]
  v_mfma_f32_16x16x32_bf16 v[84:87], v[24:27], v[36:39], v[84:87]
  s_waitcnt lgkmcnt(0)
  v_mfma_f32_16x16x32_bf16 v[88:91], v[28:31], v[32:35], v[88:91]
  v_mfma_f32_16x16x32_bf16 v[92:95], v[28:31], v[36:39], v[92:95]
  s_nop 7
  s_nop 1
  s_barrier
  v_lshlrev_b32 v5, 4, v1
  s_lshl_b32 s4, s3, 13
  v_add_u32 v5, s4, v5
  ds_write_b128 v5, v[64:67] offset:0
  ds_write_b128 v5, v[68:71] offset:1024
  ds_write_b128 v5, v[72:75] offset:2048
  ds_write_b128 v5, v[76:79] offset:3072
  ds_write_b128 v5, v[80:83] offset:4096
  ds_write_b128 v5, v[84:87] offset:5120
  ds_write_b128 v5, v[88:91] offset:6144
  ds_write_b128 v5, v[92:95] offset:7168
  s_waitcnt lgkmcnt(0)
  s_barrier
  v_lshlrev_b32 v5, 4, v1
  s_lshl_b32 s4, s41, 15
  s_lshl_b32 s5, s40, 11
  s_add_u32 s4, s4, s5
  v_add_u32 v5, s4, v5
  ds_read_b128 v[16:19], v5 offset:0
  ds_read_b128 v[20:23], v5 offset:8192
  ds_read_b128 v[24:27], v5 offset:16384
  ds_read_b128 v[28:31], v5 offset:24576
  ds_read_b128 v[32:35], v5 offset:1024
  ds_read_b128 v[36:39], v5 offset:9216
  ds_read_b128 v[40:43], v5 offset:17408
  ds_read_b128 v[44:47], v5 offset:25600
  s_waitcnt lgkmcnt(0)
  v_add_f32 v16, v16, v20
  v_add_f32 v17, v17, v21
  v_add_f32 v18, v18, v22
  v_add_f32 v19, v19, v23
  v_add_f32 v16, v16, v24
  v_add_f32 v17, v17, v25
  v_add_f32 v18, v18, v26
  v_add_f32 v19, v19, v27
  v_add_f32 v16, v16, v28
  v_add_f32 v17, v17, v29
  v_add_f32 v18, v18, v30
  v_add_f32 v19, v19, v31
  v_add_f32 v32, v32, v36
  v_add_f32 v33, v33, v37
  v_add_f32 v34, v34, v38
  v_add_f32 v35, v35, v39
  v_add_f32 v32, v32, v40
  v_add_f32 v33, v33, v41
  v_add_f32 v34, v34, v42
  v_add_f32 v35, v35, v43
  v_add_f32 v32, v32, v44
  v_add_f32 v33, v33, v45
  v_add_f32 v34, v34, v46
  v_add_f32 v35, v35, v47
  s_lshl_b32 s4, s41, 5
  s_lshl_b32 s5, s29, 6
  s_add_u32 s4, s4, s5
  v_add_u32 v9, s4, v9
  v_mul_u32_u24 v9, 1792, v9
  v_lshl_add_u32 v9, v10, 3, v9
  s_mul_i32 s4, s28, 896
  s_lshl_b32 s5, s30, 7
  s_add_u32 s4, s4, s5
  s_lshl_b32 s5, s40, 5
  s_add_u32 s4, s4, s5
  v_add_u32 v9, s4, v9
  v_cvt_pk_bf16_f32 v16, v16, v17
  v_cvt_pk_bf16_f32 v17, v18, v19
  s_mov_b32 s53, 0
  buffer_store_dwordx2 v[16:17], v9, s[16:19], s53 offen
  v_cvt_pk_bf16_f32 v32, v32, v33
  v_cvt_pk_bf16_f32 v33, v34, v35
  s_mov_b32 s53, 28672
  buffer_store_dwordx2 v[32:33], v9, s[16:19], s53 offen
L_k2_end:
  s_endpgm
.section .rodata,"a"
.p2align 6
.amdhsa_kernel attn_kernel
  .amdhsa_next_free_vgpr 480
  .amdhsa_next_free_sgpr 100
  .amdhsa_accum_offset 256
  .amdhsa_group_segment_fixed_size 0
  .amdhsa_kernarg_size 104
  .amdhsa_user_sgpr_count 2
  .amdhsa_user_sgpr_kernarg_segment_ptr 1
  .amdhsa_system_sgpr_workgroup_id_x 1
.end_amdhsa_kernel
.p2align 6
.amdhsa_kernel oproj_kernel
  .amdhsa_next_free_vgpr 96
  .amdhsa_next_free_sgpr 100
  .amdhsa_accum_offset 96
  .amdhsa_group_segment_fixed_size 0
  .amdhsa_kernarg_size 104
  .amdhsa_user_sgpr_count 2
  .amdhsa_user_sgpr_kernarg_segment_ptr 1
  .amdhsa_system_sgpr_workgroup_id_x 1
.end_amdhsa_kernel
```
